```python
import torch

def _softmax(x, axis=-1):
    return torch.softmax(x, dim=axis)
def _gelu(x):
    return torch.nn.functional.gelu(x, approximate="tanh")
def _silu(x):
    return torch.nn.functional.silu(x)
def _sigmoid(x):
    return torch.sigmoid(x)
def _layernorm(x, axis=-1, eps=1e-5):
    m = x.mean(dim=axis, keepdim=True)
    v = x.var(dim=axis, keepdim=True, unbiased=False)
    return (x - m) / torch.sqrt(v + eps)
def _scatter_add(tgt, idx, src, axis=0):
    return tgt.clone().index_add_(axis, idx, src)
def _segment_sum(src, seg, n):
    out = torch.zeros((n,) + src.shape[1:], dtype=src.dtype)
    return out.index_add_(0, seg, src)
def _pad(x, pw):
    flat = tuple(v for pair in reversed(pw) for v in pair)
    return torch.nn.functional.pad(x, flat)

kernel_name = 'concat_heads__compressed_kv_cla__grouped_kv_mqa__prompt'

def setup_inputs():

    _w = (lambda a: (lambda t: t.to(torch.bfloat16) if t.is_floating_point() else t)(torch.as_tensor(a)))
    def _A_setup():
        B, H, Sq, Sk, D, M = 1, 32, 2048, 2048, 128, 640
        Dc = 4 * D
        return {
            "x": _w((lambda *s: torch.randn(*s, dtype=torch.bfloat16) * 0.4)(B, Sq, M)),
            "c_kv": _w((lambda *s: torch.randn(*s, dtype=torch.bfloat16) * 1.6)(B, Sk, Dc)),
            "w_q": _w((lambda *s: torch.randn(*s, dtype=torch.bfloat16) * 3.2)(M, H, D) * (M ** -0.5)),
            "w_uk": _w((lambda *s: torch.randn(*s, dtype=torch.bfloat16) * 3.2)(Dc, H, D) * (Dc ** -0.5)),
            "w_uv": _w((lambda *s: torch.randn(*s, dtype=torch.bfloat16) * 1.6)(Dc, H, D) * (Dc ** -0.5)),
            "w_o": _w((lambda *s: torch.randn(*s, dtype=torch.bfloat16) * 1.6)(H, D, M) * ((H * D) ** -0.5)),
        }
    _A_in = _A_setup()

    def _B_setup():
        B, S, D, H = 1, 2048, 640, 32
        Dh = D // H
        return {
            "x": _w((lambda *s: torch.randn(*s, dtype=torch.bfloat16) * 0.1)(B, S, D)),
            "wq": _w((lambda *s: torch.randn(*s, dtype=torch.bfloat16) * 0.8)(D, H * Dh)),
            "wk": _w((lambda *s: torch.randn(*s, dtype=torch.bfloat16) * 0.8)(D, Dh)),
            "wv": _w((lambda *s: torch.randn(*s, dtype=torch.bfloat16) * 0.4)(D, Dh)),
            "wo": _w((lambda *s: torch.randn(*s, dtype=torch.bfloat16) * 0.4)(H * Dh, D)),
        }
    _B_in = _B_setup()

    return {
        "A_x": _A_in["x"],
        "A_c_kv": _A_in["c_kv"],
        "A_w_q": _A_in["w_q"],
        "A_w_uk": _A_in["w_uk"],
        "A_w_uv": _A_in["w_uv"],
        "A_w_o": _A_in["w_o"],
        "B_x": _B_in["x"],
        "B_wq": _B_in["wq"],
        "B_wk": _B_in["wk"],
        "B_wv": _B_in["wv"],
        "B_wo": _B_in["wo"],
    }

def reference(A_x, A_c_kv, A_w_q, A_w_uk, A_w_uv, A_w_o, B_x, B_wq, B_wk, B_wv, B_wo):
    def _A_ref(x, c_kv, w_q, w_uk, w_uv, w_o):
        B, Sq, M = x.shape[0], x.shape[1], x.shape[2]
        Sk = c_kv.shape[1]
        H, D = w_q.shape[1], w_q.shape[2]
        q = torch.einsum("bqm,mhd->bhqd", x, w_q)
        k = torch.einsum("bkc,chd->bhkd", c_kv, w_uk)
        v = torch.einsum("bkc,chd->bhkd", c_kv, w_uv)
        scores = torch.einsum("bhqd,bhkd->bhqk", q, k) * (D ** -0.5)
        off = Sk - Sq
        qi = torch.arange(Sq)[:, None]
        kj = torch.arange(Sk)[None, :]
        cmask = kj <= (qi + off)
        scores = torch.where(cmask[None, None], scores, -1e9)
        p = _softmax(scores, axis=-1)
        ctx = torch.einsum("bhqk,bhkd->bhqd", p, v)
        return torch.einsum("bhqd,hdm->bqm", ctx, w_o)

    def _B_ref(x, wq, wk, wv, wo):
        B, S, D = x.shape
        H = 32
        Dh = D // H
        q = (lambda x, *d: x.permute(*d))((x @ wq).reshape(B, S, H, Dh), 0, 2, 1, 3)
        k = x @ wk
        v = x @ wv
        scores = torch.einsum("bhqd,bkd->bhqk", q, k) * (Dh ** -0.5)
        p = _softmax(scores, axis=-1)
        o = torch.einsum("bhqk,bkd->bhqd", p, v)
        return (lambda x, *d: x.permute(*d))(o, 0, 2, 1, 3).reshape(B, S, H * Dh) @ wo

    a = _A_ref(A_x, A_c_kv, A_w_q, A_w_uk, A_w_uv, A_w_o)
    b = _B_ref(B_x, B_wq, B_wk, B_wv, B_wo)
    return torch.concatenate([a, b], axis=-1)
```

```asm
; @launch grid=(256,1,1) block=(256,1,1) lds=163840
.amdgcn_target "amdgcn-amd-amdhsa--gfx950"
.text
.globl concat_heads__compressed_kv_cla__grouped_kv_mqa__prompt_kernel
.p2align 8
.type concat_heads__compressed_kv_cla__grouped_kv_mqa__prompt_kernel,@function
concat_heads__compressed_kv_cla__grouped_kv_mqa__prompt_kernel:
  s_cmp_ge_u32 s2, 256
  s_cbranch_scc1 L_end
  s_load_dwordx4 s[56:59], s[0:1], 0
  s_load_dwordx2 s[42:43], s[0:1], 16
  s_load_dwordx4 s[44:47], s[0:1], 24
  s_load_dwordx4 s[4:7], s[0:1], 96
  s_getpc_b64 s[48:49]
L_pc:
  s_lshr_b32 s31, s2, 3
  s_and_b32 s31, s31, 3
  s_lshl_b32 s31, s31, 15
  v_lshlrev_b32 v3, 7, v0
  v_add_u32 v3, s31, v3
  v_min_u32 v3, L_end-L_pc, v3
  global_load_dword v202, v3, s[48:49]
  v_lshrrev_b32 v1, 6, v0
  v_and_b32 v2, 63, v0
  v_readfirstlane_b32 s30, v1
  s_and_b32 s28, s2, 7
  s_lshl_b32 s28, s28, 2
  s_lshr_b32 s31, s2, 3
  s_and_b32 s31, s31, 3
  s_add_u32 s28, s28, s31
  s_lshr_b32 s29, s2, 5
  s_or_b32 s31, s2, s30
  s_cbranch_scc1 L_notag
  s_memrealtime s[40:41]
  v_mov_b32 v61, 0
  s_waitcnt lgkmcnt(0)
  s_and_b32 s31, s40, 0xfffffff0
  s_or_b32 s31, s31, 8
  s_getreg_b32 s40, hwreg(HW_REG_XCC_ID, 0, 3)
  s_or_b32 s31, s31, s40
  s_mov_b32 s24, s4
  s_and_b32 s25, s5, 0xffff
  s_mov_b32 s26, 256
  s_mov_b32 s27, 0x20000
  v_mov_b32 v60, s31
  s_mov_b64 exec, 1
  buffer_store_dword v60, v61, s[24:27], 0 offen sc1
  s_mov_b64 exec, -1
L_notag:
  s_cmp_eq_u32 s29, 4
  s_cbranch_scc1 L_jobG
L_main:
  s_load_dwordx2 s[50:51], s[0:1], 48
  s_load_dwordx2 s[52:53], s[0:1], 56
  s_load_dwordx2 s[68:69], s[0:1], 40
  s_load_dwordx4 s[96:99], s[0:1], 80
  v_lshrrev_b32 v3, 3, v2
  v_and_b32 v4, 7, v2
  v_lshrrev_b32 v5, 4, v2
  s_lshl_b32 s31, s30, 16
  v_lshlrev_b32 v3, 10, v3
  v_add_u32 v3, s31, v3
  v_xor_b32 v6, v4, v5
  v_lshlrev_b32 v6, 4, v6
  v_xor_b32 v7, 64, v6
  v_add_u32 v8, v3, v6
  v_add_u32 v9, v3, v7
  v_add_u32 v9, 7168, v9
  v_add_u32 v10, v3, v6
  v_add_u32 v10, 14336, v10
  v_add_u32 v11, v3, v7
  v_add_u32 v11, 21504, v11
  v_and_b32 v4, 15, v2
  s_lshl_b32 s31, s30, 17
  v_lshlrev_b32 v3, 13, v5
  v_add_u32 v3, s31, v3
  v_lshlrev_b32 v6, 1, v5
  v_xor_b32 v6, v4, v6
  v_lshlrev_b32 v6, 4, v6
  v_xor_b32 v7, 128, v6
  v_add_u32 v12, v3, v6
  v_add_u32 v13, v3, v6
  v_add_u32 v13, 31744, v13
  v_add_u32 v14, v3, v7
  v_add_u32 v14, 63488, v14
  v_add_u32 v15, v3, v7
  v_add_u32 v15, 95232, v15
  s_lshl_b32 s36, s30, 13
  s_add_u32 s35, s36, 4096
  s_lshl_b32 s39, s30, 12
  s_add_u32 s38, s39, 49152
  s_add_u32 s37, s39, 32768
  s_waitcnt lgkmcnt(0)
  s_lshl_b32 s31, s29, 18
  s_add_u32 s12, s58, s31
  s_addc_u32 s13, s59, 0
  s_and_b32 s13, s13, 0xffff
  s_sub_u32 s14, 2097152, s31
  s_mov_b32 s15, 0x20000
  s_lshl_b32 s3, s28, 8
  s_add_u32 s16, s44, s3
  s_addc_u32 s17, s45, 0
  s_and_b32 s17, s17, 0xffff
  s_sub_u32 s18, 4194304, s3
  s_mov_b32 s19, 0x20000
  s_add_u32 s20, s46, s3
  s_addc_u32 s21, s47, 0
  s_and_b32 s21, s21, 0xffff
  s_sub_u32 s22, 4194304, s3
  s_mov_b32 s23, 0x20000
  s_mov_b32 s32, 0
  s_mov_b32 s33, 32768
  s_mov_b32 s34, 0
  s_add_u32 m0, s36, 0
  s_nop 0
  buffer_load_dwordx4 v8, s[12:15], s32 offen offset:0 lds
  buffer_load_dwordx4 v9, s[12:15], s32 offen offset:1024 lds
  buffer_load_dwordx4 v10, s[12:15], s32 offen offset:2048 lds
  buffer_load_dwordx4 v11, s[12:15], s32 offen offset:3072 lds
  s_add_u32 m0, s35, 0
  s_nop 0
  buffer_load_dwordx4 v8, s[12:15], s33 offen offset:0 lds
  buffer_load_dwordx4 v9, s[12:15], s33 offen offset:1024 lds
  buffer_load_dwordx4 v10, s[12:15], s33 offen offset:2048 lds
  buffer_load_dwordx4 v11, s[12:15], s33 offen offset:3072 lds
  s_add_u32 m0, s37, 0
  s_nop 0
  buffer_load_dwordx4 v12, s[16:19], s34 offen offset:0 lds
  buffer_load_dwordx4 v13, s[16:19], s34 offen offset:1024 lds
  buffer_load_dwordx4 v14, s[16:19], s34 offen offset:2048 lds
  buffer_load_dwordx4 v15, s[16:19], s34 offen offset:3072 lds
  s_add_u32 m0, s38, 0
  s_nop 0
  buffer_load_dwordx4 v12, s[20:23], s34 offen offset:0 lds
  buffer_load_dwordx4 v13, s[20:23], s34 offen offset:1024 lds
  buffer_load_dwordx4 v14, s[20:23], s34 offen offset:2048 lds
  buffer_load_dwordx4 v15, s[20:23], s34 offen offset:3072 lds
  s_add_u32 s32, s32, 128
  s_add_u32 s33, s33, 128
  s_add_u32 s34, s34, 524288
  s_cmp_eq_u32 s29, 4
  s_cbranch_scc1 L_jobG_out
L_jobG_ret:
  s_lshl_b32 s31, s29, 8
  s_lshl_b32 s41, s28, 3
  s_add_u32 s31, s31, s41
  s_lshl_b32 s41, s30, 1
  s_add_u32 s31, s31, s41
  v_and_b32 v7, 1, v2
  v_lshlrev_b32 v6, 7, v7
  v_add_u32 v3, s31, v7
  v_lshlrev_b32 v3, 10, v3
  s_mov_b32 exec_lo, 0xffff
  s_mov_b32 exec_hi, 0x0
  v_mov_b32 v193, s59
  v_add_co_u32 v192, vcc, s58, v3
  v_mov_b32 v194, 128
  v_mov_b32 v195, 128
  v_addc_co_u32 v193, vcc, 0, v193, vcc
  v_mov_b32 v196, 896
  s_mov_b64 exec, -1
  s_add_u32 m0, s36, 65536
  s_nop 0
  buffer_load_dwordx4 v8, s[12:15], s32 offen offset:0 lds
  v_bfe_u32 v3, v2, 1, 1
  v_add_u32 v3, s31, v3
  buffer_load_dwordx4 v9, s[12:15], s32 offen offset:1024 lds
  v_mul_u32_u24 v3, 1280, v3
  v_add_u32 v3, v3, v6
  s_mov_b32 exec_lo, 0x0
  s_mov_b32 exec_hi, 0xffff
  v_mov_b32 v193, s57
  v_add_co_u32 v192, vcc, s56, v3
  v_mov_b32 v194, 4294966528
  v_mov_b32 v195, 256
  v_addc_co_u32 v193, vcc, 0, v193, vcc
  v_mov_b32 v196, 1024
  s_mov_b64 exec, -1
  buffer_load_dwordx4 v10, s[12:15], s32 offen offset:2048 lds
  s_cmp_eq_u32 s29, 5
  s_cselect_b32 s40, 4, s29
  v_mov_b32 v7, s29
  v_mov_b32 v1, s40
  v_and_b32 v3, 4, v2
  v_cmp_eq_u32 vcc, 0, v3
  s_nop 1
  v_cndmask_b32 v3, v1, v7, vcc
  v_lshlrev_b32 v3, 3, v3
  buffer_load_dwordx4 v11, s[12:15], s32 offen offset:3072 lds
  v_bfe_u32 v31, v2, 1, 1
  v_add3_u32 v3, v3, v31, s41
  v_lshlrev_b32 v3, 13, v3
  v_add3_u32 v3, v3, v6, s3
  s_mov_b32 exec_lo, 0xff0000
  s_mov_b32 exec_hi, 0x0
  v_mov_b32 v193, s45
  v_add_co_u32 v192, vcc, s44, v3
  v_mov_b32 v194, 524288
  v_mov_b32 v195, 524288
  v_addc_co_u32 v193, vcc, 0, v193, vcc
  v_mov_b32 v196, 3670016
  s_mov_b32 exec_lo, 0xff000000
  s_mov_b32 exec_hi, 0x0
  v_mov_b32 v193, s47
  v_add_co_u32 v192, vcc, s46, v3
  v_mov_b32 v194, 524288
  v_mov_b32 v195, 524288
  v_addc_co_u32 v193, vcc, 0, v193, vcc
  v_mov_b32 v196, 3670016
  s_mov_b64 exec, -1
  s_add_u32 m0, s35, 65536
  s_nop 0
  buffer_load_dwordx4 v8, s[12:15], s33 offen offset:0 lds
  v_and_b32 v3, 8, v2
  v_cmp_eq_u32 vcc, 0, v3
  s_mul_i32 s40, s30, 20
  s_nop 0
  v_cndmask_b32 v3, v1, v7, vcc
  v_mul_u32_u24 v3, 80, v3
  v_bfe_u32 v31, v2, 1, 2
  v_add3_u32 v3, v3, v31, s40
  v_lshlrev_b32 v3, 13, v3
  buffer_load_dwordx4 v9, s[12:15], s33 offen offset:1024 lds
  v_add3_u32 v3, v3, v6, s3
  s_mov_b32 exec_lo, 0x0
  s_mov_b32 exec_hi, 0xffff0000
  v_mov_b32 v193, s43
  v_add_co_u32 v192, vcc, s42, v3
  v_mov_b32 v194, 4294868992
  v_mov_b32 v195, 32768
  v_addc_co_u32 v193, vcc, 0, v193, vcc
  v_mov_b32 v196, 131072
  v_mov_b32 v3, 0
  s_mov_b64 exec, -1
  buffer_load_dwordx4 v10, s[12:15], s33 offen offset:2048 lds
  v_mov_b32 v3, 0
  s_mov_b32 exec_lo, 0x0
  s_mov_b32 exec_hi, 0x8000
  v_mov_b32 v193, s5
  v_add_co_u32 v192, vcc, s4, v3
  v_mov_b32 v194, 0
  v_mov_b32 v195, 0
  v_addc_co_u32 v193, vcc, 0, v193, vcc
  v_mov_b32 v196, 0
  s_mov_b64 exec, -1
  buffer_load_dwordx4 v11, s[12:15], s33 offen offset:3072 lds
  s_lshl_b32 s40, s2, 2
  s_add_u32 s40, s40, s30
  s_lshl_b32 s41, s40, 1
  v_bfe_u32 v3, v2, 2, 1
  v_xor_b32 v3, 1, v3
  v_add_u32 v3, s41, v3
  v_mul_u32_u24 v3, 1280, v3
  v_and_b32 v7, 3, v2
  v_lshlrev_b32 v7, 7, v7
  s_add_u32 m0, s37, 65536
  s_nop 0
  buffer_load_dwordx4 v12, s[16:19], s34 offen offset:0 lds
  v_add_u32 v3, v3, v7
  v_sub_u32 v7, 1152, v7
  s_mov_b32 exec_lo, 0x0
  s_mov_b32 exec_hi, 0xff0
  v_mov_b32 v193, s51
  v_add_co_u32 v192, vcc, s50, v3
  v_mov_b32 v194, 4294966784
  v_mov_b32 v195, 512
  v_addc_co_u32 v193, vcc, 0, v193, vcc
  v_mov_b32 v196, 0
  v_mov_b32 v196, v7
  s_mov_b64 exec, -1
  buffer_load_dwordx4 v13, s[16:19], s34 offen offset:1024 lds
  s_mul_i32 s40, s40, 3
  v_subrev_u32 v3, 44, v2
  v_add_u32 v3, s40, v3
  v_min_u32 v3, 2132, v3
  v_lshlrev_b32 v3, 7, v3
  s_mov_b32 exec_lo, 0x0
  s_mov_b32 exec_hi, 0x7000
  v_mov_b32 v193, s53
  v_add_co_u32 v192, vcc, s52, v3
  v_mov_b32 v194, 4294694272
  v_mov_b32 v195, 273024
  v_addc_co_u32 v193, vcc, 0, v193, vcc
  v_mov_b32 v196, 546048
  s_mov_b64 exec, -1
  buffer_load_dwordx4 v14, s[16:19], s34 offen offset:2048 lds
  v_add_u32 v194, v194, v195
  v_med3_i32 v197, v194, 0, v196
  v_add_co_u32 v198, vcc, v192, v197
  s_nop 1
  buffer_load_dwordx4 v15, s[16:19], s34 offen offset:3072 lds
  v_addc_co_u32 v199, vcc, 0, v193, vcc
  s_and_b32 s40, s30, 1
  s_lshr_b32 s41, s30, 1
  s_lshl_b32 s31, s40, 13
  v_lshlrev_b32 v3, 7, v4
  v_add_u32 v3, s31, v3
  v_lshrrev_b32 v6, 1, v4
  v_xor_b32 v6, v5, v6
  v_lshlrev_b32 v28, 4, v6
  v_add_u32 v16, v3, v28
  s_add_u32 m0, s38, 65536
  s_nop 0
  buffer_load_dwordx4 v12, s[20:23], s34 offen offset:0 lds
  v_xor_b32 v17, 64, v16
  v_add_u32 v18, 0x10000, v16
  v_add_u32 v19, 0x10000, v17
  v_lshrrev_b32 v3, 2, v2
  v_and_b32 v3, 3, v3
  v_and_b32 v6, 1, v5
  v_lshlrev_b32 v6, 2, v6
  v_or_b32 v6, v6, v3
  v_lshlrev_b32 v7, 3, v5
  v_add_u32 v7, v7, v3
  buffer_load_dwordx4 v13, s[20:23], s34 offen offset:1024 lds
  v_lshlrev_b32 v7, 8, v7
  v_and_b32 v3, 3, v2
  v_lshlrev_b32 v3, 3, v3
  v_add_u32 v29, v7, v3
  v_lshlrev_b32 v30, 5, v6
  s_lshl_b32 s31, s41, 7
  v_xor_b32 v6, s31, v30
  v_add_u32 v7, 32768, v29
  v_xor_b32 v3, 0, v6
  v_add_u32 v20, v7, v3
  buffer_load_dwordx4 v14, s[20:23], s34 offen offset:2048 lds
  v_add_u32 v24, 0x10000, v20
  v_xor_b32 v3, 32, v6
  v_add_u32 v21, v7, v3
  v_add_u32 v25, 0x10000, v21
  v_xor_b32 v3, 64, v6
  v_add_u32 v22, v7, v3
  v_add_u32 v26, 0x10000, v22
  v_xor_b32 v3, 96, v6
  v_add_u32 v23, v7, v3
  v_add_u32 v27, 0x10000, v23
  buffer_load_dwordx4 v15, s[20:23], s34 offen offset:3072 lds
  s_add_u32 s32, s32, 128
  s_add_u32 s33, s33, 128
  s_add_u32 s34, s34, 524288
  global_load_dword v200, v[198:199], off sc1
  s_mov_b32 s46, 0
  s_cmp_eq_u32 s29, 4
  s_cbranch_scc1 L_first6
  s_waitcnt vmcnt(17)
  s_barrier
L_first:
  ds_read_b128 v[64:67], v16 offset:0
  ds_read_b64_tr_b16 v[96:97], v20 offset:0
  ds_read_b64_tr_b16 v[98:99], v20 offset:1024
  ds_read_b128 v[68:71], v16 offset:2048
  ds_read_b64_tr_b16 v[100:101], v21 offset:0
  ds_read_b64_tr_b16 v[102:103], v21 offset:1024
  ds_read_b128 v[72:75], v16 offset:4096
  ds_read_b64_tr_b16 v[104:105], v22 offset:0
  ds_read_b64_tr_b16 v[106:107], v22 offset:1024
  ds_read_b128 v[76:79], v16 offset:6144
  ds_read_b64_tr_b16 v[108:109], v23 offset:0
  ds_read_b64_tr_b16 v[110:111], v23 offset:1024
  ds_read_b128 v[80:83], v16 offset:16384
  ds_read_b64_tr_b16 v[112:113], v20 offset:16384
  ds_read_b64_tr_b16 v[114:115], v20 offset:17408
  ds_read_b128 v[84:87], v16 offset:18432
  ds_read_b64_tr_b16 v[116:117], v21 offset:16384
  ds_read_b64_tr_b16 v[118:119], v21 offset:17408
  ds_read_b128 v[88:91], v16 offset:20480
  ds_read_b64_tr_b16 v[120:121], v22 offset:16384
  ds_read_b64_tr_b16 v[122:123], v22 offset:17408
  ds_read_b128 v[92:95], v16 offset:22528
  ds_read_b64_tr_b16 v[124:125], v23 offset:16384
  ds_read_b64_tr_b16 v[126:127], v23 offset:17408
  s_mov_b32 s45, 0
  s_waitcnt lgkmcnt(15)
  v_mfma_f32_16x16x32_bf16 a[0:3], v[96:99], v[64:67], 0
  s_add_u32 s24, s6, 66060288
  s_addc_u32 s25, s7, 0
  ds_read_b128 v[128:131], v17 offset:0
  v_mfma_f32_16x16x32_bf16 a[4:7], v[96:99], v[68:71], 0
  s_and_b32 s25, s25, 0xffff
  s_mov_b32 s26, 65536
  s_mov_b32 s27, 0x20000
  v_mfma_f32_16x16x32_bf16 a[32:35], v[100:103], v[64:67], 0
  s_lshl_b32 s31, s28, 7
  ds_read_b64_tr_b16 v[160:161], v20 offset:8192
  v_and_b32 v3, 7, v2
  v_mfma_f32_16x16x32_bf16 a[36:39], v[100:103], v[68:71], 0
  v_add_u32 v194, v194, v195
  v_lshlrev_b32 v3, 2, v3
  v_mfma_f32_16x16x32_bf16 a[8:11], v[96:99], v[72:75], 0
  ds_read_b64_tr_b16 v[162:163], v20 offset:9216
  v_add_u32 v57, s31, v3
  v_mfma_f32_16x16x32_bf16 a[40:43], v[100:103], v[72:75], 0
  s_mul_i32 s31, s29, 327680
  s_add_u32 s64, s56, s31
  s_addc_u32 s65, s57, 0
  v_mfma_f32_16x16x32_bf16 a[64:67], v[104:107], v[64:67], 0
  s_and_b32 s65, s65, 0xffff
  s_sub_u32 s66, 2621440, s31
  ds_read_b128 v[132:135], v17 offset:2048
  v_mfma_f32_16x16x32_bf16 a[68:71], v[104:107], v[68:71], 0
  s_mov_b32 s67, 0x20000
  s_add_u32 s60, s42, s3
  v_med3_i32 v197, v194, 0, v196
  v_mfma_f32_16x16x32_bf16 a[72:75], v[104:107], v[72:75], 0
  s_addc_u32 s61, s43, 0
  s_and_b32 s61, s61, 0xffff
  ds_read_b64_tr_b16 v[164:165], v21 offset:8192
  s_waitcnt lgkmcnt(4)
  v_mfma_f32_16x16x32_bf16 a[12:15], v[96:99], v[76:79], 0
  s_sub_u32 s62, 5242880, s3
  s_mov_b32 s63, 0x20000
  s_lshl_b32 s31, s28, 20
  v_mfma_f32_16x16x32_bf16 a[44:47], v[100:103], v[76:79], 0
  s_add_u32 s8, s6, s31
  s_addc_u32 s9, s7, 0
  ds_read_b64_tr_b16 v[166:167], v21 offset:9216
  v_mfma_f32_16x16x32_bf16 a[76:79], v[104:107], v[76:79], 0
  s_and_b32 s9, s9, 0xffff
  s_sub_u32 s10, 33554432, s31
  v_add_co_u32 v198, vcc, v192, v197
  v_mfma_f32_16x16x32_bf16 a[96:99], v[108:111], v[64:67], 0
  s_mov_b32 s11, 0x20000
  ds_read_b128 v[136:139], v17 offset:4096
  v_add_u32 v29, 98304, v29
  v_mfma_f32_16x16x32_bf16 a[100:103], v[108:111], v[68:71], 0
  v_xor_b32 v3, 0, v30
  v_add_u32 v48, v29, v3
  v_mfma_f32_16x16x32_bf16 a[104:107], v[108:111], v[72:75], 0
  ds_read_b64_tr_b16 v[168:169], v22 offset:8192
  v_xor_b32 v3, 32, v30
  v_mfma_f32_16x16x32_bf16 a[108:111], v[108:111], v[76:79], 0
  v_addc_co_u32 v199, vcc, 0, v193, vcc
  v_add_u32 v49, v29, v3
  v_mfma_f32_16x16x32_bf16 a[16:19], v[96:99], v[80:83], 0
  ds_read_b64_tr_b16 v[170:171], v22 offset:9216
  v_xor_b32 v3, 64, v30
  v_mfma_f32_16x16x32_bf16 a[48:51], v[100:103], v[80:83], 0
  v_add_u32 v50, v29, v3
  v_xor_b32 v3, 96, v30
  v_mfma_f32_16x16x32_bf16 a[80:83], v[104:107], v[80:83], 0
  ds_read_b128 v[140:143], v17 offset:6144
  v_add_u32 v51, v29, v3
  v_mfma_f32_16x16x32_bf16 a[112:115], v[108:111], v[80:83], 0
  v_xor_b32 v3, 128, v30
  v_add_u32 v52, v29, v3
  v_mfma_f32_16x16x32_bf16 a[128:131], v[64:67], v[112:115], 0
  ds_read_b64_tr_b16 v[172:173], v23 offset:8192
  v_xor_b32 v3, 160, v30
  v_mfma_f32_16x16x32_bf16 a[132:135], v[68:71], v[112:115], 0
  v_add_u32 v53, v29, v3
  v_xor_b32 v3, 192, v30
  v_mfma_f32_16x16x32_bf16 a[136:139], v[72:75], v[112:115], 0
  ds_read_b64_tr_b16 v[174:175], v23 offset:9216
  v_add_u32 v54, v29, v3
  v_mfma_f32_16x16x32_bf16 a[140:143], v[76:79], v[112:115], 0
  v_xor_b32 v3, 224, v30
  v_add_u32 v55, v29, v3
  v_mfma_f32_16x16x32_bf16 a[144:147], v[80:83], v[112:115], 0
  ds_read_b128 v[144:147], v17 offset:16384
  v_lshrrev_b32 v3, 3, v2
  v_mfma_f32_16x16x32_bf16 a[20:23], v[96:99], v[84:87], 0
  v_and_b32 v6, 7, v2
  v_mfma_f32_16x16x32_bf16 a[52:55], v[100:103], v[84:87], 0
  s_mul_i32 s31, s30, 81920
  ds_read_b64_tr_b16 v[176:177], v20 offset:24576
  v_mul_u32_u24 v3, 1280, v3
  v_mfma_f32_16x16x32_bf16 a[84:87], v[104:107], v[84:87], 0
  v_add_u32 v3, s31, v3
  v_xor_b32 v6, v6, v5
  v_mfma_f32_16x16x32_bf16 a[116:119], v[108:111], v[84:87], 0
  ds_read_b64_tr_b16 v[178:179], v20 offset:25600
  v_lshlrev_b32 v6, 4, v6
  v_mfma_f32_16x16x32_bf16 a[148:151], v[84:87], v[112:115], 0
  v_add_u32 v40, v3, v6
  v_xor_b32 v6, 64, v6
  v_mfma_f32_16x16x32_bf16 a[160:163], v[64:67], v[116:119], 0
  ds_read_b128 v[148:151], v17 offset:18432
  v_add_u32 v41, v3, v6
  v_mfma_f32_16x16x32_bf16 a[164:167], v[68:71], v[116:119], 0
  v_add_u32 v41, 9216, v41
  v_mov_b32 v42, v12
  v_mfma_f32_16x16x32_bf16 a[168:171], v[72:75], v[116:119], 0
  ds_read_b64_tr_b16 v[180:181], v21 offset:24576
  v_subrev_u32 v43, 63488, v14
  v_mfma_f32_16x16x32_bf16 a[172:175], v[76:79], v[116:119], 0
  v_lshlrev_b32 v3, 7, v4
  v_add_u32 v3, v3, v28
  v_mfma_f32_16x16x32_bf16 a[176:179], v[80:83], v[116:119], 0
  s_lshl_b32 s31, s30, 11
  ds_read_b64_tr_b16 v[182:183], v21 offset:25600
  v_add_u32 v44, s31, v3
  v_mfma_f32_16x16x32_bf16 a[180:183], v[84:87], v[116:119], 0
  v_xor_b32 v45, 64, v44
  v_mfma_f32_16x16x32_bf16 a[24:27], v[96:99], v[88:91], 0
  s_sub_u32 s31, 14336, s31
  ds_read_b128 v[152:155], v17 offset:20480
  v_add_u32 v46, s31, v3
  v_mfma_f32_16x16x32_bf16 a[56:59], v[100:103], v[88:91], 0
  v_xor_b32 v47, 64, v46
  v_lshlrev_b32 v56, 4, v2
  v_mfma_f32_16x16x32_bf16 a[88:91], v[104:107], v[88:91], 0
  s_lshl_b32 s31, s41, 11
  s_lshl_b32 s43, s40, 15
  ds_read_b64_tr_b16 v[184:185], v22 offset:24576
  v_mfma_f32_16x16x32_bf16 a[120:123], v[108:111], v[88:91], 0
  s_add_u32 s43, s43, s31
  s_add_u32 s31, s43, 32768
  v_add_u32 v58, s31, v56
  v_mfma_f32_16x16x32_bf16 a[152:155], v[88:91], v[112:115], 0
  ds_read_b64_tr_b16 v[186:187], v22 offset:25600
  v_add_u32 v59, 0x10000, v58
  v_mfma_f32_16x16x32_bf16 a[184:187], v[88:91], v[116:119], 0
  s_lshl_b32 s31, s29, 17
  s_add_u32 s43, s43, s31
  s_lshl_b32 s31, s41, 11
  v_mfma_f32_16x16x32_bf16 a[192:195], v[64:67], v[120:123], 0
  ds_read_b128 v[156:159], v17 offset:22528
  v_add_u32 v62, s31, v58
  v_mfma_f32_16x16x32_bf16 a[196:199], v[68:71], v[120:123], 0
  v_add_u32 v63, s31, v59
  v_mfma_f32_16x16x32_bf16 a[200:203], v[72:75], v[120:123], 0
  s_add_u32 s42, s43, s31
  s_mov_b32 s44, 1040356334
  ds_read_b64_tr_b16 v[188:189], v23 offset:24576
  v_mfma_f32_16x16x32_bf16 a[204:207], v[76:79], v[120:123], 0
  v_lshlrev_b32 v3, 2, v5
  v_add_u32 v6, 0, v3
  v_mfma_f32_16x16x32_bf16 a[208:211], v[80:83], v[120:123], 0
  ds_read_b64_tr_b16 v[190:191], v23 offset:25600
  v_cmp_gt_u32 s[48:49], v6, v4
  v_mfma_f32_16x16x32_bf16 a[212:215], v[84:87], v[120:123], 0
  v_add_u32 v6, 1, v3
  v_cmp_gt_u32 s[50:51], v6, v4
  v_mfma_f32_16x16x32_bf16 a[216:219], v[88:91], v[120:123], 0
  v_add_u32 v6, 2, v3
  v_cmp_gt_u32 s[52:53], v6, v4
  v_mfma_f32_16x16x32_bf16 a[28:31], v[96:99], v[92:95], 0
  v_add_u32 v6, 3, v3
  v_cmp_gt_u32 s[54:55], v6, v4
  v_mfma_f32_16x16x32_bf16 a[60:63], v[100:103], v[92:95], 0
  v_mfma_f32_16x16x32_bf16 a[92:95], v[104:107], v[92:95], 0
  v_mfma_f32_16x16x32_bf16 a[124:127], v[108:111], v[92:95], 0
  v_mfma_f32_16x16x32_bf16 a[156:159], v[92:95], v[112:115], 0
  v_mfma_f32_16x16x32_bf16 a[188:191], v[92:95], v[116:119], 0
  v_mfma_f32_16x16x32_bf16 a[220:223], v[92:95], v[120:123], 0
  v_mfma_f32_16x16x32_bf16 a[224:227], v[64:67], v[124:127], 0
  v_mfma_f32_16x16x32_bf16 a[228:231], v[68:71], v[124:127], 0
  v_mfma_f32_16x16x32_bf16 a[232:235], v[72:75], v[124:127], 0
  v_mfma_f32_16x16x32_bf16 a[236:239], v[76:79], v[124:127], 0
  v_mfma_f32_16x16x32_bf16 a[240:243], v[80:83], v[124:127], 0
  v_mfma_f32_16x16x32_bf16 a[244:247], v[84:87], v[124:127], 0
  v_mfma_f32_16x16x32_bf16 a[248:251], v[88:91], v[124:127], 0
  v_mfma_f32_16x16x32_bf16 a[252:255], v[92:95], v[124:127], 0
  .p2align 6
L_p1loop:
  s_waitcnt lgkmcnt(0)
  v_mfma_f32_16x16x32_bf16 a[0:3], v[160:163], v[128:131], a[0:3]
  v_mfma_f32_16x16x32_bf16 a[4:7], v[160:163], v[132:135], a[4:7]
  s_waitcnt vmcnt(1) lgkmcnt(0)
  s_barrier
  v_mfma_f32_16x16x32_bf16 a[32:35], v[164:167], v[128:131], a[32:35]
  s_add_u32 m0, s36, 0
  ds_read_b128 v[64:67], v18 offset:0
  v_mfma_f32_16x16x32_bf16 a[36:39], v[164:167], v[132:135], a[36:39]
  buffer_load_dwordx4 v8, s[12:15], s32 offen offset:0 lds
  v_mfma_f32_16x16x32_bf16 a[8:11], v[160:163], v[136:139], a[8:11]
  ds_read_b64_tr_b16 v[96:97], v24 offset:0
  v_mfma_f32_16x16x32_bf16 a[40:43], v[164:167], v[136:139], a[40:43]
  v_mfma_f32_16x16x32_bf16 a[64:67], v[168:171], v[128:131], a[64:67]
  ds_read_b64_tr_b16 v[98:99], v24 offset:1024
  v_mfma_f32_16x16x32_bf16 a[68:71], v[168:171], v[132:135], a[68:71]
  buffer_load_dwordx4 v9, s[12:15], s32 offen offset:1024 lds
  v_mfma_f32_16x16x32_bf16 a[72:75], v[168:171], v[136:139], a[72:75]
  ds_read_b128 v[68:71], v18 offset:2048
  v_mfma_f32_16x16x32_bf16 a[12:15], v[160:163], v[140:143], a[12:15]
  buffer_load_dwordx4 v10, s[12:15], s32 offen offset:2048 lds
  v_mfma_f32_16x16x32_bf16 a[44:47], v[164:167], v[140:143], a[44:47]
  ds_read_b64_tr_b16 v[100:101], v25 offset:0
  v_mfma_f32_16x16x32_bf16 a[76:79], v[168:171], v[140:143], a[76:79]
  v_mfma_f32_16x16x32_bf16 a[96:99], v[172:175], v[128:131], a[96:99]
  ds_read_b64_tr_b16 v[102:103], v25 offset:1024
  v_mfma_f32_16x16x32_bf16 a[100:103], v[172:175], v[132:135], a[100:103]
  buffer_load_dwordx4 v11, s[12:15], s32 offen offset:3072 lds
  v_mfma_f32_16x16x32_bf16 a[104:107], v[172:175], v[136:139], a[104:107]
  ds_read_b128 v[72:75], v18 offset:4096
  v_mfma_f32_16x16x32_bf16 a[108:111], v[172:175], v[140:143], a[108:111]
  v_mfma_f32_16x16x32_bf16 a[16:19], v[160:163], v[144:147], a[16:19]
  s_add_u32 m0, s35, 0
  ds_read_b64_tr_b16 v[104:105], v26 offset:0
  v_mfma_f32_16x16x32_bf16 a[48:51], v[164:167], v[144:147], a[48:51]
  buffer_load_dwordx4 v8, s[12:15], s33 offen offset:0 lds
  v_mfma_f32_16x16x32_bf16 a[80:83], v[168:171], v[144:147], a[80:83]
  ds_read_b64_tr_b16 v[106:107], v26 offset:1024
  v_mfma_f32_16x16x32_bf16 a[112:115], v[172:175], v[144:147], a[112:115]
  v_mfma_f32_16x16x32_bf16 a[128:131], v[128:131], v[176:179], a[128:131]
  ds_read_b128 v[76:79], v18 offset:6144
  v_mfma_f32_16x16x32_bf16 a[132:135], v[132:135], v[176:179], a[132:135]
  buffer_load_dwordx4 v9, s[12:15], s33 offen offset:1024 lds
  v_mfma_f32_16x16x32_bf16 a[136:139], v[136:139], v[176:179], a[136:139]
  ds_read_b64_tr_b16 v[108:109], v27 offset:0
  v_mfma_f32_16x16x32_bf16 a[140:143], v[140:143], v[176:179], a[140:143]
  buffer_load_dwordx4 v10, s[12:15], s33 offen offset:2048 lds
  v_mfma_f32_16x16x32_bf16 a[144:147], v[144:147], v[176:179], a[144:147]
  ds_read_b64_tr_b16 v[110:111], v27 offset:1024
  v_mfma_f32_16x16x32_bf16 a[20:23], v[160:163], v[148:151], a[20:23]
  v_mfma_f32_16x16x32_bf16 a[52:55], v[164:167], v[148:151], a[52:55]
  ds_read_b128 v[80:83], v18 offset:16384
  v_mfma_f32_16x16x32_bf16 a[84:87], v[168:171], v[148:151], a[84:87]
  buffer_load_dwordx4 v11, s[12:15], s33 offen offset:3072 lds
  v_mfma_f32_16x16x32_bf16 a[116:119], v[172:175], v[148:151], a[116:119]
  ds_read_b64_tr_b16 v[112:113], v24 offset:16384
  v_mfma_f32_16x16x32_bf16 a[148:151], v[148:151], v[176:179], a[148:151]
  v_mfma_f32_16x16x32_bf16 a[160:163], v[128:131], v[180:183], a[160:163]
  s_add_u32 m0, s37, 0
  ds_read_b64_tr_b16 v[114:115], v24 offset:17408
  v_mfma_f32_16x16x32_bf16 a[164:167], v[132:135], v[180:183], a[164:167]
  buffer_load_dwordx4 v12, s[16:19], s34 offen offset:0 lds
  v_mfma_f32_16x16x32_bf16 a[168:171], v[136:139], v[180:183], a[168:171]
  ds_read_b128 v[84:87], v18 offset:18432
  v_mfma_f32_16x16x32_bf16 a[172:175], v[140:143], v[180:183], a[172:175]
  v_mfma_f32_16x16x32_bf16 a[176:179], v[144:147], v[180:183], a[176:179]
  ds_read_b64_tr_b16 v[116:117], v25 offset:16384
  v_mfma_f32_16x16x32_bf16 a[180:183], v[148:151], v[180:183], a[180:183]
  buffer_load_dwordx4 v13, s[16:19], s34 offen offset:1024 lds
  v_mfma_f32_16x16x32_bf16 a[24:27], v[160:163], v[152:155], a[24:27]
  ds_read_b64_tr_b16 v[118:119], v25 offset:17408
  v_mfma_f32_16x16x32_bf16 a[56:59], v[164:167], v[152:155], a[56:59]
  buffer_load_dwordx4 v14, s[16:19], s34 offen offset:2048 lds
  v_mfma_f32_16x16x32_bf16 a[88:91], v[168:171], v[152:155], a[88:91]
  ds_read_b128 v[88:91], v18 offset:20480
  v_mfma_f32_16x16x32_bf16 a[120:123], v[172:175], v[152:155], a[120:123]
  v_mfma_f32_16x16x32_bf16 a[152:155], v[152:155], v[176:179], a[152:155]
  ds_read_b64_tr_b16 v[120:121], v26 offset:16384
  v_mfma_f32_16x16x32_bf16 a[184:187], v[152:155], v[180:183], a[184:187]
  buffer_load_dwordx4 v15, s[16:19], s34 offen offset:3072 lds
  v_mfma_f32_16x16x32_bf16 a[192:195], v[128:131], v[184:187], a[192:195]
  ds_read_b64_tr_b16 v[122:123], v26 offset:17408
  v_mfma_f32_16x16x32_bf16 a[196:199], v[132:135], v[184:187], a[196:199]
  v_mfma_f32_16x16x32_bf16 a[200:203], v[136:139], v[184:187], a[200:203]
  s_add_u32 m0, s38, 0
  ds_read_b128 v[92:95], v18 offset:22528
  v_mfma_f32_16x16x32_bf16 a[204:207], v[140:143], v[184:187], a[204:207]
  buffer_load_dwordx4 v12, s[20:23], s34 offen offset:0 lds
  v_mfma_f32_16x16x32_bf16 a[208:211], v[144:147], v[184:187], a[208:211]
  ds_read_b64_tr_b16 v[124:125], v27 offset:16384
  v_mfma_f32_16x16x32_bf16 a[212:215], v[148:151], v[184:187], a[212:215]
  v_mfma_f32_16x16x32_bf16 a[216:219], v[152:155], v[184:187], a[216:219]
  ds_read_b64_tr_b16 v[126:127], v27 offset:17408
  v_mfma_f32_16x16x32_bf16 a[28:31], v[160:163], v[156:159], a[28:31]
  buffer_load_dwordx4 v13, s[20:23], s34 offen offset:1024 lds
  v_mfma_f32_16x16x32_bf16 a[60:63], v[164:167], v[156:159], a[60:63]
  v_mfma_f32_16x16x32_bf16 a[92:95], v[168:171], v[156:159], a[92:95]
  buffer_load_dwordx4 v14, s[20:23], s34 offen offset:2048 lds
  v_mfma_f32_16x16x32_bf16 a[124:127], v[172:175], v[156:159], a[124:127]
  v_mfma_f32_16x16x32_bf16 a[156:159], v[156:159], v[176:179], a[156:159]
  v_mfma_f32_16x16x32_bf16 a[188:191], v[156:159], v[180:183], a[188:191]
  v_mfma_f32_16x16x32_bf16 a[220:223], v[156:159], v[184:187], a[220:223]
  buffer_load_dwordx4 v15, s[20:23], s34 offen offset:3072 lds
  v_mfma_f32_16x16x32_bf16 a[224:227], v[128:131], v[188:191], a[224:227]
  v_mfma_f32_16x16x32_bf16 a[228:231], v[132:135], v[188:191], a[228:231]
  v_mfma_f32_16x16x32_bf16 a[232:235], v[136:139], v[188:191], a[232:235]
  global_load_dword v201, v[198:199], off sc1
  v_mfma_f32_16x16x32_bf16 a[236:239], v[140:143], v[188:191], a[236:239]
  v_mfma_f32_16x16x32_bf16 a[240:243], v[144:147], v[188:191], a[240:243]
  v_mfma_f32_16x16x32_bf16 a[244:247], v[148:151], v[188:191], a[244:247]
  v_mfma_f32_16x16x32_bf16 a[248:251], v[152:155], v[188:191], a[248:251]
  s_add_u32 s32, s32, 128
  s_add_u32 s33, s33, 128
  s_add_u32 s34, s34, 524288
  v_mfma_f32_16x16x32_bf16 a[252:255], v[156:159], v[188:191], a[252:255]
  s_waitcnt lgkmcnt(0)
  v_mfma_f32_16x16x32_bf16 a[0:3], v[96:99], v[64:67], a[0:3]
  ds_read_b128 v[128:131], v19 offset:0
  v_mfma_f32_16x16x32_bf16 a[4:7], v[96:99], v[68:71], a[4:7]
  v_mfma_f32_16x16x32_bf16 a[32:35], v[100:103], v[64:67], a[32:35]
  ds_read_b64_tr_b16 v[160:161], v24 offset:8192
  v_mfma_f32_16x16x32_bf16 a[36:39], v[100:103], v[68:71], a[36:39]
  v_add_u32 v194, v194, v195
  v_mfma_f32_16x16x32_bf16 a[8:11], v[96:99], v[72:75], a[8:11]
  ds_read_b64_tr_b16 v[162:163], v24 offset:9216
  v_mfma_f32_16x16x32_bf16 a[40:43], v[100:103], v[72:75], a[40:43]
  v_mfma_f32_16x16x32_bf16 a[64:67], v[104:107], v[64:67], a[64:67]
  ds_read_b128 v[132:135], v19 offset:2048
  v_mfma_f32_16x16x32_bf16 a[68:71], v[104:107], v[68:71], a[68:71]
  v_med3_i32 v197, v194, 0, v196
  v_mfma_f32_16x16x32_bf16 a[72:75], v[104:107], v[72:75], a[72:75]
  ds_read_b64_tr_b16 v[164:165], v25 offset:8192
  v_mfma_f32_16x16x32_bf16 a[12:15], v[96:99], v[76:79], a[12:15]
  v_mfma_f32_16x16x32_bf16 a[44:47], v[100:103], v[76:79], a[44:47]
  ds_read_b64_tr_b16 v[166:167], v25 offset:9216
  v_mfma_f32_16x16x32_bf16 a[76:79], v[104:107], v[76:79], a[76:79]
  v_add_co_u32 v198, vcc, v192, v197
  v_mfma_f32_16x16x32_bf16 a[96:99], v[108:111], v[64:67], a[96:99]
  ds_read_b128 v[136:139], v19 offset:4096
  v_mfma_f32_16x16x32_bf16 a[100:103], v[108:111], v[68:71], a[100:103]
  v_mfma_f32_16x16x32_bf16 a[104:107], v[108:111], v[72:75], a[104:107]
  ds_read_b64_tr_b16 v[168:169], v26 offset:8192
  v_mfma_f32_16x16x32_bf16 a[108:111], v[108:111], v[76:79], a[108:111]
  v_addc_co_u32 v199, vcc, 0, v193, vcc
  v_mfma_f32_16x16x32_bf16 a[16:19], v[96:99], v[80:83], a[16:19]
  ds_read_b64_tr_b16 v[170:171], v26 offset:9216
  v_mfma_f32_16x16x32_bf16 a[48:51], v[100:103], v[80:83], a[48:51]
  v_mfma_f32_16x16x32_bf16 a[80:83], v[104:107], v[80:83], a[80:83]
  ds_read_b128 v[140:143], v19 offset:6144
  v_mfma_f32_16x16x32_bf16 a[112:115], v[108:111], v[80:83], a[112:115]
  v_mfma_f32_16x16x32_bf16 a[128:131], v[64:67], v[112:115], a[128:131]
  ds_read_b64_tr_b16 v[172:173], v27 offset:8192
  v_mfma_f32_16x16x32_bf16 a[132:135], v[68:71], v[112:115], a[132:135]
  v_mfma_f32_16x16x32_bf16 a[136:139], v[72:75], v[112:115], a[136:139]
  ds_read_b64_tr_b16 v[174:175], v27 offset:9216
  v_mfma_f32_16x16x32_bf16 a[140:143], v[76:79], v[112:115], a[140:143]
  v_mfma_f32_16x16x32_bf16 a[144:147], v[80:83], v[112:115], a[144:147]
  ds_read_b128 v[144:147], v19 offset:16384
  v_mfma_f32_16x16x32_bf16 a[20:23], v[96:99], v[84:87], a[20:23]
  v_mfma_f32_16x16x32_bf16 a[52:55], v[100:103], v[84:87], a[52:55]
  ds_read_b64_tr_b16 v[176:177], v24 offset:24576
  v_mfma_f32_16x16x32_bf16 a[84:87], v[104:107], v[84:87], a[84:87]
  v_mfma_f32_16x16x32_bf16 a[116:119], v[108:111], v[84:87], a[116:119]
  ds_read_b64_tr_b16 v[178:179], v24 offset:25600
  v_mfma_f32_16x16x32_bf16 a[148:151], v[84:87], v[112:115], a[148:151]
  v_mfma_f32_16x16x32_bf16 a[160:163], v[64:67], v[116:119], a[160:163]
  ds_read_b128 v[148:151], v19 offset:18432
  v_mfma_f32_16x16x32_bf16 a[164:167], v[68:71], v[116:119], a[164:167]
  v_mfma_f32_16x16x32_bf16 a[168:171], v[72:75], v[116:119], a[168:171]
  ds_read_b64_tr_b16 v[180:181], v25 offset:24576
  v_mfma_f32_16x16x32_bf16 a[172:175], v[76:79], v[116:119], a[172:175]
  v_mfma_f32_16x16x32_bf16 a[176:179], v[80:83], v[116:119], a[176:179]
  ds_read_b64_tr_b16 v[182:183], v25 offset:25600
  v_mfma_f32_16x16x32_bf16 a[180:183], v[84:87], v[116:119], a[180:183]
  v_mfma_f32_16x16x32_bf16 a[24:27], v[96:99], v[88:91], a[24:27]
  ds_read_b128 v[152:155], v19 offset:20480
  v_mfma_f32_16x16x32_bf16 a[56:59], v[100:103], v[88:91], a[56:59]
  v_mfma_f32_16x16x32_bf16 a[88:91], v[104:107], v[88:91], a[88:91]
  ds_read_b64_tr_b16 v[184:185], v26 offset:24576
  v_mfma_f32_16x16x32_bf16 a[120:123], v[108:111], v[88:91], a[120:123]
  v_mfma_f32_16x16x32_bf16 a[152:155], v[88:91], v[112:115], a[152:155]
  ds_read_b64_tr_b16 v[186:187], v26 offset:25600
  v_mfma_f32_16x16x32_bf16 a[184:187], v[88:91], v[116:119], a[184:187]
  v_mfma_f32_16x16x32_bf16 a[192:195], v[64:67], v[120:123], a[192:195]
  ds_read_b128 v[156:159], v19 offset:22528
  v_mfma_f32_16x16x32_bf16 a[196:199], v[68:71], v[120:123], a[196:199]
  v_mfma_f32_16x16x32_bf16 a[200:203], v[72:75], v[120:123], a[200:203]
  ds_read_b64_tr_b16 v[188:189], v27 offset:24576
  v_mfma_f32_16x16x32_bf16 a[204:207], v[76:79], v[120:123], a[204:207]
  v_mfma_f32_16x16x32_bf16 a[208:211], v[80:83], v[120:123], a[208:211]
  ds_read_b64_tr_b16 v[190:191], v27 offset:25600
  v_mfma_f32_16x16x32_bf16 a[212:215], v[84:87], v[120:123], a[212:215]
  v_mfma_f32_16x16x32_bf16 a[216:219], v[88:91], v[120:123], a[216:219]
  v_mfma_f32_16x16x32_bf16 a[28:31], v[96:99], v[92:95], a[28:31]
  v_mfma_f32_16x16x32_bf16 a[60:63], v[100:103], v[92:95], a[60:63]
  v_mfma_f32_16x16x32_bf16 a[92:95], v[104:107], v[92:95], a[92:95]
  v_mfma_f32_16x16x32_bf16 a[124:127], v[108:111], v[92:95], a[124:127]
  v_mfma_f32_16x16x32_bf16 a[156:159], v[92:95], v[112:115], a[156:159]
  v_mfma_f32_16x16x32_bf16 a[188:191], v[92:95], v[116:119], a[188:191]
  v_mfma_f32_16x16x32_bf16 a[220:223], v[92:95], v[120:123], a[220:223]
  v_mfma_f32_16x16x32_bf16 a[224:227], v[64:67], v[124:127], a[224:227]
  v_mfma_f32_16x16x32_bf16 a[228:231], v[68:71], v[124:127], a[228:231]
  v_mfma_f32_16x16x32_bf16 a[232:235], v[72:75], v[124:127], a[232:235]
  v_mfma_f32_16x16x32_bf16 a[236:239], v[76:79], v[124:127], a[236:239]
  v_mfma_f32_16x16x32_bf16 a[240:243], v[80:83], v[124:127], a[240:243]
  v_mfma_f32_16x16x32_bf16 a[244:247], v[84:87], v[124:127], a[244:247]
  v_mfma_f32_16x16x32_bf16 a[248:251], v[88:91], v[124:127], a[248:251]
  v_mfma_f32_16x16x32_bf16 a[252:255], v[92:95], v[124:127], a[252:255]
  s_waitcnt lgkmcnt(0)
  v_mfma_f32_16x16x32_bf16 a[0:3], v[160:163], v[128:131], a[0:3]
  v_mfma_f32_16x16x32_bf16 a[4:7], v[160:163], v[132:135], a[4:7]
  s_waitcnt vmcnt(1) lgkmcnt(0)
  s_barrier
  v_mfma_f32_16x16x32_bf16 a[32:35], v[164:167], v[128:131], a[32:35]
  s_add_u32 m0, s36, 65536
  ds_read_b128 v[64:67], v16 offset:0
  v_mfma_f32_16x16x32_bf16 a[36:39], v[164:167], v[132:135], a[36:39]
  buffer_load_dwordx4 v8, s[12:15], s32 offen offset:0 lds
  v_mfma_f32_16x16x32_bf16 a[8:11], v[160:163], v[136:139], a[8:11]
  ds_read_b64_tr_b16 v[96:97], v20 offset:0
  v_mfma_f32_16x16x32_bf16 a[40:43], v[164:167], v[136:139], a[40:43]
  v_mfma_f32_16x16x32_bf16 a[64:67], v[168:171], v[128:131], a[64:67]
  ds_read_b64_tr_b16 v[98:99], v20 offset:1024
  v_mfma_f32_16x16x32_bf16 a[68:71], v[168:171], v[132:135], a[68:71]
  buffer_load_dwordx4 v9, s[12:15], s32 offen offset:1024 lds
  v_mfma_f32_16x16x32_bf16 a[72:75], v[168:171], v[136:139], a[72:75]
  ds_read_b128 v[68:71], v16 offset:2048
  v_mfma_f32_16x16x32_bf16 a[12:15], v[160:163], v[140:143], a[12:15]
  buffer_load_dwordx4 v10, s[12:15], s32 offen offset:2048 lds
  v_mfma_f32_16x16x32_bf16 a[44:47], v[164:167], v[140:143], a[44:47]
  ds_read_b64_tr_b16 v[100:101], v21 offset:0
  v_mfma_f32_16x16x32_bf16 a[76:79], v[168:171], v[140:143], a[76:79]
  v_mfma_f32_16x16x32_bf16 a[96:99], v[172:175], v[128:131], a[96:99]
  ds_read_b64_tr_b16 v[102:103], v21 offset:1024
  v_mfma_f32_16x16x32_bf16 a[100:103], v[172:175], v[132:135], a[100:103]
  buffer_load_dwordx4 v11, s[12:15], s32 offen offset:3072 lds
  v_mfma_f32_16x16x32_bf16 a[104:107], v[172:175], v[136:139], a[104:107]
  ds_read_b128 v[72:75], v16 offset:4096
  v_mfma_f32_16x16x32_bf16 a[108:111], v[172:175], v[140:143], a[108:111]
  v_mfma_f32_16x16x32_bf16 a[16:19], v[160:163], v[144:147], a[16:19]
  s_add_u32 m0, s35, 65536
  ds_read_b64_tr_b16 v[104:105], v22 offset:0
  v_mfma_f32_16x16x32_bf16 a[48:51], v[164:167], v[144:147], a[48:51]
  buffer_load_dwordx4 v8, s[12:15], s33 offen offset:0 lds
  v_mfma_f32_16x16x32_bf16 a[80:83], v[168:171], v[144:147], a[80:83]
  ds_read_b64_tr_b16 v[106:107], v22 offset:1024
  v_mfma_f32_16x16x32_bf16 a[112:115], v[172:175], v[144:147], a[112:115]
  v_mfma_f32_16x16x32_bf16 a[128:131], v[128:131], v[176:179], a[128:131]
  ds_read_b128 v[76:79], v16 offset:6144
  v_mfma_f32_16x16x32_bf16 a[132:135], v[132:135], v[176:179], a[132:135]
  buffer_load_dwordx4 v9, s[12:15], s33 offen offset:1024 lds
  v_mfma_f32_16x16x32_bf16 a[136:139], v[136:139], v[176:179], a[136:139]
  ds_read_b64_tr_b16 v[108:109], v23 offset:0
  v_mfma_f32_16x16x32_bf16 a[140:143], v[140:143], v[176:179], a[140:143]
  buffer_load_dwordx4 v10, s[12:15], s33 offen offset:2048 lds
  v_mfma_f32_16x16x32_bf16 a[144:147], v[144:147], v[176:179], a[144:147]
  ds_read_b64_tr_b16 v[110:111], v23 offset:1024
  v_mfma_f32_16x16x32_bf16 a[20:23], v[160:163], v[148:151], a[20:23]
  v_mfma_f32_16x16x32_bf16 a[52:55], v[164:167], v[148:151], a[52:55]
  ds_read_b128 v[80:83], v16 offset:16384
  v_mfma_f32_16x16x32_bf16 a[84:87], v[168:171], v[148:151], a[84:87]
  buffer_load_dwordx4 v11, s[12:15], s33 offen offset:3072 lds
  v_mfma_f32_16x16x32_bf16 a[116:119], v[172:175], v[148:151], a[116:119]
  ds_read_b64_tr_b16 v[112:113], v20 offset:16384
  v_mfma_f32_16x16x32_bf16 a[148:151], v[148:151], v[176:179], a[148:151]
  v_mfma_f32_16x16x32_bf16 a[160:163], v[128:131], v[180:183], a[160:163]
  s_add_u32 m0, s37, 65536
  ds_read_b64_tr_b16 v[114:115], v20 offset:17408
  v_mfma_f32_16x16x32_bf16 a[164:167], v[132:135], v[180:183], a[164:167]
  buffer_load_dwordx4 v12, s[16:19], s34 offen offset:0 lds
  v_mfma_f32_16x16x32_bf16 a[168:171], v[136:139], v[180:183], a[168:171]
  ds_read_b128 v[84:87], v16 offset:18432
  v_mfma_f32_16x16x32_bf16 a[172:175], v[140:143], v[180:183], a[172:175]
  v_mfma_f32_16x16x32_bf16 a[176:179], v[144:147], v[180:183], a[176:179]
  ds_read_b64_tr_b16 v[116:117], v21 offset:16384
  v_mfma_f32_16x16x32_bf16 a[180:183], v[148:151], v[180:183], a[180:183]
  buffer_load_dwordx4 v13, s[16:19], s34 offen offset:1024 lds
  v_mfma_f32_16x16x32_bf16 a[24:27], v[160:163], v[152:155], a[24:27]
  ds_read_b64_tr_b16 v[118:119], v21 offset:17408
  v_mfma_f32_16x16x32_bf16 a[56:59], v[164:167], v[152:155], a[56:59]
  buffer_load_dwordx4 v14, s[16:19], s34 offen offset:2048 lds
  v_mfma_f32_16x16x32_bf16 a[88:91], v[168:171], v[152:155], a[88:91]
  ds_read_b128 v[88:91], v16 offset:20480
  v_mfma_f32_16x16x32_bf16 a[120:123], v[172:175], v[152:155], a[120:123]
  v_mfma_f32_16x16x32_bf16 a[152:155], v[152:155], v[176:179], a[152:155]
  ds_read_b64_tr_b16 v[120:121], v22 offset:16384
  v_mfma_f32_16x16x32_bf16 a[184:187], v[152:155], v[180:183], a[184:187]
  buffer_load_dwordx4 v15, s[16:19], s34 offen offset:3072 lds
  v_mfma_f32_16x16x32_bf16 a[192:195], v[128:131], v[184:187], a[192:195]
  ds_read_b64_tr_b16 v[122:123], v22 offset:17408
  v_mfma_f32_16x16x32_bf16 a[196:199], v[132:135], v[184:187], a[196:199]
  v_mfma_f32_16x16x32_bf16 a[200:203], v[136:139], v[184:187], a[200:203]
  s_add_u32 m0, s38, 65536
  ds_read_b128 v[92:95], v16 offset:22528
  v_mfma_f32_16x16x32_bf16 a[204:207], v[140:143], v[184:187], a[204:207]
  buffer_load_dwordx4 v12, s[20:23], s34 offen offset:0 lds
  v_mfma_f32_16x16x32_bf16 a[208:211], v[144:147], v[184:187], a[208:211]
  ds_read_b64_tr_b16 v[124:125], v23 offset:16384
  v_mfma_f32_16x16x32_bf16 a[212:215], v[148:151], v[184:187], a[212:215]
  v_mfma_f32_16x16x32_bf16 a[216:219], v[152:155], v[184:187], a[216:219]
  ds_read_b64_tr_b16 v[126:127], v23 offset:17408
  v_mfma_f32_16x16x32_bf16 a[28:31], v[160:163], v[156:159], a[28:31]
  buffer_load_dwordx4 v13, s[20:23], s34 offen offset:1024 lds
  v_mfma_f32_16x16x32_bf16 a[60:63], v[164:167], v[156:159], a[60:63]
  v_mfma_f32_16x16x32_bf16 a[92:95], v[168:171], v[156:159], a[92:95]
  buffer_load_dwordx4 v14, s[20:23], s34 offen offset:2048 lds
  v_mfma_f32_16x16x32_bf16 a[124:127], v[172:175], v[156:159], a[124:127]
  v_mfma_f32_16x16x32_bf16 a[156:159], v[156:159], v[176:179], a[156:159]
  v_mfma_f32_16x16x32_bf16 a[188:191], v[156:159], v[180:183], a[188:191]
  v_mfma_f32_16x16x32_bf16 a[220:223], v[156:159], v[184:187], a[220:223]
  buffer_load_dwordx4 v15, s[20:23], s34 offen offset:3072 lds
  v_mfma_f32_16x16x32_bf16 a[224:227], v[128:131], v[188:191], a[224:227]
  v_mfma_f32_16x16x32_bf16 a[228:231], v[132:135], v[188:191], a[228:231]
  v_mfma_f32_16x16x32_bf16 a[232:235], v[136:139], v[188:191], a[232:235]
  global_load_dword v200, v[198:199], off sc1
  v_mfma_f32_16x16x32_bf16 a[236:239], v[140:143], v[188:191], a[236:239]
  v_mfma_f32_16x16x32_bf16 a[240:243], v[144:147], v[188:191], a[240:243]
  v_mfma_f32_16x16x32_bf16 a[244:247], v[148:151], v[188:191], a[244:247]
  v_mfma_f32_16x16x32_bf16 a[248:251], v[152:155], v[188:191], a[248:251]
  s_add_u32 s32, s32, 128
  s_add_u32 s33, s33, 128
  s_add_u32 s34, s34, 524288
  v_mfma_f32_16x16x32_bf16 a[252:255], v[156:159], v[188:191], a[252:255]
  s_waitcnt lgkmcnt(0)
  v_mfma_f32_16x16x32_bf16 a[0:3], v[96:99], v[64:67], a[0:3]
  ds_read_b128 v[128:131], v17 offset:0
  v_mfma_f32_16x16x32_bf16 a[4:7], v[96:99], v[68:71], a[4:7]
  v_mfma_f32_16x16x32_bf16 a[32:35], v[100:103], v[64:67], a[32:35]
  ds_read_b64_tr_b16 v[160:161], v20 offset:8192
  v_mfma_f32_16x16x32_bf16 a[36:39], v[100:103], v[68:71], a[36:39]
  v_add_u32 v194, v194, v195
  v_mfma_f32_16x16x32_bf16 a[8:11], v[96:99], v[72:75], a[8:11]
  ds_read_b64_tr_b16 v[162:163], v20 offset:9216
  v_mfma_f32_16x16x32_bf16 a[40:43], v[100:103], v[72:75], a[40:43]
  v_mfma_f32_16x16x32_bf16 a[64:67], v[104:107], v[64:67], a[64:67]
  ds_read_b128 v[132:135], v17 offset:2048
  v_mfma_f32_16x16x32_bf16 a[68:71], v[104:107], v[68:71], a[68:71]
  v_med3_i32 v197, v194, 0, v196
  v_mfma_f32_16x16x32_bf16 a[72:75], v[104:107], v[72:75], a[72:75]
  ds_read_b64_tr_b16 v[164:165], v21 offset:8192
  v_mfma_f32_16x16x32_bf16 a[12:15], v[96:99], v[76:79], a[12:15]
  v_mfma_f32_16x16x32_bf16 a[44:47], v[100:103], v[76:79], a[44:47]
  ds_read_b64_tr_b16 v[166:167], v21 offset:9216
  v_mfma_f32_16x16x32_bf16 a[76:79], v[104:107], v[76:79], a[76:79]
  v_add_co_u32 v198, vcc, v192, v197
  v_mfma_f32_16x16x32_bf16 a[96:99], v[108:111], v[64:67], a[96:99]
  ds_read_b128 v[136:139], v17 offset:4096
  v_mfma_f32_16x16x32_bf16 a[100:103], v[108:111], v[68:71], a[100:103]
  v_mfma_f32_16x16x32_bf16 a[104:107], v[108:111], v[72:75], a[104:107]
  ds_read_b64_tr_b16 v[168:169], v22 offset:8192
  v_mfma_f32_16x16x32_bf16 a[108:111], v[108:111], v[76:79], a[108:111]
  v_addc_co_u32 v199, vcc, 0, v193, vcc
  v_mfma_f32_16x16x32_bf16 a[16:19], v[96:99], v[80:83], a[16:19]
  ds_read_b64_tr_b16 v[170:171], v22 offset:9216
  v_mfma_f32_16x16x32_bf16 a[48:51], v[100:103], v[80:83], a[48:51]
  v_mfma_f32_16x16x32_bf16 a[80:83], v[104:107], v[80:83], a[80:83]
  ds_read_b128 v[140:143], v17 offset:6144
  v_mfma_f32_16x16x32_bf16 a[112:115], v[108:111], v[80:83], a[112:115]
  v_mfma_f32_16x16x32_bf16 a[128:131], v[64:67], v[112:115], a[128:131]
  ds_read_b64_tr_b16 v[172:173], v23 offset:8192
  v_mfma_f32_16x16x32_bf16 a[132:135], v[68:71], v[112:115], a[132:135]
  v_mfma_f32_16x16x32_bf16 a[136:139], v[72:75], v[112:115], a[136:139]
  ds_read_b64_tr_b16 v[174:175], v23 offset:9216
  v_mfma_f32_16x16x32_bf16 a[140:143], v[76:79], v[112:115], a[140:143]
  v_mfma_f32_16x16x32_bf16 a[144:147], v[80:83], v[112:115], a[144:147]
  ds_read_b128 v[144:147], v17 offset:16384
  v_mfma_f32_16x16x32_bf16 a[20:23], v[96:99], v[84:87], a[20:23]
  v_mfma_f32_16x16x32_bf16 a[52:55], v[100:103], v[84:87], a[52:55]
  ds_read_b64_tr_b16 v[176:177], v20 offset:24576
  v_mfma_f32_16x16x32_bf16 a[84:87], v[104:107], v[84:87], a[84:87]
  v_mfma_f32_16x16x32_bf16 a[116:119], v[108:111], v[84:87], a[116:119]
  ds_read_b64_tr_b16 v[178:179], v20 offset:25600
  v_mfma_f32_16x16x32_bf16 a[148:151], v[84:87], v[112:115], a[148:151]
  v_mfma_f32_16x16x32_bf16 a[160:163], v[64:67], v[116:119], a[160:163]
  ds_read_b128 v[148:151], v17 offset:18432
  v_mfma_f32_16x16x32_bf16 a[164:167], v[68:71], v[116:119], a[164:167]
  v_mfma_f32_16x16x32_bf16 a[168:171], v[72:75], v[116:119], a[168:171]
  ds_read_b64_tr_b16 v[180:181], v21 offset:24576
  v_mfma_f32_16x16x32_bf16 a[172:175], v[76:79], v[116:119], a[172:175]
  v_mfma_f32_16x16x32_bf16 a[176:179], v[80:83], v[116:119], a[176:179]
  ds_read_b64_tr_b16 v[182:183], v21 offset:25600
  v_mfma_f32_16x16x32_bf16 a[180:183], v[84:87], v[116:119], a[180:183]
  v_mfma_f32_16x16x32_bf16 a[24:27], v[96:99], v[88:91], a[24:27]
  ds_read_b128 v[152:155], v17 offset:20480
  v_mfma_f32_16x16x32_bf16 a[56:59], v[100:103], v[88:91], a[56:59]
  v_mfma_f32_16x16x32_bf16 a[88:91], v[104:107], v[88:91], a[88:91]
  ds_read_b64_tr_b16 v[184:185], v22 offset:24576
  v_mfma_f32_16x16x32_bf16 a[120:123], v[108:111], v[88:91], a[120:123]
  v_mfma_f32_16x16x32_bf16 a[152:155], v[88:91], v[112:115], a[152:155]
  ds_read_b64_tr_b16 v[186:187], v22 offset:25600
  v_mfma_f32_16x16x32_bf16 a[184:187], v[88:91], v[116:119], a[184:187]
  v_mfma_f32_16x16x32_bf16 a[192:195], v[64:67], v[120:123], a[192:195]
  ds_read_b128 v[156:159], v17 offset:22528
  v_mfma_f32_16x16x32_bf16 a[196:199], v[68:71], v[120:123], a[196:199]
  v_mfma_f32_16x16x32_bf16 a[200:203], v[72:75], v[120:123], a[200:203]
  ds_read_b64_tr_b16 v[188:189], v23 offset:24576
  v_mfma_f32_16x16x32_bf16 a[204:207], v[76:79], v[120:123], a[204:207]
  v_mfma_f32_16x16x32_bf16 a[208:211], v[80:83], v[120:123], a[208:211]
  ds_read_b64_tr_b16 v[190:191], v23 offset:25600
  v_mfma_f32_16x16x32_bf16 a[212:215], v[84:87], v[120:123], a[212:215]
  v_mfma_f32_16x16x32_bf16 a[216:219], v[88:91], v[120:123], a[216:219]
  v_mfma_f32_16x16x32_bf16 a[28:31], v[96:99], v[92:95], a[28:31]
  v_mfma_f32_16x16x32_bf16 a[60:63], v[100:103], v[92:95], a[60:63]
  v_mfma_f32_16x16x32_bf16 a[92:95], v[104:107], v[92:95], a[92:95]
  v_mfma_f32_16x16x32_bf16 a[124:127], v[108:111], v[92:95], a[124:127]
  v_mfma_f32_16x16x32_bf16 a[156:159], v[92:95], v[112:115], a[156:159]
  v_mfma_f32_16x16x32_bf16 a[188:191], v[92:95], v[116:119], a[188:191]
  v_mfma_f32_16x16x32_bf16 a[220:223], v[92:95], v[120:123], a[220:223]
  v_mfma_f32_16x16x32_bf16 a[224:227], v[64:67], v[124:127], a[224:227]
  v_mfma_f32_16x16x32_bf16 a[228:231], v[68:71], v[124:127], a[228:231]
  v_mfma_f32_16x16x32_bf16 a[232:235], v[72:75], v[124:127], a[232:235]
  v_mfma_f32_16x16x32_bf16 a[236:239], v[76:79], v[124:127], a[236:239]
  v_mfma_f32_16x16x32_bf16 a[240:243], v[80:83], v[124:127], a[240:243]
  v_mfma_f32_16x16x32_bf16 a[244:247], v[84:87], v[124:127], a[244:247]
  v_mfma_f32_16x16x32_bf16 a[248:251], v[88:91], v[124:127], a[248:251]
  v_mfma_f32_16x16x32_bf16 a[252:255], v[92:95], v[124:127], a[252:255]
  s_add_u32 s45, s45, 1
  s_cmp_lg_u32 s46, 0
  s_cbranch_scc1 L_p0pub
  s_cmp_lg_u32 s45, 3
  s_cbranch_scc1 L_p1loop
  s_waitcnt lgkmcnt(0)
  v_mfma_f32_16x16x32_bf16 a[0:3], v[160:163], v[128:131], a[0:3]
  v_mfma_f32_16x16x32_bf16 a[4:7], v[160:163], v[132:135], a[4:7]
  s_waitcnt vmcnt(1) lgkmcnt(0)
  s_barrier
  v_mfma_f32_16x16x32_bf16 a[32:35], v[164:167], v[128:131], a[32:35]
  s_add_u32 m0, s36, 0
  s_mov_b32 s32, 0
  ds_read_b128 v[64:67], v18 offset:0
  v_mfma_f32_16x16x32_bf16 a[36:39], v[164:167], v[132:135], a[36:39]
  buffer_load_dwordx4 v40, s[64:67], s32 offen offset:0 lds
  v_mfma_f32_16x16x32_bf16 a[8:11], v[160:163], v[136:139], a[8:11]
  ds_read_b64_tr_b16 v[96:97], v24 offset:0
  v_mfma_f32_16x16x32_bf16 a[40:43], v[164:167], v[136:139], a[40:43]
  v_mfma_f32_16x16x32_bf16 a[64:67], v[168:171], v[128:131], a[64:67]
  ds_read_b64_tr_b16 v[98:99], v24 offset:1024
  v_mfma_f32_16x16x32_bf16 a[68:71], v[168:171], v[132:135], a[68:71]
  buffer_load_dwordx4 v41, s[64:67], s32 offen offset:1024 lds
  v_mfma_f32_16x16x32_bf16 a[72:75], v[168:171], v[136:139], a[72:75]
  ds_read_b128 v[68:71], v18 offset:2048
  v_mfma_f32_16x16x32_bf16 a[12:15], v[160:163], v[140:143], a[12:15]
  v_mfma_f32_16x16x32_bf16 a[44:47], v[164:167], v[140:143], a[44:47]
  ds_read_b64_tr_b16 v[100:101], v25 offset:0
  v_mfma_f32_16x16x32_bf16 a[76:79], v[168:171], v[140:143], a[76:79]
  s_mov_b32 s32, 18432
  buffer_load_dwordx4 v40, s[64:67], s32 offen offset:2048 lds
  v_mfma_f32_16x16x32_bf16 a[96:99], v[172:175], v[128:131], a[96:99]
  ds_read_b64_tr_b16 v[102:103], v25 offset:1024
  v_mfma_f32_16x16x32_bf16 a[100:103], v[172:175], v[132:135], a[100:103]
  v_mfma_f32_16x16x32_bf16 a[104:107], v[172:175], v[136:139], a[104:107]
  ds_read_b128 v[72:75], v18 offset:4096
  v_mfma_f32_16x16x32_bf16 a[108:111], v[172:175], v[140:143], a[108:111]
  v_mfma_f32_16x16x32_bf16 a[16:19], v[160:163], v[144:147], a[16:19]
  ds_read_b64_tr_b16 v[104:105], v26 offset:0
  v_mfma_f32_16x16x32_bf16 a[48:51], v[164:167], v[144:147], a[48:51]
  buffer_load_dwordx4 v41, s[64:67], s32 offen offset:3072 lds
  v_mfma_f32_16x16x32_bf16 a[80:83], v[168:171], v[144:147], a[80:83]
  ds_read_b64_tr_b16 v[106:107], v26 offset:1024
  v_mfma_f32_16x16x32_bf16 a[112:115], v[172:175], v[144:147], a[112:115]
  v_mfma_f32_16x16x32_bf16 a[128:131], v[128:131], v[176:179], a[128:131]
  s_add_u32 m0, s36, 4096
  s_mov_b32 s32, 40960
  ds_read_b128 v[76:79], v18 offset:6144
  v_mfma_f32_16x16x32_bf16 a[132:135], v[132:135], v[176:179], a[132:135]
  buffer_load_dwordx4 v40, s[64:67], s32 offen offset:0 lds
  v_mfma_f32_16x16x32_bf16 a[136:139], v[136:139], v[176:179], a[136:139]
  ds_read_b64_tr_b16 v[108:109], v27 offset:0
  v_mfma_f32_16x16x32_bf16 a[140:143], v[140:143], v[176:179], a[140:143]
  v_mfma_f32_16x16x32_bf16 a[144:147], v[144:147], v[176:179], a[144:147]
  ds_read_b64_tr_b16 v[110:111], v27 offset:1024
  v_mfma_f32_16x16x32_bf16 a[20:23], v[160:163], v[148:151], a[20:23]
  buffer_load_dwordx4 v41, s[64:67], s32 offen offset:1024 lds
  v_mfma_f32_16x16x32_bf16 a[52:55], v[164:167], v[148:151], a[52:55]
  ds_read_b128 v[80:83], v18 offset:16384
  v_mfma_f32_16x16x32_bf16 a[84:87], v[168:171], v[148:151], a[84:87]
  v_mfma_f32_16x16x32_bf16 a[116:119], v[172:175], v[148:151], a[116:119]
  ds_read_b64_tr_b16 v[112:113], v24 offset:16384
  v_mfma_f32_16x16x32_bf16 a[148:151], v[148:151], v[176:179], a[148:151]
  s_mov_b32 s32, 59392
  buffer_load_dwordx4 v40, s[64:67], s32 offen offset:2048 lds
  v_mfma_f32_16x16x32_bf16 a[160:163], v[128:131], v[180:183], a[160:163]
  ds_read_b64_tr_b16 v[114:115], v24 offset:17408
  v_mfma_f32_16x16x32_bf16 a[164:167], v[132:135], v[180:183], a[164:167]
  v_mfma_f32_16x16x32_bf16 a[168:171], v[136:139], v[180:183], a[168:171]
  ds_read_b128 v[84:87], v18 offset:18432
  v_mfma_f32_16x16x32_bf16 a[172:175], v[140:143], v[180:183], a[172:175]
  v_mfma_f32_16x16x32_bf16 a[176:179], v[144:147], v[180:183], a[176:179]
  ds_read_b64_tr_b16 v[116:117], v25 offset:16384
  v_mfma_f32_16x16x32_bf16 a[180:183], v[148:151], v[180:183], a[180:183]
  buffer_load_dwordx4 v41, s[64:67], s32 offen offset:3072 lds
  v_mfma_f32_16x16x32_bf16 a[24:27], v[160:163], v[152:155], a[24:27]
  ds_read_b64_tr_b16 v[118:119], v25 offset:17408
  v_mfma_f32_16x16x32_bf16 a[56:59], v[164:167], v[152:155], a[56:59]
  v_mfma_f32_16x16x32_bf16 a[88:91], v[168:171], v[152:155], a[88:91]
  s_add_u32 m0, s39, 131072
  s_mov_b32 s34, 0
  ds_read_b128 v[88:91], v18 offset:20480
  v_mfma_f32_16x16x32_bf16 a[120:123], v[172:175], v[152:155], a[120:123]
  buffer_load_dwordx4 v42, s[60:63], s34 offen offset:0 lds
  v_mfma_f32_16x16x32_bf16 a[152:155], v[152:155], v[176:179], a[152:155]
  ds_read_b64_tr_b16 v[120:121], v26 offset:16384
  v_mfma_f32_16x16x32_bf16 a[184:187], v[152:155], v[180:183], a[184:187]
  v_mfma_f32_16x16x32_bf16 a[192:195], v[128:131], v[184:187], a[192:195]
  ds_read_b64_tr_b16 v[122:123], v26 offset:17408
  v_mfma_f32_16x16x32_bf16 a[196:199], v[132:135], v[184:187], a[196:199]
  s_mov_b32 s34, 31744
  buffer_load_dwordx4 v42, s[60:63], s34 offen offset:1024 lds
  v_mfma_f32_16x16x32_bf16 a[200:203], v[136:139], v[184:187], a[200:203]
  ds_read_b128 v[92:95], v18 offset:22528
  v_mfma_f32_16x16x32_bf16 a[204:207], v[140:143], v[184:187], a[204:207]
  v_mfma_f32_16x16x32_bf16 a[208:211], v[144:147], v[184:187], a[208:211]
  ds_read_b64_tr_b16 v[124:125], v27 offset:16384
  v_mfma_f32_16x16x32_bf16 a[212:215], v[148:151], v[184:187], a[212:215]
  s_mov_b32 s34, 63488
  buffer_load_dwordx4 v43, s[60:63], s34 offen offset:2048 lds
  v_mfma_f32_16x16x32_bf16 a[216:219], v[152:155], v[184:187], a[216:219]
  ds_read_b64_tr_b16 v[126:127], v27 offset:17408
  v_mfma_f32_16x16x32_bf16 a[28:31], v[160:163], v[156:159], a[28:31]
  v_mfma_f32_16x16x32_bf16 a[60:63], v[164:167], v[156:159], a[60:63]
  v_mfma_f32_16x16x32_bf16 a[92:95], v[168:171], v[156:159], a[92:95]
  v_mfma_f32_16x16x32_bf16 a[124:127], v[172:175], v[156:159], a[124:127]
  s_mov_b32 s34, 95232
  buffer_load_dwordx4 v43, s[60:63], s34 offen offset:3072 lds
  v_mfma_f32_16x16x32_bf16 a[156:159], v[156:159], v[176:179], a[156:159]
  v_mfma_f32_16x16x32_bf16 a[188:191], v[156:159], v[180:183], a[188:191]
  v_mfma_f32_16x16x32_bf16 a[220:223], v[156:159], v[184:187], a[220:223]
  v_mfma_f32_16x16x32_bf16 a[224:227], v[128:131], v[188:191], a[224:227]
  v_mfma_f32_16x16x32_bf16 a[228:231], v[132:135], v[188:191], a[228:231]
  v_mfma_f32_16x16x32_bf16 a[232:235], v[136:139], v[188:191], a[232:235]
  v_mfma_f32_16x16x32_bf16 a[236:239], v[140:143], v[188:191], a[236:239]
  v_mfma_f32_16x16x32_bf16 a[240:243], v[144:147], v[188:191], a[240:243]
  v_mfma_f32_16x16x32_bf16 a[244:247], v[148:151], v[188:191], a[244:247]
  v_mfma_f32_16x16x32_bf16 a[248:251], v[152:155], v[188:191], a[248:251]
  v_mfma_f32_16x16x32_bf16 a[252:255], v[156:159], v[188:191], a[252:255]
  v_readlane_b32 s100, v201, 47
  s_nop 0
  s_cmp_eq_u32 s100, 0
  s_cbranch_scc1 L_tagspin
L_tagok:
  s_getpc_b64 s[46:47]
L_pc3:
  s_lshr_b32 s31, s2, 3
  s_and_b32 s31, s31, 3
  s_lshl_b32 s31, s31, 15
  v_lshlrev_b32 v1, 7, v0
  v_add_u32 v1, s31, v1
  v_min_u32 v1, L_end-L_pc3, v1
  s_waitcnt lgkmcnt(0)
  v_mfma_f32_16x16x32_bf16 a[0:3], v[96:99], v[64:67], a[0:3]
  ds_read_b128 v[128:131], v19 offset:0
  v_mfma_f32_16x16x32_bf16 a[4:7], v[96:99], v[68:71], a[4:7]
  s_add_u32 m0, s36, 32768
  s_mov_b32 s32, 128
  v_mfma_f32_16x16x32_bf16 a[32:35], v[100:103], v[64:67], a[32:35]
  ds_read_b64_tr_b16 v[160:161], v24 offset:8192
  v_mfma_f32_16x16x32_bf16 a[36:39], v[100:103], v[68:71], a[36:39]
  buffer_load_dwordx4 v40, s[64:67], s32 offen offset:0 lds
  v_mfma_f32_16x16x32_bf16 a[8:11], v[96:99], v[72:75], a[8:11]
  ds_read_b64_tr_b16 v[162:163], v24 offset:9216
  v_mfma_f32_16x16x32_bf16 a[40:43], v[100:103], v[72:75], a[40:43]
  v_mfma_f32_16x16x32_bf16 a[64:67], v[104:107], v[64:67], a[64:67]
  ds_read_b128 v[132:135], v19 offset:2048
  v_mfma_f32_16x16x32_bf16 a[68:71], v[104:107], v[68:71], a[68:71]
  buffer_load_dwordx4 v41, s[64:67], s32 offen offset:1024 lds
  v_mfma_f32_16x16x32_bf16 a[72:75], v[104:107], v[72:75], a[72:75]
  ds_read_b64_tr_b16 v[164:165], v25 offset:8192
  v_mfma_f32_16x16x32_bf16 a[12:15], v[96:99], v[76:79], a[12:15]
  v_mfma_f32_16x16x32_bf16 a[44:47], v[100:103], v[76:79], a[44:47]
  s_mov_b32 s32, 18560
  ds_read_b64_tr_b16 v[166:167], v25 offset:9216
  v_mfma_f32_16x16x32_bf16 a[76:79], v[104:107], v[76:79], a[76:79]
  buffer_load_dwordx4 v40, s[64:67], s32 offen offset:2048 lds
  v_mfma_f32_16x16x32_bf16 a[96:99], v[108:111], v[64:67], a[96:99]
  ds_read_b128 v[136:139], v19 offset:4096
  v_mfma_f32_16x16x32_bf16 a[100:103], v[108:111], v[68:71], a[100:103]
  v_mfma_f32_16x16x32_bf16 a[104:107], v[108:111], v[72:75], a[104:107]
  ds_read_b64_tr_b16 v[168:169], v26 offset:8192
  v_mfma_f32_16x16x32_bf16 a[108:111], v[108:111], v[76:79], a[108:111]
  buffer_load_dwordx4 v41, s[64:67], s32 offen offset:3072 lds
  v_mfma_f32_16x16x32_bf16 a[16:19], v[96:99], v[80:83], a[16:19]
  ds_read_b64_tr_b16 v[170:171], v26 offset:9216
  v_mfma_f32_16x16x32_bf16 a[48:51], v[100:103], v[80:83], a[48:51]
  v_mfma_f32_16x16x32_bf16 a[80:83], v[104:107], v[80:83], a[80:83]
  ds_read_b128 v[140:143], v19 offset:6144
  v_mfma_f32_16x16x32_bf16 a[112:115], v[108:111], v[80:83], a[112:115]
  s_add_u32 m0, s36, 36864
  s_mov_b32 s32, 41088
  v_mfma_f32_16x16x32_bf16 a[128:131], v[64:67], v[112:115], a[128:131]
  ds_read_b64_tr_b16 v[172:173], v27 offset:8192
  v_mfma_f32_16x16x32_bf16 a[132:135], v[68:71], v[112:115], a[132:135]
  buffer_load_dwordx4 v40, s[64:67], s32 offen offset:0 lds
  v_mfma_f32_16x16x32_bf16 a[136:139], v[72:75], v[112:115], a[136:139]
  ds_read_b64_tr_b16 v[174:175], v27 offset:9216
  v_mfma_f32_16x16x32_bf16 a[140:143], v[76:79], v[112:115], a[140:143]
  v_mfma_f32_16x16x32_bf16 a[144:147], v[80:83], v[112:115], a[144:147]
  ds_read_b128 v[144:147], v19 offset:16384
  v_mfma_f32_16x16x32_bf16 a[20:23], v[96:99], v[84:87], a[20:23]
  buffer_load_dwordx4 v41, s[64:67], s32 offen offset:1024 lds
  v_mfma_f32_16x16x32_bf16 a[52:55], v[100:103], v[84:87], a[52:55]
  ds_read_b64_tr_b16 v[176:177], v24 offset:24576
  v_mfma_f32_16x16x32_bf16 a[84:87], v[104:107], v[84:87], a[84:87]
  v_mfma_f32_16x16x32_bf16 a[116:119], v[108:111], v[84:87], a[116:119]
  s_mov_b32 s32, 59520
  ds_read_b64_tr_b16 v[178:179], v24 offset:25600
  v_mfma_f32_16x16x32_bf16 a[148:151], v[84:87], v[112:115], a[148:151]
  buffer_load_dwordx4 v40, s[64:67], s32 offen offset:2048 lds
  v_mfma_f32_16x16x32_bf16 a[160:163], v[64:67], v[116:119], a[160:163]
  ds_read_b128 v[148:151], v19 offset:18432
  v_mfma_f32_16x16x32_bf16 a[164:167], v[68:71], v[116:119], a[164:167]
  v_mfma_f32_16x16x32_bf16 a[168:171], v[72:75], v[116:119], a[168:171]
  ds_read_b64_tr_b16 v[180:181], v25 offset:24576
  v_mfma_f32_16x16x32_bf16 a[172:175], v[76:79], v[116:119], a[172:175]
  buffer_load_dwordx4 v41, s[64:67], s32 offen offset:3072 lds
  v_mfma_f32_16x16x32_bf16 a[176:179], v[80:83], v[116:119], a[176:179]
  ds_read_b64_tr_b16 v[182:183], v25 offset:25600
  v_mfma_f32_16x16x32_bf16 a[180:183], v[84:87], v[116:119], a[180:183]
  v_mfma_f32_16x16x32_bf16 a[24:27], v[96:99], v[88:91], a[24:27]
  ds_read_b128 v[152:155], v19 offset:20480
  v_mfma_f32_16x16x32_bf16 a[56:59], v[100:103], v[88:91], a[56:59]
  s_add_u32 m0, s39, 147456
  s_mov_b32 s34, 524288
  v_mfma_f32_16x16x32_bf16 a[88:91], v[104:107], v[88:91], a[88:91]
  ds_read_b64_tr_b16 v[184:185], v26 offset:24576
  v_mfma_f32_16x16x32_bf16 a[120:123], v[108:111], v[88:91], a[120:123]
  buffer_load_dwordx4 v42, s[60:63], s34 offen offset:0 lds
  v_mfma_f32_16x16x32_bf16 a[152:155], v[88:91], v[112:115], a[152:155]
  ds_read_b64_tr_b16 v[186:187], v26 offset:25600
  v_mfma_f32_16x16x32_bf16 a[184:187], v[88:91], v[116:119], a[184:187]
  v_mfma_f32_16x16x32_bf16 a[192:195], v[64:67], v[120:123], a[192:195]
  s_mov_b32 s34, 556032
  ds_read_b128 v[156:159], v19 offset:22528
  v_mfma_f32_16x16x32_bf16 a[196:199], v[68:71], v[120:123], a[196:199]
  buffer_load_dwordx4 v42, s[60:63], s34 offen offset:1024 lds
  v_mfma_f32_16x16x32_bf16 a[200:203], v[72:75], v[120:123], a[200:203]
  ds_read_b64_tr_b16 v[188:189], v27 offset:24576
  v_mfma_f32_16x16x32_bf16 a[204:207], v[76:79], v[120:123], a[204:207]
  v_mfma_f32_16x16x32_bf16 a[208:211], v[80:83], v[120:123], a[208:211]
  s_mov_b32 s34, 587776
  ds_read_b64_tr_b16 v[190:191], v27 offset:25600
  v_mfma_f32_16x16x32_bf16 a[212:215], v[84:87], v[120:123], a[212:215]
  buffer_load_dwordx4 v43, s[60:63], s34 offen offset:2048 lds
  v_mfma_f32_16x16x32_bf16 a[216:219], v[88:91], v[120:123], a[216:219]
  v_mfma_f32_16x16x32_bf16 a[28:31], v[96:99], v[92:95], a[28:31]
  v_mfma_f32_16x16x32_bf16 a[60:63], v[100:103], v[92:95], a[60:63]
  v_mfma_f32_16x16x32_bf16 a[92:95], v[104:107], v[92:95], a[92:95]
  s_mov_b32 s34, 619520
  buffer_load_dwordx4 v43, s[60:63], s34 offen offset:3072 lds
  v_mfma_f32_16x16x32_bf16 a[124:127], v[108:111], v[92:95], a[124:127]
  v_mfma_f32_16x16x32_bf16 a[156:159], v[92:95], v[112:115], a[156:159]
  v_mfma_f32_16x16x32_bf16 a[188:191], v[92:95], v[116:119], a[188:191]
  v_mfma_f32_16x16x32_bf16 a[220:223], v[92:95], v[120:123], a[220:223]
  global_load_dword v61, v1, s[46:47]
  v_mfma_f32_16x16x32_bf16 a[224:227], v[64:67], v[124:127], a[224:227]
  v_mfma_f32_16x16x32_bf16 a[228:231], v[68:71], v[124:127], a[228:231]
  v_mfma_f32_16x16x32_bf16 a[232:235], v[72:75], v[124:127], a[232:235]
  v_mfma_f32_16x16x32_bf16 a[236:239], v[76:79], v[124:127], a[236:239]
  v_mfma_f32_16x16x32_bf16 a[240:243], v[80:83], v[124:127], a[240:243]
  v_mfma_f32_16x16x32_bf16 a[244:247], v[84:87], v[124:127], a[244:247]
  v_mfma_f32_16x16x32_bf16 a[248:251], v[88:91], v[124:127], a[248:251]
  v_mfma_f32_16x16x32_bf16 a[252:255], v[92:95], v[124:127], a[252:255]
  s_waitcnt lgkmcnt(0)
  v_mfma_f32_16x16x32_bf16 a[0:3], v[160:163], v[128:131], a[0:3]
  v_mfma_f32_16x16x32_bf16 a[4:7], v[160:163], v[132:135], a[4:7]
  s_waitcnt vmcnt(13) lgkmcnt(0)
  s_barrier
  v_mfma_f32_16x16x32_bf16 a[32:35], v[164:167], v[128:131], a[32:35]
  s_add_u32 m0, s36, 65536
  s_mov_b32 s32, 256
  ds_read_b128 v[8:11], v44 offset:0
  v_mfma_f32_16x16x32_bf16 a[36:39], v[164:167], v[132:135], a[36:39]
  buffer_load_dwordx4 v40, s[64:67], s32 offen offset:0 lds
  v_mfma_f32_16x16x32_bf16 a[8:11], v[160:163], v[136:139], a[8:11]
  ds_read_b128 v[12:15], v46 offset:0
  v_mfma_f32_16x16x32_bf16 a[40:43], v[164:167], v[136:139], a[40:43]
  v_mfma_f32_16x16x32_bf16 a[64:67], v[168:171], v[128:131], a[64:67]
  ds_read_b128 v[16:19], v44 offset:16384
  v_mfma_f32_16x16x32_bf16 a[68:71], v[168:171], v[132:135], a[68:71]
  buffer_load_dwordx4 v41, s[64:67], s32 offen offset:1024 lds
  v_mfma_f32_16x16x32_bf16 a[72:75], v[168:171], v[136:139], a[72:75]
  ds_read_b128 v[20:23], v46 offset:16384
  v_mfma_f32_16x16x32_bf16 a[12:15], v[160:163], v[140:143], a[12:15]
  v_mfma_f32_16x16x32_bf16 a[44:47], v[164:167], v[140:143], a[44:47]
  ds_read_b64_tr_b16 v[64:65], v48 offset:32768
  v_mfma_f32_16x16x32_bf16 a[76:79], v[168:171], v[140:143], a[76:79]
  s_mov_b32 s32, 18688
  buffer_load_dwordx4 v40, s[64:67], s32 offen offset:2048 lds
  v_mfma_f32_16x16x32_bf16 a[96:99], v[172:175], v[128:131], a[96:99]
  ds_read_b64_tr_b16 v[66:67], v48 offset:33792
  v_mfma_f32_16x16x32_bf16 a[100:103], v[172:175], v[132:135], a[100:103]
  v_mfma_f32_16x16x32_bf16 a[104:107], v[172:175], v[136:139], a[104:107]
  ds_read_b64_tr_b16 v[68:69], v49 offset:32768
  v_mfma_f32_16x16x32_bf16 a[108:111], v[172:175], v[140:143], a[108:111]
  v_mfma_f32_16x16x32_bf16 a[16:19], v[160:163], v[144:147], a[16:19]
  ds_read_b64_tr_b16 v[70:71], v49 offset:33792
  v_mfma_f32_16x16x32_bf16 a[48:51], v[164:167], v[144:147], a[48:51]
  buffer_load_dwordx4 v41, s[64:67], s32 offen offset:3072 lds
  v_mfma_f32_16x16x32_bf16 a[80:83], v[168:171], v[144:147], a[80:83]
  ds_read_b64_tr_b16 v[72:73], v50 offset:32768
  v_mfma_f32_16x16x32_bf16 a[112:115], v[172:175], v[144:147], a[112:115]
  v_mfma_f32_16x16x32_bf16 a[128:131], v[128:131], v[176:179], a[128:131]
  s_add_u32 m0, s36, 69632
  s_mov_b32 s32, 41216
  ds_read_b64_tr_b16 v[74:75], v50 offset:33792
  v_mfma_f32_16x16x32_bf16 a[132:135], v[132:135], v[176:179], a[132:135]
  buffer_load_dwordx4 v40, s[64:67], s32 offen offset:0 lds
  v_mfma_f32_16x16x32_bf16 a[136:139], v[136:139], v[176:179], a[136:139]
  ds_read_b64_tr_b16 v[76:77], v51 offset:32768
  v_mfma_f32_16x16x32_bf16 a[140:143], v[140:143], v[176:179], a[140:143]
  v_mfma_f32_16x16x32_bf16 a[144:147], v[144:147], v[176:179], a[144:147]
  ds_read_b64_tr_b16 v[78:79], v51 offset:33792
  v_mfma_f32_16x16x32_bf16 a[20:23], v[160:163], v[148:151], a[20:23]
  buffer_load_dwordx4 v41, s[64:67], s32 offen offset:1024 lds
  v_mfma_f32_16x16x32_bf16 a[52:55], v[164:167], v[148:151], a[52:55]
  ds_read_b64_tr_b16 v[80:81], v52 offset:32768
  v_mfma_f32_16x16x32_bf16 a[84:87], v[168:171], v[148:151], a[84:87]
  v_mfma_f32_16x16x32_bf16 a[116:119], v[172:175], v[148:151], a[116:119]
  ds_read_b64_tr_b16 v[82:83], v52 offset:33792
  v_mfma_f32_16x16x32_bf16 a[148:151], v[148:151], v[176:179], a[148:151]
  s_mov_b32 s32, 59648
  buffer_load_dwordx4 v40, s[64:67], s32 offen offset:2048 lds
  v_mfma_f32_16x16x32_bf16 a[160:163], v[128:131], v[180:183], a[160:163]
  ds_read_b64_tr_b16 v[84:85], v53 offset:32768
  v_mfma_f32_16x16x32_bf16 a[164:167], v[132:135], v[180:183], a[164:167]
  v_mfma_f32_16x16x32_bf16 a[168:171], v[136:139], v[180:183], a[168:171]
  ds_read_b64_tr_b16 v[86:87], v53 offset:33792
  v_mfma_f32_16x16x32_bf16 a[172:175], v[140:143], v[180:183], a[172:175]
  v_mfma_f32_16x16x32_bf16 a[176:179], v[144:147], v[180:183], a[176:179]
  ds_read_b64_tr_b16 v[88:89], v54 offset:32768
  v_mfma_f32_16x16x32_bf16 a[180:183], v[148:151], v[180:183], a[180:183]
  buffer_load_dwordx4 v41, s[64:67], s32 offen offset:3072 lds
  v_mfma_f32_16x16x32_bf16 a[24:27], v[160:163], v[152:155], a[24:27]
  ds_read_b64_tr_b16 v[90:91], v54 offset:33792
  v_mfma_f32_16x16x32_bf16 a[56:59], v[164:167], v[152:155], a[56:59]
  v_mfma_f32_16x16x32_bf16 a[88:91], v[168:171], v[152:155], a[88:91]
  s_add_u32 m0, s39, 98304
  s_mov_b32 s34, 1048576
  ds_read_b64_tr_b16 v[92:93], v55 offset:32768
  v_mfma_f32_16x16x32_bf16 a[120:123], v[172:175], v[152:155], a[120:123]
  buffer_load_dwordx4 v42, s[60:63], s34 offen offset:0 lds
  v_mfma_f32_16x16x32_bf16 a[152:155], v[152:155], v[176:179], a[152:155]
  ds_read_b64_tr_b16 v[94:95], v55 offset:33792
  v_mfma_f32_16x16x32_bf16 a[184:187], v[152:155], v[180:183], a[184:187]
  v_mfma_f32_16x16x32_bf16 a[192:195], v[128:131], v[184:187], a[192:195]
  v_mfma_f32_16x16x32_bf16 a[196:199], v[132:135], v[184:187], a[196:199]
  s_mov_b32 s34, 1080320
  buffer_load_dwordx4 v42, s[60:63], s34 offen offset:1024 lds
  v_mfma_f32_16x16x32_bf16 a[200:203], v[136:139], v[184:187], a[200:203]
  v_mfma_f32_16x16x32_bf16 a[204:207], v[140:143], v[184:187], a[204:207]
  v_mfma_f32_16x16x32_bf16 a[208:211], v[144:147], v[184:187], a[208:211]
  v_mfma_f32_16x16x32_bf16 a[212:215], v[148:151], v[184:187], a[212:215]
  s_mov_b32 s34, 1112064
  buffer_load_dwordx4 v43, s[60:63], s34 offen offset:2048 lds
  v_mfma_f32_16x16x32_bf16 a[216:219], v[152:155], v[184:187], a[216:219]
  v_mfma_f32_16x16x32_bf16 a[28:31], v[160:163], v[156:159], a[28:31]
  v_mfma_f32_16x16x32_bf16 a[60:63], v[164:167], v[156:159], a[60:63]
  v_mfma_f32_16x16x32_bf16 a[92:95], v[168:171], v[156:159], a[92:95]
  v_mfma_f32_16x16x32_bf16 a[124:127], v[172:175], v[156:159], a[124:127]
  s_mov_b32 s34, 1143808
  buffer_load_dwordx4 v43, s[60:63], s34 offen offset:3072 lds
  v_mfma_f32_16x16x32_bf16 a[156:159], v[156:159], v[176:179], a[156:159]
  v_mfma_f32_16x16x32_bf16 a[188:191], v[156:159], v[180:183], a[188:191]
  v_mfma_f32_16x16x32_bf16 a[220:223], v[156:159], v[184:187], a[220:223]
  v_mfma_f32_16x16x32_bf16 a[224:227], v[128:131], v[188:191], a[224:227]
  v_mfma_f32_16x16x32_bf16 a[228:231], v[132:135], v[188:191], a[228:231]
  v_mfma_f32_16x16x32_bf16 a[232:235], v[136:139], v[188:191], a[232:235]
  v_mfma_f32_16x16x32_bf16 a[236:239], v[140:143], v[188:191], a[236:239]
  v_mfma_f32_16x16x32_bf16 a[240:243], v[144:147], v[188:191], a[240:243]
  v_mfma_f32_16x16x32_bf16 a[244:247], v[148:151], v[188:191], a[244:247]
  v_mfma_f32_16x16x32_bf16 a[248:251], v[152:155], v[188:191], a[248:251]
  v_mfma_f32_16x16x32_bf16 a[252:255], v[156:159], v[188:191], a[252:255]
  s_waitcnt lgkmcnt(0)
  v_mfma_f32_16x16x32_bf16 v[128:131], v[64:67], v[8:11], 0
  ds_read_b64_tr_b16 v[96:97], v48 offset:40960
  ds_read_b64_tr_b16 v[98:99], v48 offset:41984
  v_mfma_f32_16x16x32_bf16 v[132:135], v[64:67], v[12:15], 0
  ds_read_b128 v[24:27], v45 offset:0
  v_accvgpr_read_b32 v112, a0
  v_mfma_f32_16x16x32_bf16 v[136:139], v[64:67], v[16:19], 0
  v_accvgpr_read_b32 v113, a1
  v_accvgpr_read_b32 v114, a2
  v_mfma_f32_16x16x32_bf16 v[140:143], v[64:67], v[20:23], 0
  ds_read_b64_tr_b16 v[100:101], v49 offset:40960
  ds_read_b64_tr_b16 v[102:103], v49 offset:41984
  v_mfma_f32_16x16x32_bf16 v[144:147], v[68:71], v[8:11], 0
  ds_read_b128 v[28:31], v47 offset:0
  v_accvgpr_read_b32 v115, a3
  v_mfma_f32_16x16x32_bf16 v[148:151], v[68:71], v[12:15], 0
  v_accvgpr_read_b32 v116, a32
  v_accvgpr_read_b32 v117, a33
  v_mfma_f32_16x16x32_bf16 v[152:155], v[68:71], v[16:19], 0
  ds_read_b64_tr_b16 v[104:105], v50 offset:40960
  ds_read_b64_tr_b16 v[106:107], v50 offset:41984
  v_mfma_f32_16x16x32_bf16 v[156:159], v[68:71], v[20:23], 0
  ds_read_b128 v[32:35], v45 offset:16384
  v_accvgpr_read_b32 v118, a34
  v_mfma_f32_16x16x32_bf16 v[160:163], v[72:75], v[8:11], 0
  v_accvgpr_read_b32 v119, a35
  v_mul_f32 v112, s44, v112
  v_mfma_f32_16x16x32_bf16 v[164:167], v[72:75], v[12:15], 0
  ds_read_b64_tr_b16 v[108:109], v51 offset:40960
  ds_read_b64_tr_b16 v[110:111], v51 offset:41984
  v_mfma_f32_16x16x32_bf16 v[168:171], v[72:75], v[16:19], 0
  ds_read_b128 v[36:39], v47 offset:16384
  v_mul_f32 v113, s44, v113
  v_mfma_f32_16x16x32_bf16 v[172:175], v[72:75], v[20:23], 0
  v_mul_f32 v114, s44, v114
  v_mul_f32 v115, s44, v115
  v_mfma_f32_16x16x32_bf16 v[176:179], v[76:79], v[8:11], 0
  ds_read_b64_tr_b16 v[64:65], v52 offset:40960
  ds_read_b64_tr_b16 v[66:67], v52 offset:41984
  v_mfma_f32_16x16x32_bf16 v[180:183], v[76:79], v[12:15], 0
  v_mul_f32 v116, s44, v116
  v_mul_f32 v117, s44, v117
  v_mfma_f32_16x16x32_bf16 v[184:187], v[76:79], v[16:19], 0
  v_mul_f32 v118, s44, v118
  v_mul_f32 v119, s44, v119
  v_mfma_f32_16x16x32_bf16 v[188:191], v[76:79], v[20:23], 0
  ds_read_b64_tr_b16 v[68:69], v53 offset:40960
  ds_read_b64_tr_b16 v[70:71], v53 offset:41984
  v_mfma_f32_16x16x32_bf16 v[192:195], v[80:83], v[8:11], 0
  v_cvt_pk_bf16_f32 v120, v112, v113
  v_cvt_pk_bf16_f32 v121, v114, v115
  v_mfma_f32_16x16x32_bf16 v[196:199], v[80:83], v[12:15], 0
  v_cvt_pk_bf16_f32 v122, v116, v117
  v_cvt_pk_bf16_f32 v123, v118, v119
  v_mfma_f32_16x16x32_bf16 v[200:203], v[80:83], v[16:19], 0
  ds_read_b64_tr_b16 v[72:73], v54 offset:40960
  ds_read_b64_tr_b16 v[74:75], v54 offset:41984
  v_mfma_f32_16x16x32_bf16 v[204:207], v[80:83], v[20:23], 0
  v_accvgpr_write_b32 a0, v120
  v_accvgpr_write_b32 a1, v121
  v_mfma_f32_16x16x32_bf16 v[208:211], v[84:87], v[8:11], 0
  v_accvgpr_write_b32 a2, v122
  v_accvgpr_write_b32 a3, v123
  v_mfma_f32_16x16x32_bf16 v[212:215], v[84:87], v[12:15], 0
  ds_read_b64_tr_b16 v[76:77], v55 offset:40960
  ds_read_b64_tr_b16 v[78:79], v55 offset:41984
  v_mfma_f32_16x16x32_bf16 v[216:219], v[84:87], v[16:19], 0
  v_accvgpr_read_b32 v112, a64
  v_accvgpr_read_b32 v113, a65
  v_mfma_f32_16x16x32_bf16 v[220:223], v[84:87], v[20:23], 0
  v_accvgpr_read_b32 v114, a66
  v_accvgpr_read_b32 v115, a67
  v_mfma_f32_16x16x32_bf16 v[224:227], v[88:91], v[8:11], 0
  v_accvgpr_read_b32 v116, a96
  v_accvgpr_read_b32 v117, a97
  v_mfma_f32_16x16x32_bf16 v[228:231], v[88:91], v[12:15], 0
  v_accvgpr_read_b32 v118, a98
  v_accvgpr_read_b32 v119, a99
  v_mfma_f32_16x16x32_bf16 v[232:235], v[88:91], v[16:19], 0
  v_mul_f32 v112, s44, v112
  v_mul_f32 v113, s44, v113
  v_mfma_f32_16x16x32_bf16 v[236:239], v[88:91], v[20:23], 0
  v_mul_f32 v114, s44, v114
  v_mul_f32 v115, s44, v115
  v_mfma_f32_16x16x32_bf16 v[240:243], v[92:95], v[8:11], 0
  v_mul_f32 v116, s44, v116
  v_mul_f32 v117, s44, v117
  v_mfma_f32_16x16x32_bf16 v[244:247], v[92:95], v[12:15], 0
  v_mul_f32 v118, s44, v118
  v_mul_f32 v119, s44, v119
  v_mfma_f32_16x16x32_bf16 v[248:251], v[92:95], v[16:19], 0
  v_cvt_pk_bf16_f32 v124, v112, v113
  v_cvt_pk_bf16_f32 v125, v114, v115
  v_mfma_f32_16x16x32_bf16 v[252:255], v[92:95], v[20:23], 0
  s_waitcnt lgkmcnt(0)
  v_cvt_pk_bf16_f32 v126, v116, v117
  v_cvt_pk_bf16_f32 v127, v118, v119
  v_accvgpr_write_b32 a64, v124
  v_accvgpr_write_b32 a65, v125
  v_accvgpr_write_b32 a66, v126
  v_accvgpr_write_b32 a67, v127
  v_accvgpr_read_b32 v112, a4
  v_accvgpr_read_b32 v113, a5
  v_mfma_f32_16x16x32_bf16 v[128:131], v[96:99], v[24:27], v[128:131]
  v_accvgpr_read_b32 v114, a6
  v_accvgpr_read_b32 v115, a7
  v_mfma_f32_16x16x32_bf16 v[132:135], v[96:99], v[28:31], v[132:135]
  s_waitcnt vmcnt(13) lgkmcnt(0)
  s_barrier
  v_mfma_f32_16x16x32_bf16 v[136:139], v[96:99], v[32:35], v[136:139]
  s_add_u32 m0, s36, 0
  ds_read_b64_tr_b16 v[80:81], v48 offset:49152
  ds_read_b64_tr_b16 v[82:83], v48 offset:50176
  v_mfma_f32_16x16x32_bf16 v[140:143], v[96:99], v[36:39], v[140:143]
  s_mov_b32 s32, 384
  ds_read_b128 v[8:11], v44 offset:32768
  v_accvgpr_read_b32 v116, a36
  v_mfma_f32_16x16x32_bf16 v[144:147], v[100:103], v[24:27], v[144:147]
  buffer_load_dwordx4 v40, s[64:67], s32 offen offset:0 lds
  v_mfma_f32_16x16x32_bf16 v[148:151], v[100:103], v[28:31], v[148:151]
  ds_read_b64_tr_b16 v[84:85], v49 offset:49152
  ds_read_b64_tr_b16 v[86:87], v49 offset:50176
  v_mfma_f32_16x16x32_bf16 v[152:155], v[100:103], v[32:35], v[152:155]
  ds_read_b128 v[12:15], v46 offset:32768
  v_accvgpr_read_b32 v117, a37
  v_mfma_f32_16x16x32_bf16 v[156:159], v[100:103], v[36:39], v[156:159]
  v_accvgpr_read_b32 v118, a38
  v_accvgpr_read_b32 v119, a39
  v_mfma_f32_16x16x32_bf16 v[160:163], v[104:107], v[24:27], v[160:163]
  ds_read_b64_tr_b16 v[88:89], v50 offset:49152
  ds_read_b64_tr_b16 v[90:91], v50 offset:50176
  v_mfma_f32_16x16x32_bf16 v[164:167], v[104:107], v[28:31], v[164:167]
  ds_read_b128 v[16:19], v44 offset:49152
  v_mul_f32 v112, s44, v112
  v_mfma_f32_16x16x32_bf16 v[168:171], v[104:107], v[32:35], v[168:171]
  buffer_load_dwordx4 v41, s[64:67], s32 offen offset:1024 lds
  v_mfma_f32_16x16x32_bf16 v[172:175], v[104:107], v[36:39], v[172:175]
  ds_read_b64_tr_b16 v[92:93], v51 offset:49152
  ds_read_b64_tr_b16 v[94:95], v51 offset:50176
  v_mfma_f32_16x16x32_bf16 v[176:179], v[108:111], v[24:27], v[176:179]
  ds_read_b128 v[20:23], v46 offset:49152
  v_mul_f32 v113, s44, v113
  v_mfma_f32_16x16x32_bf16 v[180:183], v[108:111], v[28:31], v[180:183]
  s_mov_b32 s32, 18816
  v_mul_f32 v114, s44, v114
  v_mul_f32 v115, s44, v115
  v_mfma_f32_16x16x32_bf16 v[184:187], v[108:111], v[32:35], v[184:187]
  ds_read_b64_tr_b16 v[96:97], v52 offset:49152
  ds_read_b64_tr_b16 v[98:99], v52 offset:50176
  v_mfma_f32_16x16x32_bf16 v[188:191], v[108:111], v[36:39], v[188:191]
  buffer_load_dwordx4 v40, s[64:67], s32 offen offset:2048 lds
  v_mfma_f32_16x16x32_bf16 v[192:195], v[64:67], v[24:27], v[192:195]
  v_mul_f32 v116, s44, v116
  v_mul_f32 v117, s44, v117
  v_mfma_f32_16x16x32_bf16 v[196:199], v[64:67], v[28:31], v[196:199]
  ds_read_b64_tr_b16 v[100:101], v53 offset:49152
  ds_read_b64_tr_b16 v[102:103], v53 offset:50176
  v_mfma_f32_16x16x32_bf16 v[200:203], v[64:67], v[32:35], v[200:203]
  v_mul_f32 v118, s44, v118
  v_mul_f32 v119, s44, v119
  v_mfma_f32_16x16x32_bf16 v[204:207], v[64:67], v[36:39], v[204:207]
  buffer_load_dwordx4 v41, s[64:67], s32 offen offset:3072 lds
  v_mfma_f32_16x16x32_bf16 v[208:211], v[68:71], v[24:27], v[208:211]
  ds_read_b64_tr_b16 v[104:105], v54 offset:49152
  ds_read_b64_tr_b16 v[106:107], v54 offset:50176
  v_mfma_f32_16x16x32_bf16 v[212:215], v[68:71], v[28:31], v[212:215]
  v_cvt_pk_bf16_f32 v120, v112, v113
  v_cvt_pk_bf16_f32 v121, v114, v115
  v_mfma_f32_16x16x32_bf16 v[216:219], v[68:71], v[32:35], v[216:219]
  s_add_u32 m0, s36, 4096
  s_mov_b32 s32, 41344
  v_cvt_pk_bf16_f32 v122, v116, v117
  v_mfma_f32_16x16x32_bf16 v[220:223], v[68:71], v[36:39], v[220:223]
  ds_read_b64_tr_b16 v[108:109], v55 offset:49152
  ds_read_b64_tr_b16 v[110:111], v55 offset:50176
  v_mfma_f32_16x16x32_bf16 v[224:227], v[72:75], v[24:27], v[224:227]
  buffer_load_dwordx4 v40, s[64:67], s32 offen offset:0 lds
  v_mfma_f32_16x16x32_bf16 v[228:231], v[72:75], v[28:31], v[228:231]
  v_cvt_pk_bf16_f32 v123, v118, v119
  v_accvgpr_write_b32 a4, v120
  v_mfma_f32_16x16x32_bf16 v[232:235], v[72:75], v[32:35], v[232:235]
  v_accvgpr_write_b32 a5, v121
  v_accvgpr_write_b32 a6, v122
  v_mfma_f32_16x16x32_bf16 v[236:239], v[72:75], v[36:39], v[236:239]
  v_accvgpr_write_b32 a7, v123
  v_accvgpr_read_b32 v112, a68
  v_mfma_f32_16x16x32_bf16 v[240:243], v[76:79], v[24:27], v[240:243]
  buffer_load_dwordx4 v41, s[64:67], s32 offen offset:1024 lds
  v_mfma_f32_16x16x32_bf16 v[244:247], v[76:79], v[28:31], v[244:247]
  v_accvgpr_read_b32 v113, a69
  v_accvgpr_read_b32 v114, a70
  v_mfma_f32_16x16x32_bf16 v[248:251], v[76:79], v[32:35], v[248:251]
  v_accvgpr_read_b32 v115, a71
  v_accvgpr_read_b32 v116, a100
  v_mfma_f32_16x16x32_bf16 v[252:255], v[76:79], v[36:39], v[252:255]
  s_waitcnt lgkmcnt(0)
  v_accvgpr_read_b32 v117, a101
  v_accvgpr_read_b32 v118, a102
  v_accvgpr_read_b32 v119, a103
  v_mul_f32 v112, s44, v112
  v_mul_f32 v113, s44, v113
  v_mul_f32 v114, s44, v114
  v_mul_f32 v115, s44, v115
  v_mul_f32 v116, s44, v116
  v_mul_f32 v117, s44, v117
  v_mfma_f32_16x16x32_bf16 v[128:131], v[80:83], v[8:11], v[128:131]
  s_mov_b32 s32, 59776
  ds_read_b64_tr_b16 v[64:65], v48 offset:57344
  ds_read_b64_tr_b16 v[66:67], v48 offset:58368
  v_mfma_f32_16x16x32_bf16 v[132:135], v[80:83], v[12:15], v[132:135]
  ds_read_b128 v[24:27], v45 offset:32768
  v_mul_f32 v118, s44, v118
  v_mfma_f32_16x16x32_bf16 v[136:139], v[80:83], v[16:19], v[136:139]
  buffer_load_dwordx4 v40, s[64:67], s32 offen offset:2048 lds
  v_mfma_f32_16x16x32_bf16 v[140:143], v[80:83], v[20:23], v[140:143]
  ds_read_b64_tr_b16 v[68:69], v49 offset:57344
  ds_read_b64_tr_b16 v[70:71], v49 offset:58368
  v_mfma_f32_16x16x32_bf16 v[144:147], v[84:87], v[8:11], v[144:147]
  ds_read_b128 v[28:31], v47 offset:32768
  v_mul_f32 v119, s44, v119
  v_mfma_f32_16x16x32_bf16 v[148:151], v[84:87], v[12:15], v[148:151]
  v_cvt_pk_bf16_f32 v124, v112, v113
  v_cvt_pk_bf16_f32 v125, v114, v115
  v_mfma_f32_16x16x32_bf16 v[152:155], v[84:87], v[16:19], v[152:155]
  ds_read_b64_tr_b16 v[72:73], v50 offset:57344
  ds_read_b64_tr_b16 v[74:75], v50 offset:58368
  v_mfma_f32_16x16x32_bf16 v[156:159], v[84:87], v[20:23], v[156:159]
  ds_read_b128 v[32:35], v45 offset:49152
  v_cvt_pk_bf16_f32 v126, v116, v117
  v_mfma_f32_16x16x32_bf16 v[160:163], v[88:91], v[8:11], v[160:163]
  buffer_load_dwordx4 v41, s[64:67], s32 offen offset:3072 lds
  v_mfma_f32_16x16x32_bf16 v[164:167], v[88:91], v[12:15], v[164:167]
  ds_read_b64_tr_b16 v[76:77], v51 offset:57344
  ds_read_b64_tr_b16 v[78:79], v51 offset:58368
  v_mfma_f32_16x16x32_bf16 v[168:171], v[88:91], v[16:19], v[168:171]
  ds_read_b128 v[36:39], v47 offset:49152
  v_cvt_pk_bf16_f32 v127, v118, v119
  v_mfma_f32_16x16x32_bf16 v[172:175], v[88:91], v[20:23], v[172:175]
  s_add_u32 m0, s39, 131072
  s_mov_b32 s34, 1572864
  v_accvgpr_write_b32 a68, v124
  v_mfma_f32_16x16x32_bf16 v[176:179], v[92:95], v[8:11], v[176:179]
  ds_read_b64_tr_b16 v[80:81], v52 offset:57344
  ds_read_b64_tr_b16 v[82:83], v52 offset:58368
  v_mfma_f32_16x16x32_bf16 v[180:183], v[92:95], v[12:15], v[180:183]
  buffer_load_dwordx4 v42, s[60:63], s34 offen offset:0 lds
  v_mfma_f32_16x16x32_bf16 v[184:187], v[92:95], v[16:19], v[184:187]
  v_accvgpr_write_b32 a69, v125
  v_accvgpr_write_b32 a70, v126
  v_mfma_f32_16x16x32_bf16 v[188:191], v[92:95], v[20:23], v[188:191]
  s_mov_b32 s34, 1604608
  ds_read_b64_tr_b16 v[84:85], v53 offset:57344
  ds_read_b64_tr_b16 v[86:87], v53 offset:58368
  v_mfma_f32_16x16x32_bf16 v[192:195], v[96:99], v[8:11], v[192:195]
  v_accvgpr_write_b32 a71, v127
  v_accvgpr_read_b32 v112, a8
  v_mfma_f32_16x16x32_bf16 v[196:199], v[96:99], v[12:15], v[196:199]
  buffer_load_dwordx4 v42, s[60:63], s34 offen offset:1024 lds
  v_mfma_f32_16x16x32_bf16 v[200:203], v[96:99], v[16:19], v[200:203]
  ds_read_b64_tr_b16 v[88:89], v54 offset:57344
  ds_read_b64_tr_b16 v[90:91], v54 offset:58368
  v_mfma_f32_16x16x32_bf16 v[204:207], v[96:99], v[20:23], v[204:207]
  v_accvgpr_read_b32 v113, a9
  v_accvgpr_read_b32 v114, a10
  v_mfma_f32_16x16x32_bf16 v[208:211], v[100:103], v[8:11], v[208:211]
  s_mov_b32 s34, 1636352
  v_accvgpr_read_b32 v115, a11
  v_accvgpr_read_b32 v116, a40
  v_mfma_f32_16x16x32_bf16 v[212:215], v[100:103], v[12:15], v[212:215]
  ds_read_b64_tr_b16 v[92:93], v55 offset:57344
  ds_read_b64_tr_b16 v[94:95], v55 offset:58368
  v_mfma_f32_16x16x32_bf16 v[216:219], v[100:103], v[16:19], v[216:219]
  buffer_load_dwordx4 v43, s[60:63], s34 offen offset:2048 lds
  v_mfma_f32_16x16x32_bf16 v[220:223], v[100:103], v[20:23], v[220:223]
  v_accvgpr_read_b32 v117, a41
  v_accvgpr_read_b32 v118, a42
  v_mfma_f32_16x16x32_bf16 v[224:227], v[104:107], v[8:11], v[224:227]
  s_mov_b32 s34, 1668096
  v_accvgpr_read_b32 v119, a43
  v_mul_f32 v112, s44, v112
  v_mfma_f32_16x16x32_bf16 v[228:231], v[104:107], v[12:15], v[228:231]
  v_mul_f32 v113, s44, v113
  v_mul_f32 v114, s44, v114
  v_mfma_f32_16x16x32_bf16 v[232:235], v[104:107], v[16:19], v[232:235]
  buffer_load_dwordx4 v43, s[60:63], s34 offen offset:3072 lds
  v_mfma_f32_16x16x32_bf16 v[236:239], v[104:107], v[20:23], v[236:239]
  v_mul_f32 v115, s44, v115
  v_mul_f32 v116, s44, v116
  v_mfma_f32_16x16x32_bf16 v[240:243], v[108:111], v[8:11], v[240:243]
  v_mul_f32 v117, s44, v117
  v_mul_f32 v118, s44, v118
  v_mfma_f32_16x16x32_bf16 v[244:247], v[108:111], v[12:15], v[244:247]
  v_mul_f32 v119, s44, v119
  v_cvt_pk_bf16_f32 v120, v112, v113
  v_mfma_f32_16x16x32_bf16 v[248:251], v[108:111], v[16:19], v[248:251]
  v_cvt_pk_bf16_f32 v121, v114, v115
  v_cvt_pk_bf16_f32 v122, v116, v117
  v_mfma_f32_16x16x32_bf16 v[252:255], v[108:111], v[20:23], v[252:255]
  s_waitcnt lgkmcnt(0)
  v_cvt_pk_bf16_f32 v123, v118, v119
  v_accvgpr_write_b32 a8, v120
  v_accvgpr_write_b32 a9, v121
  v_accvgpr_write_b32 a10, v122
  v_accvgpr_write_b32 a11, v123
  v_accvgpr_read_b32 v112, a72
  v_accvgpr_read_b32 v113, a73
  v_accvgpr_read_b32 v114, a74
  v_accvgpr_read_b32 v115, a75
  v_mfma_f32_16x16x32_bf16 v[128:131], v[64:67], v[24:27], v[128:131]
  v_add_u32 v44, 0x10000, v44
  v_add_u32 v45, 0x10000, v45
  v_mfma_f32_16x16x32_bf16 v[132:135], v[64:67], v[28:31], v[132:135]
  s_waitcnt vmcnt(12) lgkmcnt(0)
  s_barrier
  v_mfma_f32_16x16x32_bf16 v[136:139], v[64:67], v[32:35], v[136:139]
  s_add_u32 m0, s36, 32768
  v_add_u32 v46, 0x10000, v46
  v_add_u32 v47, 0x10000, v47
  v_mfma_f32_16x16x32_bf16 v[140:143], v[64:67], v[36:39], v[140:143]
  s_mov_b32 s32, 512
  ds_read_b64_tr_b16 v[96:97], v48 offset:0
  ds_read_b64_tr_b16 v[98:99], v48 offset:1024
  v_mfma_f32_16x16x32_bf16 v[144:147], v[68:71], v[24:27], v[144:147]
  ds_read_b128 v[8:11], v44 offset:0
  v_accvgpr_read_b32 v116, a104
  v_mfma_f32_16x16x32_bf16 v[148:151], v[68:71], v[28:31], v[148:151]
  ds_read_b64_tr_b16 v[100:101], v49 offset:0
  ds_read_b64_tr_b16 v[102:103], v49 offset:1024
  v_mfma_f32_16x16x32_bf16 v[152:155], v[68:71], v[32:35], v[152:155]
  ds_read_b128 v[12:15], v46 offset:0
  v_accvgpr_read_b32 v117, a105
  v_mfma_f32_16x16x32_bf16 v[156:159], v[68:71], v[36:39], v[156:159]
  buffer_load_dwordx4 v40, s[64:67], s32 offen offset:0 lds
  v_mfma_f32_16x16x32_bf16 v[160:163], v[72:75], v[24:27], v[160:163]
  ds_read_b64_tr_b16 v[104:105], v50 offset:0
  ds_read_b64_tr_b16 v[106:107], v50 offset:1024
  v_mfma_f32_16x16x32_bf16 v[164:167], v[72:75], v[28:31], v[164:167]
  ds_read_b128 v[16:19], v44 offset:16384
  v_accvgpr_read_b32 v118, a106
  v_mfma_f32_16x16x32_bf16 v[168:171], v[72:75], v[32:35], v[168:171]
  buffer_load_dwordx4 v41, s[64:67], s32 offen offset:1024 lds
  v_mfma_f32_16x16x32_bf16 v[172:175], v[72:75], v[36:39], v[172:175]
  ds_read_b64_tr_b16 v[108:109], v51 offset:0
  ds_read_b64_tr_b16 v[110:111], v51 offset:1024
  v_mfma_f32_16x16x32_bf16 v[176:179], v[76:79], v[24:27], v[176:179]
  ds_read_b128 v[20:23], v46 offset:16384
  v_accvgpr_read_b32 v119, a107
  v_mfma_f32_16x16x32_bf16 v[180:183], v[76:79], v[28:31], v[180:183]
  s_mov_b32 s32, 18944
  v_mul_f32 v112, s44, v112
  v_mul_f32 v113, s44, v113
  v_mfma_f32_16x16x32_bf16 v[184:187], v[76:79], v[32:35], v[184:187]
  ds_read_b64_tr_b16 v[64:65], v52 offset:0
  ds_read_b64_tr_b16 v[66:67], v52 offset:1024
  v_mfma_f32_16x16x32_bf16 v[188:191], v[76:79], v[36:39], v[188:191]
  buffer_load_dwordx4 v40, s[64:67], s32 offen offset:2048 lds
  v_mfma_f32_16x16x32_bf16 v[192:195], v[80:83], v[24:27], v[192:195]
  v_mul_f32 v114, s44, v114
  v_mul_f32 v115, s44, v115
  v_mfma_f32_16x16x32_bf16 v[196:199], v[80:83], v[28:31], v[196:199]
  ds_read_b64_tr_b16 v[68:69], v53 offset:0
  ds_read_b64_tr_b16 v[70:71], v53 offset:1024
  v_mfma_f32_16x16x32_bf16 v[200:203], v[80:83], v[32:35], v[200:203]
  v_mul_f32 v116, s44, v116
  v_mul_f32 v117, s44, v117
  v_mfma_f32_16x16x32_bf16 v[204:207], v[80:83], v[36:39], v[204:207]
  buffer_load_dwordx4 v41, s[64:67], s32 offen offset:3072 lds
  v_mfma_f32_16x16x32_bf16 v[208:211], v[84:87], v[24:27], v[208:211]
  ds_read_b64_tr_b16 v[72:73], v54 offset:0
  ds_read_b64_tr_b16 v[74:75], v54 offset:1024
  v_mfma_f32_16x16x32_bf16 v[212:215], v[84:87], v[28:31], v[212:215]
  v_mul_f32 v118, s44, v118
  v_mul_f32 v119, s44, v119
  v_mfma_f32_16x16x32_bf16 v[216:219], v[84:87], v[32:35], v[216:219]
  s_add_u32 m0, s36, 36864
  s_mov_b32 s32, 41472
  v_cvt_pk_bf16_f32 v124, v112, v113
  v_mfma_f32_16x16x32_bf16 v[220:223], v[84:87], v[36:39], v[220:223]
  ds_read_b64_tr_b16 v[76:77], v55 offset:0
  ds_read_b64_tr_b16 v[78:79], v55 offset:1024
  v_mfma_f32_16x16x32_bf16 v[224:227], v[88:91], v[24:27], v[224:227]
  buffer_load_dwordx4 v40, s[64:67], s32 offen offset:0 lds
  v_mfma_f32_16x16x32_bf16 v[228:231], v[88:91], v[28:31], v[228:231]
  v_cvt_pk_bf16_f32 v125, v114, v115
  v_cvt_pk_bf16_f32 v126, v116, v117
  v_mfma_f32_16x16x32_bf16 v[232:235], v[88:91], v[32:35], v[232:235]
  v_cvt_pk_bf16_f32 v127, v118, v119
  v_accvgpr_write_b32 a72, v124
  v_mfma_f32_16x16x32_bf16 v[236:239], v[88:91], v[36:39], v[236:239]
  v_accvgpr_write_b32 a73, v125
  v_accvgpr_write_b32 a74, v126
  v_mfma_f32_16x16x32_bf16 v[240:243], v[92:95], v[24:27], v[240:243]
  buffer_load_dwordx4 v41, s[64:67], s32 offen offset:1024 lds
  v_mfma_f32_16x16x32_bf16 v[244:247], v[92:95], v[28:31], v[244:247]
  v_accvgpr_write_b32 a75, v127
  v_accvgpr_read_b32 v112, a12
  v_mfma_f32_16x16x32_bf16 v[248:251], v[92:95], v[32:35], v[248:251]
  v_accvgpr_read_b32 v113, a13
  v_accvgpr_read_b32 v114, a14
  v_mfma_f32_16x16x32_bf16 v[252:255], v[92:95], v[36:39], v[252:255]
  s_waitcnt lgkmcnt(0)
  v_accvgpr_read_b32 v115, a15
  v_accvgpr_read_b32 v116, a44
  v_accvgpr_read_b32 v117, a45
  v_accvgpr_read_b32 v118, a46
  v_accvgpr_read_b32 v119, a47
  v_mul_f32 v112, s44, v112
  v_mul_f32 v113, s44, v113
  v_mul_f32 v114, s44, v114
  v_mul_f32 v115, s44, v115
  v_mfma_f32_16x16x32_bf16 v[128:131], v[96:99], v[8:11], v[128:131]
  s_mov_b32 s32, 59904
  ds_read_b64_tr_b16 v[80:81], v48 offset:8192
  ds_read_b64_tr_b16 v[82:83], v48 offset:9216
  v_mfma_f32_16x16x32_bf16 v[132:135], v[96:99], v[12:15], v[132:135]
  ds_read_b128 v[24:27], v45 offset:0
  v_mul_f32 v116, s44, v116
  v_mfma_f32_16x16x32_bf16 v[136:139], v[96:99], v[16:19], v[136:139]
  buffer_load_dwordx4 v40, s[64:67], s32 offen offset:2048 lds
  v_mfma_f32_16x16x32_bf16 v[140:143], v[96:99], v[20:23], v[140:143]
  ds_read_b64_tr_b16 v[84:85], v49 offset:8192
  ds_read_b64_tr_b16 v[86:87], v49 offset:9216
  v_mfma_f32_16x16x32_bf16 v[144:147], v[100:103], v[8:11], v[144:147]
  ds_read_b128 v[28:31], v47 offset:0
  v_mul_f32 v117, s44, v117
  v_mfma_f32_16x16x32_bf16 v[148:151], v[100:103], v[12:15], v[148:151]
  v_mul_f32 v118, s44, v118
  v_mul_f32 v119, s44, v119
  v_mfma_f32_16x16x32_bf16 v[152:155], v[100:103], v[16:19], v[152:155]
  ds_read_b64_tr_b16 v[88:89], v50 offset:8192
  ds_read_b64_tr_b16 v[90:91], v50 offset:9216
  v_mfma_f32_16x16x32_bf16 v[156:159], v[100:103], v[20:23], v[156:159]
  ds_read_b128 v[32:35], v45 offset:16384
  v_cvt_pk_bf16_f32 v120, v112, v113
  v_mfma_f32_16x16x32_bf16 v[160:163], v[104:107], v[8:11], v[160:163]
  buffer_load_dwordx4 v41, s[64:67], s32 offen offset:3072 lds
  v_mfma_f32_16x16x32_bf16 v[164:167], v[104:107], v[12:15], v[164:167]
  ds_read_b64_tr_b16 v[92:93], v51 offset:8192
  ds_read_b64_tr_b16 v[94:95], v51 offset:9216
  v_mfma_f32_16x16x32_bf16 v[168:171], v[104:107], v[16:19], v[168:171]
  ds_read_b128 v[36:39], v47 offset:16384
  v_cvt_pk_bf16_f32 v121, v114, v115
  v_mfma_f32_16x16x32_bf16 v[172:175], v[104:107], v[20:23], v[172:175]
  s_add_u32 m0, s39, 147456
  s_mov_b32 s34, 2097152
  v_cvt_pk_bf16_f32 v122, v116, v117
  v_mfma_f32_16x16x32_bf16 v[176:179], v[108:111], v[8:11], v[176:179]
  ds_read_b64_tr_b16 v[96:97], v52 offset:8192
  ds_read_b64_tr_b16 v[98:99], v52 offset:9216
  v_mfma_f32_16x16x32_bf16 v[180:183], v[108:111], v[12:15], v[180:183]
  buffer_load_dwordx4 v42, s[60:63], s34 offen offset:0 lds
  v_mfma_f32_16x16x32_bf16 v[184:187], v[108:111], v[16:19], v[184:187]
  v_cvt_pk_bf16_f32 v123, v118, v119
  v_accvgpr_write_b32 a12, v120
  v_mfma_f32_16x16x32_bf16 v[188:191], v[108:111], v[20:23], v[188:191]
  s_mov_b32 s34, 2128896
  ds_read_b64_tr_b16 v[100:101], v53 offset:8192
  ds_read_b64_tr_b16 v[102:103], v53 offset:9216
  v_mfma_f32_16x16x32_bf16 v[192:195], v[64:67], v[8:11], v[192:195]
  v_accvgpr_write_b32 a13, v121
  v_accvgpr_write_b32 a14, v122
  v_mfma_f32_16x16x32_bf16 v[196:199], v[64:67], v[12:15], v[196:199]
  buffer_load_dwordx4 v42, s[60:63], s34 offen offset:1024 lds
  v_mfma_f32_16x16x32_bf16 v[200:203], v[64:67], v[16:19], v[200:203]
  ds_read_b64_tr_b16 v[104:105], v54 offset:8192
  ds_read_b64_tr_b16 v[106:107], v54 offset:9216
  v_mfma_f32_16x16x32_bf16 v[204:207], v[64:67], v[20:23], v[204:207]
  v_accvgpr_write_b32 a15, v123
  v_accvgpr_read_b32 v112, a76
  v_mfma_f32_16x16x32_bf16 v[208:211], v[68:71], v[8:11], v[208:211]
  s_mov_b32 s34, 2160640
  v_accvgpr_read_b32 v113, a77
  v_accvgpr_read_b32 v114, a78
  v_mfma_f32_16x16x32_bf16 v[212:215], v[68:71], v[12:15], v[212:215]
  ds_read_b64_tr_b16 v[108:109], v55 offset:8192
  ds_read_b64_tr_b16 v[110:111], v55 offset:9216
  v_mfma_f32_16x16x32_bf16 v[216:219], v[68:71], v[16:19], v[216:219]
  buffer_load_dwordx4 v43, s[60:63], s34 offen offset:2048 lds
  v_mfma_f32_16x16x32_bf16 v[220:223], v[68:71], v[20:23], v[220:223]
  v_accvgpr_read_b32 v115, a79
  v_accvgpr_read_b32 v116, a108
  v_mfma_f32_16x16x32_bf16 v[224:227], v[72:75], v[8:11], v[224:227]
  s_mov_b32 s34, 2192384
  v_accvgpr_read_b32 v117, a109
  v_accvgpr_read_b32 v118, a110
  v_mfma_f32_16x16x32_bf16 v[228:231], v[72:75], v[12:15], v[228:231]
  v_accvgpr_read_b32 v119, a111
  v_mul_f32 v112, s44, v112
  v_mfma_f32_16x16x32_bf16 v[232:235], v[72:75], v[16:19], v[232:235]
  buffer_load_dwordx4 v43, s[60:63], s34 offen offset:3072 lds
  v_mfma_f32_16x16x32_bf16 v[236:239], v[72:75], v[20:23], v[236:239]
  v_mul_f32 v113, s44, v113
  v_mul_f32 v114, s44, v114
  v_mfma_f32_16x16x32_bf16 v[240:243], v[76:79], v[8:11], v[240:243]
  v_mul_f32 v115, s44, v115
  v_mul_f32 v116, s44, v116
  v_mfma_f32_16x16x32_bf16 v[244:247], v[76:79], v[12:15], v[244:247]
  v_mul_f32 v117, s44, v117
  v_mul_f32 v118, s44, v118
  v_mfma_f32_16x16x32_bf16 v[248:251], v[76:79], v[16:19], v[248:251]
  v_mul_f32 v119, s44, v119
  v_cvt_pk_bf16_f32 v124, v112, v113
  v_mfma_f32_16x16x32_bf16 v[252:255], v[76:79], v[20:23], v[252:255]
  s_waitcnt lgkmcnt(0)
  v_cvt_pk_bf16_f32 v125, v114, v115
  v_cvt_pk_bf16_f32 v126, v116, v117
  v_cvt_pk_bf16_f32 v127, v118, v119
  v_accvgpr_write_b32 a76, v124
  v_accvgpr_write_b32 a77, v125
  v_accvgpr_write_b32 a78, v126
  v_accvgpr_write_b32 a79, v127
  v_accvgpr_read_b32 v112, a128
  v_accvgpr_read_b32 v113, a129
  v_mfma_f32_16x16x32_bf16 v[128:131], v[80:83], v[24:27], v[128:131]
  v_add_u32 v44, 0xffff0000, v44
  v_add_u32 v45, 0xffff0000, v45
  v_mfma_f32_16x16x32_bf16 v[132:135], v[80:83], v[28:31], v[132:135]
  s_waitcnt vmcnt(12) lgkmcnt(0)
  s_barrier
  v_mfma_f32_16x16x32_bf16 v[136:139], v[80:83], v[32:35], v[136:139]
  s_add_u32 m0, s36, 65536
  v_add_u32 v46, 0xffff0000, v46
  v_add_u32 v47, 0xffff0000, v47
  v_mfma_f32_16x16x32_bf16 v[140:143], v[80:83], v[36:39], v[140:143]
  s_mov_b32 s32, 640
  ds_read_b64_tr_b16 v[64:65], v48 offset:32768
  ds_read_b64_tr_b16 v[66:67], v48 offset:33792
  v_mfma_f32_16x16x32_bf16 v[144:147], v[84:87], v[24:27], v[144:147]
  ds_read_b128 v[8:11], v44 offset:0
  v_accvgpr_read_b32 v114, a130
  v_mfma_f32_16x16x32_bf16 v[148:151], v[84:87], v[28:31], v[148:151]
  ds_read_b64_tr_b16 v[68:69], v49 offset:32768
  ds_read_b64_tr_b16 v[70:71], v49 offset:33792
  v_mfma_f32_16x16x32_bf16 v[152:155], v[84:87], v[32:35], v[152:155]
  ds_read_b128 v[12:15], v46 offset:0
  v_accvgpr_read_b32 v115, a131
  v_mfma_f32_16x16x32_bf16 v[156:159], v[84:87], v[36:39], v[156:159]
  buffer_load_dwordx4 v40, s[64:67], s32 offen offset:0 lds
  v_mfma_f32_16x16x32_bf16 v[160:163], v[88:91], v[24:27], v[160:163]
  ds_read_b64_tr_b16 v[72:73], v50 offset:32768
  ds_read_b64_tr_b16 v[74:75], v50 offset:33792
  v_mfma_f32_16x16x32_bf16 v[164:167], v[88:91], v[28:31], v[164:167]
  ds_read_b128 v[16:19], v44 offset:16384
  v_accvgpr_read_b32 v116, a132
  v_mfma_f32_16x16x32_bf16 v[168:171], v[88:91], v[32:35], v[168:171]
  buffer_load_dwordx4 v41, s[64:67], s32 offen offset:1024 lds
  v_mfma_f32_16x16x32_bf16 v[172:175], v[88:91], v[36:39], v[172:175]
  ds_read_b64_tr_b16 v[76:77], v51 offset:32768
  ds_read_b64_tr_b16 v[78:79], v51 offset:33792
  v_mfma_f32_16x16x32_bf16 v[176:179], v[92:95], v[24:27], v[176:179]
  ds_read_b128 v[20:23], v46 offset:16384
  v_accvgpr_read_b32 v117, a133
  v_mfma_f32_16x16x32_bf16 v[180:183], v[92:95], v[28:31], v[180:183]
  s_mov_b32 s32, 19072
  v_accvgpr_read_b32 v118, a134
  v_accvgpr_read_b32 v119, a135
  v_mfma_f32_16x16x32_bf16 v[184:187], v[92:95], v[32:35], v[184:187]
  ds_read_b64_tr_b16 v[80:81], v52 offset:32768
  ds_read_b64_tr_b16 v[82:83], v52 offset:33792
  v_mfma_f32_16x16x32_bf16 v[188:191], v[92:95], v[36:39], v[188:191]
  buffer_load_dwordx4 v40, s[64:67], s32 offen offset:2048 lds
  v_mfma_f32_16x16x32_bf16 v[192:195], v[96:99], v[24:27], v[192:195]
  v_cvt_pk_bf16_f32 v120, v112, v113
  v_cvt_pk_bf16_f32 v121, v114, v115
  v_mfma_f32_16x16x32_bf16 v[196:199], v[96:99], v[28:31], v[196:199]
  ds_read_b64_tr_b16 v[84:85], v53 offset:32768
  ds_read_b64_tr_b16 v[86:87], v53 offset:33792
  v_mfma_f32_16x16x32_bf16 v[200:203], v[96:99], v[32:35], v[200:203]
  v_cvt_pk_bf16_f32 v122, v116, v117
  v_cvt_pk_bf16_f32 v123, v118, v119
  v_mfma_f32_16x16x32_bf16 v[204:207], v[96:99], v[36:39], v[204:207]
  buffer_load_dwordx4 v41, s[64:67], s32 offen offset:3072 lds
  v_mfma_f32_16x16x32_bf16 v[208:211], v[100:103], v[24:27], v[208:211]
  ds_read_b64_tr_b16 v[88:89], v54 offset:32768
  ds_read_b64_tr_b16 v[90:91], v54 offset:33792
  v_mfma_f32_16x16x32_bf16 v[212:215], v[100:103], v[28:31], v[212:215]
  v_accvgpr_write_b32 a128, v120
  v_accvgpr_write_b32 a129, v121
  v_mfma_f32_16x16x32_bf16 v[216:219], v[100:103], v[32:35], v[216:219]
  s_add_u32 m0, s36, 69632
  s_mov_b32 s32, 41600
  v_accvgpr_write_b32 a130, v122
  v_mfma_f32_16x16x32_bf16 v[220:223], v[100:103], v[36:39], v[220:223]
  ds_read_b64_tr_b16 v[92:93], v55 offset:32768
  ds_read_b64_tr_b16 v[94:95], v55 offset:33792
  v_mfma_f32_16x16x32_bf16 v[224:227], v[104:107], v[24:27], v[224:227]
  buffer_load_dwordx4 v40, s[64:67], s32 offen offset:0 lds
  v_mfma_f32_16x16x32_bf16 v[228:231], v[104:107], v[28:31], v[228:231]
  v_accvgpr_write_b32 a131, v123
  v_accvgpr_read_b32 v112, a160
  v_mfma_f32_16x16x32_bf16 v[232:235], v[104:107], v[32:35], v[232:235]
  v_accvgpr_read_b32 v113, a161
  v_accvgpr_read_b32 v114, a162
  v_mfma_f32_16x16x32_bf16 v[236:239], v[104:107], v[36:39], v[236:239]
  v_accvgpr_read_b32 v115, a163
  v_accvgpr_read_b32 v116, a164
  v_mfma_f32_16x16x32_bf16 v[240:243], v[108:111], v[24:27], v[240:243]
  buffer_load_dwordx4 v41, s[64:67], s32 offen offset:1024 lds
  v_mfma_f32_16x16x32_bf16 v[244:247], v[108:111], v[28:31], v[244:247]
  v_accvgpr_read_b32 v117, a165
  v_accvgpr_read_b32 v118, a166
  v_mfma_f32_16x16x32_bf16 v[248:251], v[108:111], v[32:35], v[248:251]
  v_accvgpr_read_b32 v119, a167
  v_cvt_pk_bf16_f32 v124, v112, v113
  v_mfma_f32_16x16x32_bf16 v[252:255], v[108:111], v[36:39], v[252:255]
  s_waitcnt lgkmcnt(0)
  v_cvt_pk_bf16_f32 v125, v114, v115
  v_cvt_pk_bf16_f32 v126, v116, v117
  v_cvt_pk_bf16_f32 v127, v118, v119
  v_accvgpr_write_b32 a160, v124
  v_accvgpr_write_b32 a161, v125
  v_accvgpr_write_b32 a162, v126
  v_accvgpr_write_b32 a163, v127
  v_accvgpr_read_b32 v112, a192
  v_accvgpr_read_b32 v113, a193
  v_mfma_f32_16x16x32_bf16 v[128:131], v[64:67], v[8:11], v[128:131]
  s_mov_b32 s32, 60032
  ds_read_b64_tr_b16 v[96:97], v48 offset:40960
  ds_read_b64_tr_b16 v[98:99], v48 offset:41984
  v_mfma_f32_16x16x32_bf16 v[132:135], v[64:67], v[12:15], v[132:135]
  ds_read_b128 v[24:27], v45 offset:0
  v_accvgpr_read_b32 v114, a194
  v_mfma_f32_16x16x32_bf16 v[136:139], v[64:67], v[16:19], v[136:139]
  buffer_load_dwordx4 v40, s[64:67], s32 offen offset:2048 lds
  v_mfma_f32_16x16x32_bf16 v[140:143], v[64:67], v[20:23], v[140:143]
  ds_read_b64_tr_b16 v[100:101], v49 offset:40960
  ds_read_b64_tr_b16 v[102:103], v49 offset:41984
  v_mfma_f32_16x16x32_bf16 v[144:147], v[68:71], v[8:11], v[144:147]
  ds_read_b128 v[28:31], v47 offset:0
  v_accvgpr_read_b32 v115, a195
  v_mfma_f32_16x16x32_bf16 v[148:151], v[68:71], v[12:15], v[148:151]
  v_accvgpr_read_b32 v116, a196
  v_accvgpr_read_b32 v117, a197
  v_mfma_f32_16x16x32_bf16 v[152:155], v[68:71], v[16:19], v[152:155]
  ds_read_b64_tr_b16 v[104:105], v50 offset:40960
  ds_read_b64_tr_b16 v[106:107], v50 offset:41984
  v_mfma_f32_16x16x32_bf16 v[156:159], v[68:71], v[20:23], v[156:159]
  ds_read_b128 v[32:35], v45 offset:16384
  v_accvgpr_read_b32 v118, a198
  v_mfma_f32_16x16x32_bf16 v[160:163], v[72:75], v[8:11], v[160:163]
  buffer_load_dwordx4 v41, s[64:67], s32 offen offset:3072 lds
  v_mfma_f32_16x16x32_bf16 v[164:167], v[72:75], v[12:15], v[164:167]
  ds_read_b64_tr_b16 v[108:109], v51 offset:40960
  ds_read_b64_tr_b16 v[110:111], v51 offset:41984
  v_mfma_f32_16x16x32_bf16 v[168:171], v[72:75], v[16:19], v[168:171]
  ds_read_b128 v[36:39], v47 offset:16384
  v_accvgpr_read_b32 v119, a199
  v_mfma_f32_16x16x32_bf16 v[172:175], v[72:75], v[20:23], v[172:175]
  s_add_u32 m0, s39, 98304
  s_mov_b32 s34, 2621440
  v_cvt_pk_bf16_f32 v120, v112, v113
  v_mfma_f32_16x16x32_bf16 v[176:179], v[76:79], v[8:11], v[176:179]
  ds_read_b64_tr_b16 v[64:65], v52 offset:40960
  ds_read_b64_tr_b16 v[66:67], v52 offset:41984
  v_mfma_f32_16x16x32_bf16 v[180:183], v[76:79], v[12:15], v[180:183]
  buffer_load_dwordx4 v42, s[60:63], s34 offen offset:0 lds
  v_mfma_f32_16x16x32_bf16 v[184:187], v[76:79], v[16:19], v[184:187]
  v_cvt_pk_bf16_f32 v121, v114, v115
  v_cvt_pk_bf16_f32 v122, v116, v117
  v_mfma_f32_16x16x32_bf16 v[188:191], v[76:79], v[20:23], v[188:191]
  s_mov_b32 s34, 2653184
  ds_read_b64_tr_b16 v[68:69], v53 offset:40960
  ds_read_b64_tr_b16 v[70:71], v53 offset:41984
  v_mfma_f32_16x16x32_bf16 v[192:195], v[80:83], v[8:11], v[192:195]
  v_cvt_pk_bf16_f32 v123, v118, v119
  v_accvgpr_write_b32 a192, v120
  v_mfma_f32_16x16x32_bf16 v[196:199], v[80:83], v[12:15], v[196:199]
  buffer_load_dwordx4 v42, s[60:63], s34 offen offset:1024 lds
  v_mfma_f32_16x16x32_bf16 v[200:203], v[80:83], v[16:19], v[200:203]
  ds_read_b64_tr_b16 v[72:73], v54 offset:40960
  ds_read_b64_tr_b16 v[74:75], v54 offset:41984
  v_mfma_f32_16x16x32_bf16 v[204:207], v[80:83], v[20:23], v[204:207]
  v_accvgpr_write_b32 a193, v121
  v_accvgpr_write_b32 a194, v122
  v_mfma_f32_16x16x32_bf16 v[208:211], v[84:87], v[8:11], v[208:211]
  s_mov_b32 s34, 2684928
  v_accvgpr_write_b32 a195, v123
  v_accvgpr_read_b32 v112, a224
  v_mfma_f32_16x16x32_bf16 v[212:215], v[84:87], v[12:15], v[212:215]
  ds_read_b64_tr_b16 v[76:77], v55 offset:40960
  ds_read_b64_tr_b16 v[78:79], v55 offset:41984
  v_mfma_f32_16x16x32_bf16 v[216:219], v[84:87], v[16:19], v[216:219]
  buffer_load_dwordx4 v43, s[60:63], s34 offen offset:2048 lds
  v_mfma_f32_16x16x32_bf16 v[220:223], v[84:87], v[20:23], v[220:223]
  v_accvgpr_read_b32 v113, a225
  v_accvgpr_read_b32 v114, a226
  v_mfma_f32_16x16x32_bf16 v[224:227], v[88:91], v[8:11], v[224:227]
  s_mov_b32 s34, 2716672
  v_accvgpr_read_b32 v115, a227
  v_accvgpr_read_b32 v116, a228
  v_mfma_f32_16x16x32_bf16 v[228:231], v[88:91], v[12:15], v[228:231]
  v_accvgpr_read_b32 v117, a229
  v_accvgpr_read_b32 v118, a230
  v_mfma_f32_16x16x32_bf16 v[232:235], v[88:91], v[16:19], v[232:235]
  buffer_load_dwordx4 v43, s[60:63], s34 offen offset:3072 lds
  v_mfma_f32_16x16x32_bf16 v[236:239], v[88:91], v[20:23], v[236:239]
  v_accvgpr_read_b32 v119, a231
  v_cvt_pk_bf16_f32 v124, v112, v113
  v_mfma_f32_16x16x32_bf16 v[240:243], v[92:95], v[8:11], v[240:243]
  v_cvt_pk_bf16_f32 v125, v114, v115
  v_cvt_pk_bf16_f32 v126, v116, v117
  v_mfma_f32_16x16x32_bf16 v[244:247], v[92:95], v[12:15], v[244:247]
  v_cvt_pk_bf16_f32 v127, v118, v119
  v_accvgpr_write_b32 a224, v124
  v_mfma_f32_16x16x32_bf16 v[248:251], v[92:95], v[16:19], v[248:251]
  v_accvgpr_write_b32 a225, v125
  v_accvgpr_write_b32 a226, v126
  v_mfma_f32_16x16x32_bf16 v[252:255], v[92:95], v[20:23], v[252:255]
  s_waitcnt lgkmcnt(0)
  v_accvgpr_write_b32 a227, v127
  v_accvgpr_read_b32 v112, a136
  v_accvgpr_read_b32 v113, a137
  v_accvgpr_read_b32 v114, a138
  v_accvgpr_read_b32 v115, a139
  v_accvgpr_read_b32 v116, a140
  v_accvgpr_read_b32 v117, a141
  v_accvgpr_read_b32 v118, a142
  v_accvgpr_read_b32 v119, a143
  v_mfma_f32_16x16x32_bf16 v[128:131], v[96:99], v[24:27], v[128:131]
  v_cvt_pk_bf16_f32 v120, v112, v113
  v_cvt_pk_bf16_f32 v121, v114, v115
  v_mfma_f32_16x16x32_bf16 v[132:135], v[96:99], v[28:31], v[132:135]
  s_waitcnt vmcnt(12) lgkmcnt(0)
  s_barrier
  v_mfma_f32_16x16x32_bf16 v[136:139], v[96:99], v[32:35], v[136:139]
  s_add_u32 m0, s36, 0
  ds_read_b64_tr_b16 v[80:81], v48 offset:49152
  ds_read_b64_tr_b16 v[82:83], v48 offset:50176
  v_mfma_f32_16x16x32_bf16 v[140:143], v[96:99], v[36:39], v[140:143]
  s_mov_b32 s32, 768
  ds_read_b128 v[8:11], v44 offset:32768
  v_cvt_pk_bf16_f32 v122, v116, v117
  v_mfma_f32_16x16x32_bf16 v[144:147], v[100:103], v[24:27], v[144:147]
  buffer_load_dwordx4 v40, s[64:67], s32 offen offset:0 lds
  v_mfma_f32_16x16x32_bf16 v[148:151], v[100:103], v[28:31], v[148:151]
  ds_read_b64_tr_b16 v[84:85], v49 offset:49152
  ds_read_b64_tr_b16 v[86:87], v49 offset:50176
  v_mfma_f32_16x16x32_bf16 v[152:155], v[100:103], v[32:35], v[152:155]
  ds_read_b128 v[12:15], v46 offset:32768
  v_cvt_pk_bf16_f32 v123, v118, v119
  v_mfma_f32_16x16x32_bf16 v[156:159], v[100:103], v[36:39], v[156:159]
  v_accvgpr_write_b32 a136, v120
  v_accvgpr_write_b32 a137, v121
  v_mfma_f32_16x16x32_bf16 v[160:163], v[104:107], v[24:27], v[160:163]
  ds_read_b64_tr_b16 v[88:89], v50 offset:49152
  ds_read_b64_tr_b16 v[90:91], v50 offset:50176
  v_mfma_f32_16x16x32_bf16 v[164:167], v[104:107], v[28:31], v[164:167]
  ds_read_b128 v[16:19], v44 offset:49152
  v_accvgpr_write_b32 a138, v122
  v_mfma_f32_16x16x32_bf16 v[168:171], v[104:107], v[32:35], v[168:171]
  buffer_load_dwordx4 v41, s[64:67], s32 offen offset:1024 lds
  v_mfma_f32_16x16x32_bf16 v[172:175], v[104:107], v[36:39], v[172:175]
  ds_read_b64_tr_b16 v[92:93], v51 offset:49152
  ds_read_b64_tr_b16 v[94:95], v51 offset:50176
  v_mfma_f32_16x16x32_bf16 v[176:179], v[108:111], v[24:27], v[176:179]
  ds_read_b128 v[20:23], v46 offset:49152
  v_accvgpr_write_b32 a139, v123
  v_mfma_f32_16x16x32_bf16 v[180:183], v[108:111], v[28:31], v[180:183]
  s_mov_b32 s32, 19200
  v_accvgpr_read_b32 v112, a168
  v_accvgpr_read_b32 v113, a169
  v_mfma_f32_16x16x32_bf16 v[184:187], v[108:111], v[32:35], v[184:187]
  ds_read_b64_tr_b16 v[96:97], v52 offset:49152
  ds_read_b64_tr_b16 v[98:99], v52 offset:50176
  v_mfma_f32_16x16x32_bf16 v[188:191], v[108:111], v[36:39], v[188:191]
  buffer_load_dwordx4 v40, s[64:67], s32 offen offset:2048 lds
  v_mfma_f32_16x16x32_bf16 v[192:195], v[64:67], v[24:27], v[192:195]
  v_accvgpr_read_b32 v114, a170
  v_accvgpr_read_b32 v115, a171
  v_mfma_f32_16x16x32_bf16 v[196:199], v[64:67], v[28:31], v[196:199]
  ds_read_b64_tr_b16 v[100:101], v53 offset:49152
  ds_read_b64_tr_b16 v[102:103], v53 offset:50176
  v_mfma_f32_16x16x32_bf16 v[200:203], v[64:67], v[32:35], v[200:203]
  v_accvgpr_read_b32 v116, a172
  v_accvgpr_read_b32 v117, a173
  v_mfma_f32_16x16x32_bf16 v[204:207], v[64:67], v[36:39], v[204:207]
  buffer_load_dwordx4 v41, s[64:67], s32 offen offset:3072 lds
  v_mfma_f32_16x16x32_bf16 v[208:211], v[68:71], v[24:27], v[208:211]
  ds_read_b64_tr_b16 v[104:105], v54 offset:49152
  ds_read_b64_tr_b16 v[106:107], v54 offset:50176
  v_mfma_f32_16x16x32_bf16 v[212:215], v[68:71], v[28:31], v[212:215]
  v_accvgpr_read_b32 v118, a174
  v_accvgpr_read_b32 v119, a175
  v_mfma_f32_16x16x32_bf16 v[216:219], v[68:71], v[32:35], v[216:219]
  s_add_u32 m0, s36, 4096
  s_mov_b32 s32, 41728
  v_cvt_pk_bf16_f32 v124, v112, v113
  v_mfma_f32_16x16x32_bf16 v[220:223], v[68:71], v[36:39], v[220:223]
  ds_read_b64_tr_b16 v[108:109], v55 offset:49152
  ds_read_b64_tr_b16 v[110:111], v55 offset:50176
  v_mfma_f32_16x16x32_bf16 v[224:227], v[72:75], v[24:27], v[224:227]
  buffer_load_dwordx4 v40, s[64:67], s32 offen offset:0 lds
  v_mfma_f32_16x16x32_bf16 v[228:231], v[72:75], v[28:31], v[228:231]
  v_cvt_pk_bf16_f32 v125, v114, v115
  v_cvt_pk_bf16_f32 v126, v116, v117
  v_mfma_f32_16x16x32_bf16 v[232:235], v[72:75], v[32:35], v[232:235]
  v_cvt_pk_bf16_f32 v127, v118, v119
  v_accvgpr_write_b32 a168, v124
  v_mfma_f32_16x16x32_bf16 v[236:239], v[72:75], v[36:39], v[236:239]
  v_accvgpr_write_b32 a169, v125
  v_accvgpr_write_b32 a170, v126
  v_mfma_f32_16x16x32_bf16 v[240:243], v[76:79], v[24:27], v[240:243]
  buffer_load_dwordx4 v41, s[64:67], s32 offen offset:1024 lds
  v_mfma_f32_16x16x32_bf16 v[244:247], v[76:79], v[28:31], v[244:247]
  v_accvgpr_write_b32 a171, v127
  v_accvgpr_read_b32 v112, a200
  v_mfma_f32_16x16x32_bf16 v[248:251], v[76:79], v[32:35], v[248:251]
  v_accvgpr_read_b32 v113, a201
  v_accvgpr_read_b32 v114, a202
  v_mfma_f32_16x16x32_bf16 v[252:255], v[76:79], v[36:39], v[252:255]
  s_waitcnt lgkmcnt(0)
  v_accvgpr_read_b32 v115, a203
  v_accvgpr_read_b32 v116, a204
  v_accvgpr_read_b32 v117, a205
  v_accvgpr_read_b32 v118, a206
  v_accvgpr_read_b32 v119, a207
  v_cvt_pk_bf16_f32 v120, v112, v113
  v_cvt_pk_bf16_f32 v121, v114, v115
  v_cvt_pk_bf16_f32 v122, v116, v117
  v_cvt_pk_bf16_f32 v123, v118, v119
  v_mfma_f32_16x16x32_bf16 v[128:131], v[80:83], v[8:11], v[128:131]
  s_mov_b32 s32, 60160
  ds_read_b64_tr_b16 v[64:65], v48 offset:57344
  ds_read_b64_tr_b16 v[66:67], v48 offset:58368
  v_mfma_f32_16x16x32_bf16 v[132:135], v[80:83], v[12:15], v[132:135]
  ds_read_b128 v[24:27], v45 offset:32768
  v_accvgpr_write_b32 a200, v120
  v_mfma_f32_16x16x32_bf16 v[136:139], v[80:83], v[16:19], v[136:139]
  buffer_load_dwordx4 v40, s[64:67], s32 offen offset:2048 lds
  v_mfma_f32_16x16x32_bf16 v[140:143], v[80:83], v[20:23], v[140:143]
  ds_read_b64_tr_b16 v[68:69], v49 offset:57344
  ds_read_b64_tr_b16 v[70:71], v49 offset:58368
  v_mfma_f32_16x16x32_bf16 v[144:147], v[84:87], v[8:11], v[144:147]
  ds_read_b128 v[28:31], v47 offset:32768
  v_accvgpr_write_b32 a201, v121
  v_mfma_f32_16x16x32_bf16 v[148:151], v[84:87], v[12:15], v[148:151]
  v_accvgpr_write_b32 a202, v122
  v_accvgpr_write_b32 a203, v123
  v_mfma_f32_16x16x32_bf16 v[152:155], v[84:87], v[16:19], v[152:155]
  ds_read_b64_tr_b16 v[72:73], v50 offset:57344
  ds_read_b64_tr_b16 v[74:75], v50 offset:58368
  v_mfma_f32_16x16x32_bf16 v[156:159], v[84:87], v[20:23], v[156:159]
  ds_read_b128 v[32:35], v45 offset:49152
  v_accvgpr_read_b32 v112, a232
  v_mfma_f32_16x16x32_bf16 v[160:163], v[88:91], v[8:11], v[160:163]
  buffer_load_dwordx4 v41, s[64:67], s32 offen offset:3072 lds
  v_mfma_f32_16x16x32_bf16 v[164:167], v[88:91], v[12:15], v[164:167]
  ds_read_b64_tr_b16 v[76:77], v51 offset:57344
  ds_read_b64_tr_b16 v[78:79], v51 offset:58368
  v_mfma_f32_16x16x32_bf16 v[168:171], v[88:91], v[16:19], v[168:171]
  ds_read_b128 v[36:39], v47 offset:49152
  v_accvgpr_read_b32 v113, a233
  v_mfma_f32_16x16x32_bf16 v[172:175], v[88:91], v[20:23], v[172:175]
  s_add_u32 m0, s39, 131072
  s_mov_b32 s34, 3145728
  v_accvgpr_read_b32 v114, a234
  v_mfma_f32_16x16x32_bf16 v[176:179], v[92:95], v[8:11], v[176:179]
  ds_read_b64_tr_b16 v[80:81], v52 offset:57344
  ds_read_b64_tr_b16 v[82:83], v52 offset:58368
  v_mfma_f32_16x16x32_bf16 v[180:183], v[92:95], v[12:15], v[180:183]
  buffer_load_dwordx4 v42, s[60:63], s34 offen offset:0 lds
  v_mfma_f32_16x16x32_bf16 v[184:187], v[92:95], v[16:19], v[184:187]
  v_accvgpr_read_b32 v115, a235
  v_accvgpr_read_b32 v116, a236
  v_mfma_f32_16x16x32_bf16 v[188:191], v[92:95], v[20:23], v[188:191]
  s_mov_b32 s34, 3177472
  ds_read_b64_tr_b16 v[84:85], v53 offset:57344
  ds_read_b64_tr_b16 v[86:87], v53 offset:58368
  v_mfma_f32_16x16x32_bf16 v[192:195], v[96:99], v[8:11], v[192:195]
  v_accvgpr_read_b32 v117, a237
  v_accvgpr_read_b32 v118, a238
  v_mfma_f32_16x16x32_bf16 v[196:199], v[96:99], v[12:15], v[196:199]
  buffer_load_dwordx4 v42, s[60:63], s34 offen offset:1024 lds
  v_mfma_f32_16x16x32_bf16 v[200:203], v[96:99], v[16:19], v[200:203]
  ds_read_b64_tr_b16 v[88:89], v54 offset:57344
  ds_read_b64_tr_b16 v[90:91], v54 offset:58368
  v_mfma_f32_16x16x32_bf16 v[204:207], v[96:99], v[20:23], v[204:207]
  v_accvgpr_read_b32 v119, a239
  v_cvt_pk_bf16_f32 v124, v112, v113
  v_mfma_f32_16x16x32_bf16 v[208:211], v[100:103], v[8:11], v[208:211]
  s_mov_b32 s34, 3209216
  v_cvt_pk_bf16_f32 v125, v114, v115
  v_cvt_pk_bf16_f32 v126, v116, v117
  v_mfma_f32_16x16x32_bf16 v[212:215], v[100:103], v[12:15], v[212:215]
  ds_read_b64_tr_b16 v[92:93], v55 offset:57344
  ds_read_b64_tr_b16 v[94:95], v55 offset:58368
  v_mfma_f32_16x16x32_bf16 v[216:219], v[100:103], v[16:19], v[216:219]
  buffer_load_dwordx4 v43, s[60:63], s34 offen offset:2048 lds
  v_mfma_f32_16x16x32_bf16 v[220:223], v[100:103], v[20:23], v[220:223]
  v_cvt_pk_bf16_f32 v127, v118, v119
  v_accvgpr_write_b32 a232, v124
  v_mfma_f32_16x16x32_bf16 v[224:227], v[104:107], v[8:11], v[224:227]
  s_mov_b32 s34, 3240960
  v_accvgpr_write_b32 a233, v125
  v_accvgpr_write_b32 a234, v126
  v_mfma_f32_16x16x32_bf16 v[228:231], v[104:107], v[12:15], v[228:231]
  v_accvgpr_write_b32 a235, v127
  v_accvgpr_read_b32 v112, a16
  v_mfma_f32_16x16x32_bf16 v[232:235], v[104:107], v[16:19], v[232:235]
  buffer_load_dwordx4 v43, s[60:63], s34 offen offset:3072 lds
  v_mfma_f32_16x16x32_bf16 v[236:239], v[104:107], v[20:23], v[236:239]
  v_accvgpr_read_b32 v113, a17
  v_accvgpr_read_b32 v114, a18
  v_mfma_f32_16x16x32_bf16 v[240:243], v[108:111], v[8:11], v[240:243]
  v_accvgpr_read_b32 v115, a19
  v_accvgpr_read_b32 v116, a48
  v_mfma_f32_16x16x32_bf16 v[244:247], v[108:111], v[12:15], v[244:247]
  v_accvgpr_read_b32 v117, a49
  v_accvgpr_read_b32 v118, a50
  v_mfma_f32_16x16x32_bf16 v[248:251], v[108:111], v[16:19], v[248:251]
  v_accvgpr_read_b32 v119, a51
  v_mul_f32 v112, s44, v112
  v_mfma_f32_16x16x32_bf16 v[252:255], v[108:111], v[20:23], v[252:255]
  s_waitcnt lgkmcnt(0)
  v_mul_f32 v113, s44, v113
  v_mul_f32 v114, s44, v114
  v_mul_f32 v115, s44, v115
  v_mul_f32 v116, s44, v116
  v_mul_f32 v117, s44, v117
  v_mul_f32 v118, s44, v118
  v_mul_f32 v119, s44, v119
  v_cvt_pk_bf16_f32 v120, v112, v113
  v_cvt_pk_bf16_f32 v121, v114, v115
  v_mfma_f32_16x16x32_bf16 v[128:131], v[64:67], v[24:27], v[128:131]
  v_add_u32 v44, 0x10000, v44
  v_add_u32 v45, 0x10000, v45
  v_mfma_f32_16x16x32_bf16 v[132:135], v[64:67], v[28:31], v[132:135]
  s_waitcnt vmcnt(12) lgkmcnt(0)
  s_barrier
  v_mfma_f32_16x16x32_bf16 v[136:139], v[64:67], v[32:35], v[136:139]
  s_add_u32 m0, s36, 32768
  v_add_u32 v46, 0x10000, v46
  v_add_u32 v47, 0x10000, v47
  v_mfma_f32_16x16x32_bf16 v[140:143], v[64:67], v[36:39], v[140:143]
  s_mov_b32 s32, 896
  ds_read_b64_tr_b16 v[96:97], v48 offset:0
  ds_read_b64_tr_b16 v[98:99], v48 offset:1024
  v_mfma_f32_16x16x32_bf16 v[144:147], v[68:71], v[24:27], v[144:147]
  ds_read_b128 v[8:11], v44 offset:0
  v_cvt_pk_bf16_f32 v122, v116, v117
  v_mfma_f32_16x16x32_bf16 v[148:151], v[68:71], v[28:31], v[148:151]
  ds_read_b64_tr_b16 v[100:101], v49 offset:0
  ds_read_b64_tr_b16 v[102:103], v49 offset:1024
  v_mfma_f32_16x16x32_bf16 v[152:155], v[68:71], v[32:35], v[152:155]
  ds_read_b128 v[12:15], v46 offset:0
  v_cvt_pk_bf16_f32 v123, v118, v119
  v_mfma_f32_16x16x32_bf16 v[156:159], v[68:71], v[36:39], v[156:159]
  buffer_load_dwordx4 v40, s[64:67], s32 offen offset:0 lds
  v_mfma_f32_16x16x32_bf16 v[160:163], v[72:75], v[24:27], v[160:163]
  ds_read_b64_tr_b16 v[104:105], v50 offset:0
  ds_read_b64_tr_b16 v[106:107], v50 offset:1024
  v_mfma_f32_16x16x32_bf16 v[164:167], v[72:75], v[28:31], v[164:167]
  ds_read_b128 v[16:19], v44 offset:16384
  v_accvgpr_write_b32 a16, v120
  v_mfma_f32_16x16x32_bf16 v[168:171], v[72:75], v[32:35], v[168:171]
  buffer_load_dwordx4 v41, s[64:67], s32 offen offset:1024 lds
  v_mfma_f32_16x16x32_bf16 v[172:175], v[72:75], v[36:39], v[172:175]
  ds_read_b64_tr_b16 v[108:109], v51 offset:0
  ds_read_b64_tr_b16 v[110:111], v51 offset:1024
  v_mfma_f32_16x16x32_bf16 v[176:179], v[76:79], v[24:27], v[176:179]
  ds_read_b128 v[20:23], v46 offset:16384
  v_accvgpr_write_b32 a17, v121
  v_mfma_f32_16x16x32_bf16 v[180:183], v[76:79], v[28:31], v[180:183]
  s_mov_b32 s32, 19328
  v_accvgpr_write_b32 a18, v122
  v_accvgpr_write_b32 a19, v123
  v_mfma_f32_16x16x32_bf16 v[184:187], v[76:79], v[32:35], v[184:187]
  ds_read_b64_tr_b16 v[64:65], v52 offset:0
  ds_read_b64_tr_b16 v[66:67], v52 offset:1024
  v_mfma_f32_16x16x32_bf16 v[188:191], v[76:79], v[36:39], v[188:191]
  buffer_load_dwordx4 v40, s[64:67], s32 offen offset:2048 lds
  v_mfma_f32_16x16x32_bf16 v[192:195], v[80:83], v[24:27], v[192:195]
  v_accvgpr_read_b32 v112, a80
  v_accvgpr_read_b32 v113, a81
  v_mfma_f32_16x16x32_bf16 v[196:199], v[80:83], v[28:31], v[196:199]
  ds_read_b64_tr_b16 v[68:69], v53 offset:0
  ds_read_b64_tr_b16 v[70:71], v53 offset:1024
  v_mfma_f32_16x16x32_bf16 v[200:203], v[80:83], v[32:35], v[200:203]
  v_accvgpr_read_b32 v114, a82
  v_accvgpr_read_b32 v115, a83
  v_mfma_f32_16x16x32_bf16 v[204:207], v[80:83], v[36:39], v[204:207]
  buffer_load_dwordx4 v41, s[64:67], s32 offen offset:3072 lds
  v_mfma_f32_16x16x32_bf16 v[208:211], v[84:87], v[24:27], v[208:211]
  ds_read_b64_tr_b16 v[72:73], v54 offset:0
  ds_read_b64_tr_b16 v[74:75], v54 offset:1024
  v_mfma_f32_16x16x32_bf16 v[212:215], v[84:87], v[28:31], v[212:215]
  v_accvgpr_read_b32 v116, a112
  v_accvgpr_read_b32 v117, a113
  v_mfma_f32_16x16x32_bf16 v[216:219], v[84:87], v[32:35], v[216:219]
  s_add_u32 m0, s36, 36864
  s_mov_b32 s32, 41856
  v_accvgpr_read_b32 v118, a114
  v_mfma_f32_16x16x32_bf16 v[220:223], v[84:87], v[36:39], v[220:223]
  ds_read_b64_tr_b16 v[76:77], v55 offset:0
  ds_read_b64_tr_b16 v[78:79], v55 offset:1024
  v_mfma_f32_16x16x32_bf16 v[224:227], v[88:91], v[24:27], v[224:227]
  buffer_load_dwordx4 v40, s[64:67], s32 offen offset:0 lds
  v_mfma_f32_16x16x32_bf16 v[228:231], v[88:91], v[28:31], v[228:231]
  v_accvgpr_read_b32 v119, a115
  v_mul_f32 v112, s44, v112
  v_mfma_f32_16x16x32_bf16 v[232:235], v[88:91], v[32:35], v[232:235]
  v_mul_f32 v113, s44, v113
  v_mul_f32 v114, s44, v114
  v_mfma_f32_16x16x32_bf16 v[236:239], v[88:91], v[36:39], v[236:239]
  v_mul_f32 v115, s44, v115
  v_mul_f32 v116, s44, v116
  v_mfma_f32_16x16x32_bf16 v[240:243], v[92:95], v[24:27], v[240:243]
  buffer_load_dwordx4 v41, s[64:67], s32 offen offset:1024 lds
  v_mfma_f32_16x16x32_bf16 v[244:247], v[92:95], v[28:31], v[244:247]
  v_mul_f32 v117, s44, v117
  v_mul_f32 v118, s44, v118
  v_mfma_f32_16x16x32_bf16 v[248:251], v[92:95], v[32:35], v[248:251]
  v_mul_f32 v119, s44, v119
  v_cvt_pk_bf16_f32 v124, v112, v113
  v_mfma_f32_16x16x32_bf16 v[252:255], v[92:95], v[36:39], v[252:255]
  s_waitcnt lgkmcnt(0)
  v_cvt_pk_bf16_f32 v125, v114, v115
  v_cvt_pk_bf16_f32 v126, v116, v117
  v_cvt_pk_bf16_f32 v127, v118, v119
  v_accvgpr_write_b32 a80, v124
  v_accvgpr_write_b32 a81, v125
  v_accvgpr_write_b32 a82, v126
  v_accvgpr_write_b32 a83, v127
  v_accvgpr_read_b32 v112, a20
  v_accvgpr_read_b32 v113, a21
  v_mfma_f32_16x16x32_bf16 v[128:131], v[96:99], v[8:11], v[128:131]
  s_mov_b32 s32, 60288
  ds_read_b64_tr_b16 v[80:81], v48 offset:8192
  ds_read_b64_tr_b16 v[82:83], v48 offset:9216
  v_mfma_f32_16x16x32_bf16 v[132:135], v[96:99], v[12:15], v[132:135]
  ds_read_b128 v[24:27], v45 offset:0
  v_accvgpr_read_b32 v114, a22
  v_mfma_f32_16x16x32_bf16 v[136:139], v[96:99], v[16:19], v[136:139]
  buffer_load_dwordx4 v40, s[64:67], s32 offen offset:2048 lds
  v_mfma_f32_16x16x32_bf16 v[140:143], v[96:99], v[20:23], v[140:143]
  ds_read_b64_tr_b16 v[84:85], v49 offset:8192
  ds_read_b64_tr_b16 v[86:87], v49 offset:9216
  v_mfma_f32_16x16x32_bf16 v[144:147], v[100:103], v[8:11], v[144:147]
  ds_read_b128 v[28:31], v47 offset:0
  v_accvgpr_read_b32 v115, a23
  v_mfma_f32_16x16x32_bf16 v[148:151], v[100:103], v[12:15], v[148:151]
  v_accvgpr_read_b32 v116, a52
  v_accvgpr_read_b32 v117, a53
  v_mfma_f32_16x16x32_bf16 v[152:155], v[100:103], v[16:19], v[152:155]
  ds_read_b64_tr_b16 v[88:89], v50 offset:8192
  ds_read_b64_tr_b16 v[90:91], v50 offset:9216
  v_mfma_f32_16x16x32_bf16 v[156:159], v[100:103], v[20:23], v[156:159]
  ds_read_b128 v[32:35], v45 offset:16384
  v_accvgpr_read_b32 v118, a54
  v_mfma_f32_16x16x32_bf16 v[160:163], v[104:107], v[8:11], v[160:163]
  buffer_load_dwordx4 v41, s[64:67], s32 offen offset:3072 lds
  v_mfma_f32_16x16x32_bf16 v[164:167], v[104:107], v[12:15], v[164:167]
  ds_read_b64_tr_b16 v[92:93], v51 offset:8192
  ds_read_b64_tr_b16 v[94:95], v51 offset:9216
  v_mfma_f32_16x16x32_bf16 v[168:171], v[104:107], v[16:19], v[168:171]
  ds_read_b128 v[36:39], v47 offset:16384
  v_accvgpr_read_b32 v119, a55
  v_mfma_f32_16x16x32_bf16 v[172:175], v[104:107], v[20:23], v[172:175]
  s_add_u32 m0, s39, 147456
  s_mov_b32 s34, 3670016
  v_mul_f32 v112, s44, v112
  v_mfma_f32_16x16x32_bf16 v[176:179], v[108:111], v[8:11], v[176:179]
  ds_read_b64_tr_b16 v[96:97], v52 offset:8192
  ds_read_b64_tr_b16 v[98:99], v52 offset:9216
  v_mfma_f32_16x16x32_bf16 v[180:183], v[108:111], v[12:15], v[180:183]
  buffer_load_dwordx4 v42, s[60:63], s34 offen offset:0 lds
  v_mfma_f32_16x16x32_bf16 v[184:187], v[108:111], v[16:19], v[184:187]
  v_mul_f32 v113, s44, v113
  v_mul_f32 v114, s44, v114
  v_mfma_f32_16x16x32_bf16 v[188:191], v[108:111], v[20:23], v[188:191]
  s_mov_b32 s34, 3701760
  ds_read_b64_tr_b16 v[100:101], v53 offset:8192
  ds_read_b64_tr_b16 v[102:103], v53 offset:9216
  v_mfma_f32_16x16x32_bf16 v[192:195], v[64:67], v[8:11], v[192:195]
  v_mul_f32 v115, s44, v115
  v_mul_f32 v116, s44, v116
  v_mfma_f32_16x16x32_bf16 v[196:199], v[64:67], v[12:15], v[196:199]
  buffer_load_dwordx4 v42, s[60:63], s34 offen offset:1024 lds
  v_mfma_f32_16x16x32_bf16 v[200:203], v[64:67], v[16:19], v[200:203]
  ds_read_b64_tr_b16 v[104:105], v54 offset:8192
  ds_read_b64_tr_b16 v[106:107], v54 offset:9216
  v_mfma_f32_16x16x32_bf16 v[204:207], v[64:67], v[20:23], v[204:207]
  v_mul_f32 v117, s44, v117
  v_mul_f32 v118, s44, v118
  v_mfma_f32_16x16x32_bf16 v[208:211], v[68:71], v[8:11], v[208:211]
  s_mov_b32 s34, 3733504
  v_mul_f32 v119, s44, v119
  v_cvt_pk_bf16_f32 v120, v112, v113
  v_mfma_f32_16x16x32_bf16 v[212:215], v[68:71], v[12:15], v[212:215]
  ds_read_b64_tr_b16 v[108:109], v55 offset:8192
  ds_read_b64_tr_b16 v[110:111], v55 offset:9216
  v_mfma_f32_16x16x32_bf16 v[216:219], v[68:71], v[16:19], v[216:219]
  buffer_load_dwordx4 v43, s[60:63], s34 offen offset:2048 lds
  v_mfma_f32_16x16x32_bf16 v[220:223], v[68:71], v[20:23], v[220:223]
  v_cvt_pk_bf16_f32 v121, v114, v115
  v_cvt_pk_bf16_f32 v122, v116, v117
  v_mfma_f32_16x16x32_bf16 v[224:227], v[72:75], v[8:11], v[224:227]
  s_mov_b32 s34, 3765248
  v_cvt_pk_bf16_f32 v123, v118, v119
  v_accvgpr_write_b32 a20, v120
  v_mfma_f32_16x16x32_bf16 v[228:231], v[72:75], v[12:15], v[228:231]
  v_accvgpr_write_b32 a21, v121
  v_accvgpr_write_b32 a22, v122
  v_mfma_f32_16x16x32_bf16 v[232:235], v[72:75], v[16:19], v[232:235]
  buffer_load_dwordx4 v43, s[60:63], s34 offen offset:3072 lds
  v_mfma_f32_16x16x32_bf16 v[236:239], v[72:75], v[20:23], v[236:239]
  v_accvgpr_write_b32 a23, v123
  v_accvgpr_read_b32 v112, a84
  v_mfma_f32_16x16x32_bf16 v[240:243], v[76:79], v[8:11], v[240:243]
  v_accvgpr_read_b32 v113, a85
  v_accvgpr_read_b32 v114, a86
  v_mfma_f32_16x16x32_bf16 v[244:247], v[76:79], v[12:15], v[244:247]
  v_accvgpr_read_b32 v115, a87
  v_accvgpr_read_b32 v116, a116
  v_mfma_f32_16x16x32_bf16 v[248:251], v[76:79], v[16:19], v[248:251]
  v_accvgpr_read_b32 v117, a117
  v_accvgpr_read_b32 v118, a118
  v_mfma_f32_16x16x32_bf16 v[252:255], v[76:79], v[20:23], v[252:255]
  s_waitcnt lgkmcnt(0)
  v_accvgpr_read_b32 v119, a119
  v_mul_f32 v112, s44, v112
  v_mul_f32 v113, s44, v113
  v_mul_f32 v114, s44, v114
  v_mul_f32 v115, s44, v115
  v_mul_f32 v116, s44, v116
  v_mul_f32 v117, s44, v117
  v_mul_f32 v118, s44, v118
  v_mul_f32 v119, s44, v119
  v_mfma_f32_16x16x32_bf16 v[128:131], v[80:83], v[24:27], v[128:131]
  v_add_u32 v44, 0xffff0000, v44
  v_add_u32 v45, 0xffff0000, v45
  v_mfma_f32_16x16x32_bf16 v[132:135], v[80:83], v[28:31], v[132:135]
  s_waitcnt vmcnt(12) lgkmcnt(0)
  s_barrier
  v_mfma_f32_16x16x32_bf16 v[136:139], v[80:83], v[32:35], v[136:139]
  s_add_u32 m0, s36, 65536
  v_add_u32 v46, 0xffff0000, v46
  v_add_u32 v47, 0xffff0000, v47
  v_mfma_f32_16x16x32_bf16 v[140:143], v[80:83], v[36:39], v[140:143]
  s_mov_b32 s32, 1024
  ds_read_b64_tr_b16 v[64:65], v48 offset:32768
  ds_read_b64_tr_b16 v[66:67], v48 offset:33792
  v_mfma_f32_16x16x32_bf16 v[144:147], v[84:87], v[24:27], v[144:147]
  ds_read_b128 v[8:11], v44 offset:0
  v_cvt_pk_bf16_f32 v124, v112, v113
  v_mfma_f32_16x16x32_bf16 v[148:151], v[84:87], v[28:31], v[148:151]
  ds_read_b64_tr_b16 v[68:69], v49 offset:32768
  ds_read_b64_tr_b16 v[70:71], v49 offset:33792
  v_mfma_f32_16x16x32_bf16 v[152:155], v[84:87], v[32:35], v[152:155]
  ds_read_b128 v[12:15], v46 offset:0
  v_cvt_pk_bf16_f32 v125, v114, v115
  v_mfma_f32_16x16x32_bf16 v[156:159], v[84:87], v[36:39], v[156:159]
  buffer_load_dwordx4 v40, s[64:67], s32 offen offset:0 lds
  v_mfma_f32_16x16x32_bf16 v[160:163], v[88:91], v[24:27], v[160:163]
  ds_read_b64_tr_b16 v[72:73], v50 offset:32768
  ds_read_b64_tr_b16 v[74:75], v50 offset:33792
  v_mfma_f32_16x16x32_bf16 v[164:167], v[88:91], v[28:31], v[164:167]
  ds_read_b128 v[16:19], v44 offset:16384
  v_cvt_pk_bf16_f32 v126, v116, v117
  v_mfma_f32_16x16x32_bf16 v[168:171], v[88:91], v[32:35], v[168:171]
  buffer_load_dwordx4 v41, s[64:67], s32 offen offset:1024 lds
  v_mfma_f32_16x16x32_bf16 v[172:175], v[88:91], v[36:39], v[172:175]
  ds_read_b64_tr_b16 v[76:77], v51 offset:32768
  ds_read_b64_tr_b16 v[78:79], v51 offset:33792
  v_mfma_f32_16x16x32_bf16 v[176:179], v[92:95], v[24:27], v[176:179]
  ds_read_b128 v[20:23], v46 offset:16384
  v_cvt_pk_bf16_f32 v127, v118, v119
  v_mfma_f32_16x16x32_bf16 v[180:183], v[92:95], v[28:31], v[180:183]
  s_mov_b32 s32, 19456
  v_accvgpr_write_b32 a84, v124
  v_accvgpr_write_b32 a85, v125
  v_mfma_f32_16x16x32_bf16 v[184:187], v[92:95], v[32:35], v[184:187]
  ds_read_b64_tr_b16 v[80:81], v52 offset:32768
  ds_read_b64_tr_b16 v[82:83], v52 offset:33792
  v_mfma_f32_16x16x32_bf16 v[188:191], v[92:95], v[36:39], v[188:191]
  buffer_load_dwordx4 v40, s[64:67], s32 offen offset:2048 lds
  v_mfma_f32_16x16x32_bf16 v[192:195], v[96:99], v[24:27], v[192:195]
  v_accvgpr_write_b32 a86, v126
  v_accvgpr_write_b32 a87, v127
  v_mfma_f32_16x16x32_bf16 v[196:199], v[96:99], v[28:31], v[196:199]
  ds_read_b64_tr_b16 v[84:85], v53 offset:32768
  ds_read_b64_tr_b16 v[86:87], v53 offset:33792
  v_mfma_f32_16x16x32_bf16 v[200:203], v[96:99], v[32:35], v[200:203]
  v_accvgpr_read_b32 v112, a24
  v_accvgpr_read_b32 v113, a25
  v_mfma_f32_16x16x32_bf16 v[204:207], v[96:99], v[36:39], v[204:207]
  buffer_load_dwordx4 v41, s[64:67], s32 offen offset:3072 lds
  v_mfma_f32_16x16x32_bf16 v[208:211], v[100:103], v[24:27], v[208:211]
  ds_read_b64_tr_b16 v[88:89], v54 offset:32768
  ds_read_b64_tr_b16 v[90:91], v54 offset:33792
  v_mfma_f32_16x16x32_bf16 v[212:215], v[100:103], v[28:31], v[212:215]
  v_accvgpr_read_b32 v114, a26
  v_accvgpr_read_b32 v115, a27
  v_mfma_f32_16x16x32_bf16 v[216:219], v[100:103], v[32:35], v[216:219]
  s_add_u32 m0, s36, 69632
  s_mov_b32 s32, 41984
  v_accvgpr_read_b32 v116, a56
  v_mfma_f32_16x16x32_bf16 v[220:223], v[100:103], v[36:39], v[220:223]
  ds_read_b64_tr_b16 v[92:93], v55 offset:32768
  ds_read_b64_tr_b16 v[94:95], v55 offset:33792
  v_mfma_f32_16x16x32_bf16 v[224:227], v[104:107], v[24:27], v[224:227]
  buffer_load_dwordx4 v40, s[64:67], s32 offen offset:0 lds
  v_mfma_f32_16x16x32_bf16 v[228:231], v[104:107], v[28:31], v[228:231]
  v_accvgpr_read_b32 v117, a57
  v_accvgpr_read_b32 v118, a58
  v_mfma_f32_16x16x32_bf16 v[232:235], v[104:107], v[32:35], v[232:235]
  v_accvgpr_read_b32 v119, a59
  v_mul_f32 v112, s44, v112
  v_mfma_f32_16x16x32_bf16 v[236:239], v[104:107], v[36:39], v[236:239]
  v_mul_f32 v113, s44, v113
  v_mul_f32 v114, s44, v114
  v_mfma_f32_16x16x32_bf16 v[240:243], v[108:111], v[24:27], v[240:243]
  buffer_load_dwordx4 v41, s[64:67], s32 offen offset:1024 lds
  v_mfma_f32_16x16x32_bf16 v[244:247], v[108:111], v[28:31], v[244:247]
  v_mul_f32 v115, s44, v115
  v_mul_f32 v116, s44, v116
  v_mfma_f32_16x16x32_bf16 v[248:251], v[108:111], v[32:35], v[248:251]
  v_mul_f32 v117, s44, v117
  v_mul_f32 v118, s44, v118
  v_mfma_f32_16x16x32_bf16 v[252:255], v[108:111], v[36:39], v[252:255]
  s_waitcnt lgkmcnt(0)
  v_mul_f32 v119, s44, v119
  v_cvt_pk_bf16_f32 v120, v112, v113
  v_cvt_pk_bf16_f32 v121, v114, v115
  v_cvt_pk_bf16_f32 v122, v116, v117
  v_cvt_pk_bf16_f32 v123, v118, v119
  v_accvgpr_write_b32 a24, v120
  v_accvgpr_write_b32 a25, v121
  v_accvgpr_write_b32 a26, v122
  v_accvgpr_write_b32 a27, v123
  v_mfma_f32_16x16x32_bf16 v[128:131], v[64:67], v[8:11], v[128:131]
  s_mov_b32 s32, 60416
  ds_read_b64_tr_b16 v[96:97], v48 offset:40960
  ds_read_b64_tr_b16 v[98:99], v48 offset:41984
  v_mfma_f32_16x16x32_bf16 v[132:135], v[64:67], v[12:15], v[132:135]
  ds_read_b128 v[24:27], v45 offset:0
  v_accvgpr_read_b32 v112, a88
  v_mfma_f32_16x16x32_bf16 v[136:139], v[64:67], v[16:19], v[136:139]
  s_add_u32 s46, s43, 0
  buffer_load_dwordx4 v40, s[64:67], s32 offen offset:2048 lds
  v_mfma_f32_16x16x32_bf16 v[140:143], v[64:67], v[20:23], v[140:143]
  ds_read_b64_tr_b16 v[100:101], v49 offset:40960
  ds_read_b64_tr_b16 v[102:103], v49 offset:41984
  v_mfma_f32_16x16x32_bf16 v[144:147], v[68:71], v[8:11], v[144:147]
  ds_read_b128 v[28:31], v47 offset:0
  v_accvgpr_read_b32 v113, a89
  v_mfma_f32_16x16x32_bf16 v[148:151], v[68:71], v[12:15], v[148:151]
  v_accvgpr_read_b32 v114, a90
  v_accvgpr_read_b32 v115, a91
  v_mfma_f32_16x16x32_bf16 v[152:155], v[68:71], v[16:19], v[152:155]
  ds_read_b64_tr_b16 v[104:105], v50 offset:40960
  ds_read_b64_tr_b16 v[106:107], v50 offset:41984
  v_mfma_f32_16x16x32_bf16 v[156:159], v[68:71], v[20:23], v[156:159]
  ds_read_b128 v[32:35], v45 offset:16384
  v_accvgpr_read_b32 v116, a120
  v_mfma_f32_16x16x32_bf16 v[160:163], v[72:75], v[8:11], v[160:163]
  buffer_load_dwordx4 v41, s[64:67], s32 offen offset:3072 lds
  v_mfma_f32_16x16x32_bf16 v[164:167], v[72:75], v[12:15], v[164:167]
  ds_read_b64_tr_b16 v[108:109], v51 offset:40960
  ds_read_b64_tr_b16 v[110:111], v51 offset:41984
  v_mfma_f32_16x16x32_bf16 v[168:171], v[72:75], v[16:19], v[168:171]
  ds_read_b128 v[36:39], v47 offset:16384
  v_accvgpr_read_b32 v117, a121
  v_mfma_f32_16x16x32_bf16 v[172:175], v[72:75], v[20:23], v[172:175]
  s_add_u32 m0, s39, 98304
  s_mov_b32 s34, 4194304
  v_accvgpr_read_b32 v118, a122
  v_mfma_f32_16x16x32_bf16 v[176:179], v[76:79], v[8:11], v[176:179]
  ds_read_b64_tr_b16 v[64:65], v52 offset:40960
  ds_read_b64_tr_b16 v[66:67], v52 offset:41984
  v_mfma_f32_16x16x32_bf16 v[180:183], v[76:79], v[12:15], v[180:183]
  buffer_load_dwordx4 v42, s[60:63], s34 offen offset:0 lds
  v_mfma_f32_16x16x32_bf16 v[184:187], v[76:79], v[16:19], v[184:187]
  buffer_store_dwordx4 a[0:3], v56, s[8:11], s46 offen offset:0 sc1
  v_mfma_f32_16x16x32_bf16 v[188:191], v[76:79], v[20:23], v[188:191]
  s_mov_b32 s34, 4226048
  ds_read_b64_tr_b16 v[68:69], v53 offset:40960
  ds_read_b64_tr_b16 v[70:71], v53 offset:41984
  v_mfma_f32_16x16x32_bf16 v[192:195], v[80:83], v[8:11], v[192:195]
  buffer_store_dwordx4 a[64:67], v56, s[8:11], s46 offen offset:1024 sc1
  v_mfma_f32_16x16x32_bf16 v[196:199], v[80:83], v[12:15], v[196:199]
  s_add_u32 s46, s43, 4096
  buffer_load_dwordx4 v42, s[60:63], s34 offen offset:1024 lds
  v_mfma_f32_16x16x32_bf16 v[200:203], v[80:83], v[16:19], v[200:203]
  ds_read_b64_tr_b16 v[72:73], v54 offset:40960
  ds_read_b64_tr_b16 v[74:75], v54 offset:41984
  v_mfma_f32_16x16x32_bf16 v[204:207], v[80:83], v[20:23], v[204:207]
  v_accvgpr_read_b32 v119, a123
  v_mul_f32 v112, s44, v112
  v_mfma_f32_16x16x32_bf16 v[208:211], v[84:87], v[8:11], v[208:211]
  s_mov_b32 s34, 4257792
  buffer_store_dwordx4 a[4:7], v56, s[8:11], s46 offen offset:0 sc1
  v_mfma_f32_16x16x32_bf16 v[212:215], v[84:87], v[12:15], v[212:215]
  ds_read_b64_tr_b16 v[76:77], v55 offset:40960
  ds_read_b64_tr_b16 v[78:79], v55 offset:41984
  v_mfma_f32_16x16x32_bf16 v[216:219], v[84:87], v[16:19], v[216:219]
  buffer_load_dwordx4 v43, s[60:63], s34 offen offset:2048 lds
  v_mfma_f32_16x16x32_bf16 v[220:223], v[84:87], v[20:23], v[220:223]
  v_mul_f32 v113, s44, v113
  v_mul_f32 v114, s44, v114
  v_mfma_f32_16x16x32_bf16 v[224:227], v[88:91], v[8:11], v[224:227]
  s_mov_b32 s34, 4289536
  v_mul_f32 v115, s44, v115
  v_mul_f32 v116, s44, v116
  v_mfma_f32_16x16x32_bf16 v[228:231], v[88:91], v[12:15], v[228:231]
  buffer_store_dwordx4 a[68:71], v56, s[8:11], s46 offen offset:1024 sc1
  v_mfma_f32_16x16x32_bf16 v[232:235], v[88:91], v[16:19], v[232:235]
  buffer_load_dwordx4 v43, s[60:63], s34 offen offset:3072 lds
  v_mfma_f32_16x16x32_bf16 v[236:239], v[88:91], v[20:23], v[236:239]
  v_mul_f32 v117, s44, v117
  v_mul_f32 v118, s44, v118
  v_mfma_f32_16x16x32_bf16 v[240:243], v[92:95], v[8:11], v[240:243]
  v_mul_f32 v119, s44, v119
  v_cvt_pk_bf16_f32 v124, v112, v113
  v_mfma_f32_16x16x32_bf16 v[244:247], v[92:95], v[12:15], v[244:247]
  v_cvt_pk_bf16_f32 v125, v114, v115
  v_cvt_pk_bf16_f32 v126, v116, v117
  v_mfma_f32_16x16x32_bf16 v[248:251], v[92:95], v[16:19], v[248:251]
  v_cvt_pk_bf16_f32 v127, v118, v119
  v_accvgpr_write_b32 a88, v124
  v_mfma_f32_16x16x32_bf16 v[252:255], v[92:95], v[20:23], v[252:255]
  s_waitcnt lgkmcnt(0)
  v_accvgpr_write_b32 a89, v125
  v_accvgpr_write_b32 a90, v126
  v_accvgpr_write_b32 a91, v127
  v_accvgpr_read_b32 v112, a28
  v_accvgpr_read_b32 v113, a29
  v_accvgpr_read_b32 v114, a30
  v_accvgpr_read_b32 v115, a31
  v_accvgpr_read_b32 v116, a60
  v_accvgpr_read_b32 v117, a61
  v_mfma_f32_16x16x32_bf16 v[128:131], v[96:99], v[24:27], v[128:131]
  v_accvgpr_read_b32 v118, a62
  v_accvgpr_read_b32 v119, a63
  v_mfma_f32_16x16x32_bf16 v[132:135], v[96:99], v[28:31], v[132:135]
  s_waitcnt vmcnt(16) lgkmcnt(0)
  s_barrier
  v_mfma_f32_16x16x32_bf16 v[136:139], v[96:99], v[32:35], v[136:139]
  s_add_u32 m0, s36, 0
  ds_read_b64_tr_b16 v[80:81], v48 offset:49152
  ds_read_b64_tr_b16 v[82:83], v48 offset:50176
  v_mfma_f32_16x16x32_bf16 v[140:143], v[96:99], v[36:39], v[140:143]
  s_mov_b32 s32, 1152
  ds_read_b128 v[8:11], v44 offset:32768
  v_mul_f32 v112, s44, v112
  v_mfma_f32_16x16x32_bf16 v[144:147], v[100:103], v[24:27], v[144:147]
  s_add_u32 s46, s43, 8192
  buffer_load_dwordx4 v40, s[64:67], s32 offen offset:0 lds
  v_mfma_f32_16x16x32_bf16 v[148:151], v[100:103], v[28:31], v[148:151]
  ds_read_b64_tr_b16 v[84:85], v49 offset:49152
  ds_read_b64_tr_b16 v[86:87], v49 offset:50176
  v_mfma_f32_16x16x32_bf16 v[152:155], v[100:103], v[32:35], v[152:155]
  ds_read_b128 v[12:15], v46 offset:32768
  v_mul_f32 v113, s44, v113
  v_mfma_f32_16x16x32_bf16 v[156:159], v[100:103], v[36:39], v[156:159]
  v_mul_f32 v114, s44, v114
  v_mul_f32 v115, s44, v115
  v_mfma_f32_16x16x32_bf16 v[160:163], v[104:107], v[24:27], v[160:163]
  ds_read_b64_tr_b16 v[88:89], v50 offset:49152
  ds_read_b64_tr_b16 v[90:91], v50 offset:50176
  v_mfma_f32_16x16x32_bf16 v[164:167], v[104:107], v[28:31], v[164:167]
  ds_read_b128 v[16:19], v44 offset:49152
  v_mul_f32 v116, s44, v116
  v_mfma_f32_16x16x32_bf16 v[168:171], v[104:107], v[32:35], v[168:171]
  buffer_load_dwordx4 v41, s[64:67], s32 offen offset:1024 lds
  v_mfma_f32_16x16x32_bf16 v[172:175], v[104:107], v[36:39], v[172:175]
  ds_read_b64_tr_b16 v[92:93], v51 offset:49152
  ds_read_b64_tr_b16 v[94:95], v51 offset:50176
  v_mfma_f32_16x16x32_bf16 v[176:179], v[108:111], v[24:27], v[176:179]
  ds_read_b128 v[20:23], v46 offset:49152
  v_mul_f32 v117, s44, v117
  v_mfma_f32_16x16x32_bf16 v[180:183], v[108:111], v[28:31], v[180:183]
  s_mov_b32 s32, 19584
  buffer_store_dwordx4 a[8:11], v56, s[8:11], s46 offen offset:0 sc1
  v_mfma_f32_16x16x32_bf16 v[184:187], v[108:111], v[32:35], v[184:187]
  ds_read_b64_tr_b16 v[96:97], v52 offset:49152
  ds_read_b64_tr_b16 v[98:99], v52 offset:50176
  v_mfma_f32_16x16x32_bf16 v[188:191], v[108:111], v[36:39], v[188:191]
  buffer_load_dwordx4 v40, s[64:67], s32 offen offset:2048 lds
  v_mfma_f32_16x16x32_bf16 v[192:195], v[64:67], v[24:27], v[192:195]
  buffer_store_dwordx4 a[72:75], v56, s[8:11], s46 offen offset:1024 sc1
  v_mfma_f32_16x16x32_bf16 v[196:199], v[64:67], v[28:31], v[196:199]
  ds_read_b64_tr_b16 v[100:101], v53 offset:49152
  ds_read_b64_tr_b16 v[102:103], v53 offset:50176
  v_mfma_f32_16x16x32_bf16 v[200:203], v[64:67], v[32:35], v[200:203]
  s_add_u32 s46, s43, 12288
  v_mul_f32 v118, s44, v118
  v_mul_f32 v119, s44, v119
  v_mfma_f32_16x16x32_bf16 v[204:207], v[64:67], v[36:39], v[204:207]
  buffer_load_dwordx4 v41, s[64:67], s32 offen offset:3072 lds
  v_mfma_f32_16x16x32_bf16 v[208:211], v[68:71], v[24:27], v[208:211]
  ds_read_b64_tr_b16 v[104:105], v54 offset:49152
  ds_read_b64_tr_b16 v[106:107], v54 offset:50176
  v_mfma_f32_16x16x32_bf16 v[212:215], v[68:71], v[28:31], v[212:215]
  v_cvt_pk_bf16_f32 v120, v112, v113
  v_cvt_pk_bf16_f32 v121, v114, v115
  v_mfma_f32_16x16x32_bf16 v[216:219], v[68:71], v[32:35], v[216:219]
  s_add_u32 m0, s36, 4096
  s_mov_b32 s32, 42112
  v_cvt_pk_bf16_f32 v122, v116, v117
  v_mfma_f32_16x16x32_bf16 v[220:223], v[68:71], v[36:39], v[220:223]
  ds_read_b64_tr_b16 v[108:109], v55 offset:49152
  ds_read_b64_tr_b16 v[110:111], v55 offset:50176
  v_mfma_f32_16x16x32_bf16 v[224:227], v[72:75], v[24:27], v[224:227]
  buffer_load_dwordx4 v40, s[64:67], s32 offen offset:0 lds
  v_mfma_f32_16x16x32_bf16 v[228:231], v[72:75], v[28:31], v[228:231]
  buffer_store_dwordx4 a[12:15], v56, s[8:11], s46 offen offset:0 sc1
  v_mfma_f32_16x16x32_bf16 v[232:235], v[72:75], v[32:35], v[232:235]
  v_cvt_pk_bf16_f32 v123, v118, v119
  v_accvgpr_write_b32 a28, v120
  v_mfma_f32_16x16x32_bf16 v[236:239], v[72:75], v[36:39], v[236:239]
  buffer_store_dwordx4 a[76:79], v56, s[8:11], s46 offen offset:1024 sc1
  v_mfma_f32_16x16x32_bf16 v[240:243], v[76:79], v[24:27], v[240:243]
  buffer_load_dwordx4 v41, s[64:67], s32 offen offset:1024 lds
  v_mfma_f32_16x16x32_bf16 v[244:247], v[76:79], v[28:31], v[244:247]
  v_accvgpr_write_b32 a29, v121
  v_accvgpr_write_b32 a30, v122
  v_mfma_f32_16x16x32_bf16 v[248:251], v[76:79], v[32:35], v[248:251]
  v_accvgpr_write_b32 a31, v123
  v_accvgpr_read_b32 v112, a92
  v_mfma_f32_16x16x32_bf16 v[252:255], v[76:79], v[36:39], v[252:255]
  s_waitcnt lgkmcnt(0)
  v_accvgpr_read_b32 v113, a93
  v_accvgpr_read_b32 v114, a94
  v_accvgpr_read_b32 v115, a95
  v_accvgpr_read_b32 v116, a124
  v_accvgpr_read_b32 v117, a125
  v_accvgpr_read_b32 v118, a126
  v_accvgpr_read_b32 v119, a127
  v_mul_f32 v112, s44, v112
  v_mul_f32 v113, s44, v113
  v_mfma_f32_16x16x32_bf16 v[128:131], v[80:83], v[8:11], v[128:131]
  s_mov_b32 s32, 60544
  ds_read_b64_tr_b16 v[64:65], v48 offset:57344
  ds_read_b64_tr_b16 v[66:67], v48 offset:58368
  v_mfma_f32_16x16x32_bf16 v[132:135], v[80:83], v[12:15], v[132:135]
  ds_read_b128 v[24:27], v45 offset:32768
  v_mul_f32 v114, s44, v114
  v_mfma_f32_16x16x32_bf16 v[136:139], v[80:83], v[16:19], v[136:139]
  s_add_u32 s46, s42, 16384
  buffer_load_dwordx4 v40, s[64:67], s32 offen offset:2048 lds
  v_mfma_f32_16x16x32_bf16 v[140:143], v[80:83], v[20:23], v[140:143]
  ds_read_b64_tr_b16 v[68:69], v49 offset:57344
  ds_read_b64_tr_b16 v[70:71], v49 offset:58368
  v_mfma_f32_16x16x32_bf16 v[144:147], v[84:87], v[8:11], v[144:147]
  ds_read_b128 v[28:31], v47 offset:32768
  v_mul_f32 v115, s44, v115
  v_mfma_f32_16x16x32_bf16 v[148:151], v[84:87], v[12:15], v[148:151]
  v_mul_f32 v116, s44, v116
  v_mul_f32 v117, s44, v117
  v_mfma_f32_16x16x32_bf16 v[152:155], v[84:87], v[16:19], v[152:155]
  ds_read_b64_tr_b16 v[72:73], v50 offset:57344
  ds_read_b64_tr_b16 v[74:75], v50 offset:58368
  v_mfma_f32_16x16x32_bf16 v[156:159], v[84:87], v[20:23], v[156:159]
  ds_read_b128 v[32:35], v45 offset:49152
  v_mul_f32 v118, s44, v118
  v_mfma_f32_16x16x32_bf16 v[160:163], v[88:91], v[8:11], v[160:163]
  buffer_load_dwordx4 v41, s[64:67], s32 offen offset:3072 lds
  v_mfma_f32_16x16x32_bf16 v[164:167], v[88:91], v[12:15], v[164:167]
  ds_read_b64_tr_b16 v[76:77], v51 offset:57344
  ds_read_b64_tr_b16 v[78:79], v51 offset:58368
  v_mfma_f32_16x16x32_bf16 v[168:171], v[88:91], v[16:19], v[168:171]
  ds_read_b128 v[36:39], v47 offset:49152
  v_mul_f32 v119, s44, v119
  v_mfma_f32_16x16x32_bf16 v[172:175], v[88:91], v[20:23], v[172:175]
  s_add_u32 m0, s39, 131072
  s_mov_b32 s34, 4718592
  v_cvt_pk_bf16_f32 v124, v112, v113
  v_mfma_f32_16x16x32_bf16 v[176:179], v[92:95], v[8:11], v[176:179]
  ds_read_b64_tr_b16 v[80:81], v52 offset:57344
  ds_read_b64_tr_b16 v[82:83], v52 offset:58368
  v_mfma_f32_16x16x32_bf16 v[180:183], v[92:95], v[12:15], v[180:183]
  buffer_load_dwordx4 v42, s[60:63], s34 offen offset:0 lds
  v_mfma_f32_16x16x32_bf16 v[184:187], v[92:95], v[16:19], v[184:187]
  buffer_store_dwordx4 a[128:131], v56, s[8:11], s46 offen offset:0 sc1
  v_mfma_f32_16x16x32_bf16 v[188:191], v[92:95], v[20:23], v[188:191]
  s_mov_b32 s34, 4750336
  ds_read_b64_tr_b16 v[84:85], v53 offset:57344
  ds_read_b64_tr_b16 v[86:87], v53 offset:58368
  v_mfma_f32_16x16x32_bf16 v[192:195], v[96:99], v[8:11], v[192:195]
  buffer_store_dwordx4 a[160:163], v56, s[8:11], s46 offen offset:1024 sc1
  v_mfma_f32_16x16x32_bf16 v[196:199], v[96:99], v[12:15], v[196:199]
  buffer_load_dwordx4 v42, s[60:63], s34 offen offset:1024 lds
  v_mfma_f32_16x16x32_bf16 v[200:203], v[96:99], v[16:19], v[200:203]
  ds_read_b64_tr_b16 v[88:89], v54 offset:57344
  ds_read_b64_tr_b16 v[90:91], v54 offset:58368
  v_mfma_f32_16x16x32_bf16 v[204:207], v[96:99], v[20:23], v[204:207]
  buffer_store_dwordx4 a[192:195], v56, s[8:11], s46 offen offset:2048 sc1
  v_mfma_f32_16x16x32_bf16 v[208:211], v[100:103], v[8:11], v[208:211]
  s_mov_b32 s34, 4782080
  v_cvt_pk_bf16_f32 v125, v114, v115
  v_cvt_pk_bf16_f32 v126, v116, v117
  v_mfma_f32_16x16x32_bf16 v[212:215], v[100:103], v[12:15], v[212:215]
  ds_read_b64_tr_b16 v[92:93], v55 offset:57344
  ds_read_b64_tr_b16 v[94:95], v55 offset:58368
  v_mfma_f32_16x16x32_bf16 v[216:219], v[100:103], v[16:19], v[216:219]
  buffer_load_dwordx4 v43, s[60:63], s34 offen offset:2048 lds
  v_mfma_f32_16x16x32_bf16 v[220:223], v[100:103], v[20:23], v[220:223]
  v_cvt_pk_bf16_f32 v127, v118, v119
  v_accvgpr_write_b32 a92, v124
  v_mfma_f32_16x16x32_bf16 v[224:227], v[104:107], v[8:11], v[224:227]
  s_mov_b32 s34, 4813824
  buffer_store_dwordx4 a[224:227], v56, s[8:11], s46 offen offset:3072 sc1
  v_mfma_f32_16x16x32_bf16 v[228:231], v[104:107], v[12:15], v[228:231]
  v_accvgpr_write_b32 a93, v125
  v_accvgpr_write_b32 a94, v126
  v_mfma_f32_16x16x32_bf16 v[232:235], v[104:107], v[16:19], v[232:235]
  buffer_load_dwordx4 v43, s[60:63], s34 offen offset:3072 lds
  v_mfma_f32_16x16x32_bf16 v[236:239], v[104:107], v[20:23], v[236:239]
  v_accvgpr_write_b32 a95, v127
  v_accvgpr_read_b32 v112, a144
  v_mfma_f32_16x16x32_bf16 v[240:243], v[108:111], v[8:11], v[240:243]
  v_accvgpr_read_b32 v113, a145
  v_accvgpr_read_b32 v114, a146
  v_mfma_f32_16x16x32_bf16 v[244:247], v[108:111], v[12:15], v[244:247]
  v_accvgpr_read_b32 v115, a147
  v_accvgpr_read_b32 v116, a148
  v_mfma_f32_16x16x32_bf16 v[248:251], v[108:111], v[16:19], v[248:251]
  v_accvgpr_read_b32 v117, a149
  v_accvgpr_read_b32 v118, a150
  v_mfma_f32_16x16x32_bf16 v[252:255], v[108:111], v[20:23], v[252:255]
  s_waitcnt lgkmcnt(0)
  v_accvgpr_read_b32 v119, a151
  v_cvt_pk_bf16_f32 v120, v112, v113
  v_cvt_pk_bf16_f32 v121, v114, v115
  v_cvt_pk_bf16_f32 v122, v116, v117
  v_cvt_pk_bf16_f32 v123, v118, v119
  v_accvgpr_write_b32 a144, v120
  v_accvgpr_write_b32 a145, v121
  v_accvgpr_write_b32 a146, v122
  v_accvgpr_write_b32 a147, v123
  v_mfma_f32_16x16x32_bf16 v[128:131], v[64:67], v[24:27], v[128:131]
  v_add_u32 v44, 0x10000, v44
  v_add_u32 v45, 0x10000, v45
  v_mfma_f32_16x16x32_bf16 v[132:135], v[64:67], v[28:31], v[132:135]
  s_waitcnt vmcnt(20) lgkmcnt(0)
  s_barrier
  v_mfma_f32_16x16x32_bf16 v[136:139], v[64:67], v[32:35], v[136:139]
  v_add_u32 v46, 0x10000, v46
  v_add_u32 v47, 0x10000, v47
  v_mfma_f32_16x16x32_bf16 v[140:143], v[64:67], v[36:39], v[140:143]
  ds_read_b64_tr_b16 v[96:97], v48 offset:0
  ds_read_b64_tr_b16 v[98:99], v48 offset:1024
  v_mfma_f32_16x16x32_bf16 v[144:147], v[68:71], v[24:27], v[144:147]
  s_add_u32 s46, s42, 24576
  ds_read_b128 v[8:11], v44 offset:0
  v_accvgpr_read_b32 v112, a176
  v_mfma_f32_16x16x32_bf16 v[148:151], v[68:71], v[28:31], v[148:151]
  ds_read_b64_tr_b16 v[100:101], v49 offset:0
  ds_read_b64_tr_b16 v[102:103], v49 offset:1024
  v_mfma_f32_16x16x32_bf16 v[152:155], v[68:71], v[32:35], v[152:155]
  ds_read_b128 v[12:15], v46 offset:0
  v_accvgpr_read_b32 v113, a177
  v_mfma_f32_16x16x32_bf16 v[156:159], v[68:71], v[36:39], v[156:159]
  v_accvgpr_read_b32 v114, a178
  v_accvgpr_read_b32 v115, a179
  v_mfma_f32_16x16x32_bf16 v[160:163], v[72:75], v[24:27], v[160:163]
  ds_read_b64_tr_b16 v[104:105], v50 offset:0
  ds_read_b64_tr_b16 v[106:107], v50 offset:1024
  v_mfma_f32_16x16x32_bf16 v[164:167], v[72:75], v[28:31], v[164:167]
  ds_read_b128 v[16:19], v44 offset:16384
  v_accvgpr_read_b32 v116, a180
  v_mfma_f32_16x16x32_bf16 v[168:171], v[72:75], v[32:35], v[168:171]
  buffer_store_dwordx4 a[136:139], v56, s[8:11], s46 offen offset:0 sc1
  v_mfma_f32_16x16x32_bf16 v[172:175], v[72:75], v[36:39], v[172:175]
  ds_read_b64_tr_b16 v[108:109], v51 offset:0
  ds_read_b64_tr_b16 v[110:111], v51 offset:1024
  v_mfma_f32_16x16x32_bf16 v[176:179], v[76:79], v[24:27], v[176:179]
  ds_read_b128 v[20:23], v46 offset:16384
  v_accvgpr_read_b32 v117, a181
  v_mfma_f32_16x16x32_bf16 v[180:183], v[76:79], v[28:31], v[180:183]
  v_accvgpr_read_b32 v118, a182
  v_accvgpr_read_b32 v119, a183
  v_mfma_f32_16x16x32_bf16 v[184:187], v[76:79], v[32:35], v[184:187]
  ds_read_b64_tr_b16 v[64:65], v52 offset:0
  ds_read_b64_tr_b16 v[66:67], v52 offset:1024
  v_mfma_f32_16x16x32_bf16 v[188:191], v[76:79], v[36:39], v[188:191]
  buffer_store_dwordx4 a[168:171], v56, s[8:11], s46 offen offset:1024 sc1
  v_mfma_f32_16x16x32_bf16 v[192:195], v[80:83], v[24:27], v[192:195]
  v_cvt_pk_bf16_f32 v124, v112, v113
  v_cvt_pk_bf16_f32 v125, v114, v115
  v_mfma_f32_16x16x32_bf16 v[196:199], v[80:83], v[28:31], v[196:199]
  ds_read_b64_tr_b16 v[68:69], v53 offset:0
  ds_read_b64_tr_b16 v[70:71], v53 offset:1024
  v_mfma_f32_16x16x32_bf16 v[200:203], v[80:83], v[32:35], v[200:203]
  v_cvt_pk_bf16_f32 v126, v116, v117
  v_cvt_pk_bf16_f32 v127, v118, v119
  v_mfma_f32_16x16x32_bf16 v[204:207], v[80:83], v[36:39], v[204:207]
  v_accvgpr_write_b32 a176, v124
  v_accvgpr_write_b32 a177, v125
  v_mfma_f32_16x16x32_bf16 v[208:211], v[84:87], v[24:27], v[208:211]
  ds_read_b64_tr_b16 v[72:73], v54 offset:0
  ds_read_b64_tr_b16 v[74:75], v54 offset:1024
  v_mfma_f32_16x16x32_bf16 v[212:215], v[84:87], v[28:31], v[212:215]
  buffer_store_dwordx4 a[200:203], v56, s[8:11], s46 offen offset:2048 sc1
  v_mfma_f32_16x16x32_bf16 v[216:219], v[84:87], v[32:35], v[216:219]
  v_accvgpr_write_b32 a178, v126
  v_accvgpr_write_b32 a179, v127
  v_mfma_f32_16x16x32_bf16 v[220:223], v[84:87], v[36:39], v[220:223]
  ds_read_b64_tr_b16 v[76:77], v55 offset:0
  ds_read_b64_tr_b16 v[78:79], v55 offset:1024
  v_mfma_f32_16x16x32_bf16 v[224:227], v[88:91], v[24:27], v[224:227]
  v_accvgpr_read_b32 v112, a208
  v_accvgpr_read_b32 v113, a209
  v_mfma_f32_16x16x32_bf16 v[228:231], v[88:91], v[28:31], v[228:231]
  v_accvgpr_read_b32 v114, a210
  v_accvgpr_read_b32 v115, a211
  v_mfma_f32_16x16x32_bf16 v[232:235], v[88:91], v[32:35], v[232:235]
  buffer_store_dwordx4 a[232:235], v56, s[8:11], s46 offen offset:3072 sc1
  v_mfma_f32_16x16x32_bf16 v[236:239], v[88:91], v[36:39], v[236:239]
  v_accvgpr_read_b32 v116, a212
  v_accvgpr_read_b32 v117, a213
  v_mfma_f32_16x16x32_bf16 v[240:243], v[92:95], v[24:27], v[240:243]
  v_accvgpr_read_b32 v118, a214
  v_accvgpr_read_b32 v119, a215
  v_mfma_f32_16x16x32_bf16 v[244:247], v[92:95], v[28:31], v[244:247]
  v_cvt_pk_bf16_f32 v120, v112, v113
  v_cvt_pk_bf16_f32 v121, v114, v115
  v_mfma_f32_16x16x32_bf16 v[248:251], v[92:95], v[32:35], v[248:251]
  v_cvt_pk_bf16_f32 v122, v116, v117
  v_cvt_pk_bf16_f32 v123, v118, v119
  v_mfma_f32_16x16x32_bf16 v[252:255], v[92:95], v[36:39], v[252:255]
  s_waitcnt lgkmcnt(0)
  v_accvgpr_write_b32 a208, v120
  v_accvgpr_write_b32 a209, v121
  v_accvgpr_write_b32 a210, v122
  v_accvgpr_write_b32 a211, v123
  v_accvgpr_read_b32 v112, a240
  v_accvgpr_read_b32 v113, a241
  v_accvgpr_read_b32 v114, a242
  v_accvgpr_read_b32 v115, a243
  v_mfma_f32_16x16x32_bf16 v[128:131], v[96:99], v[8:11], v[128:131]
  ds_read_b64_tr_b16 v[80:81], v48 offset:8192
  ds_read_b64_tr_b16 v[82:83], v48 offset:9216
  v_mfma_f32_16x16x32_bf16 v[132:135], v[96:99], v[12:15], v[132:135]
  ds_read_b128 v[24:27], v45 offset:0
  v_accvgpr_read_b32 v116, a244
  v_mfma_f32_16x16x32_bf16 v[136:139], v[96:99], v[16:19], v[136:139]
  s_add_u32 s46, s43, 65536
  v_accvgpr_read_b32 v117, a245
  v_accvgpr_read_b32 v118, a246
  v_mfma_f32_16x16x32_bf16 v[140:143], v[96:99], v[20:23], v[140:143]
  ds_read_b64_tr_b16 v[84:85], v49 offset:8192
  ds_read_b64_tr_b16 v[86:87], v49 offset:9216
  v_mfma_f32_16x16x32_bf16 v[144:147], v[100:103], v[8:11], v[144:147]
  ds_read_b128 v[28:31], v47 offset:0
  v_accvgpr_read_b32 v119, a247
  v_mfma_f32_16x16x32_bf16 v[148:151], v[100:103], v[12:15], v[148:151]
  v_cvt_pk_bf16_f32 v124, v112, v113
  v_cvt_pk_bf16_f32 v125, v114, v115
  v_mfma_f32_16x16x32_bf16 v[152:155], v[100:103], v[16:19], v[152:155]
  ds_read_b64_tr_b16 v[88:89], v50 offset:8192
  ds_read_b64_tr_b16 v[90:91], v50 offset:9216
  v_mfma_f32_16x16x32_bf16 v[156:159], v[100:103], v[20:23], v[156:159]
  ds_read_b128 v[32:35], v45 offset:16384
  v_cvt_pk_bf16_f32 v126, v116, v117
  v_mfma_f32_16x16x32_bf16 v[160:163], v[104:107], v[8:11], v[160:163]
  buffer_store_dwordx4 a[16:19], v56, s[8:11], s46 offen offset:0 sc1
  v_mfma_f32_16x16x32_bf16 v[164:167], v[104:107], v[12:15], v[164:167]
  ds_read_b64_tr_b16 v[92:93], v51 offset:8192
  ds_read_b64_tr_b16 v[94:95], v51 offset:9216
  v_mfma_f32_16x16x32_bf16 v[168:171], v[104:107], v[16:19], v[168:171]
  ds_read_b128 v[36:39], v47 offset:16384
  v_cvt_pk_bf16_f32 v127, v118, v119
  v_mfma_f32_16x16x32_bf16 v[172:175], v[104:107], v[20:23], v[172:175]
  buffer_store_dwordx4 a[80:83], v56, s[8:11], s46 offen offset:1024 sc1
  v_mfma_f32_16x16x32_bf16 v[176:179], v[108:111], v[8:11], v[176:179]
  ds_read_b64_tr_b16 v[96:97], v52 offset:8192
  ds_read_b64_tr_b16 v[98:99], v52 offset:9216
  v_mfma_f32_16x16x32_bf16 v[180:183], v[108:111], v[12:15], v[180:183]
  v_accvgpr_write_b32 a240, v124
  v_accvgpr_write_b32 a241, v125
  v_mfma_f32_16x16x32_bf16 v[184:187], v[108:111], v[16:19], v[184:187]
  v_accvgpr_write_b32 a242, v126
  v_accvgpr_write_b32 a243, v127
  v_mfma_f32_16x16x32_bf16 v[188:191], v[108:111], v[20:23], v[188:191]
  ds_read_b64_tr_b16 v[100:101], v53 offset:8192
  ds_read_b64_tr_b16 v[102:103], v53 offset:9216
  v_mfma_f32_16x16x32_bf16 v[192:195], v[64:67], v[8:11], v[192:195]
  s_add_u32 s46, s43, 69632
  v_accvgpr_read_b32 v112, a152
  v_accvgpr_read_b32 v113, a153
  v_mfma_f32_16x16x32_bf16 v[196:199], v[64:67], v[12:15], v[196:199]
  v_accvgpr_read_b32 v114, a154
  v_accvgpr_read_b32 v115, a155
  v_mfma_f32_16x16x32_bf16 v[200:203], v[64:67], v[16:19], v[200:203]
  ds_read_b64_tr_b16 v[104:105], v54 offset:8192
  ds_read_b64_tr_b16 v[106:107], v54 offset:9216
  v_mfma_f32_16x16x32_bf16 v[204:207], v[64:67], v[20:23], v[204:207]
  v_accvgpr_read_b32 v116, a156
  v_accvgpr_read_b32 v117, a157
  v_mfma_f32_16x16x32_bf16 v[208:211], v[68:71], v[8:11], v[208:211]
  buffer_store_dwordx4 a[20:23], v56, s[8:11], s46 offen offset:0 sc1
  v_mfma_f32_16x16x32_bf16 v[212:215], v[68:71], v[12:15], v[212:215]
  ds_read_b64_tr_b16 v[108:109], v55 offset:8192
  ds_read_b64_tr_b16 v[110:111], v55 offset:9216
  v_mfma_f32_16x16x32_bf16 v[216:219], v[68:71], v[16:19], v[216:219]
  v_accvgpr_read_b32 v118, a158
  v_accvgpr_read_b32 v119, a159
  v_mfma_f32_16x16x32_bf16 v[220:223], v[68:71], v[20:23], v[220:223]
  v_cvt_pk_bf16_f32 v120, v112, v113
  v_cvt_pk_bf16_f32 v121, v114, v115
  v_mfma_f32_16x16x32_bf16 v[224:227], v[72:75], v[8:11], v[224:227]
  v_cvt_pk_bf16_f32 v122, v116, v117
  v_cvt_pk_bf16_f32 v123, v118, v119
  v_mfma_f32_16x16x32_bf16 v[228:231], v[72:75], v[12:15], v[228:231]
  buffer_store_dwordx4 a[84:87], v56, s[8:11], s46 offen offset:1024 sc1
  v_mfma_f32_16x16x32_bf16 v[232:235], v[72:75], v[16:19], v[232:235]
  v_accvgpr_write_b32 a152, v120
  v_accvgpr_write_b32 a153, v121
  v_mfma_f32_16x16x32_bf16 v[236:239], v[72:75], v[20:23], v[236:239]
  v_accvgpr_write_b32 a154, v122
  v_accvgpr_write_b32 a155, v123
  v_mfma_f32_16x16x32_bf16 v[240:243], v[76:79], v[8:11], v[240:243]
  v_accvgpr_read_b32 v112, a184
  v_accvgpr_read_b32 v113, a185
  v_mfma_f32_16x16x32_bf16 v[244:247], v[76:79], v[12:15], v[244:247]
  v_accvgpr_read_b32 v114, a186
  v_accvgpr_read_b32 v115, a187
  v_mfma_f32_16x16x32_bf16 v[248:251], v[76:79], v[16:19], v[248:251]
  v_accvgpr_read_b32 v116, a188
  v_accvgpr_read_b32 v117, a189
  v_mfma_f32_16x16x32_bf16 v[252:255], v[76:79], v[20:23], v[252:255]
  s_waitcnt lgkmcnt(0)
  v_accvgpr_read_b32 v118, a190
  v_accvgpr_read_b32 v119, a191
  v_cvt_pk_bf16_f32 v124, v112, v113
  v_cvt_pk_bf16_f32 v125, v114, v115
  v_cvt_pk_bf16_f32 v126, v116, v117
  v_cvt_pk_bf16_f32 v127, v118, v119
  v_accvgpr_write_b32 a184, v124
  v_accvgpr_write_b32 a185, v125
  v_mfma_f32_16x16x32_bf16 v[128:131], v[80:83], v[24:27], v[128:131]
  v_add_u32 v44, 0xffff0000, v44
  v_add_u32 v45, 0xffff0000, v45
  v_mfma_f32_16x16x32_bf16 v[132:135], v[80:83], v[28:31], v[132:135]
  s_waitcnt vmcnt(8) lgkmcnt(0)
  s_barrier
  v_mfma_f32_16x16x32_bf16 v[136:139], v[80:83], v[32:35], v[136:139]
  v_add_u32 v46, 0xffff0000, v46
  v_add_u32 v47, 0xffff0000, v47
  v_mfma_f32_16x16x32_bf16 v[140:143], v[80:83], v[36:39], v[140:143]
  ds_read_b64_tr_b16 v[64:65], v48 offset:32768
  ds_read_b64_tr_b16 v[66:67], v48 offset:33792
  v_mfma_f32_16x16x32_bf16 v[144:147], v[84:87], v[24:27], v[144:147]
  s_add_u32 s46, s43, 73728
  ds_read_b128 v[8:11], v44 offset:0
  v_accvgpr_write_b32 a186, v126
  v_mfma_f32_16x16x32_bf16 v[148:151], v[84:87], v[28:31], v[148:151]
  ds_read_b64_tr_b16 v[68:69], v49 offset:32768
  ds_read_b64_tr_b16 v[70:71], v49 offset:33792
  v_mfma_f32_16x16x32_bf16 v[152:155], v[84:87], v[32:35], v[152:155]
  ds_read_b128 v[12:15], v46 offset:0
  v_accvgpr_write_b32 a187, v127
  v_mfma_f32_16x16x32_bf16 v[156:159], v[84:87], v[36:39], v[156:159]
  ds_write_b128 v58, a[0:3] offset:0
  v_mfma_f32_16x16x32_bf16 v[160:163], v[88:91], v[24:27], v[160:163]
  ds_read_b64_tr_b16 v[72:73], v50 offset:32768
  ds_read_b64_tr_b16 v[74:75], v50 offset:33792
  v_mfma_f32_16x16x32_bf16 v[164:167], v[88:91], v[28:31], v[164:167]
  ds_read_b128 v[16:19], v44 offset:16384
  v_accvgpr_read_b32 v112, a216
  v_mfma_f32_16x16x32_bf16 v[168:171], v[88:91], v[32:35], v[168:171]
  buffer_store_dwordx4 a[24:27], v56, s[8:11], s46 offen offset:0 sc1
  v_mfma_f32_16x16x32_bf16 v[172:175], v[88:91], v[36:39], v[172:175]
  ds_read_b64_tr_b16 v[76:77], v51 offset:32768
  ds_read_b64_tr_b16 v[78:79], v51 offset:33792
  v_mfma_f32_16x16x32_bf16 v[176:179], v[92:95], v[24:27], v[176:179]
  ds_read_b128 v[20:23], v46 offset:16384
  v_accvgpr_read_b32 v113, a217
  v_mfma_f32_16x16x32_bf16 v[180:183], v[92:95], v[28:31], v[180:183]
  buffer_store_dwordx4 a[88:91], v56, s[8:11], s46 offen offset:1024 sc1
  v_mfma_f32_16x16x32_bf16 v[184:187], v[92:95], v[32:35], v[184:187]
  ds_read_b64_tr_b16 v[80:81], v52 offset:32768
  ds_read_b64_tr_b16 v[82:83], v52 offset:33792
  v_mfma_f32_16x16x32_bf16 v[188:191], v[92:95], v[36:39], v[188:191]
  ds_write_b128 v58, a[64:67] offset:1024
  v_mfma_f32_16x16x32_bf16 v[192:195], v[96:99], v[24:27], v[192:195]
  ds_write_b128 v58, a[4:7] offset:4096
  v_mfma_f32_16x16x32_bf16 v[196:199], v[96:99], v[28:31], v[196:199]
  ds_read_b64_tr_b16 v[84:85], v53 offset:32768
  ds_read_b64_tr_b16 v[86:87], v53 offset:33792
  v_mfma_f32_16x16x32_bf16 v[200:203], v[96:99], v[32:35], v[200:203]
  s_add_u32 s46, s43, 77824
  ds_write_b128 v58, a[68:71] offset:5120
  v_mfma_f32_16x16x32_bf16 v[204:207], v[96:99], v[36:39], v[204:207]
  ds_write_b128 v58, a[8:11] offset:8192
  v_mfma_f32_16x16x32_bf16 v[208:211], v[100:103], v[24:27], v[208:211]
  ds_read_b64_tr_b16 v[88:89], v54 offset:32768
  ds_read_b64_tr_b16 v[90:91], v54 offset:33792
  v_mfma_f32_16x16x32_bf16 v[212:215], v[100:103], v[28:31], v[212:215]
  ds_write_b128 v58, a[72:75] offset:9216
  v_mfma_f32_16x16x32_bf16 v[216:219], v[100:103], v[32:35], v[216:219]
  buffer_store_dwordx4 a[28:31], v56, s[8:11], s46 offen offset:0 sc1
  v_mfma_f32_16x16x32_bf16 v[220:223], v[100:103], v[36:39], v[220:223]
  ds_read_b64_tr_b16 v[92:93], v55 offset:32768
  ds_read_b64_tr_b16 v[94:95], v55 offset:33792
  v_mfma_f32_16x16x32_bf16 v[224:227], v[104:107], v[24:27], v[224:227]
  ds_write_b128 v58, a[12:15] offset:12288
  v_mfma_f32_16x16x32_bf16 v[228:231], v[104:107], v[28:31], v[228:231]
  v_accvgpr_read_b32 v114, a218
  v_accvgpr_read_b32 v115, a219
  v_mfma_f32_16x16x32_bf16 v[232:235], v[104:107], v[32:35], v[232:235]
  v_accvgpr_read_b32 v116, a220
  v_accvgpr_read_b32 v117, a221
  v_mfma_f32_16x16x32_bf16 v[236:239], v[104:107], v[36:39], v[236:239]
  buffer_store_dwordx4 a[92:95], v56, s[8:11], s46 offen offset:1024 sc1
  v_mfma_f32_16x16x32_bf16 v[240:243], v[108:111], v[24:27], v[240:243]
  ds_write_b128 v58, a[76:79] offset:13312
  v_mfma_f32_16x16x32_bf16 v[244:247], v[108:111], v[28:31], v[244:247]
  v_accvgpr_read_b32 v118, a222
  v_accvgpr_read_b32 v119, a223
  v_mfma_f32_16x16x32_bf16 v[248:251], v[108:111], v[32:35], v[248:251]
  v_cvt_pk_bf16_f32 v120, v112, v113
  v_cvt_pk_bf16_f32 v121, v114, v115
  v_mfma_f32_16x16x32_bf16 v[252:255], v[108:111], v[36:39], v[252:255]
  s_waitcnt lgkmcnt(2)
  v_cvt_pk_bf16_f32 v122, v116, v117
  v_cvt_pk_bf16_f32 v123, v118, v119
  v_accvgpr_write_b32 a216, v120
  v_accvgpr_write_b32 a217, v121
  v_accvgpr_write_b32 a218, v122
  v_accvgpr_write_b32 a219, v123
  v_accvgpr_read_b32 v112, a248
  v_accvgpr_read_b32 v113, a249
  v_mfma_f32_16x16x32_bf16 v[128:131], v[64:67], v[8:11], v[128:131]
  ds_read_b64_tr_b16 v[96:97], v48 offset:40960
  ds_read_b64_tr_b16 v[98:99], v48 offset:41984
  v_mfma_f32_16x16x32_bf16 v[132:135], v[64:67], v[12:15], v[132:135]
  ds_read_b128 v[24:27], v45 offset:0
  v_accvgpr_read_b32 v114, a250
  v_mfma_f32_16x16x32_bf16 v[136:139], v[64:67], v[16:19], v[136:139]
  s_add_u32 s46, s42, 81920
  ds_write_b128 v62, a[128:131] offset:16384
  v_mfma_f32_16x16x32_bf16 v[140:143], v[64:67], v[20:23], v[140:143]
  ds_read_b64_tr_b16 v[100:101], v49 offset:40960
  ds_read_b64_tr_b16 v[102:103], v49 offset:41984
  v_mfma_f32_16x16x32_bf16 v[144:147], v[68:71], v[8:11], v[144:147]
  ds_read_b128 v[28:31], v47 offset:0
  v_accvgpr_read_b32 v115, a251
  v_mfma_f32_16x16x32_bf16 v[148:151], v[68:71], v[12:15], v[148:151]
  ds_write_b128 v62, a[160:163] offset:17408
  v_mfma_f32_16x16x32_bf16 v[152:155], v[68:71], v[16:19], v[152:155]
  ds_read_b64_tr_b16 v[104:105], v50 offset:40960
  ds_read_b64_tr_b16 v[106:107], v50 offset:41984
  v_mfma_f32_16x16x32_bf16 v[156:159], v[68:71], v[20:23], v[156:159]
  ds_read_b128 v[32:35], v45 offset:16384
  v_accvgpr_read_b32 v116, a252
  v_mfma_f32_16x16x32_bf16 v[160:163], v[72:75], v[8:11], v[160:163]
  buffer_store_dwordx4 a[144:147], v56, s[8:11], s46 offen offset:0 sc1
  v_mfma_f32_16x16x32_bf16 v[164:167], v[72:75], v[12:15], v[164:167]
  ds_read_b64_tr_b16 v[108:109], v51 offset:40960
  ds_read_b64_tr_b16 v[110:111], v51 offset:41984
  v_mfma_f32_16x16x32_bf16 v[168:171], v[72:75], v[16:19], v[168:171]
  ds_read_b128 v[36:39], v47 offset:16384
  v_accvgpr_read_b32 v117, a253
  v_mfma_f32_16x16x32_bf16 v[172:175], v[72:75], v[20:23], v[172:175]
  ds_write_b128 v62, a[192:195] offset:18432
  v_mfma_f32_16x16x32_bf16 v[176:179], v[76:79], v[8:11], v[176:179]
  ds_read_b64_tr_b16 v[64:65], v52 offset:40960
  ds_read_b64_tr_b16 v[66:67], v52 offset:41984
  v_mfma_f32_16x16x32_bf16 v[180:183], v[76:79], v[12:15], v[180:183]
  buffer_store_dwordx4 a[176:179], v56, s[8:11], s46 offen offset:1024 sc1
  v_mfma_f32_16x16x32_bf16 v[184:187], v[76:79], v[16:19], v[184:187]
  ds_write_b128 v62, a[224:227] offset:19456
  v_mfma_f32_16x16x32_bf16 v[188:191], v[76:79], v[20:23], v[188:191]
  ds_read_b64_tr_b16 v[68:69], v53 offset:40960
  ds_read_b64_tr_b16 v[70:71], v53 offset:41984
  v_mfma_f32_16x16x32_bf16 v[192:195], v[80:83], v[8:11], v[192:195]
  ds_write_b128 v62, a[136:139] offset:24576
  v_mfma_f32_16x16x32_bf16 v[196:199], v[80:83], v[12:15], v[196:199]
  v_accvgpr_read_b32 v118, a254
  v_accvgpr_read_b32 v119, a255
  v_mfma_f32_16x16x32_bf16 v[200:203], v[80:83], v[16:19], v[200:203]
  ds_read_b64_tr_b16 v[72:73], v54 offset:40960
  ds_read_b64_tr_b16 v[74:75], v54 offset:41984
  v_mfma_f32_16x16x32_bf16 v[204:207], v[80:83], v[20:23], v[204:207]
  buffer_store_dwordx4 a[208:211], v56, s[8:11], s46 offen offset:2048 sc1
  v_mfma_f32_16x16x32_bf16 v[208:211], v[84:87], v[8:11], v[208:211]
  ds_write_b128 v62, a[168:171] offset:25600
  v_mfma_f32_16x16x32_bf16 v[212:215], v[84:87], v[12:15], v[212:215]
  ds_read_b64_tr_b16 v[76:77], v55 offset:40960
  ds_read_b64_tr_b16 v[78:79], v55 offset:41984
  v_mfma_f32_16x16x32_bf16 v[216:219], v[84:87], v[16:19], v[216:219]
  ds_write_b128 v62, a[200:203] offset:26624
  v_mfma_f32_16x16x32_bf16 v[220:223], v[84:87], v[20:23], v[220:223]
  v_cvt_pk_bf16_f32 v124, v112, v113
  v_cvt_pk_bf16_f32 v125, v114, v115
  v_mfma_f32_16x16x32_bf16 v[224:227], v[88:91], v[8:11], v[224:227]
  buffer_store_dwordx4 a[240:243], v56, s[8:11], s46 offen offset:3072 sc1
  v_mfma_f32_16x16x32_bf16 v[228:231], v[88:91], v[12:15], v[228:231]
  v_cvt_pk_bf16_f32 v126, v116, v117
  v_cvt_pk_bf16_f32 v127, v118, v119
  v_mfma_f32_16x16x32_bf16 v[232:235], v[88:91], v[16:19], v[232:235]
  ds_write_b128 v62, a[232:235] offset:27648
  v_mfma_f32_16x16x32_bf16 v[236:239], v[88:91], v[20:23], v[236:239]
  v_accvgpr_write_b32 a248, v124
  v_accvgpr_write_b32 a249, v125
  v_mfma_f32_16x16x32_bf16 v[240:243], v[92:95], v[8:11], v[240:243]
  v_accvgpr_write_b32 a250, v126
  v_accvgpr_write_b32 a251, v127
  v_mfma_f32_16x16x32_bf16 v[244:247], v[92:95], v[12:15], v[244:247]
  v_mfma_f32_16x16x32_bf16 v[248:251], v[92:95], v[16:19], v[248:251]
  v_mfma_f32_16x16x32_bf16 v[252:255], v[92:95], v[20:23], v[252:255]
  s_waitcnt lgkmcnt(4)
  v_mfma_f32_16x16x32_bf16 v[128:131], v[96:99], v[24:27], v[128:131]
  v_mfma_f32_16x16x32_bf16 v[132:135], v[96:99], v[28:31], v[132:135]
  s_waitcnt lgkmcnt(0)
  s_barrier
  v_mfma_f32_16x16x32_bf16 v[136:139], v[96:99], v[32:35], v[136:139]
  v_mfma_f32_16x16x32_bf16 v[140:143], v[96:99], v[36:39], v[140:143]
  ds_write_b128 v59, a[16:19] offset:0
  v_mfma_f32_16x16x32_bf16 v[144:147], v[100:103], v[24:27], v[144:147]
  s_add_u32 s46, s42, 90112
  v_mfma_f32_16x16x32_bf16 v[148:151], v[100:103], v[28:31], v[148:151]
  ds_write_b128 v59, a[80:83] offset:1024
  v_mfma_f32_16x16x32_bf16 v[152:155], v[100:103], v[32:35], v[152:155]
  v_mfma_f32_16x16x32_bf16 v[156:159], v[100:103], v[36:39], v[156:159]
  ds_write_b128 v59, a[20:23] offset:4096
  v_mfma_f32_16x16x32_bf16 v[160:163], v[104:107], v[24:27], v[160:163]
  ds_write_b128 v59, a[84:87] offset:5120
  v_mfma_f32_16x16x32_bf16 v[164:167], v[104:107], v[28:31], v[164:167]
  v_mfma_f32_16x16x32_bf16 v[168:171], v[104:107], v[32:35], v[168:171]
  buffer_store_dwordx4 a[152:155], v56, s[8:11], s46 offen offset:0 sc1
  v_mfma_f32_16x16x32_bf16 v[172:175], v[104:107], v[36:39], v[172:175]
  ds_write_b128 v59, a[24:27] offset:8192
  v_mfma_f32_16x16x32_bf16 v[176:179], v[108:111], v[24:27], v[176:179]
  ds_write_b128 v59, a[88:91] offset:9216
  v_mfma_f32_16x16x32_bf16 v[180:183], v[108:111], v[28:31], v[180:183]
  v_cvt_pk_bf16_f32 v80, v132, v133
  v_cvt_pk_bf16_f32 v81, v134, v135
  v_mfma_f32_16x16x32_bf16 v[184:187], v[108:111], v[32:35], v[184:187]
  ds_write_b128 v59, a[28:31] offset:12288
  v_mfma_f32_16x16x32_bf16 v[188:191], v[108:111], v[36:39], v[188:191]
  buffer_store_dwordx4 a[184:187], v56, s[8:11], s46 offen offset:1024 sc1
  v_mfma_f32_16x16x32_bf16 v[192:195], v[64:67], v[24:27], v[192:195]
  ds_write_b128 v59, a[92:95] offset:13312
  v_mfma_f32_16x16x32_bf16 v[196:199], v[64:67], v[28:31], v[196:199]
  ds_write_b128 v63, a[144:147] offset:16384
  v_mfma_f32_16x16x32_bf16 v[200:203], v[64:67], v[32:35], v[200:203]
  v_cvt_pk_bf16_f32 v82, v148, v149
  v_cvt_pk_bf16_f32 v83, v150, v151
  v_mfma_f32_16x16x32_bf16 v[204:207], v[64:67], v[36:39], v[204:207]
  ds_write_b128 v63, a[176:179] offset:17408
  v_mfma_f32_16x16x32_bf16 v[208:211], v[68:71], v[24:27], v[208:211]
  v_cvt_pk_bf16_f32 v96, v136, v137
  v_cvt_pk_bf16_f32 v97, v138, v139
  v_mfma_f32_16x16x32_bf16 v[212:215], v[68:71], v[28:31], v[212:215]
  buffer_store_dwordx4 a[216:219], v56, s[8:11], s46 offen offset:2048 sc1
  v_mfma_f32_16x16x32_bf16 v[216:219], v[68:71], v[32:35], v[216:219]
  ds_write_b128 v63, a[208:211] offset:18432
  v_mfma_f32_16x16x32_bf16 v[220:223], v[68:71], v[36:39], v[220:223]
  ds_write_b128 v63, a[240:243] offset:19456
  v_mfma_f32_16x16x32_bf16 v[224:227], v[72:75], v[24:27], v[224:227]
  ds_write_b128 v63, a[152:155] offset:24576
  v_mfma_f32_16x16x32_bf16 v[228:231], v[72:75], v[28:31], v[228:231]
  v_cvt_pk_bf16_f32 v98, v152, v153
  v_cvt_pk_bf16_f32 v99, v154, v155
  v_mfma_f32_16x16x32_bf16 v[232:235], v[72:75], v[32:35], v[232:235]
  buffer_store_dwordx4 a[248:251], v56, s[8:11], s46 offen offset:3072 sc1
  v_mfma_f32_16x16x32_bf16 v[236:239], v[72:75], v[36:39], v[236:239]
  ds_write_b128 v63, a[184:187] offset:25600
  v_mfma_f32_16x16x32_bf16 v[240:243], v[76:79], v[24:27], v[240:243]
  ds_write_b128 v63, a[216:219] offset:26624
  v_mfma_f32_16x16x32_bf16 v[244:247], v[76:79], v[28:31], v[244:247]
  ds_write_b128 v63, a[248:251] offset:27648
  v_mfma_f32_16x16x32_bf16 v[248:251], v[76:79], v[32:35], v[248:251]
  v_cvt_pk_bf16_f32 v112, v140, v141
  v_cvt_pk_bf16_f32 v113, v142, v143
  v_mfma_f32_16x16x32_bf16 v[252:255], v[76:79], v[36:39], v[252:255]
  v_cvt_pk_bf16_f32 v114, v156, v157
  v_cvt_pk_bf16_f32 v115, v158, v159
  v_cvt_pk_bf16_f32 v64, v128, v129
  v_cvt_pk_bf16_f32 v65, v130, v131
  v_cvt_pk_bf16_f32 v66, v144, v145
  v_cvt_pk_bf16_f32 v67, v146, v147
  v_cvt_pk_bf16_f32 v84, v164, v165
  v_cvt_pk_bf16_f32 v85, v166, v167
  v_cvt_pk_bf16_f32 v86, v180, v181
  v_cvt_pk_bf16_f32 v87, v182, v183
  v_cvt_pk_bf16_f32 v100, v168, v169
  v_cvt_pk_bf16_f32 v101, v170, v171
  v_cvt_pk_bf16_f32 v102, v184, v185
  v_cvt_pk_bf16_f32 v103, v186, v187
  v_cvt_pk_bf16_f32 v116, v172, v173
  v_cvt_pk_bf16_f32 v117, v174, v175
  v_cvt_pk_bf16_f32 v118, v188, v189
  v_cvt_pk_bf16_f32 v119, v190, v191
  v_cvt_pk_bf16_f32 v68, v160, v161
  v_cvt_pk_bf16_f32 v69, v162, v163
  v_cvt_pk_bf16_f32 v70, v176, v177
  v_cvt_pk_bf16_f32 v71, v178, v179
  v_cvt_pk_bf16_f32 v72, v192, v193
  v_cvt_pk_bf16_f32 v73, v194, v195
  v_cvt_pk_bf16_f32 v74, v208, v209
  v_cvt_pk_bf16_f32 v75, v210, v211
  v_cvt_pk_bf16_f32 v88, v196, v197
  v_cvt_pk_bf16_f32 v89, v198, v199
  v_cvt_pk_bf16_f32 v90, v212, v213
  v_cvt_pk_bf16_f32 v91, v214, v215
  v_cvt_pk_bf16_f32 v104, v200, v201
  v_cvt_pk_bf16_f32 v105, v202, v203
  v_cvt_pk_bf16_f32 v106, v216, v217
  v_cvt_pk_bf16_f32 v107, v218, v219
  v_cvt_pk_bf16_f32 v120, v204, v205
  v_cvt_pk_bf16_f32 v121, v206, v207
  v_cvt_pk_bf16_f32 v122, v220, v221
  v_cvt_pk_bf16_f32 v123, v222, v223
  v_add_u32 v1, s36, v56
  v_mov_b32 v24, v56
  v_mov_b32 v26, v57
  v_cvt_pk_bf16_f32 v76, v224, v225
  v_cvt_pk_bf16_f32 v77, v226, v227
  v_cvt_pk_bf16_f32 v78, v240, v241
  v_cvt_pk_bf16_f32 v79, v242, v243
  v_cvt_pk_bf16_f32 v92, v228, v229
  v_cvt_pk_bf16_f32 v93, v230, v231
  v_cvt_pk_bf16_f32 v94, v244, v245
  v_cvt_pk_bf16_f32 v95, v246, v247
  v_cvt_pk_bf16_f32 v108, v232, v233
  v_cvt_pk_bf16_f32 v109, v234, v235
  v_cvt_pk_bf16_f32 v110, v248, v249
  v_cvt_pk_bf16_f32 v111, v250, v251
  v_cvt_pk_bf16_f32 v124, v236, v237
  v_cvt_pk_bf16_f32 v125, v238, v239
  v_cvt_pk_bf16_f32 v126, v252, v253
  v_cvt_pk_bf16_f32 v127, v254, v255
L_p3:
  v_mov_b32 v238, v1
  v_mov_b32 v236, v24
  v_add_u32 v237, 0x10000, v24
  v_add_u32 v239, 0x20000, v24
  s_mov_b32 s39, 0
L_att_start:
  s_mov_b32 s47, -1
  v_mov_b32 v232, 0
  v_mov_b32 v233, 0
  v_mov_b32 v234, 0
  v_mov_b32 v235, 0
  s_lshl_b32 s10, s29, 17
  s_mov_b32 s35, 0
  s_waitcnt lgkmcnt(0)
  s_barrier
  s_cmp_lt_u32 s30, 2
  s_cbranch_scc0 L_attB
L_attA:
  ds_read_b128 v[128:131], v236 offset:32768
  ds_read_b128 v[132:135], v236 offset:33792
  ds_read_b128 v[136:139], v236 offset:34816
  ds_read_b128 v[140:143], v236 offset:35840
  ds_read_b128 v[144:147], v236 offset:36864
  ds_read_b128 v[148:151], v236 offset:37888
  ds_read_b128 v[152:155], v236 offset:38912
  ds_read_b128 v[156:159], v236 offset:39936
  ds_read_b128 a[144:147], v236 offset:49152
  ds_read_b128 a[148:151], v236 offset:50176
  ds_read_b128 a[152:155], v236 offset:51200
  ds_read_b128 a[156:159], v236 offset:52224
  ds_read_b128 a[160:163], v236 offset:53248
  ds_read_b128 a[164:167], v236 offset:54272
  ds_read_b128 a[168:171], v236 offset:55296
  ds_read_b128 a[172:175], v236 offset:56320
  s_cmp_lg_u32 s39, 0
  s_cbranch_scc1 L_haveA
  s_and_b32 s33, s30, 1
  v_mov_b32 v6, 4048155338
  v_mov_b32 v7, 0
  s_cmp_eq_u32 s33, 0
  s_cselect_b64 s[56:57], s[48:49], 0
  v_cndmask_b32 v240, v7, v6, s[56:57]
  s_cselect_b64 s[56:57], s[50:51], 0
  v_cndmask_b32 v241, v7, v6, s[56:57]
  s_cselect_b64 s[56:57], s[52:53], 0
  v_cndmask_b32 v242, v7, v6, s[56:57]
  s_cselect_b64 s[56:57], s[54:55], 0
  v_cndmask_b32 v243, v7, v6, s[56:57]
  s_cselect_b64 s[56:57], -1, s[48:49]
  v_cndmask_b32 v244, v7, v6, s[56:57]
  s_cselect_b64 s[56:57], -1, s[50:51]
  v_cndmask_b32 v245, v7, v6, s[56:57]
  s_cselect_b64 s[56:57], -1, s[52:53]
  v_cndmask_b32 v246, v7, v6, s[56:57]
  s_cselect_b64 s[56:57], -1, s[54:55]
  v_cndmask_b32 v247, v7, v6, s[56:57]
  s_waitcnt lgkmcnt(8)
  v_mfma_f32_16x16x32_bf16 v[56:59], v[128:131], v[112:115], 0
  v_mfma_f32_16x16x32_bf16 v[60:63], v[144:147], v[112:115], 0
  v_mfma_f32_16x16x32_bf16 v[56:59], v[132:135], v[116:119], v[56:59]
  v_mfma_f32_16x16x32_bf16 v[60:63], v[148:151], v[116:119], v[60:63]
  v_mfma_f32_16x16x32_bf16 v[56:59], v[136:139], v[120:123], v[56:59]
  v_mfma_f32_16x16x32_bf16 v[60:63], v[152:155], v[120:123], v[60:63]
  v_mfma_f32_16x16x32_bf16 v[56:59], v[140:143], v[124:127], v[56:59]
  v_mfma_f32_16x16x32_bf16 v[60:63], v[156:159], v[124:127], v[60:63]
  v_mfma_f32_16x16x32_bf16 v[48:51], v[128:131], v[96:99], 0
  v_mfma_f32_16x16x32_bf16 v[52:55], v[144:147], v[96:99], 0
  v_mfma_f32_16x16x32_bf16 v[48:51], v[132:135], v[100:103], v[48:51]
  v_mfma_f32_16x16x32_bf16 v[52:55], v[148:151], v[100:103], v[52:55]
  v_mfma_f32_16x16x32_bf16 v[48:51], v[136:139], v[104:107], v[48:51]
  v_mfma_f32_16x16x32_bf16 v[52:55], v[152:155], v[104:107], v[52:55]
  v_mfma_f32_16x16x32_bf16 v[48:51], v[140:143], v[108:111], v[48:51]
  v_mfma_f32_16x16x32_bf16 v[52:55], v[156:159], v[108:111], v[52:55]
  v_mfma_f32_16x16x32_bf16 v[40:43], v[128:131], v[80:83], 0
  v_mfma_f32_16x16x32_bf16 v[44:47], v[144:147], v[80:83], 0
  v_mfma_f32_16x16x32_bf16 v[40:43], v[132:135], v[84:87], v[40:43]
  v_mfma_f32_16x16x32_bf16 v[44:47], v[148:151], v[84:87], v[44:47]
  v_mfma_f32_16x16x32_bf16 v[40:43], v[136:139], v[88:91], v[40:43]
  v_mfma_f32_16x16x32_bf16 v[44:47], v[152:155], v[88:91], v[44:47]
  v_mfma_f32_16x16x32_bf16 v[40:43], v[140:143], v[92:95], v[40:43]
  v_mfma_f32_16x16x32_bf16 v[44:47], v[156:159], v[92:95], v[44:47]
  v_mfma_f32_16x16x32_bf16 v[32:35], v[128:131], v[64:67], v[240:243]
  v_mfma_f32_16x16x32_bf16 v[36:39], v[144:147], v[64:67], v[244:247]
  v_mfma_f32_16x16x32_bf16 v[32:35], v[132:135], v[68:71], v[32:35]
  v_mfma_f32_16x16x32_bf16 v[36:39], v[148:151], v[68:71], v[36:39]
  v_mfma_f32_16x16x32_bf16 v[32:35], v[136:139], v[72:75], v[32:35]
  v_mfma_f32_16x16x32_bf16 v[36:39], v[152:155], v[72:75], v[36:39]
  v_mfma_f32_16x16x32_bf16 v[32:35], v[140:143], v[76:79], v[32:35]
  v_mfma_f32_16x16x32_bf16 v[36:39], v[156:159], v[76:79], v[36:39]
  v_max3_f32 v228, v56, v57, v58
  v_max3_f32 v229, v59, v60, v61
  v_max3_f32 v228, v228, v62, v63
  v_max_f32 v228, v228, v229
  v_max3_f32 v224, v48, v49, v50
  v_max3_f32 v225, v51, v52, v53
  v_max3_f32 v224, v224, v54, v55
  v_max_f32 v224, v224, v225
  v_max3_f32 v220, v40, v41, v42
  v_max3_f32 v221, v43, v44, v45
  v_max3_f32 v220, v220, v46, v47
  v_max_f32 v220, v220, v221
  v_max3_f32 v216, v32, v33, v34
  v_max3_f32 v217, v35, v36, v37
  v_max3_f32 v216, v216, v38, v39
  v_max_f32 v216, v216, v217
  v_mov_b32 v217, v216
  v_mov_b32 v221, v220
  v_mov_b32 v225, v224
  v_mov_b32 v229, v228
  v_permlane32_swap_b32 v216, v217
  v_permlane32_swap_b32 v220, v221
  v_permlane32_swap_b32 v224, v225
  v_permlane32_swap_b32 v228, v229
  v_max_f32 v216, v216, v217
  v_max_f32 v220, v220, v221
  v_max_f32 v224, v224, v225
  v_max_f32 v228, v228, v229
  v_mov_b32 v217, v216
  v_mov_b32 v221, v220
  v_mov_b32 v225, v224
  v_mov_b32 v229, v228
  v_permlane16_swap_b32 v216, v217
  v_permlane16_swap_b32 v220, v221
  v_permlane16_swap_b32 v224, v225
  v_permlane16_swap_b32 v228, v229
  v_max_f32 v216, v216, v217
  v_max_f32 v220, v220, v221
  v_max_f32 v224, v224, v225
  v_max_f32 v228, v228, v229
  v_sub_f32 v217, 0, v216
  v_sub_f32 v218, 0, v216
  v_sub_f32 v219, 0, v216
  v_sub_f32 v216, 0, v216
  v_sub_f32 v221, 0, v220
  v_sub_f32 v222, 0, v220
  v_sub_f32 v223, 0, v220
  v_sub_f32 v220, 0, v220
  v_sub_f32 v225, 0, v224
  v_sub_f32 v226, 0, v224
  v_sub_f32 v227, 0, v224
  v_sub_f32 v224, 0, v224
  v_sub_f32 v229, 0, v228
  v_sub_f32 v230, 0, v228
  v_sub_f32 v231, 0, v228
  v_sub_f32 v228, 0, v228
L_haveA:
  v_mov_b32 v6, 4048155338
  s_and_b32 s33, s30, 1
  s_cmp_eq_u32 s33, 0
  s_cselect_b64 s[56:57], s[48:49], 0
  v_cndmask_b32 v32, v216, v6, s[56:57]
  v_cndmask_b32 v48, v224, v6, s[56:57]
  s_cselect_b64 s[56:57], s[50:51], 0
  v_cndmask_b32 v33, v216, v6, s[56:57]
  v_cndmask_b32 v49, v224, v6, s[56:57]
  s_cselect_b64 s[56:57], s[52:53], 0
  v_cndmask_b32 v34, v216, v6, s[56:57]
  v_cndmask_b32 v50, v224, v6, s[56:57]
  s_cselect_b64 s[56:57], s[54:55], 0
  v_cndmask_b32 v35, v216, v6, s[56:57]
  v_cndmask_b32 v51, v224, v6, s[56:57]
  s_cselect_b64 s[56:57], -1, s[48:49]
  v_cndmask_b32 v36, v216, v6, s[56:57]
  v_cndmask_b32 v52, v224, v6, s[56:57]
  s_cselect_b64 s[56:57], -1, s[50:51]
  v_cndmask_b32 v37, v216, v6, s[56:57]
  v_cndmask_b32 v53, v224, v6, s[56:57]
  s_cselect_b64 s[56:57], -1, s[52:53]
  v_cndmask_b32 v38, v216, v6, s[56:57]
  v_cndmask_b32 v54, v224, v6, s[56:57]
  s_cselect_b64 s[56:57], -1, s[54:55]
  v_cndmask_b32 v39, v216, v6, s[56:57]
  v_cndmask_b32 v55, v224, v6, s[56:57]
  s_cmp_eq_u32 s33, 1
  s_cselect_b64 s[56:57], s[48:49], 0
  v_cndmask_b32 v40, v220, v6, s[56:57]
  v_cndmask_b32 v56, v228, v6, s[56:57]
  s_cselect_b64 s[56:57], s[50:51], 0
  v_cndmask_b32 v41, v220, v6, s[56:57]
  v_cndmask_b32 v57, v228, v6, s[56:57]
  s_cselect_b64 s[56:57], s[52:53], 0
  v_cndmask_b32 v42, v220, v6, s[56:57]
  v_cndmask_b32 v58, v228, v6, s[56:57]
  s_cselect_b64 s[56:57], s[54:55], 0
  v_cndmask_b32 v43, v220, v6, s[56:57]
  v_cndmask_b32 v59, v228, v6, s[56:57]
  s_cselect_b64 s[56:57], -1, s[48:49]
  v_cndmask_b32 v44, v220, v6, s[56:57]
  v_cndmask_b32 v60, v228, v6, s[56:57]
  s_cselect_b64 s[56:57], -1, s[50:51]
  v_cndmask_b32 v45, v220, v6, s[56:57]
  v_cndmask_b32 v61, v228, v6, s[56:57]
  s_cselect_b64 s[56:57], -1, s[52:53]
  v_cndmask_b32 v46, v220, v6, s[56:57]
  v_cndmask_b32 v62, v228, v6, s[56:57]
  s_cselect_b64 s[56:57], -1, s[54:55]
  v_cndmask_b32 v47, v220, v6, s[56:57]
  v_cndmask_b32 v63, v228, v6, s[56:57]
  s_waitcnt lgkmcnt(8)
  v_mfma_f32_16x16x32_bf16 v[240:243], v[128:131], v[112:115], v[228:231]
  v_mfma_f32_16x16x32_bf16 v[244:247], v[144:147], v[112:115], v[228:231]
  v_mfma_f32_16x16x32_bf16 v[240:243], v[132:135], v[116:119], v[240:243]
  v_mfma_f32_16x16x32_bf16 v[244:247], v[148:151], v[116:119], v[244:247]
  v_mfma_f32_16x16x32_bf16 v[240:243], v[136:139], v[120:123], v[240:243]
  v_mfma_f32_16x16x32_bf16 v[244:247], v[152:155], v[120:123], v[244:247]
  v_mfma_f32_16x16x32_bf16 v[240:243], v[140:143], v[124:127], v[240:243]
  v_mfma_f32_16x16x32_bf16 v[244:247], v[156:159], v[124:127], v[244:247]
  v_mfma_f32_16x16x32_bf16 v[248:251], v[128:131], v[96:99], v[224:227]
  s_nop 5
  v_exp_f32 v240, v240
  v_mfma_f32_16x16x32_bf16 v[252:255], v[144:147], v[96:99], v[224:227]
  v_exp_f32 v241, v241
  v_mfma_f32_16x16x32_bf16 v[248:251], v[132:135], v[100:103], v[248:251]
  v_exp_f32 v242, v242
  v_mfma_f32_16x16x32_bf16 v[252:255], v[148:151], v[100:103], v[252:255]
  v_exp_f32 v243, v243
  v_mfma_f32_16x16x32_bf16 v[248:251], v[136:139], v[104:107], v[248:251]
  v_exp_f32 v244, v244
  v_mfma_f32_16x16x32_bf16 v[252:255], v[152:155], v[104:107], v[252:255]
  v_exp_f32 v245, v245
  v_mfma_f32_16x16x32_bf16 v[248:251], v[140:143], v[108:111], v[248:251]
  v_exp_f32 v246, v246
  v_mfma_f32_16x16x32_bf16 v[252:255], v[156:159], v[108:111], v[252:255]
  v_exp_f32 v247, v247
  ds_read_b128 v[160:163], v236 offset:40960
  ds_read_b128 v[164:167], v236 offset:41984
  ds_read_b128 v[168:171], v236 offset:43008
  ds_read_b128 v[172:175], v236 offset:44032
  v_add_f32 v235, v235, v240
  v_add_f32 v235, v235, v241
  v_cvt_pk_bf16_f32 v208, v240, v241
  v_add_f32 v235, v235, v242
  v_add_f32 v235, v235, v243
  v_cvt_pk_bf16_f32 v209, v242, v243
  v_add_f32 v235, v235, v244
  v_add_f32 v235, v235, v245
  v_cvt_pk_bf16_f32 v210, v244, v245
  v_mfma_f32_16x16x32_bf16 v[192:195], v[128:131], v[80:83], v[220:223]
  ds_read_b128 v[176:179], v236 offset:45056
  v_add_f32 v235, v235, v246
  v_mfma_f32_16x16x32_bf16 v[196:199], v[144:147], v[80:83], v[220:223]
  v_exp_f32 v248, v248
  v_mfma_f32_16x16x32_bf16 v[192:195], v[132:135], v[84:87], v[192:195]
  ds_read_b128 v[180:183], v236 offset:46080
  v_add_f32 v235, v235, v247
  v_mfma_f32_16x16x32_bf16 v[196:199], v[148:151], v[84:87], v[196:199]
  v_exp_f32 v249, v249
  v_mfma_f32_16x16x32_bf16 v[192:195], v[136:139], v[88:91], v[192:195]
  ds_read_b128 v[184:187], v236 offset:47104
  v_cvt_pk_bf16_f32 v211, v246, v247
  v_mfma_f32_16x16x32_bf16 v[196:199], v[152:155], v[88:91], v[196:199]
  v_exp_f32 v250, v250
  v_mfma_f32_16x16x32_bf16 v[192:195], v[140:143], v[92:95], v[192:195]
  ds_read_b128 v[188:191], v236 offset:48128
  v_add_f32 v234, v234, v248
  v_mfma_f32_16x16x32_bf16 v[196:199], v[156:159], v[92:95], v[196:199]
  s_waitcnt lgkmcnt(4)
  v_add_f32 v234, v234, v249
  v_cvt_pk_bf16_f32 v212, v248, v249
  v_mfma_f32_16x16x32_bf16 a[12:15], a[144:147], v[208:211], 0
  v_exp_f32 v251, v251
  v_mfma_f32_16x16x32_bf16 a[28:31], a[148:151], v[208:211], 0
  v_add_f32 v234, v234, v250
  v_add_f32 v234, v234, v251
  v_mfma_f32_16x16x32_bf16 a[44:47], a[152:155], v[208:211], 0
  v_exp_f32 v252, v252
  v_mfma_f32_16x16x32_bf16 a[60:63], a[156:159], v[208:211], 0
  v_cvt_pk_bf16_f32 v213, v250, v251
  v_add_f32 v234, v234, v252
  v_mfma_f32_16x16x32_bf16 a[76:79], a[160:163], v[208:211], 0
  v_exp_f32 v253, v253
  v_mfma_f32_16x16x32_bf16 a[92:95], a[164:167], v[208:211], 0
  v_add_f32 v234, v234, v253
  v_cvt_pk_bf16_f32 v214, v252, v253
  v_mfma_f32_16x16x32_bf16 a[108:111], a[168:171], v[208:211], 0
  v_exp_f32 v254, v254
  v_mfma_f32_16x16x32_bf16 a[124:127], a[172:175], v[208:211], 0
  v_exp_f32 v255, v255
  v_mfma_f32_16x16x32_bf16 v[200:203], v[128:131], v[64:67], v[32:35]
  ds_read_b128 a[176:179], v236 offset:57344
  v_add_f32 v234, v234, v254
  v_mfma_f32_16x16x32_bf16 v[204:207], v[144:147], v[64:67], v[36:39]
  v_exp_f32 v192, v192
  v_mfma_f32_16x16x32_bf16 v[200:203], v[132:135], v[68:71], v[200:203]
  ds_read_b128 a[180:183], v236 offset:58368
  v_add_f32 v234, v234, v255
  v_mfma_f32_16x16x32_bf16 v[204:207], v[148:151], v[68:71], v[204:207]
  v_exp_f32 v193, v193
  v_mfma_f32_16x16x32_bf16 v[200:203], v[136:139], v[72:75], v[200:203]
  ds_read_b128 a[184:187], v236 offset:59392
  v_cvt_pk_bf16_f32 v215, v254, v255
  v_mfma_f32_16x16x32_bf16 v[204:207], v[152:155], v[72:75], v[204:207]
  v_exp_f32 v194, v194
  v_mfma_f32_16x16x32_bf16 v[200:203], v[140:143], v[76:79], v[200:203]
  ds_read_b128 a[188:191], v236 offset:60416
  v_add_f32 v233, v233, v192
  v_mfma_f32_16x16x32_bf16 v[204:207], v[156:159], v[76:79], v[204:207]
  v_add_f32 v233, v233, v193
  v_cvt_pk_bf16_f32 v208, v192, v193
  v_mfma_f32_16x16x32_bf16 a[8:11], a[144:147], v[212:215], 0
  v_exp_f32 v195, v195
  v_mfma_f32_16x16x32_bf16 a[24:27], a[148:151], v[212:215], 0
  v_add_f32 v233, v233, v194
  v_add_f32 v233, v233, v195
  v_mfma_f32_16x16x32_bf16 a[40:43], a[152:155], v[212:215], 0
  v_exp_f32 v196, v196
  v_mfma_f32_16x16x32_bf16 a[56:59], a[156:159], v[212:215], 0
  v_cvt_pk_bf16_f32 v209, v194, v195
  v_add_f32 v233, v233, v196
  v_mfma_f32_16x16x32_bf16 a[72:75], a[160:163], v[212:215], 0
  v_exp_f32 v197, v197
  v_mfma_f32_16x16x32_bf16 a[88:91], a[164:167], v[212:215], 0
  v_add_f32 v233, v233, v197
  v_cvt_pk_bf16_f32 v210, v196, v197
  v_mfma_f32_16x16x32_bf16 a[104:107], a[168:171], v[212:215], 0
  v_exp_f32 v198, v198
  v_mfma_f32_16x16x32_bf16 a[120:123], a[172:175], v[212:215], 0
  v_exp_f32 v199, v199
  s_waitcnt vmcnt(0)
  s_barrier
  s_cmp_lg_u32 s30, 0
  s_cbranch_scc1 L_noflag
  s_lshl_b32 s31, s29, 2
  s_lshl_b32 s33, s28, 7
  s_add_u32 s31, s31, s33
  v_mov_b32 v6, s100
  v_mov_b32 v7, 0
  s_mov_b64 exec, 1
  buffer_store_dword v6, v7, s[24:27], s31 offen offset:32 sc1
  s_mov_b64 exec, -1
L_noflag:
  v_mfma_f32_16x16x32_bf16 v[240:243], v[160:163], v[112:115], v[228:231]
  s_waitcnt lgkmcnt(0)
  ds_read_b128 a[192:195], v236 offset:61440
  v_add_f32 v233, v233, v198
  v_mfma_f32_16x16x32_bf16 v[244:247], v[176:179], v[112:115], v[228:231]
  ds_read_b128 a[196:199], v236 offset:62464
  v_add_f32 v233, v233, v199
  v_mfma_f32_16x16x32_bf16 v[240:243], v[164:167], v[116:119], v[240:243]
  ds_read_b128 a[200:203], v236 offset:63488
  v_cvt_pk_bf16_f32 v211, v198, v199
  v_mfma_f32_16x16x32_bf16 v[244:247], v[180:183], v[116:119], v[244:247]
  ds_read_b128 a[204:207], v236 offset:64512
  v_mfma_f32_16x16x32_bf16 v[240:243], v[168:171], v[120:123], v[240:243]
  ds_read_b128 v[128:131], v237 offset:0
  v_mfma_f32_16x16x32_bf16 v[244:247], v[184:187], v[120:123], v[244:247]
  ds_read_b128 v[132:135], v237 offset:1024
  v_mfma_f32_16x16x32_bf16 v[240:243], v[172:175], v[124:127], v[240:243]
  ds_read_b128 v[136:139], v237 offset:2048
  v_mfma_f32_16x16x32_bf16 v[244:247], v[188:191], v[124:127], v[244:247]
  ds_read_b128 v[140:143], v237 offset:3072
  v_and_b32 v29, 31, v2
  v_mfma_f32_16x16x32_bf16 a[4:7], a[144:147], v[208:211], 0
  v_exp_f32 v200, v200
  v_mfma_f32_16x16x32_bf16 a[20:23], a[148:151], v[208:211], 0
  v_exp_f32 v201, v201
  v_mfma_f32_16x16x32_bf16 a[36:39], a[152:155], v[208:211], 0
  v_exp_f32 v202, v202
  v_mfma_f32_16x16x32_bf16 a[52:55], a[156:159], v[208:211], 0
  v_exp_f32 v203, v203
  v_mfma_f32_16x16x32_bf16 a[68:71], a[160:163], v[208:211], 0
  v_exp_f32 v204, v204
  v_mfma_f32_16x16x32_bf16 a[84:87], a[164:167], v[208:211], 0
  v_exp_f32 v205, v205
  v_mfma_f32_16x16x32_bf16 a[100:103], a[168:171], v[208:211], 0
  v_exp_f32 v206, v206
  v_mfma_f32_16x16x32_bf16 a[116:119], a[172:175], v[208:211], 0
  v_exp_f32 v207, v207
  v_lshlrev_b32 v29, 2, v29
  v_add_f32 v232, v232, v200
  v_add_f32 v232, v232, v201
  v_cvt_pk_bf16_f32 v212, v200, v201
  v_add_f32 v232, v232, v202
  v_add_f32 v232, v232, v203
  v_cvt_pk_bf16_f32 v213, v202, v203
  v_add_f32 v232, v232, v204
  v_add_f32 v232, v232, v205
  v_cvt_pk_bf16_f32 v214, v204, v205
  v_mfma_f32_16x16x32_bf16 v[248:251], v[160:163], v[96:99], v[224:227]
  s_add_u32 s12, s6, 33554432
  ds_read_b128 v[144:147], v237 offset:4096
  v_add_f32 v232, v232, v206
  v_mfma_f32_16x16x32_bf16 v[252:255], v[176:179], v[96:99], v[224:227]
  s_addc_u32 s13, s7, 0
  v_exp_f32 v240, v240
  v_mfma_f32_16x16x32_bf16 v[248:251], v[164:167], v[100:103], v[248:251]
  s_and_b32 s13, s13, 0xffff
  ds_read_b128 v[148:151], v237 offset:5120
  v_add_f32 v232, v232, v207
  v_mfma_f32_16x16x32_bf16 v[252:255], v[180:183], v[100:103], v[252:255]
  s_mov_b32 s14, 19398656
  v_exp_f32 v241, v241
  v_mfma_f32_16x16x32_bf16 v[248:251], v[168:171], v[104:107], v[248:251]
  s_mov_b32 s15, 0x20000
  ds_read_b128 v[152:155], v237 offset:6144
  v_cvt_pk_bf16_f32 v215, v206, v207
  v_mfma_f32_16x16x32_bf16 v[252:255], v[184:187], v[104:107], v[252:255]
  s_mov_b32 s58, 1075839072
  v_exp_f32 v242, v242
  v_mfma_f32_16x16x32_bf16 v[248:251], v[172:175], v[108:111], v[248:251]
  s_mov_b32 s59, 4294934783
  ds_read_b128 v[156:159], v237 offset:7168
  v_add_f32 v235, v235, v240
  v_mfma_f32_16x16x32_bf16 v[252:255], v[188:191], v[108:111], v[252:255]
  s_lshl_b32 s60, s29, 3
  v_add_f32 v235, v235, v241
  v_cvt_pk_bf16_f32 v208, v240, v241
  v_mfma_f32_16x16x32_bf16 a[0:3], a[144:147], v[212:215], 0
  s_lshr_b64 s[58:59], s[58:59], s60
  v_exp_f32 v243, v243
  v_mfma_f32_16x16x32_bf16 a[16:19], a[148:151], v[212:215], 0
  s_and_b32 s3, s58, 255
  v_add_f32 v235, v235, v242
  v_add_f32 v235, v235, v243
  v_mfma_f32_16x16x32_bf16 a[32:35], a[152:155], v[212:215], 0
  s_add_u32 s3, s3, s28
  v_exp_f32 v244, v244
  v_mfma_f32_16x16x32_bf16 a[48:51], a[156:159], v[212:215], 0
  v_cvt_pk_bf16_f32 v209, v242, v243
  v_add_f32 v235, v235, v244
  v_mfma_f32_16x16x32_bf16 a[64:67], a[160:163], v[212:215], 0
  v_exp_f32 v245, v245
  v_mfma_f32_16x16x32_bf16 a[80:83], a[164:167], v[212:215], 0
  v_add_f32 v235, v235, v245
  v_cvt_pk_bf16_f32 v210, v244, v245
  v_mfma_f32_16x16x32_bf16 a[96:99], a[168:171], v[212:215], 0
  v_exp_f32 v246, v246
  v_mfma_f32_16x16x32_bf16 a[112:115], a[172:175], v[212:215], 0
  v_exp_f32 v247, v247
  v_mfma_f32_16x16x32_bf16 v[192:195], v[160:163], v[80:83], v[220:223]
  s_cmp_lt_u32 s3, 128
  ds_read_b128 a[144:147], v237 offset:16384
  v_add_f32 v235, v235, v246
  v_mfma_f32_16x16x32_bf16 v[196:199], v[176:179], v[80:83], v[220:223]
  s_cselect_b32 s64, s68, s96
  v_exp_f32 v248, v248
  v_mfma_f32_16x16x32_bf16 v[192:195], v[164:167], v[84:87], v[192:195]
  s_cselect_b32 s65, s69, s97
  ds_read_b128 a[148:151], v237 offset:17408
  v_add_f32 v235, v235, v247
  v_mfma_f32_16x16x32_bf16 v[196:199], v[180:183], v[84:87], v[196:199]
  s_mov_b32 s60, 819200
  v_exp_f32 v249, v249
  v_mfma_f32_16x16x32_bf16 v[192:195], v[168:171], v[88:91], v[192:195]
  s_cselect_b32 s66, 5242880, s60
  ds_read_b128 a[152:155], v237 offset:18432
  v_cvt_pk_bf16_f32 v211, v246, v247
  v_mfma_f32_16x16x32_bf16 v[196:199], v[184:187], v[88:91], v[196:199]
  s_cselect_b32 s60, 0, 128
  v_exp_f32 v250, v250
  v_mfma_f32_16x16x32_bf16 v[192:195], v[172:175], v[92:95], v[192:195]
  s_and_b32 s65, s65, 0xffff
  ds_read_b128 a[156:159], v237 offset:19456
  v_add_f32 v234, v234, v248
  v_mfma_f32_16x16x32_bf16 v[196:199], v[188:191], v[92:95], v[196:199]
  s_mov_b32 s67, 0x20000
  v_add_f32 v234, v234, v249
  v_cvt_pk_bf16_f32 v212, v248, v249
  v_mfma_f32_16x16x32_bf16 a[12:15], a[176:179], v[208:211], a[12:15]
  s_sub_u32 s60, s3, s60
  v_exp_f32 v251, v251
  v_mfma_f32_16x16x32_bf16 a[28:31], a[180:183], v[208:211], a[28:31]
  s_min_u32 s60, s60, 200
  v_add_f32 v234, v234, v250
  v_add_f32 v234, v234, v251
  v_mfma_f32_16x16x32_bf16 a[44:47], a[184:187], v[208:211], a[44:47]
  s_mul_i32 s44, s60, 40960
  v_exp_f32 v252, v252
  v_mfma_f32_16x16x32_bf16 a[60:63], a[188:191], v[208:211], a[60:63]
  s_mul_i32 s60, s30, 10240
  v_cvt_pk_bf16_f32 v213, v250, v251
  v_add_f32 v234, v234, v252
  s_waitcnt lgkmcnt(1)
  v_mfma_f32_16x16x32_bf16 a[76:79], a[192:195], v[208:211], a[76:79]
  s_add_u32 s44, s44, s60
  v_exp_f32 v253, v253
  v_mfma_f32_16x16x32_bf16 a[92:95], a[196:199], v[208:211], a[92:95]
  v_add_f32 v234, v234, v253
  v_cvt_pk_bf16_f32 v214, v252, v253
  v_mfma_f32_16x16x32_bf16 a[108:111], a[200:203], v[208:211], a[108:111]
  v_exp_f32 v254, v254
  v_mfma_f32_16x16x32_bf16 a[124:127], a[204:207], v[208:211], a[124:127]
  v_exp_f32 v255, v255
  s_cmp_lg_u32 s30, 0
  s_cbranch_scc1 L_nopoll
  buffer_load_dword v27, v26, s[24:27], 0 offen offset:32 sc1
L_nopoll:
  v_mfma_f32_16x16x32_bf16 v[200:203], v[128:131], v[112:115], v[228:231]
  ds_read_b128 a[160:163], v237 offset:20480
  v_add_f32 v234, v234, v254
  v_mfma_f32_16x16x32_bf16 v[204:207], v[144:147], v[112:115], v[228:231]
  ds_read_b128 a[164:167], v237 offset:21504
  v_add_f32 v234, v234, v255
  v_mfma_f32_16x16x32_bf16 v[200:203], v[132:135], v[116:119], v[200:203]
  ds_read_b128 a[168:171], v237 offset:22528
  v_cvt_pk_bf16_f32 v215, v254, v255
  v_mfma_f32_16x16x32_bf16 v[204:207], v[148:151], v[116:119], v[204:207]
  ds_read_b128 a[172:175], v237 offset:23552
  v_mfma_f32_16x16x32_bf16 v[200:203], v[136:139], v[120:123], v[200:203]
  ds_read_b128 v[160:163], v237 offset:8192
  v_mfma_f32_16x16x32_bf16 v[204:207], v[152:155], v[120:123], v[204:207]
  ds_read_b128 v[164:167], v237 offset:9216
  v_mfma_f32_16x16x32_bf16 v[200:203], v[140:143], v[124:127], v[200:203]
  ds_read_b128 v[168:171], v237 offset:10240
  v_mfma_f32_16x16x32_bf16 v[204:207], v[156:159], v[124:127], v[204:207]
  ds_read_b128 v[172:175], v237 offset:11264
  v_mfma_f32_16x16x32_bf16 a[8:11], a[176:179], v[212:215], a[8:11]
  v_exp_f32 v192, v192
  v_mfma_f32_16x16x32_bf16 a[24:27], a[180:183], v[212:215], a[24:27]
  v_exp_f32 v193, v193
  v_mfma_f32_16x16x32_bf16 a[40:43], a[184:187], v[212:215], a[40:43]
  v_exp_f32 v194, v194
  v_mfma_f32_16x16x32_bf16 a[56:59], a[188:191], v[212:215], a[56:59]
  v_exp_f32 v195, v195
  v_mfma_f32_16x16x32_bf16 a[72:75], a[192:195], v[212:215], a[72:75]
  v_exp_f32 v196, v196
  v_mfma_f32_16x16x32_bf16 a[88:91], a[196:199], v[212:215], a[88:91]
  v_exp_f32 v197, v197
  v_mfma_f32_16x16x32_bf16 a[104:107], a[200:203], v[212:215], a[104:107]
  v_exp_f32 v198, v198
  v_mfma_f32_16x16x32_bf16 a[120:123], a[204:207], v[212:215], a[120:123]
  v_exp_f32 v199, v199
  v_add_f32 v233, v233, v192
  v_add_f32 v233, v233, v193
  v_cvt_pk_bf16_f32 v208, v192, v193
  v_add_f32 v233, v233, v194
  v_add_f32 v233, v233, v195
  v_cvt_pk_bf16_f32 v209, v194, v195
  v_add_f32 v233, v233, v196
  v_add_f32 v233, v233, v197
  v_cvt_pk_bf16_f32 v210, v196, v197
  v_mfma_f32_16x16x32_bf16 v[240:243], v[128:131], v[96:99], v[224:227]
  ds_read_b128 v[176:179], v237 offset:12288
  v_add_f32 v233, v233, v198
  v_mfma_f32_16x16x32_bf16 v[244:247], v[144:147], v[96:99], v[224:227]
  v_exp_f32 v200, v200
  v_mfma_f32_16x16x32_bf16 v[240:243], v[132:135], v[100:103], v[240:243]
  ds_read_b128 v[180:183], v237 offset:13312
  v_add_f32 v233, v233, v199
  v_mfma_f32_16x16x32_bf16 v[244:247], v[148:151], v[100:103], v[244:247]
  v_exp_f32 v201, v201
  v_mfma_f32_16x16x32_bf16 v[240:243], v[136:139], v[104:107], v[240:243]
  ds_read_b128 v[184:187], v237 offset:14336
  v_cvt_pk_bf16_f32 v211, v198, v199
  v_mfma_f32_16x16x32_bf16 v[244:247], v[152:155], v[104:107], v[244:247]
  v_exp_f32 v202, v202
  v_mfma_f32_16x16x32_bf16 v[240:243], v[140:143], v[108:111], v[240:243]
  ds_read_b128 v[188:191], v237 offset:15360
  v_add_f32 v235, v235, v200
  v_mfma_f32_16x16x32_bf16 v[244:247], v[156:159], v[108:111], v[244:247]
  v_add_f32 v235, v235, v201
  v_cvt_pk_bf16_f32 v212, v200, v201
  v_mfma_f32_16x16x32_bf16 a[4:7], a[176:179], v[208:211], a[4:7]
  v_exp_f32 v203, v203
  v_mfma_f32_16x16x32_bf16 a[20:23], a[180:183], v[208:211], a[20:23]
  v_add_f32 v235, v235, v202
  v_add_f32 v235, v235, v203
  v_mfma_f32_16x16x32_bf16 a[36:39], a[184:187], v[208:211], a[36:39]
  v_exp_f32 v204, v204
  v_mfma_f32_16x16x32_bf16 a[52:55], a[188:191], v[208:211], a[52:55]
  v_cvt_pk_bf16_f32 v213, v202, v203
  v_add_f32 v235, v235, v204
  v_mfma_f32_16x16x32_bf16 a[68:71], a[192:195], v[208:211], a[68:71]
  v_exp_f32 v205, v205
  v_mfma_f32_16x16x32_bf16 a[84:87], a[196:199], v[208:211], a[84:87]
  v_add_f32 v235, v235, v205
  v_cvt_pk_bf16_f32 v214, v204, v205
  v_mfma_f32_16x16x32_bf16 a[100:103], a[200:203], v[208:211], a[100:103]
  v_exp_f32 v206, v206
  v_mfma_f32_16x16x32_bf16 a[116:119], a[204:207], v[208:211], a[116:119]
  v_exp_f32 v207, v207
  v_mfma_f32_16x16x32_bf16 v[248:251], v[128:131], v[80:83], v[220:223]
  ds_read_b128 a[176:179], v237 offset:24576
  v_add_f32 v235, v235, v206
  v_mfma_f32_16x16x32_bf16 v[252:255], v[144:147], v[80:83], v[220:223]
  v_exp_f32 v240, v240
  v_mfma_f32_16x16x32_bf16 v[248:251], v[132:135], v[84:87], v[248:251]
  ds_read_b128 a[180:183], v237 offset:25600
  v_add_f32 v235, v235, v207
  v_mfma_f32_16x16x32_bf16 v[252:255], v[148:151], v[84:87], v[252:255]
  v_exp_f32 v241, v241
  v_mfma_f32_16x16x32_bf16 v[248:251], v[136:139], v[88:91], v[248:251]
  ds_read_b128 a[184:187], v237 offset:26624
  v_cvt_pk_bf16_f32 v215, v206, v207
  v_mfma_f32_16x16x32_bf16 v[252:255], v[152:155], v[88:91], v[252:255]
  v_exp_f32 v242, v242
  v_mfma_f32_16x16x32_bf16 v[248:251], v[140:143], v[92:95], v[248:251]
  ds_read_b128 a[188:191], v237 offset:27648
  v_add_f32 v234, v234, v240
  v_mfma_f32_16x16x32_bf16 v[252:255], v[156:159], v[92:95], v[252:255]
  v_add_f32 v234, v234, v241
  v_cvt_pk_bf16_f32 v208, v240, v241
  v_mfma_f32_16x16x32_bf16 a[12:15], a[144:147], v[212:215], a[12:15]
  v_exp_f32 v243, v243
  v_mfma_f32_16x16x32_bf16 a[28:31], a[148:151], v[212:215], a[28:31]
  v_add_f32 v234, v234, v242
  v_add_f32 v234, v234, v243
  v_mfma_f32_16x16x32_bf16 a[44:47], a[152:155], v[212:215], a[44:47]
  s_waitcnt lgkmcnt(3)
  v_exp_f32 v244, v244
  v_mfma_f32_16x16x32_bf16 a[60:63], a[156:159], v[212:215], a[60:63]
  v_cvt_pk_bf16_f32 v209, v242, v243
  v_add_f32 v234, v234, v244
  v_mfma_f32_16x16x32_bf16 a[76:79], a[160:163], v[212:215], a[76:79]
  v_exp_f32 v245, v245
  v_mfma_f32_16x16x32_bf16 a[92:95], a[164:167], v[212:215], a[92:95]
  v_add_f32 v234, v234, v245
  v_cvt_pk_bf16_f32 v210, v244, v245
  v_mfma_f32_16x16x32_bf16 a[108:111], a[168:171], v[212:215], a[108:111]
  v_exp_f32 v246, v246
  v_mfma_f32_16x16x32_bf16 a[124:127], a[172:175], v[212:215], a[124:127]
  v_exp_f32 v247, v247
  s_cmp_lg_u32 s30, 0
  s_cbranch_scc1 L_rdy0
  s_waitcnt vmcnt(0)
  v_cmp_eq_u32 vcc, s100, v27
  s_lshl_b32 s47, -1, s29
  s_nop 0
  s_or_b32 s47, s47, vcc_lo
  s_bitcmp1_b32 s47, 0
  s_cbranch_scc0 L_slow0
L_rdy0:
  s_waitcnt lgkmcnt(0)
  s_barrier
  v_mfma_f32_16x16x32_bf16 v[192:195], v[160:163], v[112:115], v[228:231]
  ds_read_b128 a[192:195], v237 offset:28672
  v_add_f32 v234, v234, v246
  v_mfma_f32_16x16x32_bf16 v[196:199], v[176:179], v[112:115], v[228:231]
  ds_read_b128 a[196:199], v237 offset:29696
  v_add_f32 v234, v234, v247
  v_mfma_f32_16x16x32_bf16 v[192:195], v[164:167], v[116:119], v[192:195]
  ds_read_b128 a[200:203], v237 offset:30720
  v_cvt_pk_bf16_f32 v211, v246, v247
  v_mfma_f32_16x16x32_bf16 v[196:199], v[180:183], v[116:119], v[196:199]
  ds_read_b128 a[204:207], v237 offset:31744
  v_mfma_f32_16x16x32_bf16 v[192:195], v[168:171], v[120:123], v[192:195]
  ds_read_b128 v[128:131], v237 offset:32768
  v_mfma_f32_16x16x32_bf16 v[196:199], v[184:187], v[120:123], v[196:199]
  ds_read_b128 v[132:135], v237 offset:33792
  v_mfma_f32_16x16x32_bf16 v[192:195], v[172:175], v[124:127], v[192:195]
  ds_read_b128 v[136:139], v237 offset:34816
  v_mfma_f32_16x16x32_bf16 v[196:199], v[188:191], v[124:127], v[196:199]
  ds_read_b128 v[140:143], v237 offset:35840
  v_mfma_f32_16x16x32_bf16 a[8:11], a[144:147], v[208:211], a[8:11]
  s_add_u32 m0, s36, 0
  v_exp_f32 v248, v248
  v_mfma_f32_16x16x32_bf16 a[24:27], a[148:151], v[208:211], a[24:27]
  v_exp_f32 v249, v249
  v_mfma_f32_16x16x32_bf16 a[40:43], a[152:155], v[208:211], a[40:43]
  v_exp_f32 v250, v250
  v_mfma_f32_16x16x32_bf16 a[56:59], a[156:159], v[208:211], a[56:59]
  v_exp_f32 v251, v251
  v_mfma_f32_16x16x32_bf16 a[72:75], a[160:163], v[208:211], a[72:75]
  v_exp_f32 v252, v252
  v_mfma_f32_16x16x32_bf16 a[88:91], a[164:167], v[208:211], a[88:91]
  v_exp_f32 v253, v253
  v_mfma_f32_16x16x32_bf16 a[104:107], a[168:171], v[208:211], a[104:107]
  v_exp_f32 v254, v254
  v_mfma_f32_16x16x32_bf16 a[120:123], a[172:175], v[208:211], a[120:123]
  v_exp_f32 v255, v255
  buffer_load_dwordx4 v238, s[8:11], s35 offen offset:0 sc1 lds
  buffer_load_dwordx4 v238, s[8:11], s35 offen offset:1024 sc1 lds
  buffer_load_dwordx4 v238, s[8:11], s35 offen offset:2048 sc1 lds
  v_add_f32 v233, v233, v248
  v_add_f32 v233, v233, v249
  v_cvt_pk_bf16_f32 v212, v248, v249
  v_add_f32 v233, v233, v250
  v_add_f32 v233, v233, v251
  v_cvt_pk_bf16_f32 v213, v250, v251
  v_add_f32 v233, v233, v252
  v_add_f32 v233, v233, v253
  v_cvt_pk_bf16_f32 v214, v252, v253
  v_mfma_f32_16x16x32_bf16 v[200:203], v[160:163], v[96:99], v[224:227]
  ds_read_b128 v[144:147], v237 offset:36864
  v_add_f32 v233, v233, v254
  v_mfma_f32_16x16x32_bf16 v[204:207], v[176:179], v[96:99], v[224:227]
  v_exp_f32 v192, v192
  v_mfma_f32_16x16x32_bf16 v[200:203], v[164:167], v[100:103], v[200:203]
  ds_read_b128 v[148:151], v237 offset:37888
  v_add_f32 v233, v233, v255
  v_mfma_f32_16x16x32_bf16 v[204:207], v[180:183], v[100:103], v[204:207]
  v_exp_f32 v193, v193
  v_mfma_f32_16x16x32_bf16 v[200:203], v[168:171], v[104:107], v[200:203]
  ds_read_b128 v[152:155], v237 offset:38912
  v_cvt_pk_bf16_f32 v215, v254, v255
  v_mfma_f32_16x16x32_bf16 v[204:207], v[184:187], v[104:107], v[204:207]
  v_exp_f32 v194, v194
  v_mfma_f32_16x16x32_bf16 v[200:203], v[172:175], v[108:111], v[200:203]
  ds_read_b128 v[156:159], v237 offset:39936
  v_add_f32 v235, v235, v192
  v_mfma_f32_16x16x32_bf16 v[204:207], v[188:191], v[108:111], v[204:207]
  v_exp_f32 v195, v195
  v_mfma_f32_16x16x32_bf16 a[4:7], a[144:147], v[212:215], a[4:7]
  buffer_load_dwordx4 v238, s[8:11], s35 offen offset:3072 sc1 lds
  v_mfma_f32_16x16x32_bf16 a[20:23], a[148:151], v[212:215], a[20:23]
  s_add_u32 s35, s35, 4096
  v_add_f32 v235, v235, v193
  v_cvt_pk_bf16_f32 v208, v192, v193
  v_mfma_f32_16x16x32_bf16 a[36:39], a[152:155], v[212:215], a[36:39]
  s_add_u32 m0, s36, 4096
  v_exp_f32 v196, v196
  v_mfma_f32_16x16x32_bf16 a[52:55], a[156:159], v[212:215], a[52:55]
  buffer_load_dwordx4 v238, s[8:11], s35 offen offset:0 sc1 lds
  v_mfma_f32_16x16x32_bf16 a[68:71], a[160:163], v[212:215], a[68:71]
  v_add_f32 v235, v235, v194
  v_add_f32 v235, v235, v195
  v_mfma_f32_16x16x32_bf16 a[84:87], a[164:167], v[212:215], a[84:87]
  v_exp_f32 v197, v197
  v_mfma_f32_16x16x32_bf16 a[100:103], a[168:171], v[212:215], a[100:103]
  v_exp_f32 v198, v198
  v_mfma_f32_16x16x32_bf16 a[116:119], a[172:175], v[212:215], a[116:119]
  v_exp_f32 v199, v199
  v_cvt_pk_bf16_f32 v209, v194, v195
  v_add_f32 v235, v235, v196
  v_add_f32 v235, v235, v197
  v_cvt_pk_bf16_f32 v210, v196, v197
  v_mfma_f32_16x16x32_bf16 v[240:243], v[160:163], v[80:83], v[40:43]
  ds_read_b128 a[144:147], v237 offset:49152
  v_add_f32 v235, v235, v198
  v_mfma_f32_16x16x32_bf16 v[244:247], v[176:179], v[80:83], v[44:47]
  ds_read_b128 a[148:151], v237 offset:50176
  v_add_f32 v235, v235, v199
  v_mfma_f32_16x16x32_bf16 v[240:243], v[164:167], v[84:87], v[240:243]
  ds_read_b128 a[152:155], v237 offset:51200
  v_cvt_pk_bf16_f32 v211, v198, v199
  v_mfma_f32_16x16x32_bf16 v[244:247], v[180:183], v[84:87], v[244:247]
  ds_read_b128 a[156:159], v237 offset:52224
  v_mfma_f32_16x16x32_bf16 v[240:243], v[168:171], v[88:91], v[240:243]
  buffer_load_dwordx4 v238, s[8:11], s35 offen offset:1024 sc1 lds
  v_mfma_f32_16x16x32_bf16 v[244:247], v[184:187], v[88:91], v[244:247]
  buffer_load_dwordx4 v238, s[8:11], s35 offen offset:2048 sc1 lds
  v_mfma_f32_16x16x32_bf16 v[240:243], v[172:175], v[92:95], v[240:243]
  buffer_load_dwordx4 v238, s[8:11], s35 offen offset:3072 sc1 lds
  v_mfma_f32_16x16x32_bf16 v[244:247], v[188:191], v[92:95], v[244:247]
  s_add_u32 s35, s35, 28672
  v_exp_f32 v200, v200
  v_mfma_f32_16x16x32_bf16 a[12:15], a[176:179], v[208:211], a[12:15]
  v_exp_f32 v201, v201
  v_mfma_f32_16x16x32_bf16 a[28:31], a[180:183], v[208:211], a[28:31]
  v_add_f32 v234, v234, v200
  v_add_f32 v234, v234, v201
  v_mfma_f32_16x16x32_bf16 a[44:47], a[184:187], v[208:211], a[44:47]
  v_exp_f32 v202, v202
  v_mfma_f32_16x16x32_bf16 a[60:63], a[188:191], v[208:211], a[60:63]
  s_waitcnt lgkmcnt(1)
  v_exp_f32 v203, v203
  v_mfma_f32_16x16x32_bf16 a[76:79], a[192:195], v[208:211], a[76:79]
  v_exp_f32 v204, v204
  v_mfma_f32_16x16x32_bf16 a[92:95], a[196:199], v[208:211], a[92:95]
  v_exp_f32 v205, v205
  v_mfma_f32_16x16x32_bf16 a[108:111], a[200:203], v[208:211], a[108:111]
  v_exp_f32 v206, v206
  v_mfma_f32_16x16x32_bf16 a[124:127], a[204:207], v[208:211], a[124:127]
  v_exp_f32 v207, v207
  v_cvt_pk_bf16_f32 v212, v200, v201
  v_add_f32 v234, v234, v202
  v_add_f32 v234, v234, v203
  v_cvt_pk_bf16_f32 v213, v202, v203
  v_add_f32 v234, v234, v204
  v_add_f32 v234, v234, v205
  v_cvt_pk_bf16_f32 v214, v204, v205
  s_cmp_lg_u32 s29, 0
  s_cbranch_scc1 L_ntA
  v_lshlrev_b32 v30, 3, v236
  buffer_load_dword v24, v30, s[64:67], s44 offen
  v_min_u32 v30, 2176, v30
  v_add_u32 v30, 8064, v30
  buffer_load_dword v25, v30, s[64:67], s44 offen
L_ntA:
  v_mfma_f32_16x16x32_bf16 v[248:251], v[128:131], v[112:115], v[228:231]
  ds_read_b128 a[160:163], v237 offset:53248
  v_add_f32 v234, v234, v206
  v_mfma_f32_16x16x32_bf16 v[252:255], v[144:147], v[112:115], v[228:231]
  ds_read_b128 a[164:167], v237 offset:54272
  v_add_f32 v234, v234, v207
  v_mfma_f32_16x16x32_bf16 v[248:251], v[132:135], v[116:119], v[248:251]
  ds_read_b128 a[168:171], v237 offset:55296
  v_cvt_pk_bf16_f32 v215, v206, v207
  v_mfma_f32_16x16x32_bf16 v[252:255], v[148:151], v[116:119], v[252:255]
  ds_read_b128 a[172:175], v237 offset:56320
  v_mfma_f32_16x16x32_bf16 v[248:251], v[136:139], v[120:123], v[248:251]
  ds_read_b128 v[160:163], v237 offset:40960
  v_mfma_f32_16x16x32_bf16 v[252:255], v[152:155], v[120:123], v[252:255]
  ds_read_b128 v[164:167], v237 offset:41984
  v_mfma_f32_16x16x32_bf16 v[248:251], v[140:143], v[124:127], v[248:251]
  ds_read_b128 v[168:171], v237 offset:43008
  v_mfma_f32_16x16x32_bf16 v[252:255], v[156:159], v[124:127], v[252:255]
  ds_read_b128 v[172:175], v237 offset:44032
  v_mfma_f32_16x16x32_bf16 a[8:11], a[176:179], v[212:215], a[8:11]
  s_add_u32 m0, s36, 32768
  v_exp_f32 v240, v240
  v_mfma_f32_16x16x32_bf16 a[24:27], a[180:183], v[212:215], a[24:27]
  v_exp_f32 v241, v241
  v_mfma_f32_16x16x32_bf16 a[40:43], a[184:187], v[212:215], a[40:43]
  v_exp_f32 v242, v242
  v_mfma_f32_16x16x32_bf16 a[56:59], a[188:191], v[212:215], a[56:59]
  v_exp_f32 v243, v243
  v_mfma_f32_16x16x32_bf16 a[72:75], a[192:195], v[212:215], a[72:75]
  v_exp_f32 v244, v244
  v_mfma_f32_16x16x32_bf16 a[88:91], a[196:199], v[212:215], a[88:91]
  v_exp_f32 v245, v245
  v_mfma_f32_16x16x32_bf16 a[104:107], a[200:203], v[212:215], a[104:107]
  v_exp_f32 v246, v246
  v_mfma_f32_16x16x32_bf16 a[120:123], a[204:207], v[212:215], a[120:123]
  v_exp_f32 v247, v247
  buffer_load_dwordx4 v238, s[8:11], s35 offen offset:0 sc1 lds
  buffer_load_dwordx4 v238, s[8:11], s35 offen offset:1024 sc1 lds
  v_add_f32 v233, v233, v240
  v_add_f32 v233, v233, v241
  v_cvt_pk_bf16_f32 v208, v240, v241
  v_add_f32 v233, v233, v242
  v_add_f32 v233, v233, v243
  v_cvt_pk_bf16_f32 v209, v242, v243
  v_add_f32 v233, v233, v244
  v_add_f32 v233, v233, v245
  v_cvt_pk_bf16_f32 v210, v244, v245
  v_mfma_f32_16x16x32_bf16 v[192:195], v[128:131], v[96:99], v[48:51]
  ds_read_b128 v[176:179], v237 offset:45056
  v_add_f32 v233, v233, v246
  v_mfma_f32_16x16x32_bf16 v[196:199], v[144:147], v[96:99], v[52:55]
  v_exp_f32 v248, v248
  v_mfma_f32_16x16x32_bf16 v[192:195], v[132:135], v[100:103], v[192:195]
  ds_read_b128 v[180:183], v237 offset:46080
  v_add_f32 v233, v233, v247
  v_mfma_f32_16x16x32_bf16 v[196:199], v[148:151], v[100:103], v[196:199]
  v_exp_f32 v249, v249
  v_mfma_f32_16x16x32_bf16 v[192:195], v[136:139], v[104:107], v[192:195]
  ds_read_b128 v[184:187], v237 offset:47104
  v_cvt_pk_bf16_f32 v211, v246, v247
  v_mfma_f32_16x16x32_bf16 v[196:199], v[152:155], v[104:107], v[196:199]
  v_exp_f32 v250, v250
  v_mfma_f32_16x16x32_bf16 v[192:195], v[140:143], v[108:111], v[192:195]
  ds_read_b128 v[188:191], v237 offset:48128
  v_add_f32 v235, v235, v248
  v_mfma_f32_16x16x32_bf16 v[196:199], v[156:159], v[108:111], v[196:199]
  v_exp_f32 v251, v251
  v_mfma_f32_16x16x32_bf16 a[4:7], a[176:179], v[208:211], a[4:7]
  buffer_load_dwordx4 v238, s[8:11], s35 offen offset:2048 sc1 lds
  v_mfma_f32_16x16x32_bf16 a[20:23], a[180:183], v[208:211], a[20:23]
  v_add_f32 v235, v235, v249
  v_cvt_pk_bf16_f32 v212, v248, v249
  v_mfma_f32_16x16x32_bf16 a[36:39], a[184:187], v[208:211], a[36:39]
  buffer_load_dwordx4 v238, s[8:11], s35 offen offset:3072 sc1 lds
  v_mfma_f32_16x16x32_bf16 a[52:55], a[188:191], v[208:211], a[52:55]
  s_add_u32 s35, s35, 4096
  v_add_f32 v235, v235, v250
  v_add_f32 v235, v235, v251
  v_mfma_f32_16x16x32_bf16 a[68:71], a[192:195], v[208:211], a[68:71]
  v_exp_f32 v252, v252
  v_mfma_f32_16x16x32_bf16 a[84:87], a[196:199], v[208:211], a[84:87]
  v_exp_f32 v253, v253
  v_mfma_f32_16x16x32_bf16 a[100:103], a[200:203], v[208:211], a[100:103]
  v_exp_f32 v254, v254
  v_mfma_f32_16x16x32_bf16 a[116:119], a[204:207], v[208:211], a[116:119]
  v_exp_f32 v255, v255
  v_cvt_pk_bf16_f32 v213, v250, v251
  v_add_f32 v235, v235, v252
  v_add_f32 v235, v235, v253
  v_cvt_pk_bf16_f32 v214, v252, v253
  s_cmp_lg_u32 s29, 0
  s_cbranch_scc1 L_pp0
  s_cmp_lg_u32 s30, 0
  s_cbranch_scc1 L_pp0
  s_mov_b32 s32, 28672
  buffer_load_dword v28, v29, s[24:27], s32 offen sc1
L_pp0:
  s_waitcnt lgkmcnt(0)
  s_barrier
  v_mfma_f32_16x16x32_bf16 v[200:203], v[160:163], v[112:115], v[228:231]
  ds_read_b128 a[176:179], v237 offset:57344
  v_add_f32 v235, v235, v254
  v_mfma_f32_16x16x32_bf16 v[204:207], v[176:179], v[112:115], v[228:231]
  ds_read_b128 a[180:183], v237 offset:58368
  v_add_f32 v235, v235, v255
  v_mfma_f32_16x16x32_bf16 v[200:203], v[164:167], v[116:119], v[200:203]
  ds_read_b128 a[184:187], v237 offset:59392
  v_cvt_pk_bf16_f32 v215, v254, v255
  v_mfma_f32_16x16x32_bf16 v[204:207], v[180:183], v[116:119], v[204:207]
  ds_read_b128 a[188:191], v237 offset:60416
  v_mfma_f32_16x16x32_bf16 v[200:203], v[168:171], v[120:123], v[200:203]
  ds_read_b128 v[128:131], v239 offset:0
  v_mfma_f32_16x16x32_bf16 v[204:207], v[184:187], v[120:123], v[204:207]
  ds_read_b128 v[132:135], v239 offset:1024
  v_mfma_f32_16x16x32_bf16 v[200:203], v[172:175], v[124:127], v[200:203]
  ds_read_b128 v[136:139], v239 offset:2048
  v_mfma_f32_16x16x32_bf16 v[204:207], v[188:191], v[124:127], v[204:207]
  ds_read_b128 v[140:143], v239 offset:3072
  v_mfma_f32_16x16x32_bf16 a[12:15], a[144:147], v[212:215], a[12:15]
  v_exp_f32 v192, v192
  v_mfma_f32_16x16x32_bf16 a[28:31], a[148:151], v[212:215], a[28:31]
  v_exp_f32 v193, v193
  v_mfma_f32_16x16x32_bf16 a[44:47], a[152:155], v[212:215], a[44:47]
  v_exp_f32 v194, v194
  v_mfma_f32_16x16x32_bf16 a[60:63], a[156:159], v[212:215], a[60:63]
  v_exp_f32 v195, v195
  v_mfma_f32_16x16x32_bf16 a[76:79], a[160:163], v[212:215], a[76:79]
  v_exp_f32 v196, v196
  v_mfma_f32_16x16x32_bf16 a[92:95], a[164:167], v[212:215], a[92:95]
  v_exp_f32 v197, v197
  v_mfma_f32_16x16x32_bf16 a[108:111], a[168:171], v[212:215], a[108:111]
  v_exp_f32 v198, v198
  v_mfma_f32_16x16x32_bf16 a[124:127], a[172:175], v[212:215], a[124:127]
  s_waitcnt lgkmcnt(0)
  v_exp_f32 v199, v199
  ds_read_b128 v[144:147], v239 offset:4096
  ds_read_b128 v[148:151], v239 offset:5120
  ds_read_b128 v[152:155], v239 offset:6144
  ds_read_b128 v[156:159], v239 offset:7168
  s_add_u32 m0, s36, 36864
  s_nop 0
  buffer_load_dwordx4 v238, s[8:11], s35 offen offset:0 sc1 lds
  buffer_load_dwordx4 v238, s[8:11], s35 offen offset:1024 sc1 lds
  v_add_f32 v234, v234, v192
  v_add_f32 v234, v234, v193
  v_cvt_pk_bf16_f32 v208, v192, v193
  v_add_f32 v234, v234, v194
  v_add_f32 v234, v234, v195
  v_cvt_pk_bf16_f32 v209, v194, v195
  v_add_f32 v234, v234, v196
  v_add_f32 v234, v234, v197
  v_cvt_pk_bf16_f32 v210, v196, v197
  v_mfma_f32_16x16x32_bf16 v[240:243], v[128:131], v[112:115], v[228:231]
  s_waitcnt lgkmcnt(3)
  ds_read_b128 a[192:195], v237 offset:61440
  v_add_f32 v234, v234, v198
  v_mfma_f32_16x16x32_bf16 v[244:247], v[144:147], v[112:115], v[228:231]
  ds_read_b128 a[196:199], v237 offset:62464
  v_add_f32 v234, v234, v199
  v_mfma_f32_16x16x32_bf16 v[240:243], v[132:135], v[116:119], v[240:243]
  s_waitcnt lgkmcnt(4)
  ds_read_b128 a[200:203], v237 offset:63488
  v_cvt_pk_bf16_f32 v211, v198, v199
  v_mfma_f32_16x16x32_bf16 v[244:247], v[148:151], v[116:119], v[244:247]
  ds_read_b128 a[204:207], v237 offset:64512
  v_mfma_f32_16x16x32_bf16 v[240:243], v[136:139], v[120:123], v[240:243]
  s_waitcnt lgkmcnt(5)
  ds_read_b128 v[160:163], v239 offset:8192
  v_mfma_f32_16x16x32_bf16 v[244:247], v[152:155], v[120:123], v[244:247]
  ds_read_b128 v[164:167], v239 offset:9216
  v_mfma_f32_16x16x32_bf16 v[240:243], v[140:143], v[124:127], v[240:243]
  s_waitcnt lgkmcnt(6)
  ds_read_b128 v[168:171], v239 offset:10240
  v_mfma_f32_16x16x32_bf16 v[244:247], v[156:159], v[124:127], v[244:247]
  ds_read_b128 v[172:175], v239 offset:11264
  v_mfma_f32_16x16x32_bf16 a[8:11], a[144:147], v[208:211], a[8:11]
  v_exp_f32 v200, v200
  v_mfma_f32_16x16x32_bf16 a[24:27], a[148:151], v[208:211], a[24:27]
  v_exp_f32 v201, v201
  v_mfma_f32_16x16x32_bf16 a[40:43], a[152:155], v[208:211], a[40:43]
  v_exp_f32 v202, v202
  v_mfma_f32_16x16x32_bf16 a[56:59], a[156:159], v[208:211], a[56:59]
  v_exp_f32 v203, v203
  v_mfma_f32_16x16x32_bf16 a[72:75], a[160:163], v[208:211], a[72:75]
  v_exp_f32 v204, v204
  v_mfma_f32_16x16x32_bf16 a[88:91], a[164:167], v[208:211], a[88:91]
  v_exp_f32 v205, v205
  v_mfma_f32_16x16x32_bf16 a[104:107], a[168:171], v[208:211], a[104:107]
  v_exp_f32 v206, v206
  v_mfma_f32_16x16x32_bf16 a[120:123], a[172:175], v[208:211], a[120:123]
  v_exp_f32 v207, v207
  ds_read_b128 v[176:179], v239 offset:12288
  ds_read_b128 v[180:183], v239 offset:13312
  ds_read_b128 v[184:187], v239 offset:14336
  ds_read_b128 v[188:191], v239 offset:15360
  buffer_load_dwordx4 v238, s[8:11], s35 offen offset:2048 sc1 lds
  buffer_load_dwordx4 v238, s[8:11], s35 offen offset:3072 sc1 lds
  s_add_u32 s35, s35, 28672
  v_add_f32 v235, v235, v200
  v_add_f32 v235, v235, v201
  v_cvt_pk_bf16_f32 v212, v200, v201
  v_add_f32 v235, v235, v202
  v_add_f32 v235, v235, v203
  v_cvt_pk_bf16_f32 v213, v202, v203
  v_add_f32 v235, v235, v204
  v_add_f32 v235, v235, v205
  v_cvt_pk_bf16_f32 v214, v204, v205
  s_waitcnt vmcnt(8) lgkmcnt(0)
  s_barrier
  v_mfma_f32_16x16x32_bf16 v[248:251], v[160:163], v[112:115], v[56:59]
  ds_read_b128 a[144:147], v239 offset:16384
  v_add_f32 v235, v235, v206
  v_mfma_f32_16x16x32_bf16 v[252:255], v[176:179], v[112:115], v[60:63]
  ds_read_b128 a[148:151], v239 offset:17408
  v_add_f32 v235, v235, v207
  v_mfma_f32_16x16x32_bf16 v[248:251], v[164:167], v[116:119], v[248:251]
  ds_read_b128 a[152:155], v239 offset:18432
  v_cvt_pk_bf16_f32 v215, v206, v207
  v_mfma_f32_16x16x32_bf16 v[252:255], v[180:183], v[116:119], v[252:255]
  ds_read_b128 a[156:159], v239 offset:19456
  v_mfma_f32_16x16x32_bf16 v[248:251], v[168:171], v[120:123], v[248:251]
  ds_read_b128 a[160:163], v239 offset:20480
  v_mfma_f32_16x16x32_bf16 v[252:255], v[184:187], v[120:123], v[252:255]
  ds_read_b128 a[164:167], v239 offset:21504
  v_mfma_f32_16x16x32_bf16 v[248:251], v[172:175], v[124:127], v[248:251]
  ds_read_b128 a[168:171], v239 offset:22528
  v_mfma_f32_16x16x32_bf16 v[252:255], v[188:191], v[124:127], v[252:255]
  ds_read_b128 a[172:175], v239 offset:23552
  v_mfma_f32_16x16x32_bf16 a[12:15], a[176:179], v[212:215], a[12:15]
  v_exp_f32 v240, v240
  v_mfma_f32_16x16x32_bf16 a[28:31], a[180:183], v[212:215], a[28:31]
  v_exp_f32 v241, v241
  v_mfma_f32_16x16x32_bf16 a[44:47], a[184:187], v[212:215], a[44:47]
  v_exp_f32 v242, v242
  v_mfma_f32_16x16x32_bf16 a[60:63], a[188:191], v[212:215], a[60:63]
  v_exp_f32 v243, v243
  v_mfma_f32_16x16x32_bf16 a[76:79], a[192:195], v[212:215], a[76:79]
  v_exp_f32 v244, v244
  v_mfma_f32_16x16x32_bf16 a[92:95], a[196:199], v[212:215], a[92:95]
  v_exp_f32 v245, v245
  v_mfma_f32_16x16x32_bf16 a[108:111], a[200:203], v[212:215], a[108:111]
  v_exp_f32 v246, v246
  v_mfma_f32_16x16x32_bf16 a[124:127], a[204:207], v[212:215], a[124:127]
  v_exp_f32 v247, v247
  ds_read_b128 v[128:131], v236 offset:0
  ds_read_b128 v[132:135], v236 offset:1024
  ds_read_b128 v[136:139], v236 offset:2048
  ds_read_b128 v[140:143], v236 offset:3072
  ds_read_b128 v[144:147], v236 offset:4096
  ds_read_b128 v[148:151], v236 offset:5120
  ds_read_b128 v[152:155], v236 offset:6144
  ds_read_b128 v[156:159], v236 offset:7168
  s_add_u32 m0, s36, 65536
  s_nop 0
  buffer_load_dwordx4 v238, s[8:11], s35 offen offset:0 sc1 lds
  buffer_load_dwordx4 v238, s[8:11], s35 offen offset:1024 sc1 lds
  buffer_load_dwordx4 v238, s[8:11], s35 offen offset:2048 sc1 lds
  v_add_f32 v235, v235, v240
  v_add_f32 v235, v235, v241
  v_cvt_pk_bf16_f32 v208, v240, v241
  v_add_f32 v235, v235, v242
  v_add_f32 v235, v235, v243
  v_cvt_pk_bf16_f32 v209, v242, v243
  v_add_f32 v235, v235, v244
  v_add_f32 v235, v235, v245
  v_cvt_pk_bf16_f32 v210, v244, v245
  s_waitcnt lgkmcnt(7)
  v_mfma_f32_16x16x32_bf16 v[192:195], v[128:131], v[64:67], v[216:219]
  s_waitcnt lgkmcnt(3)
  ds_read_b128 a[176:179], v239 offset:24576
  v_add_f32 v235, v235, v246
  v_mfma_f32_16x16x32_bf16 v[196:199], v[144:147], v[64:67], v[216:219]
  ds_read_b128 a[180:183], v239 offset:25600
  v_add_f32 v235, v235, v247
  v_mfma_f32_16x16x32_bf16 v[192:195], v[132:135], v[68:71], v[192:195]
  s_waitcnt lgkmcnt(4)
  ds_read_b128 a[184:187], v239 offset:26624
  v_cvt_pk_bf16_f32 v211, v246, v247
  v_mfma_f32_16x16x32_bf16 v[196:199], v[148:151], v[68:71], v[196:199]
  ds_read_b128 a[188:191], v239 offset:27648
  v_mfma_f32_16x16x32_bf16 v[192:195], v[136:139], v[72:75], v[192:195]
  s_waitcnt lgkmcnt(5)
  ds_read_b128 a[192:195], v239 offset:28672
  v_mfma_f32_16x16x32_bf16 v[196:199], v[152:155], v[72:75], v[196:199]
  ds_read_b128 a[196:199], v239 offset:29696
  v_mfma_f32_16x16x32_bf16 v[192:195], v[140:143], v[76:79], v[192:195]
  s_waitcnt lgkmcnt(6)
  ds_read_b128 a[200:203], v239 offset:30720
  v_mfma_f32_16x16x32_bf16 v[196:199], v[156:159], v[76:79], v[196:199]
  ds_read_b128 a[204:207], v239 offset:31744
  v_mfma_f32_16x16x32_bf16 a[12:15], a[144:147], v[208:211], a[12:15]
  v_exp_f32 v248, v248
  v_mfma_f32_16x16x32_bf16 a[28:31], a[148:151], v[208:211], a[28:31]
  v_exp_f32 v249, v249
  v_mfma_f32_16x16x32_bf16 a[44:47], a[152:155], v[208:211], a[44:47]
  v_exp_f32 v250, v250
  v_mfma_f32_16x16x32_bf16 a[60:63], a[156:159], v[208:211], a[60:63]
  v_exp_f32 v251, v251
  v_mfma_f32_16x16x32_bf16 a[76:79], a[160:163], v[208:211], a[76:79]
  v_exp_f32 v252, v252
  v_mfma_f32_16x16x32_bf16 a[92:95], a[164:167], v[208:211], a[92:95]
  v_exp_f32 v253, v253
  v_mfma_f32_16x16x32_bf16 a[108:111], a[168:171], v[208:211], a[108:111]
  v_exp_f32 v254, v254
  v_mfma_f32_16x16x32_bf16 a[124:127], a[172:175], v[208:211], a[124:127]
  v_exp_f32 v255, v255
  buffer_load_dwordx4 v238, s[8:11], s35 offen offset:3072 sc1 lds
  s_add_u32 s35, s35, 4096
  s_add_u32 m0, s36, 69632
  s_nop 0
  buffer_load_dwordx4 v238, s[8:11], s35 offen offset:0 sc1 lds
  v_add_f32 v235, v235, v248
  v_add_f32 v235, v235, v249
  v_cvt_pk_bf16_f32 v212, v248, v249
  v_add_f32 v235, v235, v250
  v_add_f32 v235, v235, v251
  v_cvt_pk_bf16_f32 v213, v250, v251
  v_add_f32 v235, v235, v252
  v_add_f32 v235, v235, v253
  v_cvt_pk_bf16_f32 v214, v252, v253
  v_mfma_f32_16x16x32_bf16 v[200:203], v[128:131], v[80:83], v[220:223]
  ds_read_b128 a[144:147], v236 offset:16384
  v_add_f32 v235, v235, v254
  v_mfma_f32_16x16x32_bf16 v[204:207], v[144:147], v[80:83], v[220:223]
  ds_read_b128 a[148:151], v236 offset:17408
  v_add_f32 v235, v235, v255
  v_mfma_f32_16x16x32_bf16 v[200:203], v[132:135], v[84:87], v[200:203]
  ds_read_b128 a[152:155], v236 offset:18432
  v_cvt_pk_bf16_f32 v215, v254, v255
  v_mfma_f32_16x16x32_bf16 v[204:207], v[148:151], v[84:87], v[204:207]
  ds_read_b128 a[156:159], v236 offset:19456
  v_mfma_f32_16x16x32_bf16 v[200:203], v[136:139], v[88:91], v[200:203]
  ds_read_b128 a[160:163], v236 offset:20480
  v_mfma_f32_16x16x32_bf16 v[204:207], v[152:155], v[88:91], v[204:207]
  ds_read_b128 a[164:167], v236 offset:21504
  v_mfma_f32_16x16x32_bf16 v[200:203], v[140:143], v[92:95], v[200:203]
  ds_read_b128 a[168:171], v236 offset:22528
  v_mfma_f32_16x16x32_bf16 v[204:207], v[156:159], v[92:95], v[204:207]
  s_waitcnt lgkmcnt(7)
  ds_read_b128 a[172:175], v236 offset:23552
  v_mfma_f32_16x16x32_bf16 a[12:15], a[176:179], v[212:215], a[12:15]
  v_exp_f32 v192, v192
  v_mfma_f32_16x16x32_bf16 a[28:31], a[180:183], v[212:215], a[28:31]
  v_exp_f32 v193, v193
  v_mfma_f32_16x16x32_bf16 a[44:47], a[184:187], v[212:215], a[44:47]
  v_exp_f32 v194, v194
  v_mfma_f32_16x16x32_bf16 a[60:63], a[188:191], v[212:215], a[60:63]
  v_exp_f32 v195, v195
  v_mfma_f32_16x16x32_bf16 a[76:79], a[192:195], v[212:215], a[76:79]
  v_exp_f32 v196, v196
  v_mfma_f32_16x16x32_bf16 a[92:95], a[196:199], v[212:215], a[92:95]
  v_exp_f32 v197, v197
  v_mfma_f32_16x16x32_bf16 a[108:111], a[200:203], v[212:215], a[108:111]
  v_exp_f32 v198, v198
  v_mfma_f32_16x16x32_bf16 a[124:127], a[204:207], v[212:215], a[124:127]
  v_exp_f32 v199, v199
  ds_read_b128 v[160:163], v236 offset:8192
  ds_read_b128 v[164:167], v236 offset:9216
  ds_read_b128 v[168:171], v236 offset:10240
  ds_read_b128 v[172:175], v236 offset:11264
  buffer_load_dwordx4 v238, s[8:11], s35 offen offset:1024 sc1 lds
  buffer_load_dwordx4 v238, s[8:11], s35 offen offset:2048 sc1 lds
  buffer_load_dwordx4 v238, s[8:11], s35 offen offset:3072 sc1 lds
  s_add_u32 s35, s35, 28672
  v_cvt_pk_bf16_f32 v208, v192, v193
  v_cvt_pk_bf16_f32 v209, v194, v195
  v_cvt_pk_bf16_f32 v210, v196, v197
  s_cmp_eq_u32 s29, 0
  s_cbranch_scc1 L_epiA
  v_add_f32 v232, v232, v192
  v_add_f32 v232, v232, v193
  v_add_f32 v232, v232, v194
  v_add_f32 v232, v232, v195
  v_add_f32 v232, v232, v196
  v_add_f32 v232, v232, v197
  v_mfma_f32_16x16x32_bf16 v[240:243], v[128:131], v[96:99], v[224:227]
  ds_read_b128 v[176:179], v236 offset:12288
  v_add_f32 v232, v232, v198
  v_mfma_f32_16x16x32_bf16 v[244:247], v[144:147], v[96:99], v[224:227]
  ds_read_b128 v[180:183], v236 offset:13312
  v_add_f32 v232, v232, v199
  v_mfma_f32_16x16x32_bf16 v[240:243], v[132:135], v[100:103], v[240:243]
  ds_read_b128 v[184:187], v236 offset:14336
  v_cvt_pk_bf16_f32 v211, v198, v199
  v_mfma_f32_16x16x32_bf16 v[244:247], v[148:151], v[100:103], v[244:247]
  ds_read_b128 v[188:191], v236 offset:15360
  v_mfma_f32_16x16x32_bf16 v[240:243], v[136:139], v[104:107], v[240:243]
  s_add_u32 m0, s36, 98304
  v_exp_f32 v200, v200
  v_mfma_f32_16x16x32_bf16 v[244:247], v[152:155], v[104:107], v[244:247]
  buffer_load_dwordx4 v238, s[8:11], s35 offen offset:0 sc1 lds
  v_mfma_f32_16x16x32_bf16 v[240:243], v[140:143], v[108:111], v[240:243]
  buffer_load_dwordx4 v238, s[8:11], s35 offen offset:1024 sc1 lds
  v_mfma_f32_16x16x32_bf16 v[244:247], v[156:159], v[108:111], v[244:247]
  s_waitcnt lgkmcnt(4)
  buffer_load_dwordx4 v238, s[8:11], s35 offen offset:2048 sc1 lds
  v_mfma_f32_16x16x32_bf16 a[0:3], a[144:147], v[208:211], a[0:3]
  v_exp_f32 v201, v201
  v_mfma_f32_16x16x32_bf16 a[16:19], a[148:151], v[208:211], a[16:19]
  v_add_f32 v233, v233, v200
  v_add_f32 v233, v233, v201
  v_mfma_f32_16x16x32_bf16 a[32:35], a[152:155], v[208:211], a[32:35]
  v_exp_f32 v202, v202
  v_mfma_f32_16x16x32_bf16 a[48:51], a[156:159], v[208:211], a[48:51]
  v_exp_f32 v203, v203
  v_mfma_f32_16x16x32_bf16 a[64:67], a[160:163], v[208:211], a[64:67]
  v_exp_f32 v204, v204
  v_mfma_f32_16x16x32_bf16 a[80:83], a[164:167], v[208:211], a[80:83]
  v_exp_f32 v205, v205
  v_mfma_f32_16x16x32_bf16 a[96:99], a[168:171], v[208:211], a[96:99]
  v_exp_f32 v206, v206
  v_mfma_f32_16x16x32_bf16 a[112:115], a[172:175], v[208:211], a[112:115]
  v_exp_f32 v207, v207
  v_cvt_pk_bf16_f32 v212, v200, v201
  v_add_f32 v233, v233, v202
  v_add_f32 v233, v233, v203
  v_cvt_pk_bf16_f32 v213, v202, v203
  v_add_f32 v233, v233, v204
  v_add_f32 v233, v233, v205
  v_cvt_pk_bf16_f32 v214, v204, v205
  v_mfma_f32_16x16x32_bf16 v[248:251], v[128:131], v[112:115], v[228:231]
  ds_read_b128 a[176:179], v236 offset:24576
  v_add_f32 v233, v233, v206
  v_mfma_f32_16x16x32_bf16 v[252:255], v[144:147], v[112:115], v[228:231]
  v_exp_f32 v240, v240
  v_mfma_f32_16x16x32_bf16 v[248:251], v[132:135], v[116:119], v[248:251]
  ds_read_b128 a[180:183], v236 offset:25600
  v_add_f32 v233, v233, v207
  v_mfma_f32_16x16x32_bf16 v[252:255], v[148:151], v[116:119], v[252:255]
  v_exp_f32 v241, v241
  v_mfma_f32_16x16x32_bf16 v[248:251], v[136:139], v[120:123], v[248:251]
  ds_read_b128 a[184:187], v236 offset:26624
  v_cvt_pk_bf16_f32 v215, v206, v207
  v_mfma_f32_16x16x32_bf16 v[252:255], v[152:155], v[120:123], v[252:255]
  v_exp_f32 v242, v242
  v_mfma_f32_16x16x32_bf16 v[248:251], v[140:143], v[124:127], v[248:251]
  ds_read_b128 a[188:191], v236 offset:27648
  v_add_f32 v234, v234, v240
  v_mfma_f32_16x16x32_bf16 v[252:255], v[156:159], v[124:127], v[252:255]
  v_exp_f32 v243, v243
  v_mfma_f32_16x16x32_bf16 a[4:7], a[144:147], v[212:215], a[4:7]
  buffer_load_dwordx4 v238, s[8:11], s35 offen offset:3072 sc1 lds
  v_mfma_f32_16x16x32_bf16 a[20:23], a[148:151], v[212:215], a[20:23]
  s_add_u32 s35, s35, 4096
  v_add_f32 v234, v234, v241
  v_cvt_pk_bf16_f32 v208, v240, v241
  v_mfma_f32_16x16x32_bf16 a[36:39], a[152:155], v[212:215], a[36:39]
  s_add_u32 m0, s36, 102400
  v_exp_f32 v244, v244
  v_mfma_f32_16x16x32_bf16 a[52:55], a[156:159], v[212:215], a[52:55]
  buffer_load_dwordx4 v238, s[8:11], s35 offen offset:0 sc1 lds
  v_mfma_f32_16x16x32_bf16 a[68:71], a[160:163], v[212:215], a[68:71]
  v_add_f32 v234, v234, v242
  v_add_f32 v234, v234, v243
  v_mfma_f32_16x16x32_bf16 a[84:87], a[164:167], v[212:215], a[84:87]
  v_exp_f32 v245, v245
  v_mfma_f32_16x16x32_bf16 a[100:103], a[168:171], v[212:215], a[100:103]
  v_exp_f32 v246, v246
  v_mfma_f32_16x16x32_bf16 a[116:119], a[172:175], v[212:215], a[116:119]
  v_exp_f32 v247, v247
  v_cvt_pk_bf16_f32 v209, v242, v243
  v_add_f32 v234, v234, v244
  v_add_f32 v234, v234, v245
  v_cvt_pk_bf16_f32 v210, v244, v245
  v_mfma_f32_16x16x32_bf16 v[192:195], v[160:163], v[64:67], v[216:219]
  s_waitcnt lgkmcnt(0)
  ds_read_b128 a[192:195], v236 offset:28672
  v_add_f32 v234, v234, v246
  v_mfma_f32_16x16x32_bf16 v[196:199], v[176:179], v[64:67], v[216:219]
  ds_read_b128 a[196:199], v236 offset:29696
  v_add_f32 v234, v234, v247
  v_mfma_f32_16x16x32_bf16 v[192:195], v[164:167], v[68:71], v[192:195]
  ds_read_b128 a[200:203], v236 offset:30720
  v_cvt_pk_bf16_f32 v211, v246, v247
  v_mfma_f32_16x16x32_bf16 v[196:199], v[180:183], v[68:71], v[196:199]
  ds_read_b128 a[204:207], v236 offset:31744
  v_mfma_f32_16x16x32_bf16 v[192:195], v[168:171], v[72:75], v[192:195]
  buffer_load_dwordx4 v238, s[8:11], s35 offen offset:1024 sc1 lds
  v_mfma_f32_16x16x32_bf16 v[196:199], v[184:187], v[72:75], v[196:199]
  buffer_load_dwordx4 v238, s[8:11], s35 offen offset:2048 sc1 lds
  v_mfma_f32_16x16x32_bf16 v[192:195], v[172:175], v[76:79], v[192:195]
  buffer_load_dwordx4 v238, s[8:11], s35 offen offset:3072 sc1 lds
  v_mfma_f32_16x16x32_bf16 v[196:199], v[188:191], v[76:79], v[196:199]
  s_add_u32 s35, s35, 28672
  v_exp_f32 v248, v248
  v_mfma_f32_16x16x32_bf16 a[8:11], a[144:147], v[208:211], a[8:11]
  v_exp_f32 v249, v249
  v_mfma_f32_16x16x32_bf16 a[24:27], a[148:151], v[208:211], a[24:27]
  v_add_f32 v235, v235, v248
  v_add_f32 v235, v235, v249
  v_mfma_f32_16x16x32_bf16 a[40:43], a[152:155], v[208:211], a[40:43]
  v_exp_f32 v250, v250
  v_mfma_f32_16x16x32_bf16 a[56:59], a[156:159], v[208:211], a[56:59]
  v_exp_f32 v251, v251
  v_mfma_f32_16x16x32_bf16 a[72:75], a[160:163], v[208:211], a[72:75]
  v_exp_f32 v252, v252
  v_mfma_f32_16x16x32_bf16 a[88:91], a[164:167], v[208:211], a[88:91]
  v_exp_f32 v253, v253
  v_mfma_f32_16x16x32_bf16 a[104:107], a[168:171], v[208:211], a[104:107]
  v_exp_f32 v254, v254
  v_mfma_f32_16x16x32_bf16 a[120:123], a[172:175], v[208:211], a[120:123]
  v_exp_f32 v255, v255
  v_cvt_pk_bf16_f32 v212, v248, v249
  v_add_f32 v235, v235, v250
  v_add_f32 v235, v235, v251
  v_cvt_pk_bf16_f32 v213, v250, v251
  v_add_f32 v235, v235, v252
  v_add_f32 v235, v235, v253
  v_cvt_pk_bf16_f32 v214, v252, v253
  s_mov_b32 s38, 0
  s_mov_b32 s45, 131072
  s_mov_b32 s33, 32768
  v_add_u32 v31, 0x8000, v236
  s_lshl_b32 s37, s29, 2
  s_sub_u32 s37, s37, 1
  v_lshlrev_b32 v30, 3, v236
  buffer_load_dword v24, v30, s[64:67], s44 offen
  v_min_u32 v30, 2176, v30
  v_add_u32 v30, 8064, v30
  buffer_load_dword v25, v30, s[64:67], s44 offen
  s_mov_b32 s31, 1
  s_bitcmp1_b32 s47, 1
  s_cbranch_scc0 L_slow1
  s_branch L_loop
L_attB:
  ds_read_b128 v[160:163], v236 offset:32768
  ds_read_b128 v[164:167], v236 offset:33792
  ds_read_b128 v[168:171], v236 offset:34816
  ds_read_b128 v[172:175], v236 offset:35840
  ds_read_b128 v[176:179], v236 offset:36864
  ds_read_b128 v[180:183], v236 offset:37888
  ds_read_b128 v[184:187], v236 offset:38912
  ds_read_b128 v[188:191], v236 offset:39936
  ds_read_b128 a[176:179], v236 offset:49152
  ds_read_b128 a[180:183], v236 offset:50176
  ds_read_b128 a[184:187], v236 offset:51200
  ds_read_b128 a[188:191], v236 offset:52224
  ds_read_b128 a[192:195], v236 offset:53248
  ds_read_b128 a[196:199], v236 offset:54272
  ds_read_b128 a[200:203], v236 offset:55296
  ds_read_b128 a[204:207], v236 offset:56320
  s_cmp_lg_u32 s39, 0
  s_cbranch_scc1 L_haveB
  s_waitcnt lgkmcnt(8)
  v_mfma_f32_16x16x32_bf16 v[56:59], v[160:163], v[112:115], 0
  v_mfma_f32_16x16x32_bf16 v[60:63], v[176:179], v[112:115], 0
  v_mfma_f32_16x16x32_bf16 v[56:59], v[164:167], v[116:119], v[56:59]
  v_mfma_f32_16x16x32_bf16 v[60:63], v[180:183], v[116:119], v[60:63]
  v_mfma_f32_16x16x32_bf16 v[56:59], v[168:171], v[120:123], v[56:59]
  v_mfma_f32_16x16x32_bf16 v[60:63], v[184:187], v[120:123], v[60:63]
  v_mfma_f32_16x16x32_bf16 v[56:59], v[172:175], v[124:127], v[56:59]
  v_mfma_f32_16x16x32_bf16 v[60:63], v[188:191], v[124:127], v[60:63]
  v_mfma_f32_16x16x32_bf16 v[48:51], v[160:163], v[96:99], 0
  v_mfma_f32_16x16x32_bf16 v[52:55], v[176:179], v[96:99], 0
  v_mfma_f32_16x16x32_bf16 v[48:51], v[164:167], v[100:103], v[48:51]
  v_mfma_f32_16x16x32_bf16 v[52:55], v[180:183], v[100:103], v[52:55]
  v_mfma_f32_16x16x32_bf16 v[48:51], v[168:171], v[104:107], v[48:51]
  v_mfma_f32_16x16x32_bf16 v[52:55], v[184:187], v[104:107], v[52:55]
  v_mfma_f32_16x16x32_bf16 v[48:51], v[172:175], v[108:111], v[48:51]
  v_mfma_f32_16x16x32_bf16 v[52:55], v[188:191], v[108:111], v[52:55]
  v_mfma_f32_16x16x32_bf16 v[40:43], v[160:163], v[80:83], 0
  v_mfma_f32_16x16x32_bf16 v[44:47], v[176:179], v[80:83], 0
  v_mfma_f32_16x16x32_bf16 v[40:43], v[164:167], v[84:87], v[40:43]
  v_mfma_f32_16x16x32_bf16 v[44:47], v[180:183], v[84:87], v[44:47]
  v_mfma_f32_16x16x32_bf16 v[40:43], v[168:171], v[88:91], v[40:43]
  v_mfma_f32_16x16x32_bf16 v[44:47], v[184:187], v[88:91], v[44:47]
  v_mfma_f32_16x16x32_bf16 v[40:43], v[172:175], v[92:95], v[40:43]
  v_mfma_f32_16x16x32_bf16 v[44:47], v[188:191], v[92:95], v[44:47]
  v_mfma_f32_16x16x32_bf16 v[32:35], v[160:163], v[64:67], 0
  v_mfma_f32_16x16x32_bf16 v[36:39], v[176:179], v[64:67], 0
  v_mfma_f32_16x16x32_bf16 v[32:35], v[164:167], v[68:71], v[32:35]
  v_mfma_f32_16x16x32_bf16 v[36:39], v[180:183], v[68:71], v[36:39]
  v_mfma_f32_16x16x32_bf16 v[32:35], v[168:171], v[72:75], v[32:35]
  v_mfma_f32_16x16x32_bf16 v[36:39], v[184:187], v[72:75], v[36:39]
  v_mfma_f32_16x16x32_bf16 v[32:35], v[172:175], v[76:79], v[32:35]
  v_mfma_f32_16x16x32_bf16 v[36:39], v[188:191], v[76:79], v[36:39]
  v_max3_f32 v228, v56, v57, v58
  v_max3_f32 v229, v59, v60, v61
  v_max3_f32 v228, v228, v62, v63
  v_max_f32 v228, v228, v229
  v_max3_f32 v224, v48, v49, v50
  v_max3_f32 v225, v51, v52, v53
  v_max3_f32 v224, v224, v54, v55
  v_max_f32 v224, v224, v225
  v_max3_f32 v220, v40, v41, v42
  v_max3_f32 v221, v43, v44, v45
  v_max3_f32 v220, v220, v46, v47
  v_max_f32 v220, v220, v221
  v_max3_f32 v216, v32, v33, v34
  v_max3_f32 v217, v35, v36, v37
  v_max3_f32 v216, v216, v38, v39
  v_max_f32 v216, v216, v217
  v_mov_b32 v217, v216
  v_mov_b32 v221, v220
  v_mov_b32 v225, v224
  v_mov_b32 v229, v228
  v_permlane32_swap_b32 v216, v217
  v_permlane32_swap_b32 v220, v221
  v_permlane32_swap_b32 v224, v225
  v_permlane32_swap_b32 v228, v229
  v_max_f32 v216, v216, v217
  v_max_f32 v220, v220, v221
  v_max_f32 v224, v224, v225
  v_max_f32 v228, v228, v229
  v_mov_b32 v217, v216
  v_mov_b32 v221, v220
  v_mov_b32 v225, v224
  v_mov_b32 v229, v228
  v_permlane16_swap_b32 v216, v217
  v_permlane16_swap_b32 v220, v221
  v_permlane16_swap_b32 v224, v225
  v_permlane16_swap_b32 v228, v229
  v_max_f32 v216, v216, v217
  v_max_f32 v220, v220, v221
  v_max_f32 v224, v224, v225
  v_max_f32 v228, v228, v229
  v_sub_f32 v217, 0, v216
  v_sub_f32 v218, 0, v216
  v_sub_f32 v219, 0, v216
  v_sub_f32 v216, 0, v216
  v_sub_f32 v221, 0, v220
  v_sub_f32 v222, 0, v220
  v_sub_f32 v223, 0, v220
  v_sub_f32 v220, 0, v220
  v_sub_f32 v225, 0, v224
  v_sub_f32 v226, 0, v224
  v_sub_f32 v227, 0, v224
  v_sub_f32 v224, 0, v224
  v_sub_f32 v229, 0, v228
  v_sub_f32 v230, 0, v228
  v_sub_f32 v231, 0, v228
  v_sub_f32 v228, 0, v228
L_haveB:
  v_mov_b32 v6, 4048155338
  s_and_b32 s33, s30, 1
  s_cmp_eq_u32 s33, 0
  s_cselect_b64 s[56:57], s[48:49], 0
  v_cndmask_b32 v32, v216, v6, s[56:57]
  v_cndmask_b32 v48, v224, v6, s[56:57]
  s_cselect_b64 s[56:57], s[50:51], 0
  v_cndmask_b32 v33, v216, v6, s[56:57]
  v_cndmask_b32 v49, v224, v6, s[56:57]
  s_cselect_b64 s[56:57], s[52:53], 0
  v_cndmask_b32 v34, v216, v6, s[56:57]
  v_cndmask_b32 v50, v224, v6, s[56:57]
  s_cselect_b64 s[56:57], s[54:55], 0
  v_cndmask_b32 v35, v216, v6, s[56:57]
  v_cndmask_b32 v51, v224, v6, s[56:57]
  s_cselect_b64 s[56:57], -1, s[48:49]
  v_cndmask_b32 v36, v216, v6, s[56:57]
  v_cndmask_b32 v52, v224, v6, s[56:57]
  s_cselect_b64 s[56:57], -1, s[50:51]
  v_cndmask_b32 v37, v216, v6, s[56:57]
  v_cndmask_b32 v53, v224, v6, s[56:57]
  s_cselect_b64 s[56:57], -1, s[52:53]
  v_cndmask_b32 v38, v216, v6, s[56:57]
  v_cndmask_b32 v54, v224, v6, s[56:57]
  s_cselect_b64 s[56:57], -1, s[54:55]
  v_cndmask_b32 v39, v216, v6, s[56:57]
  v_cndmask_b32 v55, v224, v6, s[56:57]
  s_cmp_eq_u32 s33, 1
  s_cselect_b64 s[56:57], s[48:49], 0
  v_cndmask_b32 v40, v220, v6, s[56:57]
  v_cndmask_b32 v56, v228, v6, s[56:57]
  s_cselect_b64 s[56:57], s[50:51], 0
  v_cndmask_b32 v41, v220, v6, s[56:57]
  v_cndmask_b32 v57, v228, v6, s[56:57]
  s_cselect_b64 s[56:57], s[52:53], 0
  v_cndmask_b32 v42, v220, v6, s[56:57]
  v_cndmask_b32 v58, v228, v6, s[56:57]
  s_cselect_b64 s[56:57], s[54:55], 0
  v_cndmask_b32 v43, v220, v6, s[56:57]
  v_cndmask_b32 v59, v228, v6, s[56:57]
  s_cselect_b64 s[56:57], -1, s[48:49]
  v_cndmask_b32 v44, v220, v6, s[56:57]
  v_cndmask_b32 v60, v228, v6, s[56:57]
  s_cselect_b64 s[56:57], -1, s[50:51]
  v_cndmask_b32 v45, v220, v6, s[56:57]
  v_cndmask_b32 v61, v228, v6, s[56:57]
  s_cselect_b64 s[56:57], -1, s[52:53]
  v_cndmask_b32 v46, v220, v6, s[56:57]
  v_cndmask_b32 v62, v228, v6, s[56:57]
  s_cselect_b64 s[56:57], -1, s[54:55]
  v_cndmask_b32 v47, v220, v6, s[56:57]
  v_cndmask_b32 v63, v228, v6, s[56:57]
  s_waitcnt lgkmcnt(8)
  v_mfma_f32_16x16x32_bf16 v[240:243], v[160:163], v[112:115], v[228:231]
  v_mfma_f32_16x16x32_bf16 v[244:247], v[176:179], v[112:115], v[228:231]
  v_mfma_f32_16x16x32_bf16 v[240:243], v[164:167], v[116:119], v[240:243]
  v_mfma_f32_16x16x32_bf16 v[244:247], v[180:183], v[116:119], v[244:247]
  v_mfma_f32_16x16x32_bf16 v[240:243], v[168:171], v[120:123], v[240:243]
  v_mfma_f32_16x16x32_bf16 v[244:247], v[184:187], v[120:123], v[244:247]
  v_mfma_f32_16x16x32_bf16 v[240:243], v[172:175], v[124:127], v[240:243]
  v_mfma_f32_16x16x32_bf16 v[244:247], v[188:191], v[124:127], v[244:247]
  v_mfma_f32_16x16x32_bf16 v[248:251], v[160:163], v[96:99], v[224:227]
  s_nop 5
  v_exp_f32 v240, v240
  v_mfma_f32_16x16x32_bf16 v[252:255], v[176:179], v[96:99], v[224:227]
  v_exp_f32 v241, v241
  v_mfma_f32_16x16x32_bf16 v[248:251], v[164:167], v[100:103], v[248:251]
  v_exp_f32 v242, v242
  v_mfma_f32_16x16x32_bf16 v[252:255], v[180:183], v[100:103], v[252:255]
  v_exp_f32 v243, v243
  v_mfma_f32_16x16x32_bf16 v[248:251], v[168:171], v[104:107], v[248:251]
  v_exp_f32 v244, v244
  v_mfma_f32_16x16x32_bf16 v[252:255], v[184:187], v[104:107], v[252:255]
  v_exp_f32 v245, v245
  v_mfma_f32_16x16x32_bf16 v[248:251], v[172:175], v[108:111], v[248:251]
  v_exp_f32 v246, v246
  v_mfma_f32_16x16x32_bf16 v[252:255], v[188:191], v[108:111], v[252:255]
  v_exp_f32 v247, v247
  ds_read_b128 v[128:131], v236 offset:40960
  ds_read_b128 v[132:135], v236 offset:41984
  ds_read_b128 v[136:139], v236 offset:43008
  ds_read_b128 v[140:143], v236 offset:44032
  v_add_f32 v235, v235, v240
  v_add_f32 v235, v235, v241
  v_cvt_pk_bf16_f32 v208, v240, v241
  v_add_f32 v235, v235, v242
  v_add_f32 v235, v235, v243
  v_cvt_pk_bf16_f32 v209, v242, v243
  v_add_f32 v235, v235, v244
  v_add_f32 v235, v235, v245
  v_cvt_pk_bf16_f32 v210, v244, v245
  v_mfma_f32_16x16x32_bf16 v[192:195], v[160:163], v[80:83], v[220:223]
  ds_read_b128 v[144:147], v236 offset:45056
  v_add_f32 v235, v235, v246
  v_mfma_f32_16x16x32_bf16 v[196:199], v[176:179], v[80:83], v[220:223]
  v_exp_f32 v248, v248
  v_mfma_f32_16x16x32_bf16 v[192:195], v[164:167], v[84:87], v[192:195]
  ds_read_b128 v[148:151], v236 offset:46080
  v_add_f32 v235, v235, v247
  v_mfma_f32_16x16x32_bf16 v[196:199], v[180:183], v[84:87], v[196:199]
  v_exp_f32 v249, v249
  v_mfma_f32_16x16x32_bf16 v[192:195], v[168:171], v[88:91], v[192:195]
  ds_read_b128 v[152:155], v236 offset:47104
  v_cvt_pk_bf16_f32 v211, v246, v247
  v_mfma_f32_16x16x32_bf16 v[196:199], v[184:187], v[88:91], v[196:199]
  v_exp_f32 v250, v250
  v_mfma_f32_16x16x32_bf16 v[192:195], v[172:175], v[92:95], v[192:195]
  ds_read_b128 v[156:159], v236 offset:48128
  v_add_f32 v234, v234, v248
  v_mfma_f32_16x16x32_bf16 v[196:199], v[188:191], v[92:95], v[196:199]
  s_waitcnt lgkmcnt(4)
  v_add_f32 v234, v234, v249
  v_cvt_pk_bf16_f32 v212, v248, v249
  v_mfma_f32_16x16x32_bf16 a[12:15], a[176:179], v[208:211], 0
  v_exp_f32 v251, v251
  v_mfma_f32_16x16x32_bf16 a[28:31], a[180:183], v[208:211], 0
  v_add_f32 v234, v234, v250
  v_add_f32 v234, v234, v251
  v_mfma_f32_16x16x32_bf16 a[44:47], a[184:187], v[208:211], 0
  v_exp_f32 v252, v252
  v_mfma_f32_16x16x32_bf16 a[60:63], a[188:191], v[208:211], 0
  v_cvt_pk_bf16_f32 v213, v250, v251
  v_add_f32 v234, v234, v252
  v_mfma_f32_16x16x32_bf16 a[76:79], a[192:195], v[208:211], 0
  v_exp_f32 v253, v253
  v_mfma_f32_16x16x32_bf16 a[92:95], a[196:199], v[208:211], 0
  v_add_f32 v234, v234, v253
  v_cvt_pk_bf16_f32 v214, v252, v253
  v_mfma_f32_16x16x32_bf16 a[108:111], a[200:203], v[208:211], 0
  v_exp_f32 v254, v254
  v_mfma_f32_16x16x32_bf16 a[124:127], a[204:207], v[208:211], 0
  v_exp_f32 v255, v255
  v_mfma_f32_16x16x32_bf16 v[200:203], v[160:163], v[64:67], v[216:219]
  ds_read_b128 a[144:147], v236 offset:57344
  v_add_f32 v234, v234, v254
  v_mfma_f32_16x16x32_bf16 v[204:207], v[176:179], v[64:67], v[216:219]
  v_exp_f32 v192, v192
  v_mfma_f32_16x16x32_bf16 v[200:203], v[164:167], v[68:71], v[200:203]
  ds_read_b128 a[148:151], v236 offset:58368
  v_add_f32 v234, v234, v255
  v_mfma_f32_16x16x32_bf16 v[204:207], v[180:183], v[68:71], v[204:207]
  v_exp_f32 v193, v193
  v_mfma_f32_16x16x32_bf16 v[200:203], v[168:171], v[72:75], v[200:203]
  ds_read_b128 a[152:155], v236 offset:59392
  v_cvt_pk_bf16_f32 v215, v254, v255
  v_mfma_f32_16x16x32_bf16 v[204:207], v[184:187], v[72:75], v[204:207]
  v_exp_f32 v194, v194
  v_mfma_f32_16x16x32_bf16 v[200:203], v[172:175], v[76:79], v[200:203]
  ds_read_b128 a[156:159], v236 offset:60416
  v_add_f32 v233, v233, v192
  v_mfma_f32_16x16x32_bf16 v[204:207], v[188:191], v[76:79], v[204:207]
  v_add_f32 v233, v233, v193
  v_cvt_pk_bf16_f32 v208, v192, v193
  v_mfma_f32_16x16x32_bf16 a[8:11], a[176:179], v[212:215], 0
  v_exp_f32 v195, v195
  v_mfma_f32_16x16x32_bf16 a[24:27], a[180:183], v[212:215], 0
  v_add_f32 v233, v233, v194
  v_add_f32 v233, v233, v195
  v_mfma_f32_16x16x32_bf16 a[40:43], a[184:187], v[212:215], 0
  v_exp_f32 v196, v196
  v_mfma_f32_16x16x32_bf16 a[56:59], a[188:191], v[212:215], 0
  v_cvt_pk_bf16_f32 v209, v194, v195
  v_add_f32 v233, v233, v196
  v_mfma_f32_16x16x32_bf16 a[72:75], a[192:195], v[212:215], 0
  v_exp_f32 v197, v197
  v_mfma_f32_16x16x32_bf16 a[88:91], a[196:199], v[212:215], 0
  v_add_f32 v233, v233, v197
  v_cvt_pk_bf16_f32 v210, v196, v197
  v_mfma_f32_16x16x32_bf16 a[104:107], a[200:203], v[212:215], 0
  v_exp_f32 v198, v198
  v_mfma_f32_16x16x32_bf16 a[120:123], a[204:207], v[212:215], 0
  v_exp_f32 v199, v199
  s_waitcnt vmcnt(0)
  s_barrier
  v_mfma_f32_16x16x32_bf16 v[240:243], v[128:131], v[112:115], v[228:231]
  s_waitcnt lgkmcnt(0)
  ds_read_b128 a[160:163], v236 offset:61440
  v_add_f32 v233, v233, v198
  v_mfma_f32_16x16x32_bf16 v[244:247], v[144:147], v[112:115], v[228:231]
  v_exp_f32 v200, v200
  v_mfma_f32_16x16x32_bf16 v[240:243], v[132:135], v[116:119], v[240:243]
  ds_read_b128 a[164:167], v236 offset:62464
  v_add_f32 v233, v233, v199
  v_mfma_f32_16x16x32_bf16 v[244:247], v[148:151], v[116:119], v[244:247]
  v_exp_f32 v201, v201
  v_mfma_f32_16x16x32_bf16 v[240:243], v[136:139], v[120:123], v[240:243]
  ds_read_b128 a[168:171], v236 offset:63488
  v_cvt_pk_bf16_f32 v211, v198, v199
  v_mfma_f32_16x16x32_bf16 v[244:247], v[152:155], v[120:123], v[244:247]
  v_exp_f32 v202, v202
  v_mfma_f32_16x16x32_bf16 v[240:243], v[140:143], v[124:127], v[240:243]
  ds_read_b128 a[172:175], v236 offset:64512
  v_add_f32 v232, v232, v200
  v_mfma_f32_16x16x32_bf16 v[244:247], v[156:159], v[124:127], v[244:247]
  v_add_f32 v232, v232, v201
  v_cvt_pk_bf16_f32 v212, v200, v201
  v_mfma_f32_16x16x32_bf16 a[4:7], a[176:179], v[208:211], 0
  v_and_b32 v29, 31, v2
  v_add_f32 v232, v232, v202
  v_mfma_f32_16x16x32_bf16 a[20:23], a[180:183], v[208:211], 0
  v_lshlrev_b32 v29, 2, v29
  v_mfma_f32_16x16x32_bf16 a[36:39], a[184:187], v[208:211], 0
  v_exp_f32 v203, v203
  v_mfma_f32_16x16x32_bf16 a[52:55], a[188:191], v[208:211], 0
  v_add_f32 v232, v232, v203
  v_cvt_pk_bf16_f32 v213, v202, v203
  v_mfma_f32_16x16x32_bf16 a[68:71], a[192:195], v[208:211], 0
  v_exp_f32 v204, v204
  v_mfma_f32_16x16x32_bf16 a[84:87], a[196:199], v[208:211], 0
  v_exp_f32 v205, v205
  v_mfma_f32_16x16x32_bf16 a[100:103], a[200:203], v[208:211], 0
  v_exp_f32 v206, v206
  v_mfma_f32_16x16x32_bf16 a[116:119], a[204:207], v[208:211], 0
  v_exp_f32 v207, v207
  v_add_f32 v232, v232, v204
  v_add_f32 v232, v232, v205
  v_cvt_pk_bf16_f32 v214, v204, v205
  v_mfma_f32_16x16x32_bf16 v[248:251], v[128:131], v[96:99], v[224:227]
  s_add_u32 s12, s6, 33554432
  ds_read_b128 v[160:163], v237 offset:0
  v_add_f32 v232, v232, v206
  v_mfma_f32_16x16x32_bf16 v[252:255], v[144:147], v[96:99], v[224:227]
  s_addc_u32 s13, s7, 0
  v_exp_f32 v240, v240
  v_mfma_f32_16x16x32_bf16 v[248:251], v[132:135], v[100:103], v[248:251]
  s_and_b32 s13, s13, 0xffff
  ds_read_b128 v[164:167], v237 offset:1024
  v_add_f32 v232, v232, v207
  v_mfma_f32_16x16x32_bf16 v[252:255], v[148:151], v[100:103], v[252:255]
  s_mov_b32 s14, 19398656
  v_exp_f32 v241, v241
  v_mfma_f32_16x16x32_bf16 v[248:251], v[136:139], v[104:107], v[248:251]
  s_mov_b32 s15, 0x20000
  ds_read_b128 v[168:171], v237 offset:2048
  v_cvt_pk_bf16_f32 v215, v206, v207
  v_mfma_f32_16x16x32_bf16 v[252:255], v[152:155], v[104:107], v[252:255]
  s_mov_b32 s58, 1075839072
  v_exp_f32 v242, v242
  v_mfma_f32_16x16x32_bf16 v[248:251], v[140:143], v[108:111], v[248:251]
  s_mov_b32 s59, 4294934783
  ds_read_b128 v[172:175], v237 offset:3072
  v_add_f32 v235, v235, v240
  v_mfma_f32_16x16x32_bf16 v[252:255], v[156:159], v[108:111], v[252:255]
  s_lshl_b32 s60, s29, 3
  v_add_f32 v235, v235, v241
  v_cvt_pk_bf16_f32 v208, v240, v241
  v_mfma_f32_16x16x32_bf16 a[0:3], a[176:179], v[212:215], 0
  s_lshr_b64 s[58:59], s[58:59], s60
  v_exp_f32 v243, v243
  v_mfma_f32_16x16x32_bf16 a[16:19], a[180:183], v[212:215], 0
  s_and_b32 s3, s58, 255
  v_add_f32 v235, v235, v242
  v_add_f32 v235, v235, v243
  v_mfma_f32_16x16x32_bf16 a[32:35], a[184:187], v[212:215], 0
  s_add_u32 s3, s3, s28
  v_exp_f32 v244, v244
  v_mfma_f32_16x16x32_bf16 a[48:51], a[188:191], v[212:215], 0
  v_cvt_pk_bf16_f32 v209, v242, v243
  v_add_f32 v235, v235, v244
  v_mfma_f32_16x16x32_bf16 a[64:67], a[192:195], v[212:215], 0
  v_exp_f32 v245, v245
  v_mfma_f32_16x16x32_bf16 a[80:83], a[196:199], v[212:215], 0
  v_add_f32 v235, v235, v245
  v_cvt_pk_bf16_f32 v210, v244, v245
  v_mfma_f32_16x16x32_bf16 a[96:99], a[200:203], v[212:215], 0
  v_exp_f32 v246, v246
  v_mfma_f32_16x16x32_bf16 a[112:115], a[204:207], v[212:215], 0
  v_exp_f32 v247, v247
  v_mfma_f32_16x16x32_bf16 v[192:195], v[128:131], v[80:83], v[220:223]
  s_cmp_lt_u32 s3, 128
  ds_read_b128 v[176:179], v237 offset:4096
  v_add_f32 v235, v235, v246
  v_mfma_f32_16x16x32_bf16 v[196:199], v[144:147], v[80:83], v[220:223]
  s_cselect_b32 s64, s68, s96
  v_exp_f32 v248, v248
  v_mfma_f32_16x16x32_bf16 v[192:195], v[132:135], v[84:87], v[192:195]
  s_cselect_b32 s65, s69, s97
  ds_read_b128 v[180:183], v237 offset:5120
  v_add_f32 v235, v235, v247
  v_mfma_f32_16x16x32_bf16 v[196:199], v[148:151], v[84:87], v[196:199]
  s_mov_b32 s60, 819200
  v_exp_f32 v249, v249
  v_mfma_f32_16x16x32_bf16 v[192:195], v[136:139], v[88:91], v[192:195]
  s_cselect_b32 s66, 5242880, s60
  ds_read_b128 v[184:187], v237 offset:6144
  v_cvt_pk_bf16_f32 v211, v246, v247
  v_mfma_f32_16x16x32_bf16 v[196:199], v[152:155], v[88:91], v[196:199]
  s_cselect_b32 s60, 0, 128
  v_exp_f32 v250, v250
  v_mfma_f32_16x16x32_bf16 v[192:195], v[140:143], v[92:95], v[192:195]
  s_and_b32 s65, s65, 0xffff
  ds_read_b128 v[188:191], v237 offset:7168
  v_add_f32 v234, v234, v248
  v_mfma_f32_16x16x32_bf16 v[196:199], v[156:159], v[92:95], v[196:199]
  s_mov_b32 s67, 0x20000
  v_add_f32 v234, v234, v249
  v_cvt_pk_bf16_f32 v212, v248, v249
  v_mfma_f32_16x16x32_bf16 a[12:15], a[144:147], v[208:211], a[12:15]
  s_sub_u32 s60, s3, s60
  v_exp_f32 v251, v251
  v_mfma_f32_16x16x32_bf16 a[28:31], a[148:151], v[208:211], a[28:31]
  s_min_u32 s60, s60, 200
  v_add_f32 v234, v234, v250
  v_add_f32 v234, v234, v251
  v_mfma_f32_16x16x32_bf16 a[44:47], a[152:155], v[208:211], a[44:47]
  s_mul_i32 s44, s60, 40960
  v_exp_f32 v252, v252
  v_mfma_f32_16x16x32_bf16 a[60:63], a[156:159], v[208:211], a[60:63]
  s_mul_i32 s60, s30, 10240
  v_cvt_pk_bf16_f32 v213, v250, v251
  v_add_f32 v234, v234, v252
  s_waitcnt lgkmcnt(1)
  v_mfma_f32_16x16x32_bf16 a[76:79], a[160:163], v[208:211], a[76:79]
  s_add_u32 s44, s44, s60
  v_exp_f32 v253, v253
  v_mfma_f32_16x16x32_bf16 a[92:95], a[164:167], v[208:211], a[92:95]
  v_add_f32 v234, v234, v253
  v_cvt_pk_bf16_f32 v214, v252, v253
  v_mfma_f32_16x16x32_bf16 a[108:111], a[168:171], v[208:211], a[108:111]
  v_exp_f32 v254, v254
  v_mfma_f32_16x16x32_bf16 a[124:127], a[172:175], v[208:211], a[124:127]
  v_exp_f32 v255, v255
  v_mfma_f32_16x16x32_bf16 v[200:203], v[128:131], v[64:67], v[32:35]
  ds_read_b128 a[176:179], v237 offset:16384
  v_add_f32 v234, v234, v254
  v_mfma_f32_16x16x32_bf16 v[204:207], v[144:147], v[64:67], v[36:39]
  v_exp_f32 v192, v192
  v_mfma_f32_16x16x32_bf16 v[200:203], v[132:135], v[68:71], v[200:203]
  ds_read_b128 a[180:183], v237 offset:17408
  v_add_f32 v234, v234, v255
  v_mfma_f32_16x16x32_bf16 v[204:207], v[148:151], v[68:71], v[204:207]
  v_exp_f32 v193, v193
  v_mfma_f32_16x16x32_bf16 v[200:203], v[136:139], v[72:75], v[200:203]
  ds_read_b128 a[184:187], v237 offset:18432
  v_cvt_pk_bf16_f32 v215, v254, v255
  v_mfma_f32_16x16x32_bf16 v[204:207], v[152:155], v[72:75], v[204:207]
  v_exp_f32 v194, v194
  v_mfma_f32_16x16x32_bf16 v[200:203], v[140:143], v[76:79], v[200:203]
  ds_read_b128 a[188:191], v237 offset:19456
  v_add_f32 v233, v233, v192
  v_mfma_f32_16x16x32_bf16 v[204:207], v[156:159], v[76:79], v[204:207]
  v_add_f32 v233, v233, v193
  v_cvt_pk_bf16_f32 v208, v192, v193
  v_mfma_f32_16x16x32_bf16 a[8:11], a[144:147], v[212:215], a[8:11]
  v_exp_f32 v195, v195
  v_mfma_f32_16x16x32_bf16 a[24:27], a[148:151], v[212:215], a[24:27]
  v_add_f32 v233, v233, v194
  v_add_f32 v233, v233, v195
  v_mfma_f32_16x16x32_bf16 a[40:43], a[152:155], v[212:215], a[40:43]
  v_exp_f32 v196, v196
  v_mfma_f32_16x16x32_bf16 a[56:59], a[156:159], v[212:215], a[56:59]
  v_cvt_pk_bf16_f32 v209, v194, v195
  v_add_f32 v233, v233, v196
  v_mfma_f32_16x16x32_bf16 a[72:75], a[160:163], v[212:215], a[72:75]
  v_exp_f32 v197, v197
  v_mfma_f32_16x16x32_bf16 a[88:91], a[164:167], v[212:215], a[88:91]
  v_add_f32 v233, v233, v197
  v_cvt_pk_bf16_f32 v210, v196, v197
  v_mfma_f32_16x16x32_bf16 a[104:107], a[168:171], v[212:215], a[104:107]
  v_exp_f32 v198, v198
  v_mfma_f32_16x16x32_bf16 a[120:123], a[172:175], v[212:215], a[120:123]
  v_exp_f32 v199, v199
  v_mfma_f32_16x16x32_bf16 v[240:243], v[160:163], v[112:115], v[228:231]
  ds_read_b128 a[192:195], v237 offset:20480
  v_add_f32 v233, v233, v198
  v_mfma_f32_16x16x32_bf16 v[244:247], v[176:179], v[112:115], v[228:231]
  ds_read_b128 a[196:199], v237 offset:21504
  v_add_f32 v233, v233, v199
  v_mfma_f32_16x16x32_bf16 v[240:243], v[164:167], v[116:119], v[240:243]
  ds_read_b128 a[200:203], v237 offset:22528
  v_cvt_pk_bf16_f32 v211, v198, v199
  v_mfma_f32_16x16x32_bf16 v[244:247], v[180:183], v[116:119], v[244:247]
  ds_read_b128 a[204:207], v237 offset:23552
  v_mfma_f32_16x16x32_bf16 v[240:243], v[168:171], v[120:123], v[240:243]
  ds_read_b128 v[128:131], v237 offset:8192
  v_mfma_f32_16x16x32_bf16 v[244:247], v[184:187], v[120:123], v[244:247]
  ds_read_b128 v[132:135], v237 offset:9216
  v_mfma_f32_16x16x32_bf16 v[240:243], v[172:175], v[124:127], v[240:243]
  s_waitcnt lgkmcnt(6)
  ds_read_b128 v[136:139], v237 offset:10240
  v_mfma_f32_16x16x32_bf16 v[244:247], v[188:191], v[124:127], v[244:247]
  ds_read_b128 v[140:143], v237 offset:11264
  v_mfma_f32_16x16x32_bf16 a[4:7], a[144:147], v[208:211], a[4:7]
  v_exp_f32 v200, v200
  v_mfma_f32_16x16x32_bf16 a[20:23], a[148:151], v[208:211], a[20:23]
  v_exp_f32 v201, v201
  v_mfma_f32_16x16x32_bf16 a[36:39], a[152:155], v[208:211], a[36:39]
  v_exp_f32 v202, v202
  v_mfma_f32_16x16x32_bf16 a[52:55], a[156:159], v[208:211], a[52:55]
  v_exp_f32 v203, v203
  v_mfma_f32_16x16x32_bf16 a[68:71], a[160:163], v[208:211], a[68:71]
  v_exp_f32 v204, v204
  v_mfma_f32_16x16x32_bf16 a[84:87], a[164:167], v[208:211], a[84:87]
  v_exp_f32 v205, v205
  v_mfma_f32_16x16x32_bf16 a[100:103], a[168:171], v[208:211], a[100:103]
  v_exp_f32 v206, v206
  v_mfma_f32_16x16x32_bf16 a[116:119], a[172:175], v[208:211], a[116:119]
  v_exp_f32 v207, v207
  v_add_f32 v232, v232, v200
  v_add_f32 v232, v232, v201
  v_cvt_pk_bf16_f32 v212, v200, v201
  v_add_f32 v232, v232, v202
  v_add_f32 v232, v232, v203
  v_cvt_pk_bf16_f32 v213, v202, v203
  v_add_f32 v232, v232, v204
  v_add_f32 v232, v232, v205
  v_cvt_pk_bf16_f32 v214, v204, v205
  v_mfma_f32_16x16x32_bf16 v[248:251], v[160:163], v[96:99], v[224:227]
  ds_read_b128 v[144:147], v237 offset:12288
  v_add_f32 v232, v232, v206
  v_mfma_f32_16x16x32_bf16 v[252:255], v[176:179], v[96:99], v[224:227]
  v_exp_f32 v240, v240
  v_mfma_f32_16x16x32_bf16 v[248:251], v[164:167], v[100:103], v[248:251]
  ds_read_b128 v[148:151], v237 offset:13312
  v_add_f32 v232, v232, v207
  v_mfma_f32_16x16x32_bf16 v[252:255], v[180:183], v[100:103], v[252:255]
  v_exp_f32 v241, v241
  v_mfma_f32_16x16x32_bf16 v[248:251], v[168:171], v[104:107], v[248:251]
  ds_read_b128 v[152:155], v237 offset:14336
  v_cvt_pk_bf16_f32 v215, v206, v207
  v_mfma_f32_16x16x32_bf16 v[252:255], v[184:187], v[104:107], v[252:255]
  v_exp_f32 v242, v242
  v_mfma_f32_16x16x32_bf16 v[248:251], v[172:175], v[108:111], v[248:251]
  ds_read_b128 v[156:159], v237 offset:15360
  v_add_f32 v235, v235, v240
  v_mfma_f32_16x16x32_bf16 v[252:255], v[188:191], v[108:111], v[252:255]
  v_add_f32 v235, v235, v241
  v_cvt_pk_bf16_f32 v208, v240, v241
  v_mfma_f32_16x16x32_bf16 a[0:3], a[144:147], v[212:215], a[0:3]
  v_exp_f32 v243, v243
  v_mfma_f32_16x16x32_bf16 a[16:19], a[148:151], v[212:215], a[16:19]
  v_add_f32 v235, v235, v242
  v_add_f32 v235, v235, v243
  v_mfma_f32_16x16x32_bf16 a[32:35], a[152:155], v[212:215], a[32:35]
  v_exp_f32 v244, v244
  v_mfma_f32_16x16x32_bf16 a[48:51], a[156:159], v[212:215], a[48:51]
  v_cvt_pk_bf16_f32 v209, v242, v243
  v_add_f32 v235, v235, v244
  v_mfma_f32_16x16x32_bf16 a[64:67], a[160:163], v[212:215], a[64:67]
  v_exp_f32 v245, v245
  v_mfma_f32_16x16x32_bf16 a[80:83], a[164:167], v[212:215], a[80:83]
  v_add_f32 v235, v235, v245
  v_cvt_pk_bf16_f32 v210, v244, v245
  v_mfma_f32_16x16x32_bf16 a[96:99], a[168:171], v[212:215], a[96:99]
  v_exp_f32 v246, v246
  v_mfma_f32_16x16x32_bf16 a[112:115], a[172:175], v[212:215], a[112:115]
  v_exp_f32 v247, v247
  s_waitcnt lgkmcnt(0)
  s_barrier
  v_mfma_f32_16x16x32_bf16 v[192:195], v[160:163], v[80:83], v[40:43]
  ds_read_b128 a[144:147], v237 offset:24576
  v_add_f32 v235, v235, v246
  v_mfma_f32_16x16x32_bf16 v[196:199], v[176:179], v[80:83], v[44:47]
  ds_read_b128 a[148:151], v237 offset:25600
  v_add_f32 v235, v235, v247
  v_mfma_f32_16x16x32_bf16 v[192:195], v[164:167], v[84:87], v[192:195]
  ds_read_b128 a[152:155], v237 offset:26624
  v_cvt_pk_bf16_f32 v211, v246, v247
  v_mfma_f32_16x16x32_bf16 v[196:199], v[180:183], v[84:87], v[196:199]
  ds_read_b128 a[156:159], v237 offset:27648
  v_mfma_f32_16x16x32_bf16 v[192:195], v[168:171], v[88:91], v[192:195]
  s_add_u32 m0, s36, 0
  v_exp_f32 v248, v248
  v_mfma_f32_16x16x32_bf16 v[196:199], v[184:187], v[88:91], v[196:199]
  buffer_load_dwordx4 v238, s[8:11], s35 offen offset:0 sc1 lds
  v_mfma_f32_16x16x32_bf16 v[192:195], v[172:175], v[92:95], v[192:195]
  buffer_load_dwordx4 v238, s[8:11], s35 offen offset:1024 sc1 lds
  v_mfma_f32_16x16x32_bf16 v[196:199], v[188:191], v[92:95], v[196:199]
  buffer_load_dwordx4 v238, s[8:11], s35 offen offset:2048 sc1 lds
  v_mfma_f32_16x16x32_bf16 a[12:15], a[176:179], v[208:211], a[12:15]
  v_exp_f32 v249, v249
  v_mfma_f32_16x16x32_bf16 a[28:31], a[180:183], v[208:211], a[28:31]
  v_add_f32 v234, v234, v248
  v_add_f32 v234, v234, v249
  v_mfma_f32_16x16x32_bf16 a[44:47], a[184:187], v[208:211], a[44:47]
  v_exp_f32 v250, v250
  v_mfma_f32_16x16x32_bf16 a[60:63], a[188:191], v[208:211], a[60:63]
  v_exp_f32 v251, v251
  v_mfma_f32_16x16x32_bf16 a[76:79], a[192:195], v[208:211], a[76:79]
  v_exp_f32 v252, v252
  v_mfma_f32_16x16x32_bf16 a[92:95], a[196:199], v[208:211], a[92:95]
  v_exp_f32 v253, v253
  v_mfma_f32_16x16x32_bf16 a[108:111], a[200:203], v[208:211], a[108:111]
  v_exp_f32 v254, v254
  v_mfma_f32_16x16x32_bf16 a[124:127], a[204:207], v[208:211], a[124:127]
  v_exp_f32 v255, v255
  v_cvt_pk_bf16_f32 v212, v248, v249
  v_add_f32 v234, v234, v250
  v_add_f32 v234, v234, v251
  v_cvt_pk_bf16_f32 v213, v250, v251
  v_add_f32 v234, v234, v252
  v_add_f32 v234, v234, v253
  v_cvt_pk_bf16_f32 v214, v252, v253
  v_mfma_f32_16x16x32_bf16 v[200:203], v[128:131], v[112:115], v[228:231]
  ds_read_b128 a[160:163], v237 offset:28672
  v_add_f32 v234, v234, v254
  v_mfma_f32_16x16x32_bf16 v[204:207], v[144:147], v[112:115], v[228:231]
  ds_read_b128 a[164:167], v237 offset:29696
  v_add_f32 v234, v234, v255
  v_mfma_f32_16x16x32_bf16 v[200:203], v[132:135], v[116:119], v[200:203]
  ds_read_b128 a[168:171], v237 offset:30720
  v_cvt_pk_bf16_f32 v215, v254, v255
  v_mfma_f32_16x16x32_bf16 v[204:207], v[148:151], v[116:119], v[204:207]
  ds_read_b128 a[172:175], v237 offset:31744
  v_mfma_f32_16x16x32_bf16 v[200:203], v[136:139], v[120:123], v[200:203]
  ds_read_b128 v[160:163], v237 offset:32768
  v_mfma_f32_16x16x32_bf16 v[204:207], v[152:155], v[120:123], v[204:207]
  ds_read_b128 v[164:167], v237 offset:33792
  v_mfma_f32_16x16x32_bf16 v[200:203], v[140:143], v[124:127], v[200:203]
  ds_read_b128 v[168:171], v237 offset:34816
  v_mfma_f32_16x16x32_bf16 v[204:207], v[156:159], v[124:127], v[204:207]
  ds_read_b128 v[172:175], v237 offset:35840
  v_mfma_f32_16x16x32_bf16 a[8:11], a[176:179], v[212:215], a[8:11]
  v_exp_f32 v192, v192
  v_mfma_f32_16x16x32_bf16 a[24:27], a[180:183], v[212:215], a[24:27]
  v_exp_f32 v193, v193
  v_mfma_f32_16x16x32_bf16 a[40:43], a[184:187], v[212:215], a[40:43]
  v_exp_f32 v194, v194
  v_mfma_f32_16x16x32_bf16 a[56:59], a[188:191], v[212:215], a[56:59]
  v_exp_f32 v195, v195
  v_mfma_f32_16x16x32_bf16 a[72:75], a[192:195], v[212:215], a[72:75]
  v_exp_f32 v196, v196
  v_mfma_f32_16x16x32_bf16 a[88:91], a[196:199], v[212:215], a[88:91]
  v_exp_f32 v197, v197
  v_mfma_f32_16x16x32_bf16 a[104:107], a[200:203], v[212:215], a[104:107]
  v_exp_f32 v198, v198
  v_mfma_f32_16x16x32_bf16 a[120:123], a[204:207], v[212:215], a[120:123]
  v_exp_f32 v199, v199
  buffer_load_dwordx4 v238, s[8:11], s35 offen offset:3072 sc1 lds
  s_add_u32 s35, s35, 4096
  s_add_u32 m0, s36, 4096
  s_nop 0
  buffer_load_dwordx4 v238, s[8:11], s35 offen offset:0 sc1 lds
  v_add_f32 v233, v233, v192
  v_add_f32 v233, v233, v193
  v_cvt_pk_bf16_f32 v208, v192, v193
  v_add_f32 v233, v233, v194
  v_add_f32 v233, v233, v195
  v_cvt_pk_bf16_f32 v209, v194, v195
  v_add_f32 v233, v233, v196
  v_add_f32 v233, v233, v197
  v_cvt_pk_bf16_f32 v210, v196, v197
  v_mfma_f32_16x16x32_bf16 v[240:243], v[128:131], v[96:99], v[224:227]
  ds_read_b128 v[176:179], v237 offset:36864
  v_add_f32 v233, v233, v198
  v_mfma_f32_16x16x32_bf16 v[244:247], v[144:147], v[96:99], v[224:227]
  ds_read_b128 v[180:183], v237 offset:37888
  v_add_f32 v233, v233, v199
  v_mfma_f32_16x16x32_bf16 v[240:243], v[132:135], v[100:103], v[240:243]
  ds_read_b128 v[184:187], v237 offset:38912
  v_cvt_pk_bf16_f32 v211, v198, v199
  v_mfma_f32_16x16x32_bf16 v[244:247], v[148:151], v[100:103], v[244:247]
  ds_read_b128 v[188:191], v237 offset:39936
  v_mfma_f32_16x16x32_bf16 v[240:243], v[136:139], v[104:107], v[240:243]
  buffer_load_dwordx4 v238, s[8:11], s35 offen offset:1024 sc1 lds
  v_mfma_f32_16x16x32_bf16 v[244:247], v[152:155], v[104:107], v[244:247]
  buffer_load_dwordx4 v238, s[8:11], s35 offen offset:2048 sc1 lds
  v_mfma_f32_16x16x32_bf16 v[240:243], v[140:143], v[108:111], v[240:243]
  buffer_load_dwordx4 v238, s[8:11], s35 offen offset:3072 sc1 lds
  v_mfma_f32_16x16x32_bf16 v[244:247], v[156:159], v[108:111], v[244:247]
  s_add_u32 s35, s35, 28672
  v_exp_f32 v200, v200
  v_mfma_f32_16x16x32_bf16 a[4:7], a[176:179], v[208:211], a[4:7]
  v_exp_f32 v201, v201
  v_mfma_f32_16x16x32_bf16 a[20:23], a[180:183], v[208:211], a[20:23]
  v_add_f32 v235, v235, v200
  v_add_f32 v235, v235, v201
  v_mfma_f32_16x16x32_bf16 a[36:39], a[184:187], v[208:211], a[36:39]
  v_exp_f32 v202, v202
  v_mfma_f32_16x16x32_bf16 a[52:55], a[188:191], v[208:211], a[52:55]
  v_exp_f32 v203, v203
  v_mfma_f32_16x16x32_bf16 a[68:71], a[192:195], v[208:211], a[68:71]
  v_exp_f32 v204, v204
  v_mfma_f32_16x16x32_bf16 a[84:87], a[196:199], v[208:211], a[84:87]
  v_exp_f32 v205, v205
  v_mfma_f32_16x16x32_bf16 a[100:103], a[200:203], v[208:211], a[100:103]
  v_exp_f32 v206, v206
  v_mfma_f32_16x16x32_bf16 a[116:119], a[204:207], v[208:211], a[116:119]
  v_exp_f32 v207, v207
  v_cvt_pk_bf16_f32 v212, v200, v201
  v_add_f32 v235, v235, v202
  v_add_f32 v235, v235, v203
  v_cvt_pk_bf16_f32 v213, v202, v203
  v_add_f32 v235, v235, v204
  v_add_f32 v235, v235, v205
  v_cvt_pk_bf16_f32 v214, v204, v205
  s_cmp_lg_u32 s29, 0
  s_cbranch_scc1 L_ntB
  v_lshlrev_b32 v30, 3, v236
  buffer_load_dword v24, v30, s[64:67], s44 offen
  v_min_u32 v30, 2176, v30
  v_add_u32 v30, 8064, v30
  buffer_load_dword v25, v30, s[64:67], s44 offen
L_ntB:
  s_waitcnt lgkmcnt(0)
  v_mfma_f32_16x16x32_bf16 v[248:251], v[160:163], v[112:115], v[228:231]
  ds_read_b128 a[176:179], v237 offset:49152
  v_add_f32 v235, v235, v206
  v_mfma_f32_16x16x32_bf16 v[252:255], v[176:179], v[112:115], v[228:231]
  ds_read_b128 a[180:183], v237 offset:50176
  v_add_f32 v235, v235, v207
  v_mfma_f32_16x16x32_bf16 v[248:251], v[164:167], v[116:119], v[248:251]
  ds_read_b128 a[184:187], v237 offset:51200
  v_cvt_pk_bf16_f32 v215, v206, v207
  v_mfma_f32_16x16x32_bf16 v[252:255], v[180:183], v[116:119], v[252:255]
  ds_read_b128 a[188:191], v237 offset:52224
  v_mfma_f32_16x16x32_bf16 v[248:251], v[168:171], v[120:123], v[248:251]
  ds_read_b128 v[128:131], v237 offset:40960
  v_mfma_f32_16x16x32_bf16 v[252:255], v[184:187], v[120:123], v[252:255]
  ds_read_b128 v[132:135], v237 offset:41984
  v_mfma_f32_16x16x32_bf16 v[248:251], v[172:175], v[124:127], v[248:251]
  ds_read_b128 v[136:139], v237 offset:43008
  v_mfma_f32_16x16x32_bf16 v[252:255], v[188:191], v[124:127], v[252:255]
  ds_read_b128 v[140:143], v237 offset:44032
  v_mfma_f32_16x16x32_bf16 a[12:15], a[144:147], v[212:215], a[12:15]
  s_add_u32 m0, s36, 32768
  v_exp_f32 v240, v240
  v_mfma_f32_16x16x32_bf16 a[28:31], a[148:151], v[212:215], a[28:31]
  v_exp_f32 v241, v241
  v_mfma_f32_16x16x32_bf16 a[44:47], a[152:155], v[212:215], a[44:47]
  v_exp_f32 v242, v242
  v_mfma_f32_16x16x32_bf16 a[60:63], a[156:159], v[212:215], a[60:63]
  v_exp_f32 v243, v243
  v_mfma_f32_16x16x32_bf16 a[76:79], a[160:163], v[212:215], a[76:79]
  v_exp_f32 v244, v244
  v_mfma_f32_16x16x32_bf16 a[92:95], a[164:167], v[212:215], a[92:95]
  v_exp_f32 v245, v245
  v_mfma_f32_16x16x32_bf16 a[108:111], a[168:171], v[212:215], a[108:111]
  v_exp_f32 v246, v246
  v_mfma_f32_16x16x32_bf16 a[124:127], a[172:175], v[212:215], a[124:127]
  v_exp_f32 v247, v247
  buffer_load_dwordx4 v238, s[8:11], s35 offen offset:0 sc1 lds
  buffer_load_dwordx4 v238, s[8:11], s35 offen offset:1024 sc1 lds
  v_add_f32 v234, v234, v240
  v_add_f32 v234, v234, v241
  v_cvt_pk_bf16_f32 v208, v240, v241
  v_add_f32 v234, v234, v242
  v_add_f32 v234, v234, v243
  v_cvt_pk_bf16_f32 v209, v242, v243
  v_add_f32 v234, v234, v244
  v_add_f32 v234, v234, v245
  v_cvt_pk_bf16_f32 v210, v244, v245
  v_mfma_f32_16x16x32_bf16 v[192:195], v[160:163], v[96:99], v[224:227]
  ds_read_b128 a[192:195], v237 offset:53248
  v_add_f32 v234, v234, v246
  v_mfma_f32_16x16x32_bf16 v[196:199], v[176:179], v[96:99], v[224:227]
  ds_read_b128 a[196:199], v237 offset:54272
  v_add_f32 v234, v234, v247
  v_mfma_f32_16x16x32_bf16 v[192:195], v[164:167], v[100:103], v[192:195]
  ds_read_b128 a[200:203], v237 offset:55296
  v_cvt_pk_bf16_f32 v211, v246, v247
  v_mfma_f32_16x16x32_bf16 v[196:199], v[180:183], v[100:103], v[196:199]
  ds_read_b128 a[204:207], v237 offset:56320
  v_mfma_f32_16x16x32_bf16 v[192:195], v[168:171], v[104:107], v[192:195]
  ds_read_b128 v[144:147], v237 offset:45056
  v_mfma_f32_16x16x32_bf16 v[196:199], v[184:187], v[104:107], v[196:199]
  ds_read_b128 v[148:151], v237 offset:46080
  v_mfma_f32_16x16x32_bf16 v[192:195], v[172:175], v[108:111], v[192:195]
  ds_read_b128 v[152:155], v237 offset:47104
  v_mfma_f32_16x16x32_bf16 v[196:199], v[188:191], v[108:111], v[196:199]
  ds_read_b128 v[156:159], v237 offset:48128
  v_mfma_f32_16x16x32_bf16 a[8:11], a[144:147], v[208:211], a[8:11]
  v_exp_f32 v248, v248
  v_mfma_f32_16x16x32_bf16 a[24:27], a[148:151], v[208:211], a[24:27]
  v_exp_f32 v249, v249
  v_mfma_f32_16x16x32_bf16 a[40:43], a[152:155], v[208:211], a[40:43]
  v_exp_f32 v250, v250
  v_mfma_f32_16x16x32_bf16 a[56:59], a[156:159], v[208:211], a[56:59]
  v_exp_f32 v251, v251
  v_mfma_f32_16x16x32_bf16 a[72:75], a[160:163], v[208:211], a[72:75]
  v_exp_f32 v252, v252
  v_mfma_f32_16x16x32_bf16 a[88:91], a[164:167], v[208:211], a[88:91]
  v_exp_f32 v253, v253
  v_mfma_f32_16x16x32_bf16 a[104:107], a[168:171], v[208:211], a[104:107]
  v_exp_f32 v254, v254
  v_mfma_f32_16x16x32_bf16 a[120:123], a[172:175], v[208:211], a[120:123]
  v_exp_f32 v255, v255
  buffer_load_dwordx4 v238, s[8:11], s35 offen offset:2048 sc1 lds
  buffer_load_dwordx4 v238, s[8:11], s35 offen offset:3072 sc1 lds
  s_add_u32 s35, s35, 4096
  v_add_f32 v235, v235, v248
  v_add_f32 v235, v235, v249
  v_cvt_pk_bf16_f32 v212, v248, v249
  v_add_f32 v235, v235, v250
  v_add_f32 v235, v235, v251
  v_cvt_pk_bf16_f32 v213, v250, v251
  v_add_f32 v235, v235, v252
  v_add_f32 v235, v235, v253
  v_cvt_pk_bf16_f32 v214, v252, v253
  s_waitcnt lgkmcnt(0)
  s_barrier
  v_mfma_f32_16x16x32_bf16 v[200:203], v[128:131], v[112:115], v[228:231]
  ds_read_b128 a[144:147], v237 offset:57344
  v_add_f32 v235, v235, v254
  v_mfma_f32_16x16x32_bf16 v[204:207], v[144:147], v[112:115], v[228:231]
  ds_read_b128 a[148:151], v237 offset:58368
  v_add_f32 v235, v235, v255
  v_mfma_f32_16x16x32_bf16 v[200:203], v[132:135], v[116:119], v[200:203]
  ds_read_b128 a[152:155], v237 offset:59392
  v_cvt_pk_bf16_f32 v215, v254, v255
  v_mfma_f32_16x16x32_bf16 v[204:207], v[148:151], v[116:119], v[204:207]
  ds_read_b128 a[156:159], v237 offset:60416
  v_mfma_f32_16x16x32_bf16 v[200:203], v[136:139], v[120:123], v[200:203]
  ds_read_b128 v[160:163], v239 offset:0
  v_mfma_f32_16x16x32_bf16 v[204:207], v[152:155], v[120:123], v[204:207]
  ds_read_b128 v[164:167], v239 offset:1024
  v_mfma_f32_16x16x32_bf16 v[200:203], v[140:143], v[124:127], v[200:203]
  ds_read_b128 v[168:171], v239 offset:2048
  v_mfma_f32_16x16x32_bf16 v[204:207], v[156:159], v[124:127], v[204:207]
  ds_read_b128 v[172:175], v239 offset:3072
  v_mfma_f32_16x16x32_bf16 a[12:15], a[176:179], v[212:215], a[12:15]
  s_add_u32 m0, s36, 36864
  v_exp_f32 v192, v192
  v_mfma_f32_16x16x32_bf16 a[28:31], a[180:183], v[212:215], a[28:31]
  v_exp_f32 v193, v193
  v_mfma_f32_16x16x32_bf16 a[44:47], a[184:187], v[212:215], a[44:47]
  v_exp_f32 v194, v194
  v_mfma_f32_16x16x32_bf16 a[60:63], a[188:191], v[212:215], a[60:63]
  v_exp_f32 v195, v195
  v_mfma_f32_16x16x32_bf16 a[76:79], a[192:195], v[212:215], a[76:79]
  v_exp_f32 v196, v196
  v_mfma_f32_16x16x32_bf16 a[92:95], a[196:199], v[212:215], a[92:95]
  v_exp_f32 v197, v197
  v_mfma_f32_16x16x32_bf16 a[108:111], a[200:203], v[212:215], a[108:111]
  v_exp_f32 v198, v198
  v_mfma_f32_16x16x32_bf16 a[124:127], a[204:207], v[212:215], a[124:127]
  v_exp_f32 v199, v199
  buffer_load_dwordx4 v238, s[8:11], s35 offen offset:0 sc1 lds
  buffer_load_dwordx4 v238, s[8:11], s35 offen offset:1024 sc1 lds
  v_add_f32 v234, v234, v192
  v_add_f32 v234, v234, v193
  v_cvt_pk_bf16_f32 v208, v192, v193
  v_add_f32 v234, v234, v194
  v_add_f32 v234, v234, v195
  v_cvt_pk_bf16_f32 v209, v194, v195
  v_add_f32 v234, v234, v196
  v_add_f32 v234, v234, v197
  v_cvt_pk_bf16_f32 v210, v196, v197
  v_mfma_f32_16x16x32_bf16 v[240:243], v[128:131], v[96:99], v[48:51]
  ds_read_b128 a[160:163], v237 offset:61440
  v_add_f32 v234, v234, v198
  v_mfma_f32_16x16x32_bf16 v[244:247], v[144:147], v[96:99], v[52:55]
  ds_read_b128 a[164:167], v237 offset:62464
  v_add_f32 v234, v234, v199
  v_mfma_f32_16x16x32_bf16 v[240:243], v[132:135], v[100:103], v[240:243]
  ds_read_b128 a[168:171], v237 offset:63488
  v_cvt_pk_bf16_f32 v211, v198, v199
  v_mfma_f32_16x16x32_bf16 v[244:247], v[148:151], v[100:103], v[244:247]
  ds_read_b128 a[172:175], v237 offset:64512
  v_mfma_f32_16x16x32_bf16 v[240:243], v[136:139], v[104:107], v[240:243]
  ds_read_b128 v[176:179], v239 offset:4096
  v_mfma_f32_16x16x32_bf16 v[244:247], v[152:155], v[104:107], v[244:247]
  ds_read_b128 v[180:183], v239 offset:5120
  v_mfma_f32_16x16x32_bf16 v[240:243], v[140:143], v[108:111], v[240:243]
  ds_read_b128 v[184:187], v239 offset:6144
  v_mfma_f32_16x16x32_bf16 v[244:247], v[156:159], v[108:111], v[244:247]
  ds_read_b128 v[188:191], v239 offset:7168
  v_mfma_f32_16x16x32_bf16 a[8:11], a[176:179], v[208:211], a[8:11]
  v_exp_f32 v200, v200
  v_mfma_f32_16x16x32_bf16 a[24:27], a[180:183], v[208:211], a[24:27]
  v_exp_f32 v201, v201
  v_mfma_f32_16x16x32_bf16 a[40:43], a[184:187], v[208:211], a[40:43]
  v_exp_f32 v202, v202
  v_mfma_f32_16x16x32_bf16 a[56:59], a[188:191], v[208:211], a[56:59]
  v_exp_f32 v203, v203
  v_mfma_f32_16x16x32_bf16 a[72:75], a[192:195], v[208:211], a[72:75]
  v_exp_f32 v204, v204
  v_mfma_f32_16x16x32_bf16 a[88:91], a[196:199], v[208:211], a[88:91]
  v_exp_f32 v205, v205
  v_mfma_f32_16x16x32_bf16 a[104:107], a[200:203], v[208:211], a[104:107]
  v_exp_f32 v206, v206
  v_mfma_f32_16x16x32_bf16 a[120:123], a[204:207], v[208:211], a[120:123]
  v_exp_f32 v207, v207
  buffer_load_dwordx4 v238, s[8:11], s35 offen offset:2048 sc1 lds
  buffer_load_dwordx4 v238, s[8:11], s35 offen offset:3072 sc1 lds
  s_add_u32 s35, s35, 28672
  v_add_f32 v235, v235, v200
  v_add_f32 v235, v235, v201
  v_cvt_pk_bf16_f32 v212, v200, v201
  v_add_f32 v235, v235, v202
  v_add_f32 v235, v235, v203
  v_cvt_pk_bf16_f32 v213, v202, v203
  v_add_f32 v235, v235, v204
  v_add_f32 v235, v235, v205
  v_cvt_pk_bf16_f32 v214, v204, v205
  s_waitcnt vmcnt(8) lgkmcnt(0)
  s_barrier
  v_mfma_f32_16x16x32_bf16 v[248:251], v[160:163], v[112:115], v[56:59]
  ds_read_b128 a[176:179], v239 offset:16384
  v_add_f32 v235, v235, v206
  v_mfma_f32_16x16x32_bf16 v[252:255], v[176:179], v[112:115], v[60:63]
  ds_read_b128 a[180:183], v239 offset:17408
  v_add_f32 v235, v235, v207
  v_mfma_f32_16x16x32_bf16 v[248:251], v[164:167], v[116:119], v[248:251]
  ds_read_b128 a[184:187], v239 offset:18432
  v_cvt_pk_bf16_f32 v215, v206, v207
  v_mfma_f32_16x16x32_bf16 v[252:255], v[180:183], v[116:119], v[252:255]
  ds_read_b128 a[188:191], v239 offset:19456
  v_mfma_f32_16x16x32_bf16 v[248:251], v[168:171], v[120:123], v[248:251]
  ds_read_b128 v[128:131], v236 offset:0
  v_mfma_f32_16x16x32_bf16 v[252:255], v[184:187], v[120:123], v[252:255]
  ds_read_b128 v[132:135], v236 offset:1024
  v_mfma_f32_16x16x32_bf16 v[248:251], v[172:175], v[124:127], v[248:251]
  ds_read_b128 v[136:139], v236 offset:2048
  v_mfma_f32_16x16x32_bf16 v[252:255], v[188:191], v[124:127], v[252:255]
  ds_read_b128 v[140:143], v236 offset:3072
  v_mfma_f32_16x16x32_bf16 a[12:15], a[144:147], v[212:215], a[12:15]
  v_exp_f32 v240, v240
  v_mfma_f32_16x16x32_bf16 a[28:31], a[148:151], v[212:215], a[28:31]
  v_exp_f32 v241, v241
  v_mfma_f32_16x16x32_bf16 a[44:47], a[152:155], v[212:215], a[44:47]
  v_exp_f32 v242, v242
  v_mfma_f32_16x16x32_bf16 a[60:63], a[156:159], v[212:215], a[60:63]
  v_exp_f32 v243, v243
  v_mfma_f32_16x16x32_bf16 a[76:79], a[160:163], v[212:215], a[76:79]
  v_exp_f32 v244, v244
  v_mfma_f32_16x16x32_bf16 a[92:95], a[164:167], v[212:215], a[92:95]
  v_exp_f32 v245, v245
  v_mfma_f32_16x16x32_bf16 a[108:111], a[168:171], v[212:215], a[108:111]
  v_exp_f32 v246, v246
  v_mfma_f32_16x16x32_bf16 a[124:127], a[172:175], v[212:215], a[124:127]
  s_waitcnt lgkmcnt(0)
  v_exp_f32 v247, v247
  ds_read_b128 v[144:147], v236 offset:4096
  ds_read_b128 v[148:151], v236 offset:5120
  ds_read_b128 v[152:155], v236 offset:6144
  ds_read_b128 v[156:159], v236 offset:7168
  s_add_u32 m0, s36, 65536
  s_nop 0
  buffer_load_dwordx4 v238, s[8:11], s35 offen offset:0 sc1 lds
  buffer_load_dwordx4 v238, s[8:11], s35 offen offset:1024 sc1 lds
  buffer_load_dwordx4 v238, s[8:11], s35 offen offset:2048 sc1 lds
  v_add_f32 v234, v234, v240
  v_add_f32 v234, v234, v241
  v_cvt_pk_bf16_f32 v208, v240, v241
  v_add_f32 v234, v234, v242
  v_add_f32 v234, v234, v243
  v_cvt_pk_bf16_f32 v209, v242, v243
  v_add_f32 v234, v234, v244
  v_add_f32 v234, v234, v245
  v_cvt_pk_bf16_f32 v210, v244, v245
  v_mfma_f32_16x16x32_bf16 v[192:195], v[128:131], v[64:67], v[216:219]
  s_waitcnt lgkmcnt(3)
  ds_read_b128 a[192:195], v239 offset:20480
  v_add_f32 v234, v234, v246
  v_mfma_f32_16x16x32_bf16 v[196:199], v[144:147], v[64:67], v[216:219]
  v_exp_f32 v248, v248
  v_mfma_f32_16x16x32_bf16 v[192:195], v[132:135], v[68:71], v[192:195]
  s_waitcnt lgkmcnt(3)
  ds_read_b128 a[196:199], v239 offset:21504
  v_add_f32 v234, v234, v247
  v_mfma_f32_16x16x32_bf16 v[196:199], v[148:151], v[68:71], v[196:199]
  v_exp_f32 v249, v249
  v_mfma_f32_16x16x32_bf16 v[192:195], v[136:139], v[72:75], v[192:195]
  s_waitcnt lgkmcnt(2)
  ds_read_b128 a[200:203], v239 offset:22528
  v_cvt_pk_bf16_f32 v211, v246, v247
  v_mfma_f32_16x16x32_bf16 v[196:199], v[152:155], v[72:75], v[196:199]
  v_exp_f32 v250, v250
  v_mfma_f32_16x16x32_bf16 v[192:195], v[140:143], v[76:79], v[192:195]
  ds_read_b128 a[204:207], v239 offset:23552
  v_add_f32 v235, v235, v248
  v_mfma_f32_16x16x32_bf16 v[196:199], v[156:159], v[76:79], v[196:199]
  v_exp_f32 v251, v251
  v_mfma_f32_16x16x32_bf16 a[8:11], a[144:147], v[208:211], a[8:11]
  buffer_load_dwordx4 v238, s[8:11], s35 offen offset:3072 sc1 lds
  v_mfma_f32_16x16x32_bf16 a[24:27], a[148:151], v[208:211], a[24:27]
  s_add_u32 s35, s35, 4096
  v_add_f32 v235, v235, v249
  v_cvt_pk_bf16_f32 v212, v248, v249
  v_mfma_f32_16x16x32_bf16 a[40:43], a[152:155], v[208:211], a[40:43]
  s_add_u32 m0, s36, 69632
  v_exp_f32 v252, v252
  v_mfma_f32_16x16x32_bf16 a[56:59], a[156:159], v[208:211], a[56:59]
  buffer_load_dwordx4 v238, s[8:11], s35 offen offset:0 sc1 lds
  v_mfma_f32_16x16x32_bf16 a[72:75], a[160:163], v[208:211], a[72:75]
  v_add_f32 v235, v235, v250
  v_add_f32 v235, v235, v251
  v_mfma_f32_16x16x32_bf16 a[88:91], a[164:167], v[208:211], a[88:91]
  v_exp_f32 v253, v253
  v_mfma_f32_16x16x32_bf16 a[104:107], a[168:171], v[208:211], a[104:107]
  v_exp_f32 v254, v254
  v_mfma_f32_16x16x32_bf16 a[120:123], a[172:175], v[208:211], a[120:123]
  v_exp_f32 v255, v255
  v_cvt_pk_bf16_f32 v213, v250, v251
  v_add_f32 v235, v235, v252
  v_add_f32 v235, v235, v253
  v_cvt_pk_bf16_f32 v214, v252, v253
  v_mfma_f32_16x16x32_bf16 v[200:203], v[128:131], v[80:83], v[220:223]
  ds_read_b128 a[144:147], v236 offset:16384
  v_add_f32 v235, v235, v254
  v_mfma_f32_16x16x32_bf16 v[204:207], v[144:147], v[80:83], v[220:223]
  ds_read_b128 a[148:151], v236 offset:17408
  v_add_f32 v235, v235, v255
  v_mfma_f32_16x16x32_bf16 v[200:203], v[132:135], v[84:87], v[200:203]
  ds_read_b128 a[152:155], v236 offset:18432
  v_cvt_pk_bf16_f32 v215, v254, v255
  v_mfma_f32_16x16x32_bf16 v[204:207], v[148:151], v[84:87], v[204:207]
  ds_read_b128 a[156:159], v236 offset:19456
  v_mfma_f32_16x16x32_bf16 v[200:203], v[136:139], v[88:91], v[200:203]
  ds_read_b128 a[160:163], v236 offset:20480
  v_mfma_f32_16x16x32_bf16 v[204:207], v[152:155], v[88:91], v[204:207]
  ds_read_b128 a[164:167], v236 offset:21504
  v_mfma_f32_16x16x32_bf16 v[200:203], v[140:143], v[92:95], v[200:203]
  ds_read_b128 a[168:171], v236 offset:22528
  v_mfma_f32_16x16x32_bf16 v[204:207], v[156:159], v[92:95], v[204:207]
  ds_read_b128 a[172:175], v236 offset:23552
  v_mfma_f32_16x16x32_bf16 a[12:15], a[176:179], v[212:215], a[12:15]
  v_exp_f32 v192, v192
  v_mfma_f32_16x16x32_bf16 a[28:31], a[180:183], v[212:215], a[28:31]
  v_exp_f32 v193, v193
  v_mfma_f32_16x16x32_bf16 a[44:47], a[184:187], v[212:215], a[44:47]
  v_exp_f32 v194, v194
  v_mfma_f32_16x16x32_bf16 a[60:63], a[188:191], v[212:215], a[60:63]
  s_waitcnt lgkmcnt(6)
  v_exp_f32 v195, v195
  v_mfma_f32_16x16x32_bf16 a[76:79], a[192:195], v[212:215], a[76:79]
  v_exp_f32 v196, v196
  v_mfma_f32_16x16x32_bf16 a[92:95], a[196:199], v[212:215], a[92:95]
  v_exp_f32 v197, v197
  v_mfma_f32_16x16x32_bf16 a[108:111], a[200:203], v[212:215], a[108:111]
  v_exp_f32 v198, v198
  v_mfma_f32_16x16x32_bf16 a[124:127], a[204:207], v[212:215], a[124:127]
  v_exp_f32 v199, v199
  ds_read_b128 v[160:163], v236 offset:8192
  ds_read_b128 v[164:167], v236 offset:9216
  ds_read_b128 v[168:171], v236 offset:10240
  ds_read_b128 v[172:175], v236 offset:11264
  buffer_load_dwordx4 v238, s[8:11], s35 offen offset:1024 sc1 lds
  buffer_load_dwordx4 v238, s[8:11], s35 offen offset:2048 sc1 lds
  buffer_load_dwordx4 v238, s[8:11], s35 offen offset:3072 sc1 lds
  s_add_u32 s35, s35, 28672
  v_cvt_pk_bf16_f32 v208, v192, v193
  v_cvt_pk_bf16_f32 v209, v194, v195
  v_cvt_pk_bf16_f32 v210, v196, v197
  s_cmp_eq_u32 s29, 0
  s_cbranch_scc1 L_epiA
  v_add_f32 v232, v232, v192
  v_add_f32 v232, v232, v193
  v_add_f32 v232, v232, v194
  v_add_f32 v232, v232, v195
  v_add_f32 v232, v232, v196
  v_add_f32 v232, v232, v197
  v_mfma_f32_16x16x32_bf16 v[240:243], v[128:131], v[96:99], v[224:227]
  ds_read_b128 v[176:179], v236 offset:12288
  v_add_f32 v232, v232, v198
  v_mfma_f32_16x16x32_bf16 v[244:247], v[144:147], v[96:99], v[224:227]
  ds_read_b128 v[180:183], v236 offset:13312
  v_add_f32 v232, v232, v199
  v_mfma_f32_16x16x32_bf16 v[240:243], v[132:135], v[100:103], v[240:243]
  ds_read_b128 v[184:187], v236 offset:14336
  v_cvt_pk_bf16_f32 v211, v198, v199
  v_mfma_f32_16x16x32_bf16 v[244:247], v[148:151], v[100:103], v[244:247]
  ds_read_b128 v[188:191], v236 offset:15360
  v_mfma_f32_16x16x32_bf16 v[240:243], v[136:139], v[104:107], v[240:243]
  s_add_u32 m0, s36, 98304
  v_exp_f32 v200, v200
  v_mfma_f32_16x16x32_bf16 v[244:247], v[152:155], v[104:107], v[244:247]
  buffer_load_dwordx4 v238, s[8:11], s35 offen offset:0 sc1 lds
  v_mfma_f32_16x16x32_bf16 v[240:243], v[140:143], v[108:111], v[240:243]
  buffer_load_dwordx4 v238, s[8:11], s35 offen offset:1024 sc1 lds
  v_mfma_f32_16x16x32_bf16 v[244:247], v[156:159], v[108:111], v[244:247]
  buffer_load_dwordx4 v238, s[8:11], s35 offen offset:2048 sc1 lds
  v_mfma_f32_16x16x32_bf16 a[0:3], a[144:147], v[208:211], a[0:3]
  v_exp_f32 v201, v201
  v_mfma_f32_16x16x32_bf16 a[16:19], a[148:151], v[208:211], a[16:19]
  s_waitcnt lgkmcnt(3)
  v_add_f32 v233, v233, v200
  v_add_f32 v233, v233, v201
  v_mfma_f32_16x16x32_bf16 a[32:35], a[152:155], v[208:211], a[32:35]
  v_exp_f32 v202, v202
  v_mfma_f32_16x16x32_bf16 a[48:51], a[156:159], v[208:211], a[48:51]
  v_exp_f32 v203, v203
  v_mfma_f32_16x16x32_bf16 a[64:67], a[160:163], v[208:211], a[64:67]
  v_exp_f32 v204, v204
  v_mfma_f32_16x16x32_bf16 a[80:83], a[164:167], v[208:211], a[80:83]
  v_exp_f32 v205, v205
  v_mfma_f32_16x16x32_bf16 a[96:99], a[168:171], v[208:211], a[96:99]
  v_exp_f32 v206, v206
  v_mfma_f32_16x16x32_bf16 a[112:115], a[172:175], v[208:211], a[112:115]
  v_exp_f32 v207, v207
  v_cvt_pk_bf16_f32 v212, v200, v201
  v_add_f32 v233, v233, v202
  v_add_f32 v233, v233, v203
  v_cvt_pk_bf16_f32 v213, v202, v203
  v_add_f32 v233, v233, v204
  v_add_f32 v233, v233, v205
  v_cvt_pk_bf16_f32 v214, v204, v205
  v_mfma_f32_16x16x32_bf16 v[248:251], v[128:131], v[112:115], v[228:231]
  ds_read_b128 a[176:179], v236 offset:24576
  v_add_f32 v233, v233, v206
  v_mfma_f32_16x16x32_bf16 v[252:255], v[144:147], v[112:115], v[228:231]
  v_exp_f32 v240, v240
  v_mfma_f32_16x16x32_bf16 v[248:251], v[132:135], v[116:119], v[248:251]
  ds_read_b128 a[180:183], v236 offset:25600
  v_add_f32 v233, v233, v207
  v_mfma_f32_16x16x32_bf16 v[252:255], v[148:151], v[116:119], v[252:255]
  v_exp_f32 v241, v241
  v_mfma_f32_16x16x32_bf16 v[248:251], v[136:139], v[120:123], v[248:251]
  ds_read_b128 a[184:187], v236 offset:26624
  v_cvt_pk_bf16_f32 v215, v206, v207
  v_mfma_f32_16x16x32_bf16 v[252:255], v[152:155], v[120:123], v[252:255]
  v_exp_f32 v242, v242
  v_mfma_f32_16x16x32_bf16 v[248:251], v[140:143], v[124:127], v[248:251]
  ds_read_b128 a[188:191], v236 offset:27648
  v_add_f32 v234, v234, v240
  v_mfma_f32_16x16x32_bf16 v[252:255], v[156:159], v[124:127], v[252:255]
  v_exp_f32 v243, v243
  v_mfma_f32_16x16x32_bf16 a[4:7], a[144:147], v[212:215], a[4:7]
  buffer_load_dwordx4 v238, s[8:11], s35 offen offset:3072 sc1 lds
  v_mfma_f32_16x16x32_bf16 a[20:23], a[148:151], v[212:215], a[20:23]
  s_add_u32 s35, s35, 4096
  v_add_f32 v234, v234, v241
  v_cvt_pk_bf16_f32 v208, v240, v241
  v_mfma_f32_16x16x32_bf16 a[36:39], a[152:155], v[212:215], a[36:39]
  s_add_u32 m0, s36, 102400
  v_exp_f32 v244, v244
  v_mfma_f32_16x16x32_bf16 a[52:55], a[156:159], v[212:215], a[52:55]
  buffer_load_dwordx4 v238, s[8:11], s35 offen offset:0 sc1 lds
  v_mfma_f32_16x16x32_bf16 a[68:71], a[160:163], v[212:215], a[68:71]
  v_add_f32 v234, v234, v242
  v_add_f32 v234, v234, v243
  v_mfma_f32_16x16x32_bf16 a[84:87], a[164:167], v[212:215], a[84:87]
  v_exp_f32 v245, v245
  v_mfma_f32_16x16x32_bf16 a[100:103], a[168:171], v[212:215], a[100:103]
  v_exp_f32 v246, v246
  v_mfma_f32_16x16x32_bf16 a[116:119], a[172:175], v[212:215], a[116:119]
  v_exp_f32 v247, v247
  v_cvt_pk_bf16_f32 v209, v242, v243
  v_add_f32 v234, v234, v244
  v_add_f32 v234, v234, v245
  v_cvt_pk_bf16_f32 v210, v244, v245
  v_mfma_f32_16x16x32_bf16 v[192:195], v[160:163], v[64:67], v[216:219]
  ds_read_b128 a[192:195], v236 offset:28672
  v_add_f32 v234, v234, v246
  v_mfma_f32_16x16x32_bf16 v[196:199], v[176:179], v[64:67], v[216:219]
  ds_read_b128 a[196:199], v236 offset:29696
  v_add_f32 v234, v234, v247
  v_mfma_f32_16x16x32_bf16 v[192:195], v[164:167], v[68:71], v[192:195]
  s_waitcnt lgkmcnt(2)
  ds_read_b128 a[200:203], v236 offset:30720
  v_cvt_pk_bf16_f32 v211, v246, v247
  v_mfma_f32_16x16x32_bf16 v[196:199], v[180:183], v[68:71], v[196:199]
  ds_read_b128 a[204:207], v236 offset:31744
  v_mfma_f32_16x16x32_bf16 v[192:195], v[168:171], v[72:75], v[192:195]
  buffer_load_dwordx4 v238, s[8:11], s35 offen offset:1024 sc1 lds
  v_mfma_f32_16x16x32_bf16 v[196:199], v[184:187], v[72:75], v[196:199]
  buffer_load_dwordx4 v238, s[8:11], s35 offen offset:2048 sc1 lds
  v_mfma_f32_16x16x32_bf16 v[192:195], v[172:175], v[76:79], v[192:195]
  buffer_load_dwordx4 v238, s[8:11], s35 offen offset:3072 sc1 lds
  v_mfma_f32_16x16x32_bf16 v[196:199], v[188:191], v[76:79], v[196:199]
  s_add_u32 s35, s35, 28672
  v_exp_f32 v248, v248
  v_mfma_f32_16x16x32_bf16 a[8:11], a[144:147], v[208:211], a[8:11]
  v_exp_f32 v249, v249
  v_mfma_f32_16x16x32_bf16 a[24:27], a[148:151], v[208:211], a[24:27]
  v_add_f32 v235, v235, v248
  v_add_f32 v235, v235, v249
  v_mfma_f32_16x16x32_bf16 a[40:43], a[152:155], v[208:211], a[40:43]
  v_exp_f32 v250, v250
  v_mfma_f32_16x16x32_bf16 a[56:59], a[156:159], v[208:211], a[56:59]
  v_exp_f32 v251, v251
  v_mfma_f32_16x16x32_bf16 a[72:75], a[160:163], v[208:211], a[72:75]
  v_exp_f32 v252, v252
  v_mfma_f32_16x16x32_bf16 a[88:91], a[164:167], v[208:211], a[88:91]
  v_exp_f32 v253, v253
  v_mfma_f32_16x16x32_bf16 a[104:107], a[168:171], v[208:211], a[104:107]
  v_exp_f32 v254, v254
  v_mfma_f32_16x16x32_bf16 a[120:123], a[172:175], v[208:211], a[120:123]
  v_exp_f32 v255, v255
  v_cvt_pk_bf16_f32 v212, v248, v249
  v_add_f32 v235, v235, v250
  v_add_f32 v235, v235, v251
  v_cvt_pk_bf16_f32 v213, v250, v251
  v_add_f32 v235, v235, v252
  v_add_f32 v235, v235, v253
  v_cvt_pk_bf16_f32 v214, v252, v253
  s_mov_b32 s38, 0
  s_mov_b32 s45, 131072
  s_mov_b32 s33, 32768
  v_add_u32 v31, 0x8000, v236
  s_lshl_b32 s37, s29, 2
  s_sub_u32 s37, s37, 1
  v_lshlrev_b32 v30, 3, v236
  buffer_load_dword v24, v30, s[64:67], s44 offen
  v_min_u32 v30, 2176, v30
  v_add_u32 v30, 8064, v30
  buffer_load_dword v25, v30, s[64:67], s44 offen
  s_mov_b32 s31, 1
  s_bitcmp1_b32 s47, 1
  s_cbranch_scc0 L_slow1
  .p2align 6
L_loop:
  v_mfma_f32_16x16x32_bf16 v[200:203], v[160:163], v[80:83], v[220:223]
  s_waitcnt vmcnt(16) lgkmcnt(0)
  s_barrier
  v_mfma_f32_16x16x32_bf16 v[204:207], v[176:179], v[80:83], v[220:223]
  ds_read_b128 v[128:131], v31 offset:0
  v_add_f32 v235, v235, v254
  v_mfma_f32_16x16x32_bf16 v[200:203], v[164:167], v[84:87], v[200:203]
  v_exp_f32 v192, v192
  v_mfma_f32_16x16x32_bf16 v[204:207], v[180:183], v[84:87], v[204:207]
  ds_read_b128 v[132:135], v31 offset:1024
  v_add_f32 v235, v235, v255
  v_mfma_f32_16x16x32_bf16 v[200:203], v[168:171], v[88:91], v[200:203]
  s_add_u32 m0, s36, s45
  v_exp_f32 v193, v193
  v_mfma_f32_16x16x32_bf16 v[204:207], v[184:187], v[88:91], v[204:207]
  ds_read_b128 v[136:139], v31 offset:2048
  v_cvt_pk_bf16_f32 v215, v254, v255
  v_mfma_f32_16x16x32_bf16 v[200:203], v[172:175], v[92:95], v[200:203]
  v_exp_f32 v194, v194
  v_mfma_f32_16x16x32_bf16 v[204:207], v[188:191], v[92:95], v[204:207]
  ds_read_b128 v[140:143], v31 offset:3072
  v_add_f32 v232, v232, v192
  v_mfma_f32_16x16x32_bf16 a[12:15], a[144:147], v[212:215], a[12:15]
  v_exp_f32 v195, v195
  v_mfma_f32_16x16x32_bf16 a[28:31], a[148:151], v[212:215], a[28:31]
  buffer_load_dwordx4 v238, s[8:11], s35 offen offset:0 sc1 lds
  v_mfma_f32_16x16x32_bf16 a[44:47], a[152:155], v[212:215], a[44:47]
  v_add_f32 v232, v232, v193
  v_cvt_pk_bf16_f32 v208, v192, v193
  v_mfma_f32_16x16x32_bf16 a[60:63], a[156:159], v[212:215], a[60:63]
  v_add_f32 v232, v232, v194
  v_add_f32 v232, v232, v195
  v_mfma_f32_16x16x32_bf16 a[76:79], a[160:163], v[212:215], a[76:79]
  v_exp_f32 v196, v196
  v_mfma_f32_16x16x32_bf16 a[92:95], a[164:167], v[212:215], a[92:95]
  v_exp_f32 v197, v197
  v_mfma_f32_16x16x32_bf16 a[108:111], a[168:171], v[212:215], a[108:111]
  v_exp_f32 v198, v198
  v_mfma_f32_16x16x32_bf16 a[124:127], a[172:175], v[212:215], a[124:127]
  v_exp_f32 v199, v199
  v_cvt_pk_bf16_f32 v209, v194, v195
  v_add_f32 v232, v232, v196
  v_add_f32 v232, v232, v197
  v_cvt_pk_bf16_f32 v210, v196, v197
  v_mfma_f32_16x16x32_bf16 v[240:243], v[160:163], v[96:99], v[224:227]
  ds_read_b128 v[144:147], v31 offset:4096
  v_add_f32 v232, v232, v198
  v_mfma_f32_16x16x32_bf16 v[244:247], v[176:179], v[96:99], v[224:227]
  v_exp_f32 v200, v200
  v_mfma_f32_16x16x32_bf16 v[240:243], v[164:167], v[100:103], v[240:243]
  ds_read_b128 v[148:151], v31 offset:5120
  v_add_f32 v232, v232, v199
  v_mfma_f32_16x16x32_bf16 v[244:247], v[180:183], v[100:103], v[244:247]
  v_exp_f32 v201, v201
  v_mfma_f32_16x16x32_bf16 v[240:243], v[168:171], v[104:107], v[240:243]
  ds_read_b128 v[152:155], v31 offset:6144
  v_cvt_pk_bf16_f32 v211, v198, v199
  v_mfma_f32_16x16x32_bf16 v[244:247], v[184:187], v[104:107], v[244:247]
  v_exp_f32 v202, v202
  v_mfma_f32_16x16x32_bf16 v[240:243], v[172:175], v[108:111], v[240:243]
  ds_read_b128 v[156:159], v31 offset:7168
  v_add_f32 v233, v233, v200
  v_mfma_f32_16x16x32_bf16 v[244:247], v[188:191], v[108:111], v[244:247]
  v_exp_f32 v203, v203
  v_mfma_f32_16x16x32_bf16 a[0:3], a[176:179], v[208:211], a[0:3]
  buffer_load_dwordx4 v238, s[8:11], s35 offen offset:1024 sc1 lds
  v_mfma_f32_16x16x32_bf16 a[16:19], a[180:183], v[208:211], a[16:19]
  v_add_f32 v233, v233, v201
  v_cvt_pk_bf16_f32 v212, v200, v201
  v_mfma_f32_16x16x32_bf16 a[32:35], a[184:187], v[208:211], a[32:35]
  v_add_f32 v233, v233, v202
  v_add_f32 v233, v233, v203
  v_mfma_f32_16x16x32_bf16 a[48:51], a[188:191], v[208:211], a[48:51]
  v_exp_f32 v204, v204
  v_mfma_f32_16x16x32_bf16 a[64:67], a[192:195], v[208:211], a[64:67]
  v_cvt_pk_bf16_f32 v213, v202, v203
  v_add_f32 v233, v233, v204
  v_mfma_f32_16x16x32_bf16 a[80:83], a[196:199], v[208:211], a[80:83]
  v_exp_f32 v205, v205
  v_mfma_f32_16x16x32_bf16 a[96:99], a[200:203], v[208:211], a[96:99]
  v_exp_f32 v206, v206
  v_mfma_f32_16x16x32_bf16 a[112:115], a[204:207], v[208:211], a[112:115]
  v_exp_f32 v207, v207
  v_add_f32 v233, v233, v205
  v_cvt_pk_bf16_f32 v214, v204, v205
  v_mfma_f32_16x16x32_bf16 v[248:251], v[160:163], v[112:115], v[228:231]
  ds_read_b128 a[144:147], v31 offset:16384
  v_add_f32 v233, v233, v206
  v_mfma_f32_16x16x32_bf16 v[252:255], v[176:179], v[112:115], v[228:231]
  v_exp_f32 v240, v240
  v_mfma_f32_16x16x32_bf16 v[248:251], v[164:167], v[116:119], v[248:251]
  ds_read_b128 a[148:151], v31 offset:17408
  v_add_f32 v233, v233, v207
  v_mfma_f32_16x16x32_bf16 v[252:255], v[180:183], v[116:119], v[252:255]
  v_exp_f32 v241, v241
  v_mfma_f32_16x16x32_bf16 v[248:251], v[168:171], v[120:123], v[248:251]
  ds_read_b128 a[152:155], v31 offset:18432
  v_cvt_pk_bf16_f32 v215, v206, v207
  v_mfma_f32_16x16x32_bf16 v[252:255], v[184:187], v[120:123], v[252:255]
  v_exp_f32 v242, v242
  v_mfma_f32_16x16x32_bf16 v[248:251], v[172:175], v[124:127], v[248:251]
  ds_read_b128 a[156:159], v31 offset:19456
  v_add_f32 v234, v234, v240
  v_mfma_f32_16x16x32_bf16 v[252:255], v[188:191], v[124:127], v[252:255]
  v_exp_f32 v243, v243
  v_mfma_f32_16x16x32_bf16 a[4:7], a[176:179], v[212:215], a[4:7]
  buffer_load_dwordx4 v238, s[8:11], s35 offen offset:2048 sc1 lds
  v_mfma_f32_16x16x32_bf16 a[20:23], a[180:183], v[212:215], a[20:23]
  v_add_f32 v234, v234, v241
  v_cvt_pk_bf16_f32 v208, v240, v241
  v_mfma_f32_16x16x32_bf16 a[36:39], a[184:187], v[212:215], a[36:39]
  v_add_f32 v234, v234, v242
  v_add_f32 v234, v234, v243
  v_mfma_f32_16x16x32_bf16 a[52:55], a[188:191], v[212:215], a[52:55]
  v_exp_f32 v244, v244
  v_mfma_f32_16x16x32_bf16 a[68:71], a[192:195], v[212:215], a[68:71]
  v_cvt_pk_bf16_f32 v209, v242, v243
  v_add_f32 v234, v234, v244
  v_mfma_f32_16x16x32_bf16 a[84:87], a[196:199], v[212:215], a[84:87]
  v_exp_f32 v245, v245
  v_mfma_f32_16x16x32_bf16 a[100:103], a[200:203], v[212:215], a[100:103]
  v_exp_f32 v246, v246
  v_mfma_f32_16x16x32_bf16 a[116:119], a[204:207], v[212:215], a[116:119]
  s_waitcnt lgkmcnt(0)
  v_exp_f32 v247, v247
  v_add_f32 v234, v234, v245
  v_cvt_pk_bf16_f32 v210, v244, v245
  v_mfma_f32_16x16x32_bf16 v[192:195], v[128:131], v[64:67], v[216:219]
  ds_read_b128 a[160:163], v31 offset:20480
  v_add_f32 v234, v234, v246
  v_mfma_f32_16x16x32_bf16 v[196:199], v[144:147], v[64:67], v[216:219]
  v_exp_f32 v248, v248
  v_mfma_f32_16x16x32_bf16 v[192:195], v[132:135], v[68:71], v[192:195]
  ds_read_b128 a[164:167], v31 offset:21504
  v_add_f32 v234, v234, v247
  v_mfma_f32_16x16x32_bf16 v[196:199], v[148:151], v[68:71], v[196:199]
  v_exp_f32 v249, v249
  v_mfma_f32_16x16x32_bf16 v[192:195], v[136:139], v[72:75], v[192:195]
  ds_read_b128 a[168:171], v31 offset:22528
  v_cvt_pk_bf16_f32 v211, v246, v247
  v_mfma_f32_16x16x32_bf16 v[196:199], v[152:155], v[72:75], v[196:199]
  v_exp_f32 v250, v250
  v_mfma_f32_16x16x32_bf16 v[192:195], v[140:143], v[76:79], v[192:195]
  ds_read_b128 a[172:175], v31 offset:23552
  v_add_f32 v235, v235, v248
  v_mfma_f32_16x16x32_bf16 v[196:199], v[156:159], v[76:79], v[196:199]
  v_exp_f32 v251, v251
  v_mfma_f32_16x16x32_bf16 a[8:11], a[176:179], v[208:211], a[8:11]
  buffer_load_dwordx4 v238, s[8:11], s35 offen offset:3072 sc1 lds
  v_mfma_f32_16x16x32_bf16 a[24:27], a[180:183], v[208:211], a[24:27]
  s_add_u32 s35, s35, 4096
  v_add_f32 v235, v235, v249
  v_cvt_pk_bf16_f32 v212, v248, v249
  v_mfma_f32_16x16x32_bf16 a[40:43], a[184:187], v[208:211], a[40:43]
  v_add_f32 v235, v235, v250
  v_add_f32 v235, v235, v251
  v_mfma_f32_16x16x32_bf16 a[56:59], a[188:191], v[208:211], a[56:59]
  v_exp_f32 v252, v252
  v_mfma_f32_16x16x32_bf16 a[72:75], a[192:195], v[208:211], a[72:75]
  v_cvt_pk_bf16_f32 v213, v250, v251
  v_add_f32 v235, v235, v252
  v_mfma_f32_16x16x32_bf16 a[88:91], a[196:199], v[208:211], a[88:91]
  v_exp_f32 v253, v253
  v_mfma_f32_16x16x32_bf16 a[104:107], a[200:203], v[208:211], a[104:107]
  v_exp_f32 v254, v254
  v_mfma_f32_16x16x32_bf16 a[120:123], a[204:207], v[208:211], a[120:123]
  v_exp_f32 v255, v255
  v_add_f32 v235, v235, v253
  v_cvt_pk_bf16_f32 v214, v252, v253
  v_mfma_f32_16x16x32_bf16 v[200:203], v[128:131], v[80:83], v[220:223]
  ds_read_b128 v[160:163], v31 offset:8192
  v_add_f32 v235, v235, v254
  v_mfma_f32_16x16x32_bf16 v[204:207], v[144:147], v[80:83], v[220:223]
  v_exp_f32 v192, v192
  v_mfma_f32_16x16x32_bf16 v[200:203], v[132:135], v[84:87], v[200:203]
  ds_read_b128 v[164:167], v31 offset:9216
  v_add_f32 v235, v235, v255
  v_mfma_f32_16x16x32_bf16 v[204:207], v[148:151], v[84:87], v[204:207]
  s_add_u32 m0, m0, 4096
  v_exp_f32 v193, v193
  v_mfma_f32_16x16x32_bf16 v[200:203], v[136:139], v[88:91], v[200:203]
  ds_read_b128 v[168:171], v31 offset:10240
  v_cvt_pk_bf16_f32 v215, v254, v255
  v_mfma_f32_16x16x32_bf16 v[204:207], v[152:155], v[88:91], v[204:207]
  v_exp_f32 v194, v194
  v_mfma_f32_16x16x32_bf16 v[200:203], v[140:143], v[92:95], v[200:203]
  ds_read_b128 v[172:175], v31 offset:11264
  v_add_f32 v232, v232, v192
  v_mfma_f32_16x16x32_bf16 v[204:207], v[156:159], v[92:95], v[204:207]
  v_exp_f32 v195, v195
  v_mfma_f32_16x16x32_bf16 a[12:15], a[176:179], v[212:215], a[12:15]
  buffer_load_dwordx4 v238, s[8:11], s35 offen offset:0 sc1 lds
  v_mfma_f32_16x16x32_bf16 a[28:31], a[180:183], v[212:215], a[28:31]
  v_add_f32 v232, v232, v193
  v_cvt_pk_bf16_f32 v208, v192, v193
  v_mfma_f32_16x16x32_bf16 a[44:47], a[184:187], v[212:215], a[44:47]
  v_add_f32 v232, v232, v194
  v_add_f32 v232, v232, v195
  v_mfma_f32_16x16x32_bf16 a[60:63], a[188:191], v[212:215], a[60:63]
  v_exp_f32 v196, v196
  v_mfma_f32_16x16x32_bf16 a[76:79], a[192:195], v[212:215], a[76:79]
  v_cvt_pk_bf16_f32 v209, v194, v195
  v_add_f32 v232, v232, v196
  v_mfma_f32_16x16x32_bf16 a[92:95], a[196:199], v[212:215], a[92:95]
  v_exp_f32 v197, v197
  v_mfma_f32_16x16x32_bf16 a[108:111], a[200:203], v[212:215], a[108:111]
  v_exp_f32 v198, v198
  v_mfma_f32_16x16x32_bf16 a[124:127], a[204:207], v[212:215], a[124:127]
  v_exp_f32 v199, v199
  v_add_f32 v232, v232, v197
  v_cvt_pk_bf16_f32 v210, v196, v197
  v_mfma_f32_16x16x32_bf16 v[240:243], v[128:131], v[96:99], v[224:227]
  ds_read_b128 v[176:179], v31 offset:12288
  v_add_f32 v232, v232, v198
  v_mfma_f32_16x16x32_bf16 v[244:247], v[144:147], v[96:99], v[224:227]
  v_exp_f32 v200, v200
  v_mfma_f32_16x16x32_bf16 v[240:243], v[132:135], v[100:103], v[240:243]
  ds_read_b128 v[180:183], v31 offset:13312
  v_add_f32 v232, v232, v199
  v_mfma_f32_16x16x32_bf16 v[244:247], v[148:151], v[100:103], v[244:247]
  v_exp_f32 v201, v201
  v_mfma_f32_16x16x32_bf16 v[240:243], v[136:139], v[104:107], v[240:243]
  ds_read_b128 v[184:187], v31 offset:14336
  v_cvt_pk_bf16_f32 v211, v198, v199
  v_mfma_f32_16x16x32_bf16 v[244:247], v[152:155], v[104:107], v[244:247]
  v_exp_f32 v202, v202
  v_mfma_f32_16x16x32_bf16 v[240:243], v[140:143], v[108:111], v[240:243]
  ds_read_b128 v[188:191], v31 offset:15360
  v_add_f32 v233, v233, v200
  v_mfma_f32_16x16x32_bf16 v[244:247], v[156:159], v[108:111], v[244:247]
  v_exp_f32 v203, v203
  v_mfma_f32_16x16x32_bf16 a[0:3], a[144:147], v[208:211], a[0:3]
  buffer_load_dwordx4 v238, s[8:11], s35 offen offset:1024 sc1 lds
  v_mfma_f32_16x16x32_bf16 a[16:19], a[148:151], v[208:211], a[16:19]
  s_mov_b32 s45, s38
  v_add_f32 v233, v233, v201
  v_cvt_pk_bf16_f32 v212, v200, v201
  v_mfma_f32_16x16x32_bf16 a[32:35], a[152:155], v[208:211], a[32:35]
  s_mov_b32 s38, s33
  v_add_f32 v233, v233, v202
  v_add_f32 v233, v233, v203
  v_mfma_f32_16x16x32_bf16 a[48:51], a[156:159], v[208:211], a[48:51]
  s_waitcnt lgkmcnt(2)
  v_exp_f32 v204, v204
  v_mfma_f32_16x16x32_bf16 a[64:67], a[160:163], v[208:211], a[64:67]
  v_cvt_pk_bf16_f32 v213, v202, v203
  v_add_f32 v233, v233, v204
  v_mfma_f32_16x16x32_bf16 a[80:83], a[164:167], v[208:211], a[80:83]
  v_exp_f32 v205, v205
  v_mfma_f32_16x16x32_bf16 a[96:99], a[168:171], v[208:211], a[96:99]
  v_exp_f32 v206, v206
  v_mfma_f32_16x16x32_bf16 a[112:115], a[172:175], v[208:211], a[112:115]
  v_exp_f32 v207, v207
  v_add_f32 v233, v233, v205
  v_cvt_pk_bf16_f32 v214, v204, v205
  v_mfma_f32_16x16x32_bf16 v[248:251], v[128:131], v[112:115], v[228:231]
  ds_read_b128 a[176:179], v31 offset:24576
  v_add_f32 v233, v233, v206
  v_mfma_f32_16x16x32_bf16 v[252:255], v[144:147], v[112:115], v[228:231]
  v_exp_f32 v240, v240
  v_mfma_f32_16x16x32_bf16 v[248:251], v[132:135], v[116:119], v[248:251]
  ds_read_b128 a[180:183], v31 offset:25600
  v_add_f32 v233, v233, v207
  v_mfma_f32_16x16x32_bf16 v[252:255], v[148:151], v[116:119], v[252:255]
  v_exp_f32 v241, v241
  v_mfma_f32_16x16x32_bf16 v[248:251], v[136:139], v[120:123], v[248:251]
  ds_read_b128 a[184:187], v31 offset:26624
  v_cvt_pk_bf16_f32 v215, v206, v207
  v_mfma_f32_16x16x32_bf16 v[252:255], v[152:155], v[120:123], v[252:255]
  v_exp_f32 v242, v242
  v_mfma_f32_16x16x32_bf16 v[248:251], v[140:143], v[124:127], v[248:251]
  ds_read_b128 a[188:191], v31 offset:27648
  v_add_f32 v234, v234, v240
  v_mfma_f32_16x16x32_bf16 v[252:255], v[156:159], v[124:127], v[252:255]
  v_exp_f32 v243, v243
  v_mfma_f32_16x16x32_bf16 a[4:7], a[144:147], v[212:215], a[4:7]
  buffer_load_dwordx4 v238, s[8:11], s35 offen offset:2048 sc1 lds
  v_mfma_f32_16x16x32_bf16 a[20:23], a[148:151], v[212:215], a[20:23]
  s_add_u32 s33, s33, 32768
  v_add_f32 v234, v234, v241
  v_cvt_pk_bf16_f32 v208, v240, v241
  v_mfma_f32_16x16x32_bf16 a[36:39], a[152:155], v[212:215], a[36:39]
  s_cmp_eq_u32 s33, 163840
  v_add_f32 v234, v234, v242
  v_add_f32 v234, v234, v243
  v_mfma_f32_16x16x32_bf16 a[52:55], a[156:159], v[212:215], a[52:55]
  s_cselect_b32 s33, 0, s33
  v_exp_f32 v244, v244
  v_mfma_f32_16x16x32_bf16 a[68:71], a[160:163], v[212:215], a[68:71]
  v_cvt_pk_bf16_f32 v209, v242, v243
  v_add_f32 v234, v234, v244
  v_mfma_f32_16x16x32_bf16 a[84:87], a[164:167], v[212:215], a[84:87]
  v_exp_f32 v245, v245
  v_mfma_f32_16x16x32_bf16 a[100:103], a[168:171], v[212:215], a[100:103]
  v_exp_f32 v246, v246
  v_mfma_f32_16x16x32_bf16 a[116:119], a[172:175], v[212:215], a[116:119]
  v_exp_f32 v247, v247
  v_add_f32 v234, v234, v245
  v_cvt_pk_bf16_f32 v210, v244, v245
  v_mfma_f32_16x16x32_bf16 v[192:195], v[160:163], v[64:67], v[216:219]
  ds_read_b128 a[192:195], v31 offset:28672
  v_add_f32 v234, v234, v246
  v_mfma_f32_16x16x32_bf16 v[196:199], v[176:179], v[64:67], v[216:219]
  v_exp_f32 v248, v248
  v_mfma_f32_16x16x32_bf16 v[192:195], v[164:167], v[68:71], v[192:195]
  ds_read_b128 a[196:199], v31 offset:29696
  v_add_f32 v234, v234, v247
  v_mfma_f32_16x16x32_bf16 v[196:199], v[180:183], v[68:71], v[196:199]
  v_exp_f32 v249, v249
  v_mfma_f32_16x16x32_bf16 v[192:195], v[168:171], v[72:75], v[192:195]
  s_waitcnt lgkmcnt(2)
  ds_read_b128 a[200:203], v31 offset:30720
  v_cvt_pk_bf16_f32 v211, v246, v247
  v_mfma_f32_16x16x32_bf16 v[196:199], v[184:187], v[72:75], v[196:199]
  v_exp_f32 v250, v250
  v_mfma_f32_16x16x32_bf16 v[192:195], v[172:175], v[76:79], v[192:195]
  ds_read_b128 a[204:207], v31 offset:31744
  v_add_f32 v235, v235, v248
  v_mfma_f32_16x16x32_bf16 v[196:199], v[188:191], v[76:79], v[196:199]
  v_exp_f32 v251, v251
  v_mfma_f32_16x16x32_bf16 a[8:11], a[144:147], v[208:211], a[8:11]
  buffer_load_dwordx4 v238, s[8:11], s35 offen offset:3072 sc1 lds
  v_mfma_f32_16x16x32_bf16 a[24:27], a[148:151], v[208:211], a[24:27]
  s_add_u32 s35, s35, 28672
  v_add_f32 v235, v235, v249
  v_cvt_pk_bf16_f32 v212, v248, v249
  v_mfma_f32_16x16x32_bf16 a[40:43], a[152:155], v[208:211], a[40:43]
  s_lshr_b32 s31, s35, 17
  v_add_u32 v31, s33, v236
  v_add_f32 v235, v235, v250
  v_mfma_f32_16x16x32_bf16 a[56:59], a[156:159], v[208:211], a[56:59]
  s_sub_u32 s37, s37, 1
  v_add_f32 v235, v235, v251
  v_cvt_pk_bf16_f32 v213, v250, v251
  v_mfma_f32_16x16x32_bf16 a[72:75], a[160:163], v[208:211], a[72:75]
  s_lshr_b32 s46, s47, s31
  v_exp_f32 v252, v252
  v_mfma_f32_16x16x32_bf16 a[88:91], a[164:167], v[208:211], a[88:91]
  s_and_b32 s46, s46, 1
  v_exp_f32 v253, v253
  v_mfma_f32_16x16x32_bf16 a[104:107], a[168:171], v[208:211], a[104:107]
  s_min_u32 s46, s46, s37
  v_exp_f32 v254, v254
  v_mfma_f32_16x16x32_bf16 a[120:123], a[172:175], v[208:211], a[120:123]
  s_cmp_lg_u32 s46, 0
  v_exp_f32 v255, v255
  v_add_f32 v235, v235, v252
  v_add_f32 v235, v235, v253
  v_cvt_pk_bf16_f32 v214, v252, v253
  s_cbranch_scc1 L_loop
  s_cmp_lg_u32 s37, 0
  s_cbranch_scc1 L_slow1
L_tail:
  s_cmp_lg_u32 s30, 0
  s_cbranch_scc1 L_pp1
  s_mov_b32 s32, 28672
  buffer_load_dword v28, v29, s[24:27], s32 offen sc1
L_pp1:
  v_mfma_f32_16x16x32_bf16 v[200:203], v[160:163], v[80:83], v[220:223]
  v_add_f32 v235, v235, v254
  v_add_f32 v235, v235, v255
  v_mfma_f32_16x16x32_bf16 v[204:207], v[176:179], v[80:83], v[220:223]
  v_exp_f32 v192, v192
  v_mfma_f32_16x16x32_bf16 v[200:203], v[164:167], v[84:87], v[200:203]
  v_cvt_pk_bf16_f32 v215, v254, v255
  v_add_f32 v232, v232, v192
  v_mfma_f32_16x16x32_bf16 v[204:207], v[180:183], v[84:87], v[204:207]
  v_exp_f32 v193, v193
  v_mfma_f32_16x16x32_bf16 v[200:203], v[168:171], v[88:91], v[200:203]
  v_add_f32 v232, v232, v193
  v_cvt_pk_bf16_f32 v208, v192, v193
  v_mfma_f32_16x16x32_bf16 v[204:207], v[184:187], v[88:91], v[204:207]
  v_exp_f32 v194, v194
  v_mfma_f32_16x16x32_bf16 v[200:203], v[172:175], v[92:95], v[200:203]
  v_exp_f32 v195, v195
  v_mfma_f32_16x16x32_bf16 v[204:207], v[188:191], v[92:95], v[204:207]
  v_add_f32 v232, v232, v194
  v_add_f32 v232, v232, v195
  v_mfma_f32_16x16x32_bf16 a[12:15], a[144:147], v[212:215], a[12:15]
  v_exp_f32 v196, v196
  v_mfma_f32_16x16x32_bf16 a[28:31], a[148:151], v[212:215], a[28:31]
  v_cvt_pk_bf16_f32 v209, v194, v195
  v_add_f32 v232, v232, v196
  v_mfma_f32_16x16x32_bf16 a[44:47], a[152:155], v[212:215], a[44:47]
  v_exp_f32 v197, v197
  v_mfma_f32_16x16x32_bf16 a[60:63], a[156:159], v[212:215], a[60:63]
  v_add_f32 v232, v232, v197
  v_cvt_pk_bf16_f32 v210, v196, v197
  v_mfma_f32_16x16x32_bf16 a[76:79], a[160:163], v[212:215], a[76:79]
  v_exp_f32 v198, v198
  v_mfma_f32_16x16x32_bf16 a[92:95], a[164:167], v[212:215], a[92:95]
  v_exp_f32 v199, v199
  v_mfma_f32_16x16x32_bf16 a[108:111], a[168:171], v[212:215], a[108:111]
  v_mfma_f32_16x16x32_bf16 a[124:127], a[172:175], v[212:215], a[124:127]
  v_mfma_f32_16x16x32_bf16 v[240:243], v[160:163], v[96:99], v[224:227]
  v_add_f32 v232, v232, v198
  v_add_f32 v232, v232, v199
  v_mfma_f32_16x16x32_bf16 v[244:247], v[176:179], v[96:99], v[224:227]
  v_exp_f32 v200, v200
  v_mfma_f32_16x16x32_bf16 v[240:243], v[164:167], v[100:103], v[240:243]
  v_cvt_pk_bf16_f32 v211, v198, v199
  v_add_f32 v233, v233, v200
  v_mfma_f32_16x16x32_bf16 v[244:247], v[180:183], v[100:103], v[244:247]
  v_exp_f32 v201, v201
  v_mfma_f32_16x16x32_bf16 v[240:243], v[168:171], v[104:107], v[240:243]
  v_add_f32 v233, v233, v201
  v_cvt_pk_bf16_f32 v212, v200, v201
  v_mfma_f32_16x16x32_bf16 v[244:247], v[184:187], v[104:107], v[244:247]
  v_exp_f32 v202, v202
  v_mfma_f32_16x16x32_bf16 v[240:243], v[172:175], v[108:111], v[240:243]
  v_exp_f32 v203, v203
  v_mfma_f32_16x16x32_bf16 v[244:247], v[188:191], v[108:111], v[244:247]
  v_add_f32 v233, v233, v202
  v_add_f32 v233, v233, v203
  v_mfma_f32_16x16x32_bf16 a[0:3], a[176:179], v[208:211], a[0:3]
  v_exp_f32 v204, v204
  v_mfma_f32_16x16x32_bf16 a[16:19], a[180:183], v[208:211], a[16:19]
  v_cvt_pk_bf16_f32 v213, v202, v203
  v_add_f32 v233, v233, v204
  v_mfma_f32_16x16x32_bf16 a[32:35], a[184:187], v[208:211], a[32:35]
  v_exp_f32 v205, v205
  v_mfma_f32_16x16x32_bf16 a[48:51], a[188:191], v[208:211], a[48:51]
  s_waitcnt lgkmcnt(0)
  v_add_f32 v233, v233, v205
  v_cvt_pk_bf16_f32 v214, v204, v205
  v_mfma_f32_16x16x32_bf16 a[64:67], a[192:195], v[208:211], a[64:67]
  v_exp_f32 v206, v206
  v_mfma_f32_16x16x32_bf16 a[80:83], a[196:199], v[208:211], a[80:83]
  v_exp_f32 v207, v207
  v_mfma_f32_16x16x32_bf16 a[96:99], a[200:203], v[208:211], a[96:99]
  v_mfma_f32_16x16x32_bf16 a[112:115], a[204:207], v[208:211], a[112:115]
  v_mfma_f32_16x16x32_bf16 v[248:251], v[160:163], v[112:115], v[228:231]
  v_add_f32 v233, v233, v206
  v_add_f32 v233, v233, v207
  v_mfma_f32_16x16x32_bf16 v[252:255], v[176:179], v[112:115], v[228:231]
  v_exp_f32 v240, v240
  v_mfma_f32_16x16x32_bf16 v[248:251], v[164:167], v[116:119], v[248:251]
  v_cvt_pk_bf16_f32 v215, v206, v207
  v_add_f32 v234, v234, v240
  v_mfma_f32_16x16x32_bf16 v[252:255], v[180:183], v[116:119], v[252:255]
  v_exp_f32 v241, v241
  v_mfma_f32_16x16x32_bf16 v[248:251], v[168:171], v[120:123], v[248:251]
  v_add_f32 v234, v234, v241
  v_cvt_pk_bf16_f32 v208, v240, v241
  v_mfma_f32_16x16x32_bf16 v[252:255], v[184:187], v[120:123], v[252:255]
  v_exp_f32 v242, v242
  v_mfma_f32_16x16x32_bf16 v[248:251], v[172:175], v[124:127], v[248:251]
  v_exp_f32 v243, v243
  v_mfma_f32_16x16x32_bf16 v[252:255], v[188:191], v[124:127], v[252:255]
  v_add_f32 v234, v234, v242
  v_add_f32 v234, v234, v243
  v_mfma_f32_16x16x32_bf16 a[4:7], a[176:179], v[212:215], a[4:7]
  v_exp_f32 v244, v244
  v_mfma_f32_16x16x32_bf16 a[20:23], a[180:183], v[212:215], a[20:23]
  v_cvt_pk_bf16_f32 v209, v242, v243
  v_add_f32 v234, v234, v244
  v_mfma_f32_16x16x32_bf16 a[36:39], a[184:187], v[212:215], a[36:39]
  v_exp_f32 v245, v245
  v_mfma_f32_16x16x32_bf16 a[52:55], a[188:191], v[212:215], a[52:55]
  v_add_f32 v234, v234, v245
  v_cvt_pk_bf16_f32 v210, v244, v245
  v_mfma_f32_16x16x32_bf16 a[68:71], a[192:195], v[212:215], a[68:71]
  v_exp_f32 v246, v246
  v_mfma_f32_16x16x32_bf16 a[84:87], a[196:199], v[212:215], a[84:87]
  v_exp_f32 v247, v247
  v_mfma_f32_16x16x32_bf16 a[100:103], a[200:203], v[212:215], a[100:103]
  v_mfma_f32_16x16x32_bf16 a[116:119], a[204:207], v[212:215], a[116:119]
  v_add_f32 v234, v234, v246
  v_add_f32 v234, v234, v247
  v_cvt_pk_bf16_f32 v211, v246, v247
  s_nop 1
  v_mfma_f32_16x16x32_bf16 a[8:11], a[176:179], v[208:211], a[8:11]
  v_exp_f32 v248, v248
  v_mfma_f32_16x16x32_bf16 a[24:27], a[180:183], v[208:211], a[24:27]
  v_exp_f32 v249, v249
  v_mfma_f32_16x16x32_bf16 a[40:43], a[184:187], v[208:211], a[40:43]
  v_exp_f32 v250, v250
  v_mfma_f32_16x16x32_bf16 a[56:59], a[188:191], v[208:211], a[56:59]
  v_exp_f32 v251, v251
  v_mfma_f32_16x16x32_bf16 a[72:75], a[192:195], v[208:211], a[72:75]
  v_exp_f32 v252, v252
  v_mfma_f32_16x16x32_bf16 a[88:91], a[196:199], v[208:211], a[88:91]
  v_exp_f32 v253, v253
  v_mfma_f32_16x16x32_bf16 a[104:107], a[200:203], v[208:211], a[104:107]
  v_exp_f32 v254, v254
  v_mfma_f32_16x16x32_bf16 a[120:123], a[204:207], v[208:211], a[120:123]
  v_exp_f32 v255, v255
  v_add_f32 v235, v235, v248
  v_add_f32 v235, v235, v249
  v_cvt_pk_bf16_f32 v212, v248, v249
  v_add_f32 v235, v235, v250
  v_add_f32 v235, v235, v251
  v_cvt_pk_bf16_f32 v213, v250, v251
  v_add_f32 v235, v235, v252
  v_add_f32 v235, v235, v253
  v_cvt_pk_bf16_f32 v214, v252, v253
  v_add_f32 v235, v235, v254
  v_add_f32 v235, v235, v255
  v_cvt_pk_bf16_f32 v215, v254, v255
  s_nop 1
  v_mfma_f32_16x16x32_bf16 a[12:15], a[176:179], v[212:215], a[12:15]
  v_mfma_f32_16x16x32_bf16 a[28:31], a[180:183], v[212:215], a[28:31]
  v_mfma_f32_16x16x32_bf16 a[44:47], a[184:187], v[212:215], a[44:47]
  v_mfma_f32_16x16x32_bf16 a[60:63], a[188:191], v[212:215], a[60:63]
  v_mfma_f32_16x16x32_bf16 a[76:79], a[192:195], v[212:215], a[76:79]
  v_mfma_f32_16x16x32_bf16 a[92:95], a[196:199], v[212:215], a[92:95]
  v_mfma_f32_16x16x32_bf16 a[108:111], a[200:203], v[212:215], a[108:111]
  v_mfma_f32_16x16x32_bf16 a[124:127], a[204:207], v[212:215], a[124:127]
L_epiA:
  s_lshl_b32 s31, s29, 2
  s_lshr_b32 s40, 1061701, s31
  s_and_b32 s40, s40, 15
  s_mov_b32 s42, 201656320
  s_mov_b32 s43, 3840
  s_lshl_b32 s31, s29, 3
  s_lshr_b64 s[42:43], s[42:43], s31
  s_and_b32 s41, s42, 255
  s_lshl_b32 s41, s41, 2
  s_mul_i32 s31, s30, s40
  s_add_u32 s41, s41, s31
  s_add_u32 s16, s6, 65011712
  s_addc_u32 s17, s7, 0
  s_and_b32 s17, s17, 0xffff
  s_mov_b32 s18, 229376
  s_mov_b32 s19, 0x20000
  s_mul_i32 s61, s30, 7168
  v_add_u32 v238, s61, v236
  s_waitcnt vmcnt(0) lgkmcnt(0)
  s_cmp_lg_u32 s30, 0
  s_cbranch_scc1 L_p0ok
  v_cmp_ne_u32 vcc, s100, v28
  s_mov_b32 s32, 28672
  s_cmp_eq_u64 vcc, 0
  s_cbranch_scc1 L_p0ok
  s_mov_b32 s34, 262144
L_p0s:
  buffer_load_dword v28, v29, s[24:27], s32 offen sc1
  s_waitcnt vmcnt(0)
  v_cmp_ne_u32 vcc, s100, v28
  s_sub_u32 s34, s34, 1
  s_cselect_b64 vcc, 0, vcc
  s_cmp_lg_u64 vcc, 0
  s_cbranch_scc1 L_p0s
L_p0ok:
  s_barrier
  s_cmp_eq_u32 s40, 0
  s_cbranch_scc1 L_epi0
  s_add_u32 s20, s6, 61865984
  s_addc_u32 s21, s7, 0
  s_and_b32 s21, s21, 0xffff
  s_mov_b32 s22, 2621440
  s_mov_b32 s23, 0x20000
  s_lshr_b32 s42, s41, 5
  s_lshl_b32 s31, s28, 1
  s_add_u32 s42, s42, s31
  s_and_b32 s43, s41, 31
  v_and_b32 v3, 31, v2
  v_lshlrev_b32 v3, 3, v3
  v_add_u32 v3, 1024, v3
  s_lshl_b32 s58, s42, 5
  s_add_u32 s58, s58, s43
  s_mul_i32 s58, s58, 1280
  s_cmp_ge_u32 s3, 148
  s_cselect_b32 s66, 0, s66
  s_mul_i32 s59, s30, 10496
  s_add_u32 s59, s59, 98304
  s_mov_b64 exec, 0xffff
  s_add_u32 m0, s59, 1024
  s_add_u32 s34, s44, 1024
  buffer_load_dwordx4 v236, s[64:67], s34 offen lds
  s_add_u32 m0, s59, 2336
  s_add_u32 s34, s44, 2304
  buffer_load_dwordx4 v236, s[64:67], s34 offen lds
  s_add_u32 m0, s59, 3648
  s_add_u32 s34, s44, 3584
  buffer_load_dwordx4 v236, s[64:67], s34 offen lds
  s_add_u32 m0, s59, 4960
  s_add_u32 s34, s44, 4864
  buffer_load_dwordx4 v236, s[64:67], s34 offen lds
  s_add_u32 m0, s59, 6272
  s_add_u32 s34, s44, 6144
  buffer_load_dwordx4 v236, s[64:67], s34 offen lds
  s_add_u32 m0, s59, 7584
  s_add_u32 s34, s44, 7424
  buffer_load_dwordx4 v236, s[64:67], s34 offen lds
  s_add_u32 m0, s59, 8896
  s_add_u32 s34, s44, 8704
  buffer_load_dwordx4 v236, s[64:67], s34 offen lds
  s_add_u32 m0, s59, 10208
  s_add_u32 s34, s44, 9984
  buffer_load_dwordx4 v236, s[64:67], s34 offen lds
  s_mov_b64 exec, -1
  v_mov_b32 v248, v232
  v_mov_b32 v249, v233
  v_mov_b32 v250, v234
  v_mov_b32 v251, v235
  s_nop 0
  v_permlane32_swap_b32 v232, v248
  v_permlane32_swap_b32 v233, v249
  v_permlane32_swap_b32 v234, v250
  v_permlane32_swap_b32 v235, v251
  s_nop 0
  v_add_f32 v232, v232, v248
  v_add_f32 v233, v233, v249
  buffer_load_dwordx4 v[192:195], v236, s[20:23], s58 offen offset:0 sc1
  v_add_f32 v234, v234, v250
  v_add_f32 v235, v235, v251
  v_mov_b32 v248, v232
  v_mov_b32 v249, v233
  v_mov_b32 v250, v234
  v_mov_b32 v251, v235
  s_nop 0
  v_permlane16_swap_b32 v232, v248
  v_permlane16_swap_b32 v233, v249
  v_permlane16_swap_b32 v234, v250
  v_permlane16_swap_b32 v235, v251
  s_nop 0
  v_add_f32 v232, v232, v248
  buffer_load_dwordx2 v[196:197], v3, s[20:23], s58 offen offset:0 sc1
  v_add_f32 v233, v233, v249
  v_add_f32 v234, v234, v250
  v_add_f32 v235, v235, v251
  v_accvgpr_write_b32 a128, v232
  v_accvgpr_write_b32 a132, v233
  v_accvgpr_write_b32 a136, v234
  v_accvgpr_write_b32 a140, v235
  s_mov_b32 s31, 1904214016
  s_mov_b64 s[56:57], 0
  v_accvgpr_read_b32 v240, a128
  v_cmp_ngt_f32 vcc, s31, v240
  s_nop 1
  s_or_b64 s[56:57], s[56:57], vcc
  buffer_load_dwordx4 v[200:203], v236, s[20:23], s58 offen offset:1280 sc1
  v_cmp_nlt_f32 vcc, 0.5, v240
  s_nop 1
  s_or_b64 s[56:57], s[56:57], vcc
  v_accvgpr_read_b32 v241, a132
  v_cmp_ngt_f32 vcc, s31, v241
  s_nop 1
  s_or_b64 s[56:57], s[56:57], vcc
  v_cmp_nlt_f32 vcc, 0.5, v241
  s_nop 1
  s_or_b64 s[56:57], s[56:57], vcc
  buffer_load_dwordx2 v[204:205], v3, s[20:23], s58 offen offset:1280 sc1
  v_accvgpr_read_b32 v242, a136
  v_cmp_ngt_f32 vcc, s31, v242
  s_nop 1
  s_or_b64 s[56:57], s[56:57], vcc
  v_cmp_nlt_f32 vcc, 0.5, v242
  s_nop 1
  s_or_b64 s[56:57], s[56:57], vcc
  v_accvgpr_read_b32 v243, a140
  v_cmp_ngt_f32 vcc, s31, v243
  s_nop 1
  s_or_b64 s[56:57], s[56:57], vcc
  v_cmp_nlt_f32 vcc, 0.5, v243
  s_nop 1
  s_or_b64 s[56:57], s[56:57], vcc
  buffer_load_dwordx4 v[208:211], v236, s[20:23], s58 offen offset:2560 sc1
  s_cmp_lg_u64 s[56:57], 0
  s_cselect_b32 s31, 1, 0
  v_mov_b32 v7, s31
  s_lshl_b32 s31, s30, 2
  s_add_u32 s31, s31, 163824
  v_mov_b32 v6, s31
  ds_write_b32 v6, v7
  v_rcp_f32 v244, v240
  v_rcp_f32 v245, v241
  v_rcp_f32 v246, v242
  buffer_load_dwordx2 v[212:213], v3, s[20:23], s58 offen offset:2560 sc1
  v_rcp_f32 v247, v243
  s_lshl_b32 s31, s29, 4
  s_add_u32 s32, s31, s30
  s_sub_u32 s33, s31, s30
  s_add_u32 s33, s33, 7
  s_mul_i32 s32, s32, 151552
  s_mul_i32 s33, s33, 151552
  s_lshl_b32 s31, s28, 12
  s_add_u32 s32, s32, s31
  s_add_u32 s33, s33, s31
  v_accvgpr_read_b32 v128, a0
  v_accvgpr_read_b32 v129, a1
  s_add_u32 s58, s58, 3840
  buffer_load_dwordx4 v[216:219], v236, s[20:23], s58 offen offset:0 sc1
  v_accvgpr_read_b32 v130, a2
  v_accvgpr_read_b32 v131, a3
  v_accvgpr_read_b32 v132, a16
  v_accvgpr_read_b32 v133, a17
  v_accvgpr_read_b32 v134, a18
  v_accvgpr_read_b32 v135, a19
  v_mul_f32 v128, v128, v244
  v_mul_f32 v129, v129, v244
  v_mul_f32 v130, v130, v244
  v_mul_f32 v131, v131, v244
  v_mul_f32 v132, v132, v244
  v_mul_f32 v133, v133, v244
  buffer_load_dwordx2 v[220:221], v3, s[20:23], s58 offen offset:0 sc1
  v_mul_f32 v134, v134, v244
  v_mul_f32 v135, v135, v244
  v_cvt_pk_bf16_f32 v136, v128, v129
  v_cvt_pk_bf16_f32 v137, v130, v131
  v_cvt_pk_bf16_f32 v138, v132, v133
  v_cvt_pk_bf16_f32 v139, v134, v135
  buffer_store_dwordx4 v[136:139], v236, s[12:15], s32 offen offset:0 sc1
  v_accvgpr_read_b32 v144, a32
  v_accvgpr_read_b32 v145, a33
  v_accvgpr_read_b32 v146, a34
  v_accvgpr_read_b32 v147, a35
  v_accvgpr_read_b32 v148, a48
  buffer_load_dwordx4 v[224:227], v236, s[20:23], s58 offen offset:1280 sc1
  v_accvgpr_read_b32 v149, a49
  v_accvgpr_read_b32 v150, a50
  v_accvgpr_read_b32 v151, a51
  v_mul_f32 v144, v144, v244
  v_mul_f32 v145, v145, v244
  v_mul_f32 v146, v146, v244
  v_mul_f32 v147, v147, v244
  v_mul_f32 v148, v148, v244
  v_mul_f32 v149, v149, v244
  v_mul_f32 v150, v150, v244
  v_mul_f32 v151, v151, v244
  v_cvt_pk_bf16_f32 v152, v144, v145
  buffer_load_dwordx2 v[228:229], v3, s[20:23], s58 offen offset:1280 sc1
  v_cvt_pk_bf16_f32 v153, v146, v147
  v_cvt_pk_bf16_f32 v154, v148, v149
  v_cvt_pk_bf16_f32 v155, v150, v151
  buffer_store_dwordx4 v[152:155], v236, s[12:15], s32 offen offset:1024 sc1
  v_accvgpr_read_b32 v160, a64
  v_accvgpr_read_b32 v161, a65
  v_accvgpr_read_b32 v162, a66
  v_accvgpr_read_b32 v163, a67
  v_accvgpr_read_b32 v164, a80
  v_accvgpr_read_b32 v165, a81
  v_accvgpr_read_b32 v166, a82
  v_accvgpr_read_b32 v167, a83
  s_add_u32 m0, s61, 0
  s_mov_b32 s34, 0
  buffer_load_dwordx4 v238, s[16:19], s34 offen offset:0 sc1 lds
  v_mul_f32 v160, v160, v244
  v_mul_f32 v161, v161, v244
  v_mul_f32 v162, v162, v244
  v_mul_f32 v163, v163, v244
  v_mul_f32 v164, v164, v244
  v_mul_f32 v165, v165, v244
  v_mul_f32 v166, v166, v244
  v_mul_f32 v167, v167, v244
  v_cvt_pk_bf16_f32 v168, v160, v161
  v_cvt_pk_bf16_f32 v169, v162, v163
  v_cvt_pk_bf16_f32 v170, v164, v165
  v_cvt_pk_bf16_f32 v171, v166, v167
  buffer_load_dwordx4 v238, s[16:19], s34 offen offset:1024 sc1 lds
  buffer_store_dwordx4 v[168:171], v236, s[12:15], s32 offen offset:2048 sc1
  v_accvgpr_read_b32 v176, a96
  v_accvgpr_read_b32 v177, a97
  v_accvgpr_read_b32 v178, a98
  v_accvgpr_read_b32 v179, a99
  v_accvgpr_read_b32 v180, a112
  v_accvgpr_read_b32 v181, a113
  v_accvgpr_read_b32 v182, a114
  v_accvgpr_read_b32 v183, a115
  v_mul_f32 v176, v176, v244
  v_mul_f32 v177, v177, v244
  v_mul_f32 v178, v178, v244
  buffer_load_dwordx4 v238, s[16:19], s34 offen offset:2048 sc1 lds
  v_mul_f32 v179, v179, v244
  v_mul_f32 v180, v180, v244
  v_mul_f32 v181, v181, v244
  v_mul_f32 v182, v182, v244
  v_mul_f32 v183, v183, v244
  v_cvt_pk_bf16_f32 v184, v176, v177
  v_cvt_pk_bf16_f32 v185, v178, v179
  v_cvt_pk_bf16_f32 v186, v180, v181
  v_cvt_pk_bf16_f32 v187, v182, v183
  buffer_store_dwordx4 v[184:187], v236, s[12:15], s32 offen offset:3072 sc1
  v_accvgpr_read_b32 v128, a4
  v_accvgpr_read_b32 v129, a5
  buffer_load_dwordx4 v238, s[16:19], s34 offen offset:3072 sc1 lds
  v_accvgpr_read_b32 v130, a6
  v_accvgpr_read_b32 v131, a7
  v_accvgpr_read_b32 v132, a20
  v_accvgpr_read_b32 v133, a21
  v_accvgpr_read_b32 v134, a22
  v_accvgpr_read_b32 v135, a23
  v_mul_f32 v128, v128, v245
  v_mul_f32 v129, v129, v245
  v_mul_f32 v130, v130, v245
  v_mul_f32 v131, v131, v245
  v_mul_f32 v132, v132, v245
  v_mul_f32 v133, v133, v245
  s_add_u32 m0, s61, 4096
  s_mov_b32 s34, 4096
  buffer_load_dwordx4 v238, s[16:19], s34 offen offset:0 sc1 lds
  v_mul_f32 v134, v134, v245
  v_mul_f32 v135, v135, v245
  v_cvt_pk_bf16_f32 v136, v128, v129
  v_cvt_pk_bf16_f32 v137, v130, v131
  v_cvt_pk_bf16_f32 v138, v132, v133
  v_cvt_pk_bf16_f32 v139, v134, v135
  buffer_store_dwordx4 v[136:139], v236, s[12:15], s33 offen offset:0 sc1
  v_accvgpr_read_b32 v144, a36
  v_accvgpr_read_b32 v145, a37
  v_accvgpr_read_b32 v146, a38
  v_accvgpr_read_b32 v147, a39
  v_accvgpr_read_b32 v148, a52
  buffer_load_dwordx4 v238, s[16:19], s34 offen offset:1024 sc1 lds
  v_accvgpr_read_b32 v149, a53
  v_accvgpr_read_b32 v150, a54
  v_accvgpr_read_b32 v151, a55
  v_mul_f32 v144, v144, v245
  v_mul_f32 v145, v145, v245
  v_mul_f32 v146, v146, v245
  v_mul_f32 v147, v147, v245
  v_mul_f32 v148, v148, v245
  v_mul_f32 v149, v149, v245
  v_mul_f32 v150, v150, v245
  v_mul_f32 v151, v151, v245
  v_cvt_pk_bf16_f32 v152, v144, v145
  buffer_load_dwordx4 v238, s[16:19], s34 offen offset:2048 sc1 lds
  v_cvt_pk_bf16_f32 v153, v146, v147
  v_cvt_pk_bf16_f32 v154, v148, v149
  v_cvt_pk_bf16_f32 v155, v150, v151
  buffer_store_dwordx4 v[152:155], v236, s[12:15], s33 offen offset:1024 sc1
  v_accvgpr_read_b32 v160, a68
  v_accvgpr_read_b32 v161, a69
  v_accvgpr_read_b32 v162, a70
  v_accvgpr_read_b32 v163, a71
  v_accvgpr_read_b32 v164, a84
  v_accvgpr_read_b32 v165, a85
  v_accvgpr_read_b32 v166, a86
  v_accvgpr_read_b32 v167, a87
  s_add_u32 m0, s59, 0
  s_add_u32 s34, s44, 0
  buffer_load_dwordx4 v236, s[64:67], s34 offen lds
  v_mul_f32 v160, v160, v245
  v_mul_f32 v161, v161, v245
  v_mul_f32 v162, v162, v245
  v_mul_f32 v163, v163, v245
  v_mul_f32 v164, v164, v245
  v_mul_f32 v165, v165, v245
  v_mul_f32 v166, v166, v245
  v_mul_f32 v167, v167, v245
  v_cvt_pk_bf16_f32 v168, v160, v161
  v_cvt_pk_bf16_f32 v169, v162, v163
  v_cvt_pk_bf16_f32 v170, v164, v165
  v_cvt_pk_bf16_f32 v171, v166, v167
  s_add_u32 m0, s59, 1312
  s_add_u32 s34, s44, 1280
  buffer_load_dwordx4 v236, s[64:67], s34 offen lds
  buffer_store_dwordx4 v[168:171], v236, s[12:15], s33 offen offset:2048 sc1
  v_accvgpr_read_b32 v176, a100
  v_accvgpr_read_b32 v177, a101
  v_accvgpr_read_b32 v178, a102
  v_accvgpr_read_b32 v179, a103
  v_accvgpr_read_b32 v180, a116
  v_accvgpr_read_b32 v181, a117
  v_accvgpr_read_b32 v182, a118
  v_accvgpr_read_b32 v183, a119
  v_mul_f32 v176, v176, v245
  v_mul_f32 v177, v177, v245
  v_mul_f32 v178, v178, v245
  s_add_u32 m0, s59, 2624
  s_add_u32 s34, s44, 2560
  buffer_load_dwordx4 v236, s[64:67], s34 offen lds
  v_mul_f32 v179, v179, v245
  v_mul_f32 v180, v180, v245
  v_mul_f32 v181, v181, v245
  v_mul_f32 v182, v182, v245
  v_mul_f32 v183, v183, v245
  v_cvt_pk_bf16_f32 v184, v176, v177
  v_cvt_pk_bf16_f32 v185, v178, v179
  v_cvt_pk_bf16_f32 v186, v180, v181
  v_cvt_pk_bf16_f32 v187, v182, v183
  buffer_store_dwordx4 v[184:187], v236, s[12:15], s33 offen offset:3072 sc1
  s_add_u32 s32, s32, 1212416
  s_add_u32 s33, s33, 1212416
  s_add_u32 m0, s59, 3936
  s_add_u32 s34, s44, 3840
  buffer_load_dwordx4 v236, s[64:67], s34 offen lds
  v_accvgpr_read_b32 v128, a8
  v_accvgpr_read_b32 v129, a9
  v_accvgpr_read_b32 v130, a10
  v_accvgpr_read_b32 v131, a11
  v_accvgpr_read_b32 v132, a24
  v_accvgpr_read_b32 v133, a25
  v_accvgpr_read_b32 v134, a26
  v_accvgpr_read_b32 v135, a27
  v_mul_f32 v128, v128, v246
  v_mul_f32 v129, v129, v246
  v_mul_f32 v130, v130, v246
  v_mul_f32 v131, v131, v246
  s_add_u32 m0, s59, 5248
  s_add_u32 s34, s44, 5120
  buffer_load_dwordx4 v236, s[64:67], s34 offen lds
  v_mul_f32 v132, v132, v246
  v_mul_f32 v133, v133, v246
  v_mul_f32 v134, v134, v246
  v_mul_f32 v135, v135, v246
  v_cvt_pk_bf16_f32 v136, v128, v129
  v_cvt_pk_bf16_f32 v137, v130, v131
  v_cvt_pk_bf16_f32 v138, v132, v133
  v_cvt_pk_bf16_f32 v139, v134, v135
  buffer_store_dwordx4 v[136:139], v236, s[12:15], s32 offen offset:0 sc1
  v_accvgpr_read_b32 v144, a40
  v_accvgpr_read_b32 v145, a41
  v_accvgpr_read_b32 v146, a42
  s_add_u32 m0, s59, 6560
  s_add_u32 s34, s44, 6400
  buffer_load_dwordx4 v236, s[64:67], s34 offen lds
  v_accvgpr_read_b32 v147, a43
  v_accvgpr_read_b32 v148, a56
  v_accvgpr_read_b32 v149, a57
  v_accvgpr_read_b32 v150, a58
  v_accvgpr_read_b32 v151, a59
  v_mul_f32 v144, v144, v246
  v_mul_f32 v145, v145, v246
  v_mul_f32 v146, v146, v246
  v_mul_f32 v147, v147, v246
  v_mul_f32 v148, v148, v246
  v_mul_f32 v149, v149, v246
  v_mul_f32 v150, v150, v246
  s_add_u32 m0, s59, 7872
  s_add_u32 s34, s44, 7680
  buffer_load_dwordx4 v236, s[64:67], s34 offen lds
  v_mul_f32 v151, v151, v246
  v_cvt_pk_bf16_f32 v152, v144, v145
  v_cvt_pk_bf16_f32 v153, v146, v147
  v_cvt_pk_bf16_f32 v154, v148, v149
  v_cvt_pk_bf16_f32 v155, v150, v151
  buffer_store_dwordx4 v[152:155], v236, s[12:15], s32 offen offset:1024 sc1
  v_accvgpr_read_b32 v160, a72
  v_accvgpr_read_b32 v161, a73
  v_accvgpr_read_b32 v162, a74
  v_accvgpr_read_b32 v163, a75
  v_accvgpr_read_b32 v164, a88
  v_accvgpr_read_b32 v165, a89
  s_add_u32 m0, s59, 9184
  s_add_u32 s34, s44, 8960
  buffer_load_dwordx4 v236, s[64:67], s34 offen lds
  v_accvgpr_read_b32 v166, a90
  v_accvgpr_read_b32 v167, a91
  v_mul_f32 v160, v160, v246
  v_mul_f32 v161, v161, v246
  v_mul_f32 v162, v162, v246
  v_mul_f32 v163, v163, v246
  v_mul_f32 v164, v164, v246
  v_mul_f32 v165, v165, v246
  v_mul_f32 v166, v166, v246
  v_mul_f32 v167, v167, v246
  v_cvt_pk_bf16_f32 v168, v160, v161
  v_cvt_pk_bf16_f32 v169, v162, v163
  s_add_u32 m0, s61, 32768
  s_mov_b32 s34, 28672
  buffer_load_dwordx4 v238, s[16:19], s34 offen offset:0 sc1 lds
  v_cvt_pk_bf16_f32 v170, v164, v165
  v_cvt_pk_bf16_f32 v171, v166, v167
  buffer_store_dwordx4 v[168:171], v236, s[12:15], s32 offen offset:2048 sc1
  v_accvgpr_read_b32 v176, a104
  v_accvgpr_read_b32 v177, a105
  v_accvgpr_read_b32 v178, a106
  v_accvgpr_read_b32 v179, a107
  v_accvgpr_read_b32 v180, a120
  v_accvgpr_read_b32 v181, a121
  v_accvgpr_read_b32 v182, a122
  v_accvgpr_read_b32 v183, a123
  v_mul_f32 v176, v176, v246
  buffer_load_dwordx4 v238, s[16:19], s34 offen offset:1024 sc1 lds
  v_mul_f32 v177, v177, v246
  v_mul_f32 v178, v178, v246
  v_mul_f32 v179, v179, v246
  v_mul_f32 v180, v180, v246
  v_mul_f32 v181, v181, v246
  v_mul_f32 v182, v182, v246
  v_mul_f32 v183, v183, v246
  v_cvt_pk_bf16_f32 v184, v176, v177
  v_cvt_pk_bf16_f32 v185, v178, v179
  v_cvt_pk_bf16_f32 v186, v180, v181
  v_cvt_pk_bf16_f32 v187, v182, v183
  buffer_store_dwordx4 v[184:187], v236, s[12:15], s32 offen offset:3072 sc1
  buffer_load_dwordx4 v238, s[16:19], s34 offen offset:2048 sc1 lds
  v_accvgpr_read_b32 v128, a12
  v_accvgpr_read_b32 v129, a13
  v_accvgpr_read_b32 v130, a14
  v_accvgpr_read_b32 v131, a15
  v_accvgpr_read_b32 v132, a28
  v_accvgpr_read_b32 v133, a29
  v_accvgpr_read_b32 v134, a30
  v_accvgpr_read_b32 v135, a31
  v_mul_f32 v128, v128, v247
  v_mul_f32 v129, v129, v247
  v_mul_f32 v130, v130, v247
  v_mul_f32 v131, v131, v247
  buffer_load_dwordx4 v238, s[16:19], s34 offen offset:3072 sc1 lds
  v_mul_f32 v132, v132, v247
  v_mul_f32 v133, v133, v247
  v_mul_f32 v134, v134, v247
  v_mul_f32 v135, v135, v247
  v_cvt_pk_bf16_f32 v136, v128, v129
  v_cvt_pk_bf16_f32 v137, v130, v131
  v_cvt_pk_bf16_f32 v138, v132, v133
  v_cvt_pk_bf16_f32 v139, v134, v135
  buffer_store_dwordx4 v[136:139], v236, s[12:15], s33 offen offset:0 sc1
  v_accvgpr_read_b32 v144, a44
  v_accvgpr_read_b32 v145, a45
  v_accvgpr_read_b32 v146, a46
  s_add_u32 m0, s61, 36864
  s_mov_b32 s34, 32768
  buffer_load_dwordx4 v238, s[16:19], s34 offen offset:0 sc1 lds
  v_accvgpr_read_b32 v147, a47
  v_accvgpr_read_b32 v148, a60
  v_accvgpr_read_b32 v149, a61
  v_accvgpr_read_b32 v150, a62
  v_accvgpr_read_b32 v151, a63
  v_mul_f32 v144, v144, v247
  v_mul_f32 v145, v145, v247
  v_mul_f32 v146, v146, v247
  v_mul_f32 v147, v147, v247
  v_mul_f32 v148, v148, v247
  v_mul_f32 v149, v149, v247
  v_mul_f32 v150, v150, v247
  buffer_load_dwordx4 v238, s[16:19], s34 offen offset:1024 sc1 lds
  v_mul_f32 v151, v151, v247
  v_cvt_pk_bf16_f32 v152, v144, v145
  v_cvt_pk_bf16_f32 v153, v146, v147
  v_cvt_pk_bf16_f32 v154, v148, v149
  v_cvt_pk_bf16_f32 v155, v150, v151
  buffer_store_dwordx4 v[152:155], v236, s[12:15], s33 offen offset:1024 sc1
  v_accvgpr_read_b32 v160, a76
  v_accvgpr_read_b32 v161, a77
  v_accvgpr_read_b32 v162, a78
  v_accvgpr_read_b32 v163, a79
  v_accvgpr_read_b32 v164, a92
  v_accvgpr_read_b32 v165, a93
  buffer_load_dwordx4 v238, s[16:19], s34 offen offset:2048 sc1 lds
  v_accvgpr_read_b32 v166, a94
  v_accvgpr_read_b32 v167, a95
  v_mul_f32 v160, v160, v247
  v_mul_f32 v161, v161, v247
  v_mul_f32 v162, v162, v247
  v_mul_f32 v163, v163, v247
  v_mul_f32 v164, v164, v247
  v_mul_f32 v165, v165, v247
  v_mul_f32 v166, v166, v247
  v_mul_f32 v167, v167, v247
  v_cvt_pk_bf16_f32 v168, v160, v161
  v_cvt_pk_bf16_f32 v169, v162, v163
  v_cvt_pk_bf16_f32 v170, v164, v165
  v_cvt_pk_bf16_f32 v171, v166, v167
  buffer_store_dwordx4 v[168:171], v236, s[12:15], s33 offen offset:2048 sc1
  v_accvgpr_read_b32 v176, a108
  v_accvgpr_read_b32 v177, a109
  v_accvgpr_read_b32 v178, a110
  v_accvgpr_read_b32 v179, a111
  v_accvgpr_read_b32 v180, a124
  v_accvgpr_read_b32 v181, a125
  v_accvgpr_read_b32 v182, a126
  v_accvgpr_read_b32 v183, a127
  v_mul_f32 v176, v176, v247
  v_mul_f32 v177, v177, v247
  v_mul_f32 v178, v178, v247
  v_mul_f32 v179, v179, v247
  v_mul_f32 v180, v180, v247
  v_mul_f32 v181, v181, v247
  v_mul_f32 v182, v182, v247
  v_mul_f32 v183, v183, v247
  v_cvt_pk_bf16_f32 v184, v176, v177
  v_cvt_pk_bf16_f32 v185, v178, v179
  v_cvt_pk_bf16_f32 v186, v180, v181
  v_cvt_pk_bf16_f32 v187, v182, v183
  buffer_store_dwordx4 v[184:187], v236, s[12:15], s33 offen offset:3072 sc1
  s_waitcnt vmcnt(13) lgkmcnt(0)
L_nopref2:
  s_barrier
  v_mov_b32 v6, 163824
  ds_read_b128 v[12:15], v6
  s_waitcnt lgkmcnt(0)
  v_or3_b32 v12, v12, v13, v14
  v_or_b32 v12, v12, v15
  s_nop 0
  v_readfirstlane_b32 s31, v12
  s_nop 0
  s_cmp_lg_u32 s39, 0
  s_cselect_b32 s31, 0, s31
  s_cmp_lg_u32 s31, 0
  s_cbranch_scc1 L_fbA
  s_cmp_eq_u32 s40, 0
  s_cbranch_scc1 L_fin0
  s_mov_b32 s39, 0
  s_cmp_eq_u32 s30, 0
  s_cselect_b32 s45, 1, 0
  s_cmp_lt_u32 s3, 128
  s_cselect_b32 s31, 2, 3
  s_mov_b32 s33, 5248
  s_cselect_b32 s33, 20992, s33
  v_bfe_u32 v6, v2, 2, 2
  v_lshlrev_b32 v3, s31, v5
  v_add_u32 v3, v3, v6
  v_mul_u32_u24 v3, 1312, v3
  v_and_b32 v7, 3, v2
  v_mul_u32_u24 v7, 40, v7
  s_mul_i32 s31, s30, 320
  s_add_u32 s31, s31, 98304
  v_add3_u32 v3, v3, v7, s31
  v_add_u32 v6, s33, v3
  v_add_u32 v27, 4096, v236
  ds_read_b64_tr_b16 v[28:29], v3 offset:0
  ds_read_b64_tr_b16 v[30:31], v6 offset:0
  ds_read_b64_tr_b16 v[32:33], v3 offset:8
  ds_read_b64_tr_b16 v[34:35], v6 offset:8
  ds_read_b64_tr_b16 v[36:37], v3 offset:16
  ds_read_b64_tr_b16 v[38:39], v6 offset:16
  ds_read_b64_tr_b16 v[40:41], v3 offset:24
  ds_read_b64_tr_b16 v[42:43], v6 offset:24
  ds_read_b64_tr_b16 v[44:45], v3 offset:32
  ds_read_b64_tr_b16 v[46:47], v6 offset:32
  ds_read_b64_tr_b16 v[48:49], v3 offset:160
  ds_read_b64_tr_b16 v[50:51], v6 offset:160
  ds_read_b64_tr_b16 v[52:53], v3 offset:168
  ds_read_b64_tr_b16 v[54:55], v6 offset:168
  ds_read_b64_tr_b16 v[56:57], v3 offset:176
  ds_read_b64_tr_b16 v[58:59], v6 offset:176
  ds_read_b64_tr_b16 v[60:61], v3 offset:184
  ds_read_b64_tr_b16 v[62:63], v6 offset:184
  ds_read_b64_tr_b16 v[180:181], v3 offset:192
  ds_read_b64_tr_b16 v[182:183], v6 offset:192
  s_add_u32 s64, s6, 54525952
  s_addc_u32 s65, s7, 0
  s_and_b32 s65, s65, 0xffff
  s_mov_b32 s66, 6062080
  s_mov_b32 s67, 0x20000
  s_mul_i32 s44, s30, 1515520
  s_mul_i32 s33, s3, 5120
  s_add_u32 s44, s44, s33
  s_cmp_ge_u32 s3, 148
  s_cselect_b32 s66, 0, s66
L_B_start:
  ds_read_b128 v[144:147], v236 offset:0
  ds_read_b128 v[152:155], v236 offset:24576
  s_mov_b32 s34, 86016
  s_mov_b32 s38, 0
  s_mov_b32 s37, 8
  s_cmp_eq_u32 s40, 1
  s_cbranch_scc1 L_B1
  s_cmp_eq_u32 s40, 3
  s_cbranch_scc1 L_B3
  s_cmp_eq_u32 s40, 4
  s_cbranch_scc1 L_B4
  s_branch L_B5
L_B1:
  s_cmp_lg_u32 s39, 0
  s_cbranch_scc1 L_Bh1
  s_mov_b32 vcc_lo, -1
  s_mov_b32 vcc_hi, 0
  v_cndmask_b32 v196, 0, v196, vcc
  v_cndmask_b32 v197, 0, v197, vcc
  v_accvgpr_write_b32 a0, 0
  v_accvgpr_write_b32 a1, 0
  v_accvgpr_write_b32 a2, 0
  v_accvgpr_write_b32 a3, 0
  v_accvgpr_write_b32 a4, 0
  v_accvgpr_write_b32 a5, 0
  v_accvgpr_write_b32 a6, 0
  v_accvgpr_write_b32 a7, 0
  v_accvgpr_write_b32 a8, 0
  v_accvgpr_write_b32 a9, 0
  v_accvgpr_write_b32 a10, 0
  v_accvgpr_write_b32 a11, 0
  s_waitcnt lgkmcnt(0)
  v_mfma_f32_32x32x16_bf16 v[64:79], v[144:147], v[192:195], 0
  buffer_store_dwordx4 v[28:31], v236, s[64:67], s44 offen offset:0 sc1
  v_accvgpr_write_b32 a12, 0
  v_accvgpr_write_b32 a13, 0
  v_accvgpr_write_b32 a14, 0
  v_accvgpr_write_b32 a15, 0
  s_add_u32 s31, s2, s100
  s_and_b32 s48, s31, 3
  s_lshr_b32 s32, s31, 2
  buffer_store_dwordx4 v[32:35], v236, s[64:67], s44 offen offset:1024 sc1
  s_xor_b32 s31, s31, s32
  s_and_b32 s31, s31, 1
  s_lshl_b32 s49, s31, 3
  s_mov_b32 s56, 0
  s_mov_b32 s57, 0
  s_cmp_eq_u32 s48, 1
  s_cselect_b32 s56, 470618644, s56
  s_cselect_b32 s57, 134746129, s57
  buffer_store_dwordx4 v[36:39], v236, s[64:67], s44 offen offset:2048 sc1
  s_cmp_eq_u32 s48, 2
  s_cselect_b32 s56, 606020380, s56
  s_cselect_b32 s57, 605822241, s57
  s_cmp_eq_u32 s48, 3
  s_cselect_b32 s56, 942682936, s56
  s_cselect_b32 s57, 740568878, s57
  buffer_store_dwordx4 v[40:43], v236, s[64:67], s44 offen offset:3072 sc1
  s_lshl_b32 s31, s29, 3
  s_lshr_b64 s[56:57], s[56:57], s31
  s_and_b32 s54, s56, 255
  s_mov_b32 s56, 135269640
  s_mov_b32 s57, 337383698
  s_lshr_b64 s[56:57], s[56:57], s31
  s_and_b32 s55, s56, 255
  buffer_store_dwordx4 v[44:47], v27, s[64:67], s44 offen sc1
  s_cmp_eq_u32 s49, 0
  s_cselect_b32 s32, 3, 2
  s_bitcmp1_b32 s48, 0
  s_cselect_b32 s33, s32, 0
  s_add_u32 s54, s54, s33
  s_lshl_b32 s33, s33, 1
  s_sub_u32 s32, s32, s33
  s_add_u32 s44, s44, 757760
  s_add_u32 s55, s55, s32
  s_lshl_b32 s31, s29, 2
  s_lshr_b32 s31, 544478803, s31
  s_sub_u32 s32, s31, s48
  s_and_b32 s32, s32, 3
  s_and_b32 s31, s31, 4
  s_or_b32 s31, s31, s32
  v_mfma_f32_32x32x8_bf16 v[64:79], v[152:153], v[196:197], v[64:79]
  s_add_u32 m0, s61, 65536
  s_mov_b32 s60, 57344
  buffer_load_dwordx4 v238, s[16:19], s60 offen offset:0 sc1 lds
  buffer_store_dwordx4 v[48:51], v236, s[64:67], s44 offen offset:0 sc1
  s_and_b32 s50, s31, 2
  s_bfe_u32 s32, s28, 0x10001
  s_or_b32 s50, s50, s32
  s_and_b32 s32, s31, 1
  s_lshl_b32 s32, s32, 1
  s_and_b32 s31, s31, 4
  s_or_b32 s31, s31, s32
  buffer_load_dwordx4 v238, s[16:19], s60 offen offset:1024 sc1 lds
  buffer_store_dwordx4 v[52:55], v236, s[64:67], s44 offen offset:1024 sc1
  s_and_b32 s32, s28, 1
  s_or_b32 s31, s31, s32
  s_lshl_b32 s31, s31, 2
  s_lshr_b32 s31, 1980781618, s31
  s_and_b32 s31, s31, 7
  s_add_u32 s49, s49, s31
  s_lshl_b32 s51, s49, 2
  buffer_load_dwordx4 v238, s[16:19], s60 offen offset:2048 sc1 lds
  buffer_store_dwordx4 v[56:59], v236, s[64:67], s44 offen offset:2048 sc1
  s_add_u32 s51, s51, s50
  s_and_b32 s52, s30, 1
  s_lshr_b32 s53, s30, 1
  v_and_b32 v9, 31, v2
  v_lshlrev_b32 v9, 2, v9
  s_lshr_b32 s62, s49, 1
  s_lshl_b32 s62, s62, 7
  buffer_load_dwordx4 v238, s[16:19], s60 offen offset:3072 sc1 lds
  buffer_store_dwordx4 v[60:63], v236, s[64:67], s44 offen offset:3072 sc1
  s_add_u32 s62, s62, 4096
  s_lshr_b32 s31, s54, 1
  s_add_u32 s32, s54, s55
  s_add_u32 s32, s32, 1
  s_lshr_b32 s32, s32, 1
  s_sub_u32 s32, s32, s31
  s_bfm_b32 s63, s32, s31
  s_add_u32 m0, s61, 69632
  s_mov_b32 s60, 61440
  buffer_load_dwordx4 v238, s[16:19], s60 offen offset:0 sc1 lds
  buffer_store_dwordx4 v[180:183], v27, s[64:67], s44 offen sc1
  s_lshl_b32 s31, s50, 1
  s_add_u32 s31, s31, s53
  s_mul_i32 s31, s31, 148
  s_lshl_b32 s32, s54, 1
  s_add_u32 s31, s31, s32
  s_add_u32 s31, s31, s52
  s_mul_i32 s58, s31, 5120
  buffer_load_dwordx4 v238, s[16:19], s60 offen offset:1024 sc1 lds
  s_lshl_b32 s31, s49, 3
  s_lshl_b32 s33, s30, 1
  s_add_u32 s31, s31, s33
  s_mul_i32 s31, s31, 148
  s_add_u32 s31, s31, s32
  s_lshl_b32 s59, s31, 10
  s_cmp_eq_u32 s30, 0
  s_cselect_b32 s47, 0x43, 1
  buffer_load_dwordx4 v238, s[16:19], s60 offen offset:2048 sc1 lds
  v_max3_f32 v240, v64, v65, v66
  v_max3_f32 v240, v240, v67, v68
  v_max3_f32 v240, v240, v69, v70
  v_max3_f32 v240, v240, v71, v72
  v_max3_f32 v240, v240, v73, v74
  v_max3_f32 v240, v240, v75, v76
  v_max3_f32 v240, v240, v77, v78
  v_max_f32 v240, v240, v79
  s_mov_b32 vcc_lo, -1
  s_mov_b32 vcc_hi, 0
  v_mov_b32 v248, v240
  s_nop 1
  v_permlane32_swap_b32 v240, v248
  v_max_f32 v240, v240, v248
  v_sub_f32 v240, 0, v240
  v_and_b32 v248, 0xffff0000, v240
  v_sub_f32 v240, v240, v248
  v_lshrrev_b32 v248, 16, v248
  v_and_b32 v6, 0xffff0000, v240
  v_or_b32 v248, v248, v6
  v_sub_f32 v240, v240, v6
  v_lshrrev_b32 v240, 16, v240
  v_cndmask_b32 v196, v248, v196, vcc
  v_cndmask_b32 v197, v240, v197, vcc
L_Bh1:
  v_mov_b32 v176, v236
  v_add_u32 v177, 0x8000, v236
  s_add_u32 s33, s61, 98304
  s_waitcnt lgkmcnt(0)
  v_mfma_f32_32x32x16_bf16 v[64:79], v[144:147], v[192:195], 0
  ds_read_b128 v[148:151], v176 offset:3072
  v_mfma_f32_32x32x8_bf16 v[64:79], v[152:153], v[196:197], v[64:79]
  s_waitcnt lgkmcnt(0)
  v_mfma_f32_32x32x16_bf16 v[80:95], v[148:151], v[192:195], 0
  ds_read_b128 v[144:147], v176 offset:6144
  s_nop 8
  v_exp_f32 v64, v64
  v_exp_f32 v65, v65
  v_exp_f32 v66, v66
  v_exp_f32 v67, v67
  v_cvt_pk_bf16_f32 v96, v64, v65
  v_mfma_f32_32x32x8_bf16 v[80:95], v[154:155], v[196:197], v[80:95]
  ds_read_b128 v[156:159], v176 offset:25600
  v_cvt_pk_bf16_f32 v97, v66, v67
  v_exp_f32 v68, v68
  v_exp_f32 v69, v69
  v_exp_f32 v70, v70
  v_exp_f32 v71, v71
  v_cvt_pk_bf16_f32 v98, v68, v69
  ds_read_b128 v[160:163], v176 offset:1024
  v_cvt_pk_bf16_f32 v99, v70, v71
  v_exp_f32 v72, v72
  v_exp_f32 v73, v73
  v_exp_f32 v74, v74
  v_exp_f32 v75, v75
  v_cvt_pk_bf16_f32 v100, v72, v73
  ds_read_b128 v[164:167], v176 offset:2048
  v_cvt_pk_bf16_f32 v101, v74, v75
  v_exp_f32 v76, v76
  v_exp_f32 v77, v77
  v_exp_f32 v78, v78
  v_exp_f32 v79, v79
  v_cvt_pk_bf16_f32 v102, v76, v77
  v_cvt_pk_bf16_f32 v103, v78, v79
  s_waitcnt vmcnt(17) lgkmcnt(0)
  v_mfma_f32_32x32x16_bf16 v[64:79], v[144:147], v[192:195], 0
  s_barrier
  s_cmp_lg_u32 s30, 0
  s_cbranch_scc1 L_cf1
  s_mov_b32 s46, s33
  s_lshl_b32 s31, s29, 7
  s_lshl_b32 s33, s28, 2
  s_add_u32 s31, s31, s33
  s_add_u32 s31, s31, 4096
  v_mov_b32 v6, s100
  v_mov_b32 v7, 0
  s_mov_b64 exec, 1
  buffer_store_dword v6, v7, s[24:27], s31 offen offset:0 sc1
  s_mov_b64 exec, -1
  s_mov_b32 s33, s46
L_cf1:
  s_branch L_Bin1
  .p2align 6
L_Bloop1:
  v_mfma_f32_32x32x16_bf16 v[64:79], v[144:147], v[192:195], 0
  s_waitcnt vmcnt(7) lgkmcnt(0)
  s_barrier
L_Bin1:
  ds_read_b128 v[148:151], v176 offset:9216
  v_exp_f32 v80, v80
  v_exp_f32 v81, v81
  v_exp_f32 v82, v82
  v_exp_f32 v83, v83
  v_cvt_pk_bf16_f32 v104, v80, v81
  v_mfma_f32_32x32x16_bf16 a[0:15], v[160:163], v[96:99], a[0:15]
  ds_read_b128 v[168:171], v176 offset:4096
  v_cvt_pk_bf16_f32 v105, v82, v83
  v_exp_f32 v84, v84
  v_exp_f32 v85, v85
  v_exp_f32 v86, v86
  v_exp_f32 v87, v87
  v_cvt_pk_bf16_f32 v106, v84, v85
  v_mfma_f32_32x32x8_bf16 v[64:79], v[156:157], v[196:197], v[64:79]
  s_waitcnt lgkmcnt(0)
  ds_read_b128 v[172:175], v176 offset:5120
  v_cvt_pk_bf16_f32 v107, v86, v87
  v_exp_f32 v88, v88
  v_exp_f32 v89, v89
  v_exp_f32 v90, v90
  v_exp_f32 v91, v91
  v_cvt_pk_bf16_f32 v108, v88, v89
  v_mfma_f32_32x32x16_bf16 a[0:15], v[164:167], v[100:103], a[0:15]
  s_mov_b32 m0, s33
  s_nop 0
  buffer_load_dwordx4 v238, s[16:19], s34 offen offset:0 sc1 lds
  v_cvt_pk_bf16_f32 v109, v90, v91
  v_exp_f32 v92, v92
  v_exp_f32 v93, v93
  v_exp_f32 v94, v94
  v_exp_f32 v95, v95
  v_cvt_pk_bf16_f32 v110, v92, v93
  v_cvt_pk_bf16_f32 v111, v94, v95
  v_mfma_f32_32x32x16_bf16 v[80:95], v[148:151], v[192:195], 0
  ds_read_b128 v[144:147], v176 offset:12288
  ds_read_b128 v[152:155], v176 offset:26624
  v_exp_f32 v64, v64
  v_exp_f32 v65, v65
  v_exp_f32 v66, v66
  v_exp_f32 v67, v67
  v_cvt_pk_bf16_f32 v96, v64, v65
  v_mfma_f32_32x32x16_bf16 a[0:15], v[168:171], v[104:107], a[0:15]
  ds_read_b128 v[160:163], v176 offset:7168
  ds_read_b128 v[164:167], v176 offset:8192
  v_cvt_pk_bf16_f32 v97, v66, v67
  v_exp_f32 v68, v68
  v_exp_f32 v69, v69
  v_exp_f32 v70, v70
  v_exp_f32 v71, v71
  v_cvt_pk_bf16_f32 v98, v68, v69
  v_mfma_f32_32x32x8_bf16 v[80:95], v[158:159], v[196:197], v[80:95]
  s_waitcnt lgkmcnt(2)
  buffer_load_dwordx4 v238, s[16:19], s34 offen offset:1024 sc1 lds
  v_cvt_pk_bf16_f32 v99, v70, v71
  v_exp_f32 v72, v72
  v_exp_f32 v73, v73
  v_exp_f32 v74, v74
  v_exp_f32 v75, v75
  v_cvt_pk_bf16_f32 v100, v72, v73
  v_mfma_f32_32x32x16_bf16 a[0:15], v[172:175], v[108:111], a[0:15]
  v_cvt_pk_bf16_f32 v101, v74, v75
  v_exp_f32 v76, v76
  v_exp_f32 v77, v77
  v_exp_f32 v78, v78
  v_exp_f32 v79, v79
  v_cvt_pk_bf16_f32 v102, v76, v77
  v_cvt_pk_bf16_f32 v103, v78, v79
  v_mfma_f32_32x32x16_bf16 v[64:79], v[144:147], v[192:195], 0
  s_waitcnt lgkmcnt(0)
  ds_read_b128 v[148:151], v176 offset:15360
  v_exp_f32 v80, v80
  v_exp_f32 v81, v81
  v_exp_f32 v82, v82
  v_exp_f32 v83, v83
  v_cvt_pk_bf16_f32 v104, v80, v81
  v_mfma_f32_32x32x16_bf16 a[0:15], v[160:163], v[96:99], a[0:15]
  ds_read_b128 v[168:171], v176 offset:10240
  v_cvt_pk_bf16_f32 v105, v82, v83
  v_exp_f32 v84, v84
  v_exp_f32 v85, v85
  v_exp_f32 v86, v86
  v_exp_f32 v87, v87
  v_cvt_pk_bf16_f32 v106, v84, v85
  v_mfma_f32_32x32x8_bf16 v[64:79], v[152:153], v[196:197], v[64:79]
  ds_read_b128 v[172:175], v176 offset:11264
  v_cvt_pk_bf16_f32 v107, v86, v87
  v_exp_f32 v88, v88
  v_exp_f32 v89, v89
  v_exp_f32 v90, v90
  v_exp_f32 v91, v91
  v_cvt_pk_bf16_f32 v108, v88, v89
  v_mfma_f32_32x32x16_bf16 a[0:15], v[164:167], v[100:103], a[0:15]
  s_waitcnt lgkmcnt(1)
  buffer_load_dwordx4 v238, s[16:19], s34 offen offset:2048 sc1 lds
  v_cvt_pk_bf16_f32 v109, v90, v91
  v_exp_f32 v92, v92
  v_exp_f32 v93, v93
  v_exp_f32 v94, v94
  v_exp_f32 v95, v95
  v_cvt_pk_bf16_f32 v110, v92, v93
  v_cvt_pk_bf16_f32 v111, v94, v95
  v_mfma_f32_32x32x16_bf16 v[80:95], v[148:151], v[192:195], 0
  ds_read_b128 v[144:147], v176 offset:18432
  ds_read_b128 v[156:159], v176 offset:27648
  v_exp_f32 v64, v64
  v_exp_f32 v65, v65
  v_exp_f32 v66, v66
  v_exp_f32 v67, v67
  v_cvt_pk_bf16_f32 v96, v64, v65
  v_mfma_f32_32x32x16_bf16 a[0:15], v[168:171], v[104:107], a[0:15]
  ds_read_b128 v[160:163], v176 offset:13312
  ds_read_b128 v[164:167], v176 offset:14336
  v_cvt_pk_bf16_f32 v97, v66, v67
  v_exp_f32 v68, v68
  v_exp_f32 v69, v69
  v_exp_f32 v70, v70
  v_exp_f32 v71, v71
  v_cvt_pk_bf16_f32 v98, v68, v69
  v_mfma_f32_32x32x8_bf16 v[80:95], v[154:155], v[196:197], v[80:95]
  s_waitcnt lgkmcnt(2)
  buffer_load_dwordx4 v238, s[16:19], s34 offen offset:3072 sc1 lds
  s_add_u32 s34, s34, 4096
  v_cvt_pk_bf16_f32 v99, v70, v71
  v_exp_f32 v72, v72
  v_exp_f32 v73, v73
  v_exp_f32 v74, v74
  v_exp_f32 v75, v75
  v_cvt_pk_bf16_f32 v100, v72, v73
  v_mfma_f32_32x32x16_bf16 a[0:15], v[172:175], v[108:111], a[0:15]
  v_cvt_pk_bf16_f32 v101, v74, v75
  v_exp_f32 v76, v76
  v_exp_f32 v77, v77
  v_exp_f32 v78, v78
  v_exp_f32 v79, v79
  v_cvt_pk_bf16_f32 v102, v76, v77
  v_cvt_pk_bf16_f32 v103, v78, v79
  v_mfma_f32_32x32x16_bf16 v[64:79], v[144:147], v[192:195], 0
  s_waitcnt lgkmcnt(0)
  ds_read_b128 v[148:151], v176 offset:21504
  v_exp_f32 v80, v80
  v_exp_f32 v81, v81
  v_exp_f32 v82, v82
  v_exp_f32 v83, v83
  v_cvt_pk_bf16_f32 v104, v80, v81
  v_mfma_f32_32x32x16_bf16 a[0:15], v[160:163], v[96:99], a[0:15]
  ds_read_b128 v[168:171], v176 offset:16384
  v_cvt_pk_bf16_f32 v105, v82, v83
  v_exp_f32 v84, v84
  v_exp_f32 v85, v85
  v_exp_f32 v86, v86
  v_exp_f32 v87, v87
  v_cvt_pk_bf16_f32 v106, v84, v85
  v_mfma_f32_32x32x8_bf16 v[64:79], v[156:157], v[196:197], v[64:79]
  s_waitcnt lgkmcnt(0)
  ds_read_b128 v[172:175], v176 offset:17408
  v_cvt_pk_bf16_f32 v107, v86, v87
  v_exp_f32 v88, v88
  v_exp_f32 v89, v89
  v_exp_f32 v90, v90
  v_exp_f32 v91, v91
  v_cvt_pk_bf16_f32 v108, v88, v89
  v_mfma_f32_32x32x16_bf16 a[0:15], v[164:167], v[100:103], a[0:15]
  s_add_u32 m0, s33, 4096
  s_nop 0
  buffer_load_dwordx4 v238, s[16:19], s34 offen offset:0 sc1 lds
  v_cvt_pk_bf16_f32 v109, v90, v91
  v_exp_f32 v92, v92
  v_exp_f32 v93, v93
  v_exp_f32 v94, v94
  v_exp_f32 v95, v95
  v_cvt_pk_bf16_f32 v110, v92, v93
  v_cvt_pk_bf16_f32 v111, v94, v95
  v_mfma_f32_32x32x16_bf16 v[80:95], v[148:151], v[192:195], 0
  ds_read_b128 v[144:147], v177 offset:0
  ds_read_b128 v[152:155], v177 offset:24576
  v_exp_f32 v64, v64
  v_exp_f32 v65, v65
  v_exp_f32 v66, v66
  v_exp_f32 v67, v67
  v_cvt_pk_bf16_f32 v96, v64, v65
  v_mfma_f32_32x32x16_bf16 a[0:15], v[168:171], v[104:107], a[0:15]
  s_add_u32 s31, s38, 65536
  ds_read_b128 v[160:163], v176 offset:19456
  ds_read_b128 v[164:167], v176 offset:20480
  v_cvt_pk_bf16_f32 v97, v66, v67
  v_exp_f32 v68, v68
  v_exp_f32 v69, v69
  v_exp_f32 v70, v70
  v_exp_f32 v71, v71
  v_cvt_pk_bf16_f32 v98, v68, v69
  v_mfma_f32_32x32x8_bf16 v[80:95], v[158:159], v[196:197], v[80:95]
  s_waitcnt lgkmcnt(2)
  buffer_load_dwordx4 v238, s[16:19], s34 offen offset:1024 sc1 lds
  v_cvt_pk_bf16_f32 v99, v70, v71
  v_exp_f32 v72, v72
  v_exp_f32 v73, v73
  v_exp_f32 v74, v74
  v_exp_f32 v75, v75
  v_cvt_pk_bf16_f32 v100, v72, v73
  v_mfma_f32_32x32x16_bf16 a[0:15], v[172:175], v[108:111], a[0:15]
  s_and_b32 s31, s31, 0x1ffff
  v_cvt_pk_bf16_f32 v101, v74, v75
  v_exp_f32 v76, v76
  v_exp_f32 v77, v77
  v_exp_f32 v78, v78
  v_exp_f32 v79, v79
  v_cvt_pk_bf16_f32 v102, v76, v77
  v_cvt_pk_bf16_f32 v103, v78, v79
  v_mfma_f32_32x32x16_bf16 v[64:79], v[144:147], v[192:195], 0
  s_waitcnt lgkmcnt(0)
  ds_read_b128 v[148:151], v177 offset:3072
  v_exp_f32 v80, v80
  v_exp_f32 v81, v81
  v_exp_f32 v82, v82
  v_exp_f32 v83, v83
  v_cvt_pk_bf16_f32 v104, v80, v81
  v_mfma_f32_32x32x16_bf16 a[0:15], v[160:163], v[96:99], a[0:15]
  s_add_u32 s33, s38, s61
  ds_read_b128 v[168:171], v176 offset:22528
  v_cvt_pk_bf16_f32 v105, v82, v83
  v_exp_f32 v84, v84
  v_exp_f32 v85, v85
  v_exp_f32 v86, v86
  v_exp_f32 v87, v87
  v_cvt_pk_bf16_f32 v106, v84, v85
  v_mfma_f32_32x32x8_bf16 v[64:79], v[152:153], v[196:197], v[64:79]
  s_add_u32 s38, s38, 32768
  ds_read_b128 v[172:175], v176 offset:23552
  v_cvt_pk_bf16_f32 v107, v86, v87
  v_exp_f32 v88, v88
  v_exp_f32 v89, v89
  v_exp_f32 v90, v90
  v_exp_f32 v91, v91
  v_cvt_pk_bf16_f32 v108, v88, v89
  v_mfma_f32_32x32x16_bf16 a[0:15], v[164:167], v[100:103], a[0:15]
  s_waitcnt lgkmcnt(1)
  buffer_load_dwordx4 v238, s[16:19], s34 offen offset:2048 sc1 lds
  s_add_u32 s34, s34, 24576
  v_cvt_pk_bf16_f32 v109, v90, v91
  v_exp_f32 v92, v92
  v_exp_f32 v93, v93
  v_exp_f32 v94, v94
  v_exp_f32 v95, v95
  v_cvt_pk_bf16_f32 v110, v92, v93
  v_cvt_pk_bf16_f32 v111, v94, v95
  v_mfma_f32_32x32x16_bf16 v[80:95], v[148:151], v[192:195], 0
  s_and_b32 s38, s38, 0x1ffff
  ds_read_b128 v[144:147], v177 offset:6144
  v_exp_f32 v64, v64
  v_exp_f32 v65, v65
  v_exp_f32 v66, v66
  v_exp_f32 v67, v67
  v_cvt_pk_bf16_f32 v96, v64, v65
  v_mfma_f32_32x32x16_bf16 a[0:15], v[168:171], v[104:107], a[0:15]
  s_sub_u32 s37, s37, 1
  ds_read_b128 v[156:159], v177 offset:25600
  v_cvt_pk_bf16_f32 v97, v66, v67
  v_exp_f32 v68, v68
  v_exp_f32 v69, v69
  v_exp_f32 v70, v70
  v_exp_f32 v71, v71
  v_cvt_pk_bf16_f32 v98, v68, v69
  v_mfma_f32_32x32x8_bf16 v[80:95], v[154:155], v[196:197], v[80:95]
  s_waitcnt lgkmcnt(1)
  ds_read_b128 v[160:163], v177 offset:1024
  v_cvt_pk_bf16_f32 v99, v70, v71
  v_exp_f32 v72, v72
  v_exp_f32 v73, v73
  v_exp_f32 v74, v74
  v_exp_f32 v75, v75
  v_cvt_pk_bf16_f32 v100, v72, v73
  v_mfma_f32_32x32x16_bf16 a[0:15], v[172:175], v[108:111], a[0:15]
  s_bitcmp0_b32 s47, s37
  s_waitcnt lgkmcnt(3)
  ds_read_b128 v[164:167], v177 offset:2048
  v_cvt_pk_bf16_f32 v101, v74, v75
  v_exp_f32 v76, v76
  v_exp_f32 v77, v77
  v_exp_f32 v78, v78
  v_exp_f32 v79, v79
  v_cvt_pk_bf16_f32 v102, v76, v77
  v_cvt_pk_bf16_f32 v103, v78, v79
  v_mov_b32 v176, v177
  v_add_u32 v177, s31, v236
  s_cbranch_scc1 L_Bloop1
  s_cmp_eq_u32 s37, 0
  s_cbranch_scc1 L_Bend
  s_cmp_eq_u32 s37, 6
  s_cbranch_scc1 L_pb1
  s_mov_b32 s32, 29696
  buffer_load_dwordx4 v[20:23], v236, s[24:27], s32 offen sc1
  buffer_load_dword v24, v9, s[24:27], s62 offen sc1
  s_branch L_Bloop1
L_pb1:
  s_cmp_eq_u32 s45, 0
  s_cbranch_scc1 L_Bloop1
  s_mov_b32 s45, 0
  s_min_u32 s31, s3, 255
  s_lshl_b32 s31, s31, 2
  s_add_u32 s31, s31, 29696
  v_mov_b32 v6, s100
  v_mov_b32 v7, 0
  s_mov_b64 exec, 1
  buffer_store_dword v6, v7, s[24:27], s31 offen offset:0 sc1
  s_mov_b64 exec, -1
  s_branch L_Bloop1
L_B3:
  s_cmp_lg_u32 s39, 0
  s_cbranch_scc1 L_Bh3
  s_mov_b32 vcc_lo, -1
  s_mov_b32 vcc_hi, 0
  v_cndmask_b32 v196, 0, v196, vcc
  v_cndmask_b32 v197, 0, v197, vcc
  v_cndmask_b32 v204, 0, v204, vcc
  v_cndmask_b32 v205, 0, v205, vcc
  v_cndmask_b32 v212, 0, v212, vcc
  v_cndmask_b32 v213, 0, v213, vcc
  v_accvgpr_write_b32 a0, 0
  v_accvgpr_write_b32 a1, 0
  v_accvgpr_write_b32 a2, 0
  v_accvgpr_write_b32 a3, 0
  v_accvgpr_write_b32 a4, 0
  v_accvgpr_write_b32 a5, 0
  v_accvgpr_write_b32 a6, 0
  v_accvgpr_write_b32 a7, 0
  v_accvgpr_write_b32 a8, 0
  v_accvgpr_write_b32 a9, 0
  v_accvgpr_write_b32 a10, 0
  v_accvgpr_write_b32 a11, 0
  s_waitcnt lgkmcnt(0)
  v_mfma_f32_32x32x16_bf16 v[64:79], v[144:147], v[192:195], 0
  buffer_store_dwordx4 v[28:31], v236, s[64:67], s44 offen offset:0 sc1
  v_accvgpr_write_b32 a12, 0
  v_accvgpr_write_b32 a13, 0
  v_accvgpr_write_b32 a14, 0
  v_accvgpr_write_b32 a15, 0
  v_accvgpr_write_b32 a16, 0
  v_accvgpr_write_b32 a17, 0
  v_accvgpr_write_b32 a18, 0
  v_accvgpr_write_b32 a19, 0
  v_accvgpr_write_b32 a20, 0
  v_accvgpr_write_b32 a21, 0
  buffer_store_dwordx4 v[32:35], v236, s[64:67], s44 offen offset:1024 sc1
  v_accvgpr_write_b32 a22, 0
  v_accvgpr_write_b32 a23, 0
  v_accvgpr_write_b32 a24, 0
  v_accvgpr_write_b32 a25, 0
  v_accvgpr_write_b32 a26, 0
  v_accvgpr_write_b32 a27, 0
  v_accvgpr_write_b32 a28, 0
  v_accvgpr_write_b32 a29, 0
  v_accvgpr_write_b32 a30, 0
  v_accvgpr_write_b32 a31, 0
  v_mfma_f32_32x32x16_bf16 v[80:95], v[144:147], v[200:203], 0
  buffer_store_dwordx4 v[36:39], v236, s[64:67], s44 offen offset:2048 sc1
  v_accvgpr_write_b32 a32, 0
  v_accvgpr_write_b32 a33, 0
  v_accvgpr_write_b32 a34, 0
  v_accvgpr_write_b32 a35, 0
  v_accvgpr_write_b32 a36, 0
  v_accvgpr_write_b32 a37, 0
  v_accvgpr_write_b32 a38, 0
  v_accvgpr_write_b32 a39, 0
  v_accvgpr_write_b32 a40, 0
  v_accvgpr_write_b32 a41, 0
  buffer_store_dwordx4 v[40:43], v236, s[64:67], s44 offen offset:3072 sc1
  v_accvgpr_write_b32 a42, 0
  v_accvgpr_write_b32 a43, 0
  v_accvgpr_write_b32 a44, 0
  v_accvgpr_write_b32 a45, 0
  v_accvgpr_write_b32 a46, 0
  v_accvgpr_write_b32 a47, 0
  s_add_u32 s31, s2, s100
  s_and_b32 s48, s31, 3
  s_lshr_b32 s32, s31, 2
  s_xor_b32 s31, s31, s32
  v_mfma_f32_32x32x16_bf16 v[96:111], v[144:147], v[208:211], 0
  buffer_store_dwordx4 v[44:47], v27, s[64:67], s44 offen sc1
  s_and_b32 s31, s31, 1
  s_lshl_b32 s49, s31, 3
  s_mov_b32 s56, 0
  s_mov_b32 s57, 0
  s_cmp_eq_u32 s48, 1
  s_cselect_b32 s56, 470618644, s56
  s_cselect_b32 s57, 134746129, s57
  s_cmp_eq_u32 s48, 2
  s_cselect_b32 s56, 606020380, s56
  s_cselect_b32 s57, 605822241, s57
  s_add_u32 s44, s44, 757760
  s_cmp_eq_u32 s48, 3
  s_cselect_b32 s56, 942682936, s56
  s_cselect_b32 s57, 740568878, s57
  s_lshl_b32 s31, s29, 3
  s_lshr_b64 s[56:57], s[56:57], s31
  s_and_b32 s54, s56, 255
  s_mov_b32 s56, 135269640
  s_mov_b32 s57, 337383698
  s_lshr_b64 s[56:57], s[56:57], s31
  s_and_b32 s55, s56, 255
  v_mfma_f32_32x32x8_bf16 v[64:79], v[152:153], v[196:197], v[64:79]
  buffer_store_dwordx4 v[48:51], v236, s[64:67], s44 offen offset:0 sc1
  s_cmp_eq_u32 s49, 0
  s_cselect_b32 s32, 3, 2
  s_bitcmp1_b32 s48, 0
  s_cselect_b32 s33, s32, 0
  s_add_u32 s54, s54, s33
  s_lshl_b32 s33, s33, 1
  s_sub_u32 s32, s32, s33
  s_add_u32 s55, s55, s32
  s_lshl_b32 s31, s29, 2
  s_lshr_b32 s31, 544478803, s31
  buffer_store_dwordx4 v[52:55], v236, s[64:67], s44 offen offset:1024 sc1
  s_sub_u32 s32, s31, s48
  s_and_b32 s32, s32, 3
  s_and_b32 s31, s31, 4
  s_or_b32 s31, s31, s32
  s_and_b32 s50, s31, 2
  s_bfe_u32 s32, s28, 0x10001
  s_or_b32 s50, s50, s32
  s_and_b32 s32, s31, 1
  s_lshl_b32 s32, s32, 1
  s_and_b32 s31, s31, 4
  v_mfma_f32_32x32x8_bf16 v[80:95], v[152:153], v[204:205], v[80:95]
  buffer_store_dwordx4 v[56:59], v236, s[64:67], s44 offen offset:2048 sc1
  s_or_b32 s31, s31, s32
  s_and_b32 s32, s28, 1
  s_or_b32 s31, s31, s32
  s_lshl_b32 s31, s31, 2
  s_lshr_b32 s31, 1980781618, s31
  s_and_b32 s31, s31, 7
  s_add_u32 s49, s49, s31
  s_lshl_b32 s51, s49, 2
  s_add_u32 s51, s51, s50
  s_and_b32 s52, s30, 1
  buffer_store_dwordx4 v[60:63], v236, s[64:67], s44 offen offset:3072 sc1
  s_lshr_b32 s53, s30, 1
  v_and_b32 v9, 31, v2
  v_lshlrev_b32 v9, 2, v9
  s_lshr_b32 s62, s49, 1
  s_lshl_b32 s62, s62, 7
  s_add_u32 s62, s62, 4096
  s_lshr_b32 s31, s54, 1
  s_add_u32 s32, s54, s55
  s_add_u32 s32, s32, 1
  s_lshr_b32 s32, s32, 1
  v_mfma_f32_32x32x8_bf16 v[96:111], v[152:153], v[212:213], v[96:111]
  s_add_u32 m0, s61, 65536
  s_mov_b32 s60, 57344
  buffer_load_dwordx4 v238, s[16:19], s60 offen offset:0 sc1 lds
  buffer_store_dwordx4 v[180:183], v27, s[64:67], s44 offen sc1
  s_sub_u32 s32, s32, s31
  s_bfm_b32 s63, s32, s31
  s_lshl_b32 s31, s50, 1
  s_add_u32 s31, s31, s53
  s_mul_i32 s31, s31, 148
  s_lshl_b32 s32, s54, 1
  s_add_u32 s31, s31, s32
  s_add_u32 s31, s31, s52
  s_mul_i32 s58, s31, 5120
  buffer_load_dwordx4 v238, s[16:19], s60 offen offset:1024 sc1 lds
  s_lshl_b32 s31, s49, 3
  s_lshl_b32 s33, s30, 1
  s_add_u32 s31, s31, s33
  s_mul_i32 s31, s31, 148
  s_add_u32 s31, s31, s32
  s_lshl_b32 s59, s31, 10
  s_cmp_eq_u32 s30, 0
  s_cselect_b32 s47, 0x43, 1
  v_max3_f32 v240, v64, v65, v66
  v_max3_f32 v240, v240, v67, v68
  buffer_load_dwordx4 v238, s[16:19], s60 offen offset:2048 sc1 lds
  v_max3_f32 v240, v240, v69, v70
  v_max3_f32 v240, v240, v71, v72
  v_max3_f32 v240, v240, v73, v74
  v_max3_f32 v240, v240, v75, v76
  v_max3_f32 v240, v240, v77, v78
  v_max_f32 v240, v240, v79
  v_max3_f32 v241, v80, v81, v82
  v_max3_f32 v241, v241, v83, v84
  v_max3_f32 v241, v241, v85, v86
  v_max3_f32 v241, v241, v87, v88
  buffer_load_dwordx4 v238, s[16:19], s60 offen offset:3072 sc1 lds
  v_max3_f32 v241, v241, v89, v90
  v_max3_f32 v241, v241, v91, v92
  v_max3_f32 v241, v241, v93, v94
  v_max_f32 v241, v241, v95
  v_max3_f32 v242, v96, v97, v98
  v_max3_f32 v242, v242, v99, v100
  v_max3_f32 v242, v242, v101, v102
  v_max3_f32 v242, v242, v103, v104
  v_max3_f32 v242, v242, v105, v106
  v_max3_f32 v242, v242, v107, v108
  s_add_u32 m0, s61, 69632
  s_mov_b32 s60, 61440
  buffer_load_dwordx4 v238, s[16:19], s60 offen offset:0 sc1 lds
  v_max3_f32 v242, v242, v109, v110
  v_max_f32 v242, v242, v111
  s_mov_b32 vcc_lo, -1
  s_mov_b32 vcc_hi, 0
  v_mov_b32 v248, v240
  v_mov_b32 v249, v241
  v_mov_b32 v250, v242
  v_permlane32_swap_b32 v240, v248
  v_permlane32_swap_b32 v241, v249
  v_permlane32_swap_b32 v242, v250
  buffer_load_dwordx4 v238, s[16:19], s60 offen offset:1024 sc1 lds
  v_max_f32 v240, v240, v248
  v_sub_f32 v240, 0, v240
  v_and_b32 v248, 0xffff0000, v240
  v_sub_f32 v240, v240, v248
  v_lshrrev_b32 v248, 16, v248
  v_and_b32 v6, 0xffff0000, v240
  v_or_b32 v248, v248, v6
  v_sub_f32 v240, v240, v6
  v_lshrrev_b32 v240, 16, v240
  v_cndmask_b32 v196, v248, v196, vcc
  buffer_load_dwordx4 v238, s[16:19], s60 offen offset:2048 sc1 lds
  v_cndmask_b32 v197, v240, v197, vcc
  v_max_f32 v241, v241, v249
  v_sub_f32 v241, 0, v241
  v_and_b32 v249, 0xffff0000, v241
  v_sub_f32 v241, v241, v249
  v_lshrrev_b32 v249, 16, v249
  v_and_b32 v6, 0xffff0000, v241
  v_or_b32 v249, v249, v6
  v_sub_f32 v241, v241, v6
  v_lshrrev_b32 v241, 16, v241
  v_cndmask_b32 v204, v249, v204, vcc
  v_cndmask_b32 v205, v241, v205, vcc
  v_max_f32 v242, v242, v250
  v_sub_f32 v242, 0, v242
  v_and_b32 v250, 0xffff0000, v242
  v_sub_f32 v242, v242, v250
  v_lshrrev_b32 v250, 16, v250
  v_and_b32 v6, 0xffff0000, v242
  v_or_b32 v250, v250, v6
  v_sub_f32 v242, v242, v6
  v_lshrrev_b32 v242, 16, v242
  v_cndmask_b32 v212, v250, v212, vcc
  v_cndmask_b32 v213, v242, v213, vcc
L_Bh3:
  v_mov_b32 v176, v236
  v_add_u32 v177, 0x8000, v236
  s_add_u32 s33, s61, 98304
  s_waitcnt lgkmcnt(0)
  v_mfma_f32_32x32x16_bf16 v[64:79], v[144:147], v[192:195], 0
  v_mfma_f32_32x32x8_bf16 v[64:79], v[152:153], v[196:197], v[64:79]
  v_mfma_f32_32x32x16_bf16 v[80:95], v[144:147], v[200:203], 0
  ds_read_b128 v[160:163], v176 offset:1024
  s_nop 9
  v_exp_f32 v64, v64
  v_exp_f32 v65, v65
  v_exp_f32 v66, v66
  v_exp_f32 v67, v67
  v_cvt_pk_bf16_f32 v96, v64, v65
  v_mfma_f32_32x32x8_bf16 v[80:95], v[152:153], v[204:205], v[80:95]
  ds_read_b128 v[164:167], v176 offset:2048
  v_cvt_pk_bf16_f32 v97, v66, v67
  v_exp_f32 v68, v68
  v_exp_f32 v69, v69
  v_exp_f32 v70, v70
  v_exp_f32 v71, v71
  v_cvt_pk_bf16_f32 v98, v68, v69
  v_cvt_pk_bf16_f32 v99, v70, v71
  v_exp_f32 v72, v72
  v_exp_f32 v73, v73
  v_exp_f32 v74, v74
  v_exp_f32 v75, v75
  v_cvt_pk_bf16_f32 v100, v72, v73
  v_cvt_pk_bf16_f32 v101, v74, v75
  v_exp_f32 v76, v76
  v_exp_f32 v77, v77
  v_exp_f32 v78, v78
  v_exp_f32 v79, v79
  v_cvt_pk_bf16_f32 v102, v76, v77
  v_cvt_pk_bf16_f32 v103, v78, v79
  s_waitcnt vmcnt(17) lgkmcnt(0)
  v_mfma_f32_32x32x16_bf16 v[64:79], v[144:147], v[208:211], 0
  s_barrier
  s_cmp_lg_u32 s30, 0
  s_cbranch_scc1 L_cf3
  s_mov_b32 s46, s33
  s_lshl_b32 s31, s29, 7
  s_lshl_b32 s33, s28, 2
  s_add_u32 s31, s31, s33
  s_add_u32 s31, s31, 4096
  v_mov_b32 v6, s100
  v_mov_b32 v7, 0
  s_mov_b64 exec, 1
  buffer_store_dword v6, v7, s[24:27], s31 offen offset:0 sc1
  s_mov_b64 exec, -1
  s_mov_b32 s33, s46
L_cf3:
  s_branch L_Bin3
  .p2align 6
L_Bloop3:
  v_mfma_f32_32x32x16_bf16 v[64:79], v[144:147], v[208:211], 0
  s_waitcnt vmcnt(7) lgkmcnt(0)
  s_barrier
L_Bin3:
  ds_read_b128 v[148:151], v176 offset:3072
  v_exp_f32 v80, v80
  v_exp_f32 v81, v81
  v_exp_f32 v82, v82
  v_exp_f32 v83, v83
  v_cvt_pk_bf16_f32 v104, v80, v81
  v_mfma_f32_32x32x16_bf16 a[0:15], v[160:163], v[96:99], a[0:15]
  s_mov_b32 m0, s33
  v_cvt_pk_bf16_f32 v105, v82, v83
  v_exp_f32 v84, v84
  v_exp_f32 v85, v85
  v_exp_f32 v86, v86
  v_exp_f32 v87, v87
  v_cvt_pk_bf16_f32 v106, v84, v85
  v_mfma_f32_32x32x8_bf16 v[64:79], v[152:153], v[212:213], v[64:79]
  buffer_load_dwordx4 v238, s[16:19], s34 offen offset:0 sc1 lds
  v_cvt_pk_bf16_f32 v107, v86, v87
  v_exp_f32 v88, v88
  v_exp_f32 v89, v89
  v_exp_f32 v90, v90
  v_exp_f32 v91, v91
  v_cvt_pk_bf16_f32 v108, v88, v89
  v_mfma_f32_32x32x16_bf16 a[0:15], v[164:167], v[100:103], a[0:15]
  s_waitcnt lgkmcnt(0)
  v_cvt_pk_bf16_f32 v109, v90, v91
  v_exp_f32 v92, v92
  v_exp_f32 v93, v93
  v_exp_f32 v94, v94
  v_exp_f32 v95, v95
  v_cvt_pk_bf16_f32 v110, v92, v93
  v_cvt_pk_bf16_f32 v111, v94, v95
  v_mfma_f32_32x32x16_bf16 v[80:95], v[148:151], v[192:195], 0
  v_exp_f32 v64, v64
  v_exp_f32 v65, v65
  v_exp_f32 v66, v66
  v_exp_f32 v67, v67
  v_cvt_pk_bf16_f32 v96, v64, v65
  v_mfma_f32_32x32x16_bf16 a[16:31], v[160:163], v[104:107], a[16:31]
  v_cvt_pk_bf16_f32 v97, v66, v67
  v_exp_f32 v68, v68
  v_exp_f32 v69, v69
  v_exp_f32 v70, v70
  v_exp_f32 v71, v71
  v_cvt_pk_bf16_f32 v98, v68, v69
  v_mfma_f32_32x32x8_bf16 v[80:95], v[154:155], v[196:197], v[80:95]
  v_cvt_pk_bf16_f32 v99, v70, v71
  v_exp_f32 v72, v72
  v_exp_f32 v73, v73
  v_exp_f32 v74, v74
  v_exp_f32 v75, v75
  v_cvt_pk_bf16_f32 v100, v72, v73
  v_mfma_f32_32x32x16_bf16 a[16:31], v[164:167], v[108:111], a[16:31]
  v_cvt_pk_bf16_f32 v101, v74, v75
  v_exp_f32 v76, v76
  v_exp_f32 v77, v77
  v_exp_f32 v78, v78
  v_exp_f32 v79, v79
  v_cvt_pk_bf16_f32 v102, v76, v77
  v_cvt_pk_bf16_f32 v103, v78, v79
  v_mfma_f32_32x32x16_bf16 v[64:79], v[148:151], v[200:203], 0
  ds_read_b128 v[168:171], v176 offset:4096
  v_exp_f32 v80, v80
  v_exp_f32 v81, v81
  v_exp_f32 v82, v82
  v_exp_f32 v83, v83
  v_cvt_pk_bf16_f32 v104, v80, v81
  v_mfma_f32_32x32x16_bf16 a[32:47], v[160:163], v[96:99], a[32:47]
  ds_read_b128 v[172:175], v176 offset:5120
  v_cvt_pk_bf16_f32 v105, v82, v83
  v_exp_f32 v84, v84
  v_exp_f32 v85, v85
  v_exp_f32 v86, v86
  v_exp_f32 v87, v87
  v_cvt_pk_bf16_f32 v106, v84, v85
  v_mfma_f32_32x32x8_bf16 v[64:79], v[154:155], v[204:205], v[64:79]
  v_cvt_pk_bf16_f32 v107, v86, v87
  v_exp_f32 v88, v88
  v_exp_f32 v89, v89
  v_exp_f32 v90, v90
  v_exp_f32 v91, v91
  v_cvt_pk_bf16_f32 v108, v88, v89
  v_mfma_f32_32x32x16_bf16 a[32:47], v[164:167], v[100:103], a[32:47]
  v_cvt_pk_bf16_f32 v109, v90, v91
  v_exp_f32 v92, v92
  v_exp_f32 v93, v93
  v_exp_f32 v94, v94
  v_exp_f32 v95, v95
  v_cvt_pk_bf16_f32 v110, v92, v93
  v_cvt_pk_bf16_f32 v111, v94, v95
  v_mfma_f32_32x32x16_bf16 v[80:95], v[148:151], v[208:211], 0
  s_waitcnt lgkmcnt(0)
  ds_read_b128 v[144:147], v176 offset:6144
  v_exp_f32 v64, v64
  v_exp_f32 v65, v65
  v_exp_f32 v66, v66
  v_exp_f32 v67, v67
  v_cvt_pk_bf16_f32 v96, v64, v65
  v_mfma_f32_32x32x16_bf16 a[0:15], v[168:171], v[104:107], a[0:15]
  ds_read_b128 v[156:159], v176 offset:25600
  v_cvt_pk_bf16_f32 v97, v66, v67
  v_exp_f32 v68, v68
  v_exp_f32 v69, v69
  v_exp_f32 v70, v70
  v_exp_f32 v71, v71
  v_cvt_pk_bf16_f32 v98, v68, v69
  v_mfma_f32_32x32x8_bf16 v[80:95], v[154:155], v[212:213], v[80:95]
  buffer_load_dwordx4 v238, s[16:19], s34 offen offset:1024 sc1 lds
  v_cvt_pk_bf16_f32 v99, v70, v71
  v_exp_f32 v72, v72
  v_exp_f32 v73, v73
  v_exp_f32 v74, v74
  v_exp_f32 v75, v75
  v_cvt_pk_bf16_f32 v100, v72, v73
  v_mfma_f32_32x32x16_bf16 a[0:15], v[172:175], v[108:111], a[0:15]
  s_waitcnt lgkmcnt(0)
  v_cvt_pk_bf16_f32 v101, v74, v75
  v_exp_f32 v76, v76
  v_exp_f32 v77, v77
  v_exp_f32 v78, v78
  v_exp_f32 v79, v79
  v_cvt_pk_bf16_f32 v102, v76, v77
  v_cvt_pk_bf16_f32 v103, v78, v79
  v_mfma_f32_32x32x16_bf16 v[64:79], v[144:147], v[192:195], 0
  v_exp_f32 v80, v80
  v_exp_f32 v81, v81
  v_exp_f32 v82, v82
  v_exp_f32 v83, v83
  v_cvt_pk_bf16_f32 v104, v80, v81
  v_mfma_f32_32x32x16_bf16 a[16:31], v[168:171], v[96:99], a[16:31]
  v_cvt_pk_bf16_f32 v105, v82, v83
  v_exp_f32 v84, v84
  v_exp_f32 v85, v85
  v_exp_f32 v86, v86
  v_exp_f32 v87, v87
  v_cvt_pk_bf16_f32 v106, v84, v85
  v_mfma_f32_32x32x8_bf16 v[64:79], v[156:157], v[196:197], v[64:79]
  v_cvt_pk_bf16_f32 v107, v86, v87
  v_exp_f32 v88, v88
  v_exp_f32 v89, v89
  v_exp_f32 v90, v90
  v_exp_f32 v91, v91
  v_cvt_pk_bf16_f32 v108, v88, v89
  v_mfma_f32_32x32x16_bf16 a[16:31], v[172:175], v[100:103], a[16:31]
  v_cvt_pk_bf16_f32 v109, v90, v91
  v_exp_f32 v92, v92
  v_exp_f32 v93, v93
  v_exp_f32 v94, v94
  v_exp_f32 v95, v95
  v_cvt_pk_bf16_f32 v110, v92, v93
  v_cvt_pk_bf16_f32 v111, v94, v95
  v_mfma_f32_32x32x16_bf16 v[80:95], v[144:147], v[200:203], 0
  ds_read_b128 v[160:163], v176 offset:7168
  v_exp_f32 v64, v64
  v_exp_f32 v65, v65
  v_exp_f32 v66, v66
  v_exp_f32 v67, v67
  v_cvt_pk_bf16_f32 v96, v64, v65
  v_mfma_f32_32x32x16_bf16 a[32:47], v[168:171], v[104:107], a[32:47]
  ds_read_b128 v[164:167], v176 offset:8192
  v_cvt_pk_bf16_f32 v97, v66, v67
  v_exp_f32 v68, v68
  v_exp_f32 v69, v69
  v_exp_f32 v70, v70
  v_exp_f32 v71, v71
  v_cvt_pk_bf16_f32 v98, v68, v69
  v_mfma_f32_32x32x8_bf16 v[80:95], v[156:157], v[204:205], v[80:95]
  v_cvt_pk_bf16_f32 v99, v70, v71
  v_exp_f32 v72, v72
  v_exp_f32 v73, v73
  v_exp_f32 v74, v74
  v_exp_f32 v75, v75
  v_cvt_pk_bf16_f32 v100, v72, v73
  v_mfma_f32_32x32x16_bf16 a[32:47], v[172:175], v[108:111], a[32:47]
  v_cvt_pk_bf16_f32 v101, v74, v75
  v_exp_f32 v76, v76
  v_exp_f32 v77, v77
  v_exp_f32 v78, v78
  v_exp_f32 v79, v79
  v_cvt_pk_bf16_f32 v102, v76, v77
  v_cvt_pk_bf16_f32 v103, v78, v79
  v_mfma_f32_32x32x16_bf16 v[64:79], v[144:147], v[208:211], 0
  s_waitcnt lgkmcnt(0)
  ds_read_b128 v[148:151], v176 offset:9216
  v_exp_f32 v80, v80
  v_exp_f32 v81, v81
  v_exp_f32 v82, v82
  v_exp_f32 v83, v83
  v_cvt_pk_bf16_f32 v104, v80, v81
  v_mfma_f32_32x32x16_bf16 a[0:15], v[160:163], v[96:99], a[0:15]
  buffer_load_dwordx4 v238, s[16:19], s34 offen offset:2048 sc1 lds
  v_cvt_pk_bf16_f32 v105, v82, v83
  v_exp_f32 v84, v84
  v_exp_f32 v85, v85
  v_exp_f32 v86, v86
  v_exp_f32 v87, v87
  v_cvt_pk_bf16_f32 v106, v84, v85
  v_mfma_f32_32x32x8_bf16 v[64:79], v[156:157], v[212:213], v[64:79]
  v_cvt_pk_bf16_f32 v107, v86, v87
  v_exp_f32 v88, v88
  v_exp_f32 v89, v89
  v_exp_f32 v90, v90
  v_exp_f32 v91, v91
  v_cvt_pk_bf16_f32 v108, v88, v89
  v_mfma_f32_32x32x16_bf16 a[0:15], v[164:167], v[100:103], a[0:15]
  s_waitcnt lgkmcnt(0)
  v_cvt_pk_bf16_f32 v109, v90, v91
  v_exp_f32 v92, v92
  v_exp_f32 v93, v93
  v_exp_f32 v94, v94
  v_exp_f32 v95, v95
  v_cvt_pk_bf16_f32 v110, v92, v93
  v_cvt_pk_bf16_f32 v111, v94, v95
  v_mfma_f32_32x32x16_bf16 v[80:95], v[148:151], v[192:195], 0
  v_exp_f32 v64, v64
  v_exp_f32 v65, v65
  v_exp_f32 v66, v66
  v_exp_f32 v67, v67
  v_cvt_pk_bf16_f32 v96, v64, v65
  v_mfma_f32_32x32x16_bf16 a[16:31], v[160:163], v[104:107], a[16:31]
  v_cvt_pk_bf16_f32 v97, v66, v67
  v_exp_f32 v68, v68
  v_exp_f32 v69, v69
  v_exp_f32 v70, v70
  v_exp_f32 v71, v71
  v_cvt_pk_bf16_f32 v98, v68, v69
  v_mfma_f32_32x32x8_bf16 v[80:95], v[158:159], v[196:197], v[80:95]
  v_cvt_pk_bf16_f32 v99, v70, v71
  v_exp_f32 v72, v72
  v_exp_f32 v73, v73
  v_exp_f32 v74, v74
  v_exp_f32 v75, v75
  v_cvt_pk_bf16_f32 v100, v72, v73
  v_mfma_f32_32x32x16_bf16 a[16:31], v[164:167], v[108:111], a[16:31]
  v_cvt_pk_bf16_f32 v101, v74, v75
  v_exp_f32 v76, v76
  v_exp_f32 v77, v77
  v_exp_f32 v78, v78
  v_exp_f32 v79, v79
  v_cvt_pk_bf16_f32 v102, v76, v77
  v_cvt_pk_bf16_f32 v103, v78, v79
  v_mfma_f32_32x32x16_bf16 v[64:79], v[148:151], v[200:203], 0
  ds_read_b128 v[168:171], v176 offset:10240
  v_exp_f32 v80, v80
  v_exp_f32 v81, v81
  v_exp_f32 v82, v82
  v_exp_f32 v83, v83
  v_cvt_pk_bf16_f32 v104, v80, v81
  v_mfma_f32_32x32x16_bf16 a[32:47], v[160:163], v[96:99], a[32:47]
  ds_read_b128 v[172:175], v176 offset:11264
  v_cvt_pk_bf16_f32 v105, v82, v83
  v_exp_f32 v84, v84
  v_exp_f32 v85, v85
  v_exp_f32 v86, v86
  v_exp_f32 v87, v87
  v_cvt_pk_bf16_f32 v106, v84, v85
  v_mfma_f32_32x32x8_bf16 v[64:79], v[158:159], v[204:205], v[64:79]
  v_cvt_pk_bf16_f32 v107, v86, v87
  v_exp_f32 v88, v88
  v_exp_f32 v89, v89
  v_exp_f32 v90, v90
  v_exp_f32 v91, v91
  v_cvt_pk_bf16_f32 v108, v88, v89
  v_mfma_f32_32x32x16_bf16 a[32:47], v[164:167], v[100:103], a[32:47]
  v_cvt_pk_bf16_f32 v109, v90, v91
  v_exp_f32 v92, v92
  v_exp_f32 v93, v93
  v_exp_f32 v94, v94
  v_exp_f32 v95, v95
  v_cvt_pk_bf16_f32 v110, v92, v93
  v_cvt_pk_bf16_f32 v111, v94, v95
  v_mfma_f32_32x32x16_bf16 v[80:95], v[148:151], v[208:211], 0
  s_waitcnt lgkmcnt(0)
  ds_read_b128 v[144:147], v176 offset:12288
  v_exp_f32 v64, v64
  v_exp_f32 v65, v65
  v_exp_f32 v66, v66
  v_exp_f32 v67, v67
  v_cvt_pk_bf16_f32 v96, v64, v65
  v_mfma_f32_32x32x16_bf16 a[0:15], v[168:171], v[104:107], a[0:15]
  ds_read_b128 v[152:155], v176 offset:26624
  v_cvt_pk_bf16_f32 v97, v66, v67
  v_exp_f32 v68, v68
  v_exp_f32 v69, v69
  v_exp_f32 v70, v70
  v_exp_f32 v71, v71
  v_cvt_pk_bf16_f32 v98, v68, v69
  v_mfma_f32_32x32x8_bf16 v[80:95], v[158:159], v[212:213], v[80:95]
  s_waitcnt lgkmcnt(0)
  buffer_load_dwordx4 v238, s[16:19], s34 offen offset:3072 sc1 lds
  v_cvt_pk_bf16_f32 v99, v70, v71
  v_exp_f32 v72, v72
  v_exp_f32 v73, v73
  v_exp_f32 v74, v74
  v_exp_f32 v75, v75
  v_cvt_pk_bf16_f32 v100, v72, v73
  v_mfma_f32_32x32x16_bf16 a[0:15], v[172:175], v[108:111], a[0:15]
  s_add_u32 s34, s34, 4096
  v_cvt_pk_bf16_f32 v101, v74, v75
  v_exp_f32 v76, v76
  v_exp_f32 v77, v77
  v_exp_f32 v78, v78
  v_exp_f32 v79, v79
  v_cvt_pk_bf16_f32 v102, v76, v77
  v_cvt_pk_bf16_f32 v103, v78, v79
  v_mfma_f32_32x32x16_bf16 v[64:79], v[144:147], v[192:195], 0
  v_exp_f32 v80, v80
  v_exp_f32 v81, v81
  v_exp_f32 v82, v82
  v_exp_f32 v83, v83
  v_cvt_pk_bf16_f32 v104, v80, v81
  v_mfma_f32_32x32x16_bf16 a[16:31], v[168:171], v[96:99], a[16:31]
  v_cvt_pk_bf16_f32 v105, v82, v83
  v_exp_f32 v84, v84
  v_exp_f32 v85, v85
  v_exp_f32 v86, v86
  v_exp_f32 v87, v87
  v_cvt_pk_bf16_f32 v106, v84, v85
  v_mfma_f32_32x32x8_bf16 v[64:79], v[152:153], v[196:197], v[64:79]
  v_cvt_pk_bf16_f32 v107, v86, v87
  v_exp_f32 v88, v88
  v_exp_f32 v89, v89
  v_exp_f32 v90, v90
  v_exp_f32 v91, v91
  v_cvt_pk_bf16_f32 v108, v88, v89
  v_mfma_f32_32x32x16_bf16 a[16:31], v[172:175], v[100:103], a[16:31]
  v_cvt_pk_bf16_f32 v109, v90, v91
  v_exp_f32 v92, v92
  v_exp_f32 v93, v93
  v_exp_f32 v94, v94
  v_exp_f32 v95, v95
  v_cvt_pk_bf16_f32 v110, v92, v93
  v_cvt_pk_bf16_f32 v111, v94, v95
  v_mfma_f32_32x32x16_bf16 v[80:95], v[144:147], v[200:203], 0
  ds_read_b128 v[160:163], v176 offset:13312
  v_exp_f32 v64, v64
  v_exp_f32 v65, v65
  v_exp_f32 v66, v66
  v_exp_f32 v67, v67
  v_cvt_pk_bf16_f32 v96, v64, v65
  v_mfma_f32_32x32x16_bf16 a[32:47], v[168:171], v[104:107], a[32:47]
  ds_read_b128 v[164:167], v176 offset:14336
  v_cvt_pk_bf16_f32 v97, v66, v67
  v_exp_f32 v68, v68
  v_exp_f32 v69, v69
  v_exp_f32 v70, v70
  v_exp_f32 v71, v71
  v_cvt_pk_bf16_f32 v98, v68, v69
  v_mfma_f32_32x32x8_bf16 v[80:95], v[152:153], v[204:205], v[80:95]
  v_cvt_pk_bf16_f32 v99, v70, v71
  v_exp_f32 v72, v72
  v_exp_f32 v73, v73
  v_exp_f32 v74, v74
  v_exp_f32 v75, v75
  v_cvt_pk_bf16_f32 v100, v72, v73
  v_mfma_f32_32x32x16_bf16 a[32:47], v[172:175], v[108:111], a[32:47]
  v_cvt_pk_bf16_f32 v101, v74, v75
  v_exp_f32 v76, v76
  v_exp_f32 v77, v77
  v_exp_f32 v78, v78
  v_exp_f32 v79, v79
  v_cvt_pk_bf16_f32 v102, v76, v77
  v_cvt_pk_bf16_f32 v103, v78, v79
  v_mfma_f32_32x32x16_bf16 v[64:79], v[144:147], v[208:211], 0
  s_waitcnt lgkmcnt(0)
  ds_read_b128 v[148:151], v176 offset:15360
  v_exp_f32 v80, v80
  v_exp_f32 v81, v81
  v_exp_f32 v82, v82
  v_exp_f32 v83, v83
  v_cvt_pk_bf16_f32 v104, v80, v81
  v_mfma_f32_32x32x16_bf16 a[0:15], v[160:163], v[96:99], a[0:15]
  s_add_u32 m0, s33, 4096
  v_cvt_pk_bf16_f32 v105, v82, v83
  v_exp_f32 v84, v84
  v_exp_f32 v85, v85
  v_exp_f32 v86, v86
  v_exp_f32 v87, v87
  v_cvt_pk_bf16_f32 v106, v84, v85
  v_mfma_f32_32x32x8_bf16 v[64:79], v[152:153], v[212:213], v[64:79]
  buffer_load_dwordx4 v238, s[16:19], s34 offen offset:0 sc1 lds
  v_cvt_pk_bf16_f32 v107, v86, v87
  v_exp_f32 v88, v88
  v_exp_f32 v89, v89
  v_exp_f32 v90, v90
  v_exp_f32 v91, v91
  v_cvt_pk_bf16_f32 v108, v88, v89
  v_mfma_f32_32x32x16_bf16 a[0:15], v[164:167], v[100:103], a[0:15]
  s_waitcnt lgkmcnt(0)
  v_cvt_pk_bf16_f32 v109, v90, v91
  v_exp_f32 v92, v92
  v_exp_f32 v93, v93
  v_exp_f32 v94, v94
  v_exp_f32 v95, v95
  v_cvt_pk_bf16_f32 v110, v92, v93
  v_cvt_pk_bf16_f32 v111, v94, v95
  v_mfma_f32_32x32x16_bf16 v[80:95], v[148:151], v[192:195], 0
  v_exp_f32 v64, v64
  v_exp_f32 v65, v65
  v_exp_f32 v66, v66
  v_exp_f32 v67, v67
  v_cvt_pk_bf16_f32 v96, v64, v65
  v_mfma_f32_32x32x16_bf16 a[16:31], v[160:163], v[104:107], a[16:31]
  v_cvt_pk_bf16_f32 v97, v66, v67
  v_exp_f32 v68, v68
  v_exp_f32 v69, v69
  v_exp_f32 v70, v70
  v_exp_f32 v71, v71
  v_cvt_pk_bf16_f32 v98, v68, v69
  v_mfma_f32_32x32x8_bf16 v[80:95], v[154:155], v[196:197], v[80:95]
  v_cvt_pk_bf16_f32 v99, v70, v71
  v_exp_f32 v72, v72
  v_exp_f32 v73, v73
  v_exp_f32 v74, v74
  v_exp_f32 v75, v75
  v_cvt_pk_bf16_f32 v100, v72, v73
  v_mfma_f32_32x32x16_bf16 a[16:31], v[164:167], v[108:111], a[16:31]
  v_cvt_pk_bf16_f32 v101, v74, v75
  v_exp_f32 v76, v76
  v_exp_f32 v77, v77
  v_exp_f32 v78, v78
  v_exp_f32 v79, v79
  v_cvt_pk_bf16_f32 v102, v76, v77
  v_cvt_pk_bf16_f32 v103, v78, v79
  v_mfma_f32_32x32x16_bf16 v[64:79], v[148:151], v[200:203], 0
  ds_read_b128 v[168:171], v176 offset:16384
  v_exp_f32 v80, v80
  v_exp_f32 v81, v81
  v_exp_f32 v82, v82
  v_exp_f32 v83, v83
  v_cvt_pk_bf16_f32 v104, v80, v81
  v_mfma_f32_32x32x16_bf16 a[32:47], v[160:163], v[96:99], a[32:47]
  ds_read_b128 v[172:175], v176 offset:17408
  v_cvt_pk_bf16_f32 v105, v82, v83
  v_exp_f32 v84, v84
  v_exp_f32 v85, v85
  v_exp_f32 v86, v86
  v_exp_f32 v87, v87
  v_cvt_pk_bf16_f32 v106, v84, v85
  v_mfma_f32_32x32x8_bf16 v[64:79], v[154:155], v[204:205], v[64:79]
  v_cvt_pk_bf16_f32 v107, v86, v87
  v_exp_f32 v88, v88
  v_exp_f32 v89, v89
  v_exp_f32 v90, v90
  v_exp_f32 v91, v91
  v_cvt_pk_bf16_f32 v108, v88, v89
  v_mfma_f32_32x32x16_bf16 a[32:47], v[164:167], v[100:103], a[32:47]
  v_cvt_pk_bf16_f32 v109, v90, v91
  v_exp_f32 v92, v92
  v_exp_f32 v93, v93
  v_exp_f32 v94, v94
  v_exp_f32 v95, v95
  v_cvt_pk_bf16_f32 v110, v92, v93
  v_cvt_pk_bf16_f32 v111, v94, v95
  v_mfma_f32_32x32x16_bf16 v[80:95], v[148:151], v[208:211], 0
  s_waitcnt lgkmcnt(0)
  ds_read_b128 v[144:147], v176 offset:18432
  v_exp_f32 v64, v64
  v_exp_f32 v65, v65
  v_exp_f32 v66, v66
  v_exp_f32 v67, v67
  v_cvt_pk_bf16_f32 v96, v64, v65
  v_mfma_f32_32x32x16_bf16 a[0:15], v[168:171], v[104:107], a[0:15]
  ds_read_b128 v[156:159], v176 offset:27648
  v_cvt_pk_bf16_f32 v97, v66, v67
  v_exp_f32 v68, v68
  v_exp_f32 v69, v69
  v_exp_f32 v70, v70
  v_exp_f32 v71, v71
  v_cvt_pk_bf16_f32 v98, v68, v69
  v_mfma_f32_32x32x8_bf16 v[80:95], v[154:155], v[212:213], v[80:95]
  buffer_load_dwordx4 v238, s[16:19], s34 offen offset:1024 sc1 lds
  v_cvt_pk_bf16_f32 v99, v70, v71
  v_exp_f32 v72, v72
  v_exp_f32 v73, v73
  v_exp_f32 v74, v74
  v_exp_f32 v75, v75
  v_cvt_pk_bf16_f32 v100, v72, v73
  v_mfma_f32_32x32x16_bf16 a[0:15], v[172:175], v[108:111], a[0:15]
  s_waitcnt lgkmcnt(0)
  v_cvt_pk_bf16_f32 v101, v74, v75
  v_exp_f32 v76, v76
  v_exp_f32 v77, v77
  v_exp_f32 v78, v78
  v_exp_f32 v79, v79
  v_cvt_pk_bf16_f32 v102, v76, v77
  v_cvt_pk_bf16_f32 v103, v78, v79
  v_mfma_f32_32x32x16_bf16 v[64:79], v[144:147], v[192:195], 0
  v_exp_f32 v80, v80
  v_exp_f32 v81, v81
  v_exp_f32 v82, v82
  v_exp_f32 v83, v83
  v_cvt_pk_bf16_f32 v104, v80, v81
  v_mfma_f32_32x32x16_bf16 a[16:31], v[168:171], v[96:99], a[16:31]
  v_cvt_pk_bf16_f32 v105, v82, v83
  v_exp_f32 v84, v84
  v_exp_f32 v85, v85
  v_exp_f32 v86, v86
  v_exp_f32 v87, v87
  v_cvt_pk_bf16_f32 v106, v84, v85
  v_mfma_f32_32x32x8_bf16 v[64:79], v[156:157], v[196:197], v[64:79]
  v_cvt_pk_bf16_f32 v107, v86, v87
  v_exp_f32 v88, v88
  v_exp_f32 v89, v89
  v_exp_f32 v90, v90
  v_exp_f32 v91, v91
  v_cvt_pk_bf16_f32 v108, v88, v89
  v_mfma_f32_32x32x16_bf16 a[16:31], v[172:175], v[100:103], a[16:31]
  v_cvt_pk_bf16_f32 v109, v90, v91
  v_exp_f32 v92, v92
  v_exp_f32 v93, v93
  v_exp_f32 v94, v94
  v_exp_f32 v95, v95
  v_cvt_pk_bf16_f32 v110, v92, v93
  v_cvt_pk_bf16_f32 v111, v94, v95
  v_mfma_f32_32x32x16_bf16 v[80:95], v[144:147], v[200:203], 0
  ds_read_b128 v[160:163], v176 offset:19456
  v_exp_f32 v64, v64
  v_exp_f32 v65, v65
  v_exp_f32 v66, v66
  v_exp_f32 v67, v67
  v_cvt_pk_bf16_f32 v96, v64, v65
  v_mfma_f32_32x32x16_bf16 a[32:47], v[168:171], v[104:107], a[32:47]
  ds_read_b128 v[164:167], v176 offset:20480
  v_cvt_pk_bf16_f32 v97, v66, v67
  v_exp_f32 v68, v68
  v_exp_f32 v69, v69
  v_exp_f32 v70, v70
  v_exp_f32 v71, v71
  v_cvt_pk_bf16_f32 v98, v68, v69
  v_mfma_f32_32x32x8_bf16 v[80:95], v[156:157], v[204:205], v[80:95]
  v_cvt_pk_bf16_f32 v99, v70, v71
  v_exp_f32 v72, v72
  v_exp_f32 v73, v73
  v_exp_f32 v74, v74
  v_exp_f32 v75, v75
  v_cvt_pk_bf16_f32 v100, v72, v73
  v_mfma_f32_32x32x16_bf16 a[32:47], v[172:175], v[108:111], a[32:47]
  v_cvt_pk_bf16_f32 v101, v74, v75
  v_exp_f32 v76, v76
  v_exp_f32 v77, v77
  v_exp_f32 v78, v78
  v_exp_f32 v79, v79
  v_cvt_pk_bf16_f32 v102, v76, v77
  v_cvt_pk_bf16_f32 v103, v78, v79
  v_mfma_f32_32x32x16_bf16 v[64:79], v[144:147], v[208:211], 0
  s_waitcnt lgkmcnt(0)
  ds_read_b128 v[148:151], v176 offset:21504
  v_exp_f32 v80, v80
  v_exp_f32 v81, v81
  v_exp_f32 v82, v82
  v_exp_f32 v83, v83
  v_cvt_pk_bf16_f32 v104, v80, v81
  v_mfma_f32_32x32x16_bf16 a[0:15], v[160:163], v[96:99], a[0:15]
  buffer_load_dwordx4 v238, s[16:19], s34 offen offset:2048 sc1 lds
  v_cvt_pk_bf16_f32 v105, v82, v83
  v_exp_f32 v84, v84
  v_exp_f32 v85, v85
  v_exp_f32 v86, v86
  v_exp_f32 v87, v87
  v_cvt_pk_bf16_f32 v106, v84, v85
  v_mfma_f32_32x32x8_bf16 v[64:79], v[156:157], v[212:213], v[64:79]
  s_add_u32 s34, s34, 24576
  v_cvt_pk_bf16_f32 v107, v86, v87
  v_exp_f32 v88, v88
  v_exp_f32 v89, v89
  v_exp_f32 v90, v90
  v_exp_f32 v91, v91
  v_cvt_pk_bf16_f32 v108, v88, v89
  v_mfma_f32_32x32x16_bf16 a[0:15], v[164:167], v[100:103], a[0:15]
  s_waitcnt lgkmcnt(0)
  v_cvt_pk_bf16_f32 v109, v90, v91
  v_exp_f32 v92, v92
  v_exp_f32 v93, v93
  v_exp_f32 v94, v94
  v_exp_f32 v95, v95
  v_cvt_pk_bf16_f32 v110, v92, v93
  v_cvt_pk_bf16_f32 v111, v94, v95
  v_mfma_f32_32x32x16_bf16 v[80:95], v[148:151], v[192:195], 0
  v_exp_f32 v64, v64
  v_exp_f32 v65, v65
  v_exp_f32 v66, v66
  v_exp_f32 v67, v67
  v_cvt_pk_bf16_f32 v96, v64, v65
  v_mfma_f32_32x32x16_bf16 a[16:31], v[160:163], v[104:107], a[16:31]
  v_cvt_pk_bf16_f32 v97, v66, v67
  v_exp_f32 v68, v68
  v_exp_f32 v69, v69
  v_exp_f32 v70, v70
  v_exp_f32 v71, v71
  v_cvt_pk_bf16_f32 v98, v68, v69
  v_mfma_f32_32x32x8_bf16 v[80:95], v[158:159], v[196:197], v[80:95]
  v_cvt_pk_bf16_f32 v99, v70, v71
  v_exp_f32 v72, v72
  v_exp_f32 v73, v73
  v_exp_f32 v74, v74
  v_exp_f32 v75, v75
  v_cvt_pk_bf16_f32 v100, v72, v73
  v_mfma_f32_32x32x16_bf16 a[16:31], v[164:167], v[108:111], a[16:31]
  v_cvt_pk_bf16_f32 v101, v74, v75
  v_exp_f32 v76, v76
  v_exp_f32 v77, v77
  v_exp_f32 v78, v78
  v_exp_f32 v79, v79
  v_cvt_pk_bf16_f32 v102, v76, v77
  v_cvt_pk_bf16_f32 v103, v78, v79
  v_mfma_f32_32x32x16_bf16 v[64:79], v[148:151], v[200:203], 0
  ds_read_b128 v[168:171], v176 offset:22528
  v_exp_f32 v80, v80
  v_exp_f32 v81, v81
  v_exp_f32 v82, v82
  v_exp_f32 v83, v83
  v_cvt_pk_bf16_f32 v104, v80, v81
  v_mfma_f32_32x32x16_bf16 a[32:47], v[160:163], v[96:99], a[32:47]
  ds_read_b128 v[172:175], v176 offset:23552
  v_cvt_pk_bf16_f32 v105, v82, v83
  v_exp_f32 v84, v84
  v_exp_f32 v85, v85
  v_exp_f32 v86, v86
  v_exp_f32 v87, v87
  v_cvt_pk_bf16_f32 v106, v84, v85
  v_mfma_f32_32x32x8_bf16 v[64:79], v[158:159], v[204:205], v[64:79]
  v_cvt_pk_bf16_f32 v107, v86, v87
  v_exp_f32 v88, v88
  v_exp_f32 v89, v89
  v_exp_f32 v90, v90
  v_exp_f32 v91, v91
  v_cvt_pk_bf16_f32 v108, v88, v89
  v_mfma_f32_32x32x16_bf16 a[32:47], v[164:167], v[100:103], a[32:47]
  v_cvt_pk_bf16_f32 v109, v90, v91
  v_exp_f32 v92, v92
  v_exp_f32 v93, v93
  v_exp_f32 v94, v94
  v_exp_f32 v95, v95
  v_cvt_pk_bf16_f32 v110, v92, v93
  v_cvt_pk_bf16_f32 v111, v94, v95
  v_mfma_f32_32x32x16_bf16 v[80:95], v[148:151], v[208:211], 0
  s_waitcnt lgkmcnt(0)
  ds_read_b128 v[144:147], v177 offset:0
  v_exp_f32 v64, v64
  v_exp_f32 v65, v65
  v_exp_f32 v66, v66
  v_exp_f32 v67, v67
  v_cvt_pk_bf16_f32 v96, v64, v65
  v_mfma_f32_32x32x16_bf16 a[0:15], v[168:171], v[104:107], a[0:15]
  ds_read_b128 v[152:155], v177 offset:24576
  v_cvt_pk_bf16_f32 v97, v66, v67
  v_exp_f32 v68, v68
  v_exp_f32 v69, v69
  v_exp_f32 v70, v70
  v_exp_f32 v71, v71
  v_cvt_pk_bf16_f32 v98, v68, v69
  v_mfma_f32_32x32x8_bf16 v[80:95], v[158:159], v[212:213], v[80:95]
  v_cvt_pk_bf16_f32 v99, v70, v71
  v_exp_f32 v72, v72
  v_exp_f32 v73, v73
  v_exp_f32 v74, v74
  v_exp_f32 v75, v75
  v_cvt_pk_bf16_f32 v100, v72, v73
  v_mfma_f32_32x32x16_bf16 a[0:15], v[172:175], v[108:111], a[0:15]
  s_waitcnt lgkmcnt(0)
  v_cvt_pk_bf16_f32 v101, v74, v75
  v_exp_f32 v76, v76
  v_exp_f32 v77, v77
  v_exp_f32 v78, v78
  v_exp_f32 v79, v79
  v_cvt_pk_bf16_f32 v102, v76, v77
  v_cvt_pk_bf16_f32 v103, v78, v79
  v_mfma_f32_32x32x16_bf16 v[64:79], v[144:147], v[192:195], 0
  v_exp_f32 v80, v80
  v_exp_f32 v81, v81
  v_exp_f32 v82, v82
  v_exp_f32 v83, v83
  v_cvt_pk_bf16_f32 v104, v80, v81
  v_mfma_f32_32x32x16_bf16 a[16:31], v[168:171], v[96:99], a[16:31]
  s_add_u32 s31, s38, 65536
  v_cvt_pk_bf16_f32 v105, v82, v83
  v_exp_f32 v84, v84
  v_exp_f32 v85, v85
  v_exp_f32 v86, v86
  v_exp_f32 v87, v87
  v_cvt_pk_bf16_f32 v106, v84, v85
  v_mfma_f32_32x32x8_bf16 v[64:79], v[152:153], v[196:197], v[64:79]
  s_and_b32 s31, s31, 0x1ffff
  v_cvt_pk_bf16_f32 v107, v86, v87
  v_exp_f32 v88, v88
  v_exp_f32 v89, v89
  v_exp_f32 v90, v90
  v_exp_f32 v91, v91
  v_cvt_pk_bf16_f32 v108, v88, v89
  v_mfma_f32_32x32x16_bf16 a[16:31], v[172:175], v[100:103], a[16:31]
  s_add_u32 s33, s38, s61
  v_cvt_pk_bf16_f32 v109, v90, v91
  v_exp_f32 v92, v92
  v_exp_f32 v93, v93
  v_exp_f32 v94, v94
  v_exp_f32 v95, v95
  v_cvt_pk_bf16_f32 v110, v92, v93
  v_cvt_pk_bf16_f32 v111, v94, v95
  v_mfma_f32_32x32x16_bf16 v[80:95], v[144:147], v[200:203], 0
  s_add_u32 s38, s38, 32768
  ds_read_b128 v[160:163], v177 offset:1024
  v_exp_f32 v64, v64
  v_exp_f32 v65, v65
  v_exp_f32 v66, v66
  v_exp_f32 v67, v67
  v_cvt_pk_bf16_f32 v96, v64, v65
  v_mfma_f32_32x32x16_bf16 a[32:47], v[168:171], v[104:107], a[32:47]
  s_and_b32 s38, s38, 0x1ffff
  ds_read_b128 v[164:167], v177 offset:2048
  v_cvt_pk_bf16_f32 v97, v66, v67
  v_exp_f32 v68, v68
  v_exp_f32 v69, v69
  v_exp_f32 v70, v70
  v_exp_f32 v71, v71
  v_cvt_pk_bf16_f32 v98, v68, v69
  v_mfma_f32_32x32x8_bf16 v[80:95], v[152:153], v[204:205], v[80:95]
  s_sub_u32 s37, s37, 1
  v_cvt_pk_bf16_f32 v99, v70, v71
  v_exp_f32 v72, v72
  v_exp_f32 v73, v73
  v_exp_f32 v74, v74
  v_exp_f32 v75, v75
  v_cvt_pk_bf16_f32 v100, v72, v73
  v_mfma_f32_32x32x16_bf16 a[32:47], v[172:175], v[108:111], a[32:47]
  s_bitcmp0_b32 s47, s37
  v_cvt_pk_bf16_f32 v101, v74, v75
  v_exp_f32 v76, v76
  v_exp_f32 v77, v77
  v_exp_f32 v78, v78
  v_exp_f32 v79, v79
  v_cvt_pk_bf16_f32 v102, v76, v77
  v_cvt_pk_bf16_f32 v103, v78, v79
  v_mov_b32 v176, v177
  v_add_u32 v177, s31, v236
  s_cbranch_scc1 L_Bloop3
  s_cmp_eq_u32 s37, 0
  s_cbranch_scc1 L_Bend
  s_cmp_eq_u32 s37, 6
  s_cbranch_scc1 L_pb3
  s_mov_b32 s32, 29696
  buffer_load_dwordx4 v[20:23], v236, s[24:27], s32 offen sc1
  buffer_load_dword v24, v9, s[24:27], s62 offen sc1
  s_branch L_Bloop3
L_pb3:
  s_cmp_eq_u32 s45, 0
  s_cbranch_scc1 L_Bloop3
  s_mov_b32 s45, 0
  s_min_u32 s31, s3, 255
  s_lshl_b32 s31, s31, 2
  s_add_u32 s31, s31, 29696
  v_mov_b32 v6, s100
  v_mov_b32 v7, 0
  s_mov_b64 exec, 1
  buffer_store_dword v6, v7, s[24:27], s31 offen offset:0 sc1
  s_mov_b64 exec, -1
  s_branch L_Bloop3
L_B4:
  s_cmp_lg_u32 s39, 0
  s_cbranch_scc1 L_Bh4
  s_mov_b32 vcc_lo, -1
  s_mov_b32 vcc_hi, 0
  v_cndmask_b32 v196, 0, v196, vcc
  v_cndmask_b32 v197, 0, v197, vcc
  v_cndmask_b32 v204, 0, v204, vcc
  v_cndmask_b32 v205, 0, v205, vcc
  v_cndmask_b32 v212, 0, v212, vcc
  v_cndmask_b32 v213, 0, v213, vcc
  v_cndmask_b32 v220, 0, v220, vcc
  v_cndmask_b32 v221, 0, v221, vcc
  v_accvgpr_write_b32 a0, 0
  v_accvgpr_write_b32 a1, 0
  v_accvgpr_write_b32 a2, 0
  v_accvgpr_write_b32 a3, 0
  v_accvgpr_write_b32 a4, 0
  v_accvgpr_write_b32 a5, 0
  v_accvgpr_write_b32 a6, 0
  v_accvgpr_write_b32 a7, 0
  v_accvgpr_write_b32 a8, 0
  v_accvgpr_write_b32 a9, 0
  v_accvgpr_write_b32 a10, 0
  v_accvgpr_write_b32 a11, 0
  s_waitcnt lgkmcnt(0)
  v_mfma_f32_32x32x16_bf16 v[64:79], v[144:147], v[192:195], 0
  buffer_store_dwordx4 v[28:31], v236, s[64:67], s44 offen offset:0 sc1
  v_accvgpr_write_b32 a12, 0
  v_accvgpr_write_b32 a13, 0
  v_accvgpr_write_b32 a14, 0
  v_accvgpr_write_b32 a15, 0
  v_accvgpr_write_b32 a16, 0
  v_accvgpr_write_b32 a17, 0
  v_accvgpr_write_b32 a18, 0
  v_accvgpr_write_b32 a19, 0
  v_accvgpr_write_b32 a20, 0
  v_accvgpr_write_b32 a21, 0
  v_accvgpr_write_b32 a22, 0
  v_accvgpr_write_b32 a23, 0
  buffer_store_dwordx4 v[32:35], v236, s[64:67], s44 offen offset:1024 sc1
  v_accvgpr_write_b32 a24, 0
  v_accvgpr_write_b32 a25, 0
  v_accvgpr_write_b32 a26, 0
  v_accvgpr_write_b32 a27, 0
  v_mfma_f32_32x32x16_bf16 v[80:95], v[144:147], v[200:203], 0
  v_accvgpr_write_b32 a28, 0
  v_accvgpr_write_b32 a29, 0
  v_accvgpr_write_b32 a30, 0
  v_accvgpr_write_b32 a31, 0
  v_accvgpr_write_b32 a32, 0
  v_accvgpr_write_b32 a33, 0
  v_accvgpr_write_b32 a34, 0
  v_accvgpr_write_b32 a35, 0
  buffer_store_dwordx4 v[36:39], v236, s[64:67], s44 offen offset:2048 sc1
  v_accvgpr_write_b32 a36, 0
  v_accvgpr_write_b32 a37, 0
  v_accvgpr_write_b32 a38, 0
  v_accvgpr_write_b32 a39, 0
  v_accvgpr_write_b32 a40, 0
  v_accvgpr_write_b32 a41, 0
  v_accvgpr_write_b32 a42, 0
  v_accvgpr_write_b32 a43, 0
  v_accvgpr_write_b32 a44, 0
  v_mfma_f32_32x32x16_bf16 v[96:111], v[144:147], v[208:211], 0
  v_accvgpr_write_b32 a45, 0
  v_accvgpr_write_b32 a46, 0
  v_accvgpr_write_b32 a47, 0
  buffer_store_dwordx4 v[40:43], v236, s[64:67], s44 offen offset:3072 sc1
  v_accvgpr_write_b32 a48, 0
  v_accvgpr_write_b32 a49, 0
  v_accvgpr_write_b32 a50, 0
  v_accvgpr_write_b32 a51, 0
  v_accvgpr_write_b32 a52, 0
  v_accvgpr_write_b32 a53, 0
  v_accvgpr_write_b32 a54, 0
  v_accvgpr_write_b32 a55, 0
  v_accvgpr_write_b32 a56, 0
  v_accvgpr_write_b32 a57, 0
  v_accvgpr_write_b32 a58, 0
  v_accvgpr_write_b32 a59, 0
  buffer_store_dwordx4 v[44:47], v27, s[64:67], s44 offen sc1
  v_accvgpr_write_b32 a60, 0
  v_mfma_f32_32x32x16_bf16 v[112:127], v[144:147], v[216:219], 0
  v_accvgpr_write_b32 a61, 0
  v_accvgpr_write_b32 a62, 0
  v_accvgpr_write_b32 a63, 0
  s_add_u32 s31, s2, s100
  s_and_b32 s48, s31, 3
  s_lshr_b32 s32, s31, 2
  s_xor_b32 s31, s31, s32
  s_and_b32 s31, s31, 1
  s_lshl_b32 s49, s31, 3
  s_mov_b32 s56, 0
  s_mov_b32 s57, 0
  s_add_u32 s44, s44, 757760
  s_cmp_eq_u32 s48, 1
  s_cselect_b32 s56, 470618644, s56
  s_cselect_b32 s57, 134746129, s57
  s_cmp_eq_u32 s48, 2
  s_cselect_b32 s56, 606020380, s56
  s_cselect_b32 s57, 605822241, s57
  v_mfma_f32_32x32x8_bf16 v[64:79], v[152:153], v[196:197], v[64:79]
  s_cmp_eq_u32 s48, 3
  s_cselect_b32 s56, 942682936, s56
  s_cselect_b32 s57, 740568878, s57
  s_lshl_b32 s31, s29, 3
  s_lshr_b64 s[56:57], s[56:57], s31
  s_and_b32 s54, s56, 255
  buffer_store_dwordx4 v[48:51], v236, s[64:67], s44 offen offset:0 sc1
  s_mov_b32 s56, 135269640
  s_mov_b32 s57, 337383698
  s_lshr_b64 s[56:57], s[56:57], s31
  s_and_b32 s55, s56, 255
  s_cmp_eq_u32 s49, 0
  s_cselect_b32 s32, 3, 2
  s_bitcmp1_b32 s48, 0
  s_cselect_b32 s33, s32, 0
  s_add_u32 s54, s54, s33
  s_lshl_b32 s33, s33, 1
  s_sub_u32 s32, s32, s33
  v_mfma_f32_32x32x8_bf16 v[80:95], v[152:153], v[204:205], v[80:95]
  s_add_u32 s55, s55, s32
  buffer_store_dwordx4 v[52:55], v236, s[64:67], s44 offen offset:1024 sc1
  s_lshl_b32 s31, s29, 2
  s_lshr_b32 s31, 544478803, s31
  s_sub_u32 s32, s31, s48
  s_and_b32 s32, s32, 3
  s_and_b32 s31, s31, 4
  s_or_b32 s31, s31, s32
  s_and_b32 s50, s31, 2
  s_bfe_u32 s32, s28, 0x10001
  s_or_b32 s50, s50, s32
  s_and_b32 s32, s31, 1
  s_lshl_b32 s32, s32, 1
  s_and_b32 s31, s31, 4
  buffer_store_dwordx4 v[56:59], v236, s[64:67], s44 offen offset:2048 sc1
  s_or_b32 s31, s31, s32
  s_and_b32 s32, s28, 1
  s_or_b32 s31, s31, s32
  v_mfma_f32_32x32x8_bf16 v[96:111], v[152:153], v[212:213], v[96:111]
  s_lshl_b32 s31, s31, 2
  s_lshr_b32 s31, 1980781618, s31
  s_and_b32 s31, s31, 7
  s_add_u32 s49, s49, s31
  s_lshl_b32 s51, s49, 2
  s_add_u32 s51, s51, s50
  s_and_b32 s52, s30, 1
  s_lshr_b32 s53, s30, 1
  v_and_b32 v9, 31, v2
  buffer_store_dwordx4 v[60:63], v236, s[64:67], s44 offen offset:3072 sc1
  v_lshlrev_b32 v9, 2, v9
  s_lshr_b32 s62, s49, 1
  s_lshl_b32 s62, s62, 7
  s_add_u32 s62, s62, 4096
  s_lshr_b32 s31, s54, 1
  s_add_u32 s32, s54, s55
  s_add_u32 s32, s32, 1
  s_lshr_b32 s32, s32, 1
  v_mfma_f32_32x32x8_bf16 v[112:127], v[152:153], v[220:221], v[112:127]
  s_add_u32 m0, s61, 65536
  s_mov_b32 s60, 57344
  buffer_load_dwordx4 v238, s[16:19], s60 offen offset:0 sc1 lds
  s_sub_u32 s32, s32, s31
  s_bfm_b32 s63, s32, s31
  s_lshl_b32 s31, s50, 1
  s_add_u32 s31, s31, s53
  buffer_store_dwordx4 v[180:183], v27, s[64:67], s44 offen sc1
  s_mul_i32 s31, s31, 148
  s_lshl_b32 s32, s54, 1
  s_add_u32 s31, s31, s32
  s_add_u32 s31, s31, s52
  s_mul_i32 s58, s31, 5120
  s_lshl_b32 s31, s49, 3
  s_lshl_b32 s33, s30, 1
  s_add_u32 s31, s31, s33
  buffer_load_dwordx4 v238, s[16:19], s60 offen offset:1024 sc1 lds
  s_mul_i32 s31, s31, 148
  s_add_u32 s31, s31, s32
  s_lshl_b32 s59, s31, 10
  s_cmp_eq_u32 s30, 0
  s_cselect_b32 s47, 0x43, 1
  v_max3_f32 v240, v64, v65, v66
  v_max3_f32 v240, v240, v67, v68
  v_max3_f32 v240, v240, v69, v70
  v_max3_f32 v240, v240, v71, v72
  v_max3_f32 v240, v240, v73, v74
  v_max3_f32 v240, v240, v75, v76
  v_max3_f32 v240, v240, v77, v78
  v_max_f32 v240, v240, v79
  buffer_load_dwordx4 v238, s[16:19], s60 offen offset:2048 sc1 lds
  v_max3_f32 v241, v80, v81, v82
  v_max3_f32 v241, v241, v83, v84
  v_max3_f32 v241, v241, v85, v86
  v_max3_f32 v241, v241, v87, v88
  v_max3_f32 v241, v241, v89, v90
  v_max3_f32 v241, v241, v91, v92
  v_max3_f32 v241, v241, v93, v94
  v_max_f32 v241, v241, v95
  v_max3_f32 v242, v96, v97, v98
  v_max3_f32 v242, v242, v99, v100
  v_max3_f32 v242, v242, v101, v102
  v_max3_f32 v242, v242, v103, v104
  v_max3_f32 v242, v242, v105, v106
  buffer_load_dwordx4 v238, s[16:19], s60 offen offset:3072 sc1 lds
  v_max3_f32 v242, v242, v107, v108
  v_max3_f32 v242, v242, v109, v110
  v_max_f32 v242, v242, v111
  v_max3_f32 v243, v112, v113, v114
  v_max3_f32 v243, v243, v115, v116
  v_max3_f32 v243, v243, v117, v118
  v_max3_f32 v243, v243, v119, v120
  v_max3_f32 v243, v243, v121, v122
  v_max3_f32 v243, v243, v123, v124
  v_max3_f32 v243, v243, v125, v126
  v_max_f32 v243, v243, v127
  s_mov_b32 vcc_lo, -1
  s_mov_b32 vcc_hi, 0
  s_add_u32 m0, s61, 69632
  s_mov_b32 s60, 61440
  buffer_load_dwordx4 v238, s[16:19], s60 offen offset:0 sc1 lds
  v_mov_b32 v248, v240
  v_mov_b32 v249, v241
  v_mov_b32 v250, v242
  v_mov_b32 v251, v243
  v_permlane32_swap_b32 v240, v248
  v_permlane32_swap_b32 v241, v249
  v_permlane32_swap_b32 v242, v250
  v_permlane32_swap_b32 v243, v251
  v_max_f32 v240, v240, v248
  v_sub_f32 v240, 0, v240
  v_and_b32 v248, 0xffff0000, v240
  v_sub_f32 v240, v240, v248
  v_lshrrev_b32 v248, 16, v248
  buffer_load_dwordx4 v238, s[16:19], s60 offen offset:1024 sc1 lds
  v_and_b32 v6, 0xffff0000, v240
  v_or_b32 v248, v248, v6
  v_sub_f32 v240, v240, v6
  v_lshrrev_b32 v240, 16, v240
  v_cndmask_b32 v196, v248, v196, vcc
  v_cndmask_b32 v197, v240, v197, vcc
  v_max_f32 v241, v241, v249
  v_sub_f32 v241, 0, v241
  v_and_b32 v249, 0xffff0000, v241
  v_sub_f32 v241, v241, v249
  v_lshrrev_b32 v249, 16, v249
  v_and_b32 v6, 0xffff0000, v241
  v_or_b32 v249, v249, v6
  buffer_load_dwordx4 v238, s[16:19], s60 offen offset:2048 sc1 lds
  v_sub_f32 v241, v241, v6
  v_lshrrev_b32 v241, 16, v241
  v_cndmask_b32 v204, v249, v204, vcc
  v_cndmask_b32 v205, v241, v205, vcc
  v_max_f32 v242, v242, v250
  v_sub_f32 v242, 0, v242
  v_and_b32 v250, 0xffff0000, v242
  v_sub_f32 v242, v242, v250
  v_lshrrev_b32 v250, 16, v250
  v_and_b32 v6, 0xffff0000, v242
  v_or_b32 v250, v250, v6
  v_sub_f32 v242, v242, v6
  v_lshrrev_b32 v242, 16, v242
  v_cndmask_b32 v212, v250, v212, vcc
  v_cndmask_b32 v213, v242, v213, vcc
  v_max_f32 v243, v243, v251
  v_sub_f32 v243, 0, v243
  v_and_b32 v251, 0xffff0000, v243
  v_sub_f32 v243, v243, v251
  v_lshrrev_b32 v251, 16, v251
  v_and_b32 v6, 0xffff0000, v243
  v_or_b32 v251, v251, v6
  v_sub_f32 v243, v243, v6
  v_lshrrev_b32 v243, 16, v243
  v_cndmask_b32 v220, v251, v220, vcc
  v_cndmask_b32 v221, v243, v221, vcc
L_Bh4:
  v_mov_b32 v176, v236
  v_add_u32 v177, 0x8000, v236
  s_add_u32 s33, s61, 98304
  s_waitcnt lgkmcnt(0)
  v_mfma_f32_32x32x16_bf16 v[64:79], v[144:147], v[192:195], 0
  v_mfma_f32_32x32x8_bf16 v[64:79], v[152:153], v[196:197], v[64:79]
  v_mfma_f32_32x32x16_bf16 v[80:95], v[144:147], v[200:203], 0
  ds_read_b128 v[160:163], v176 offset:1024
  s_nop 9
  v_exp_f32 v64, v64
  v_exp_f32 v65, v65
  v_exp_f32 v66, v66
  v_exp_f32 v67, v67
  v_cvt_pk_bf16_f32 v96, v64, v65
  v_mfma_f32_32x32x8_bf16 v[80:95], v[152:153], v[204:205], v[80:95]
  ds_read_b128 v[164:167], v176 offset:2048
  v_cvt_pk_bf16_f32 v97, v66, v67
  v_exp_f32 v68, v68
  v_exp_f32 v69, v69
  v_exp_f32 v70, v70
  v_exp_f32 v71, v71
  v_cvt_pk_bf16_f32 v98, v68, v69
  v_cvt_pk_bf16_f32 v99, v70, v71
  v_exp_f32 v72, v72
  v_exp_f32 v73, v73
  v_exp_f32 v74, v74
  v_exp_f32 v75, v75
  v_cvt_pk_bf16_f32 v100, v72, v73
  v_cvt_pk_bf16_f32 v101, v74, v75
  v_exp_f32 v76, v76
  v_exp_f32 v77, v77
  v_exp_f32 v78, v78
  v_exp_f32 v79, v79
  v_cvt_pk_bf16_f32 v102, v76, v77
  v_cvt_pk_bf16_f32 v103, v78, v79
  s_waitcnt vmcnt(17) lgkmcnt(0)
  v_mfma_f32_32x32x16_bf16 v[64:79], v[144:147], v[208:211], 0
  s_barrier
  s_cmp_lg_u32 s30, 0
  s_cbranch_scc1 L_cf4
  s_mov_b32 s46, s33
  s_lshl_b32 s31, s29, 7
  s_lshl_b32 s33, s28, 2
  s_add_u32 s31, s31, s33
  s_add_u32 s31, s31, 4096
  v_mov_b32 v6, s100
  v_mov_b32 v7, 0
  s_mov_b64 exec, 1
  buffer_store_dword v6, v7, s[24:27], s31 offen offset:0 sc1
  s_mov_b64 exec, -1
  s_mov_b32 s33, s46
L_cf4:
  s_branch L_Bin4
  .p2align 6
L_Bloop4:
  v_mfma_f32_32x32x16_bf16 v[64:79], v[144:147], v[208:211], 0
  s_waitcnt vmcnt(7) lgkmcnt(0)
  s_barrier
L_Bin4:
  s_mov_b32 m0, s33
  v_exp_f32 v80, v80
  v_exp_f32 v81, v81
  v_exp_f32 v82, v82
  v_exp_f32 v83, v83
  v_cvt_pk_bf16_f32 v104, v80, v81
  v_mfma_f32_32x32x16_bf16 a[0:15], v[160:163], v[96:99], a[0:15]
  buffer_load_dwordx4 v238, s[16:19], s34 offen offset:0 sc1 lds
  v_cvt_pk_bf16_f32 v105, v82, v83
  v_exp_f32 v84, v84
  v_exp_f32 v85, v85
  v_exp_f32 v86, v86
  v_exp_f32 v87, v87
  v_cvt_pk_bf16_f32 v106, v84, v85
  v_mfma_f32_32x32x8_bf16 v[64:79], v[152:153], v[212:213], v[64:79]
  v_cvt_pk_bf16_f32 v107, v86, v87
  v_exp_f32 v88, v88
  v_exp_f32 v89, v89
  v_exp_f32 v90, v90
  v_exp_f32 v91, v91
  v_cvt_pk_bf16_f32 v108, v88, v89
  v_mfma_f32_32x32x16_bf16 a[0:15], v[164:167], v[100:103], a[0:15]
  v_cvt_pk_bf16_f32 v109, v90, v91
  v_exp_f32 v92, v92
  v_exp_f32 v93, v93
  v_exp_f32 v94, v94
  v_exp_f32 v95, v95
  v_cvt_pk_bf16_f32 v110, v92, v93
  v_cvt_pk_bf16_f32 v111, v94, v95
  v_mfma_f32_32x32x16_bf16 v[80:95], v[144:147], v[216:219], 0
  ds_read_b128 v[148:151], v176 offset:3072
  v_exp_f32 v64, v64
  v_exp_f32 v65, v65
  v_exp_f32 v66, v66
  v_exp_f32 v67, v67
  v_cvt_pk_bf16_f32 v96, v64, v65
  v_mfma_f32_32x32x16_bf16 a[16:31], v[160:163], v[104:107], a[16:31]
  v_cvt_pk_bf16_f32 v97, v66, v67
  v_exp_f32 v68, v68
  v_exp_f32 v69, v69
  v_exp_f32 v70, v70
  v_exp_f32 v71, v71
  v_cvt_pk_bf16_f32 v98, v68, v69
  v_mfma_f32_32x32x8_bf16 v[80:95], v[152:153], v[220:221], v[80:95]
  v_cvt_pk_bf16_f32 v99, v70, v71
  v_exp_f32 v72, v72
  v_exp_f32 v73, v73
  v_exp_f32 v74, v74
  v_exp_f32 v75, v75
  v_cvt_pk_bf16_f32 v100, v72, v73
  v_mfma_f32_32x32x16_bf16 a[16:31], v[164:167], v[108:111], a[16:31]
  s_waitcnt lgkmcnt(0)
  v_cvt_pk_bf16_f32 v101, v74, v75
  v_exp_f32 v76, v76
  v_exp_f32 v77, v77
  v_exp_f32 v78, v78
  v_exp_f32 v79, v79
  v_cvt_pk_bf16_f32 v102, v76, v77
  v_cvt_pk_bf16_f32 v103, v78, v79
  v_mfma_f32_32x32x16_bf16 v[64:79], v[148:151], v[192:195], 0
  v_exp_f32 v80, v80
  v_exp_f32 v81, v81
  v_exp_f32 v82, v82
  v_exp_f32 v83, v83
  v_cvt_pk_bf16_f32 v104, v80, v81
  v_mfma_f32_32x32x16_bf16 a[32:47], v[160:163], v[96:99], a[32:47]
  v_cvt_pk_bf16_f32 v105, v82, v83
  v_exp_f32 v84, v84
  v_exp_f32 v85, v85
  v_exp_f32 v86, v86
  v_exp_f32 v87, v87
  v_cvt_pk_bf16_f32 v106, v84, v85
  v_mfma_f32_32x32x8_bf16 v[64:79], v[154:155], v[196:197], v[64:79]
  v_cvt_pk_bf16_f32 v107, v86, v87
  v_exp_f32 v88, v88
  v_exp_f32 v89, v89
  v_exp_f32 v90, v90
  v_exp_f32 v91, v91
  v_cvt_pk_bf16_f32 v108, v88, v89
  v_mfma_f32_32x32x16_bf16 a[32:47], v[164:167], v[100:103], a[32:47]
  v_cvt_pk_bf16_f32 v109, v90, v91
  v_exp_f32 v92, v92
  v_exp_f32 v93, v93
  v_exp_f32 v94, v94
  v_exp_f32 v95, v95
  v_cvt_pk_bf16_f32 v110, v92, v93
  v_cvt_pk_bf16_f32 v111, v94, v95
  v_mfma_f32_32x32x16_bf16 v[80:95], v[148:151], v[200:203], 0
  ds_read_b128 v[168:171], v176 offset:4096
  v_exp_f32 v64, v64
  v_exp_f32 v65, v65
  v_exp_f32 v66, v66
  v_exp_f32 v67, v67
  v_cvt_pk_bf16_f32 v96, v64, v65
  v_mfma_f32_32x32x16_bf16 a[48:63], v[160:163], v[104:107], a[48:63]
  ds_read_b128 v[172:175], v176 offset:5120
  v_cvt_pk_bf16_f32 v97, v66, v67
  v_exp_f32 v68, v68
  v_exp_f32 v69, v69
  v_exp_f32 v70, v70
  v_exp_f32 v71, v71
  v_cvt_pk_bf16_f32 v98, v68, v69
  v_mfma_f32_32x32x8_bf16 v[80:95], v[154:155], v[204:205], v[80:95]
  v_cvt_pk_bf16_f32 v99, v70, v71
  v_exp_f32 v72, v72
  v_exp_f32 v73, v73
  v_exp_f32 v74, v74
  v_exp_f32 v75, v75
  v_cvt_pk_bf16_f32 v100, v72, v73
  v_mfma_f32_32x32x16_bf16 a[48:63], v[164:167], v[108:111], a[48:63]
  v_cvt_pk_bf16_f32 v101, v74, v75
  v_exp_f32 v76, v76
  v_exp_f32 v77, v77
  v_exp_f32 v78, v78
  v_exp_f32 v79, v79
  v_cvt_pk_bf16_f32 v102, v76, v77
  v_cvt_pk_bf16_f32 v103, v78, v79
  v_mfma_f32_32x32x16_bf16 v[64:79], v[148:151], v[208:211], 0
  s_waitcnt lgkmcnt(0)
  buffer_load_dwordx4 v238, s[16:19], s34 offen offset:1024 sc1 lds
  v_exp_f32 v80, v80
  v_exp_f32 v81, v81
  v_exp_f32 v82, v82
  v_exp_f32 v83, v83
  v_cvt_pk_bf16_f32 v104, v80, v81
  v_mfma_f32_32x32x16_bf16 a[0:15], v[168:171], v[96:99], a[0:15]
  v_cvt_pk_bf16_f32 v105, v82, v83
  v_exp_f32 v84, v84
  v_exp_f32 v85, v85
  v_exp_f32 v86, v86
  v_exp_f32 v87, v87
  v_cvt_pk_bf16_f32 v106, v84, v85
  v_mfma_f32_32x32x8_bf16 v[64:79], v[154:155], v[212:213], v[64:79]
  v_cvt_pk_bf16_f32 v107, v86, v87
  v_exp_f32 v88, v88
  v_exp_f32 v89, v89
  v_exp_f32 v90, v90
  v_exp_f32 v91, v91
  v_cvt_pk_bf16_f32 v108, v88, v89
  v_mfma_f32_32x32x16_bf16 a[0:15], v[172:175], v[100:103], a[0:15]
  v_cvt_pk_bf16_f32 v109, v90, v91
  v_exp_f32 v92, v92
  v_exp_f32 v93, v93
  v_exp_f32 v94, v94
  v_exp_f32 v95, v95
  v_cvt_pk_bf16_f32 v110, v92, v93
  v_cvt_pk_bf16_f32 v111, v94, v95
  v_mfma_f32_32x32x16_bf16 v[80:95], v[148:151], v[216:219], 0
  ds_read_b128 v[144:147], v176 offset:6144
  v_exp_f32 v64, v64
  v_exp_f32 v65, v65
  v_exp_f32 v66, v66
  v_exp_f32 v67, v67
  v_cvt_pk_bf16_f32 v96, v64, v65
  v_mfma_f32_32x32x16_bf16 a[16:31], v[168:171], v[104:107], a[16:31]
  ds_read_b128 v[156:159], v176 offset:25600
  v_cvt_pk_bf16_f32 v97, v66, v67
  v_exp_f32 v68, v68
  v_exp_f32 v69, v69
  v_exp_f32 v70, v70
  v_exp_f32 v71, v71
  v_cvt_pk_bf16_f32 v98, v68, v69
  v_mfma_f32_32x32x8_bf16 v[80:95], v[154:155], v[220:221], v[80:95]
  v_cvt_pk_bf16_f32 v99, v70, v71
  v_exp_f32 v72, v72
  v_exp_f32 v73, v73
  v_exp_f32 v74, v74
  v_exp_f32 v75, v75
  v_cvt_pk_bf16_f32 v100, v72, v73
  v_mfma_f32_32x32x16_bf16 a[16:31], v[172:175], v[108:111], a[16:31]
  s_waitcnt lgkmcnt(0)
  v_cvt_pk_bf16_f32 v101, v74, v75
  v_exp_f32 v76, v76
  v_exp_f32 v77, v77
  v_exp_f32 v78, v78
  v_exp_f32 v79, v79
  v_cvt_pk_bf16_f32 v102, v76, v77
  v_cvt_pk_bf16_f32 v103, v78, v79
  v_mfma_f32_32x32x16_bf16 v[64:79], v[144:147], v[192:195], 0
  v_exp_f32 v80, v80
  v_exp_f32 v81, v81
  v_exp_f32 v82, v82
  v_exp_f32 v83, v83
  v_cvt_pk_bf16_f32 v104, v80, v81
  v_mfma_f32_32x32x16_bf16 a[32:47], v[168:171], v[96:99], a[32:47]
  v_cvt_pk_bf16_f32 v105, v82, v83
  v_exp_f32 v84, v84
  v_exp_f32 v85, v85
  v_exp_f32 v86, v86
  v_exp_f32 v87, v87
  v_cvt_pk_bf16_f32 v106, v84, v85
  v_mfma_f32_32x32x8_bf16 v[64:79], v[156:157], v[196:197], v[64:79]
  v_cvt_pk_bf16_f32 v107, v86, v87
  v_exp_f32 v88, v88
  v_exp_f32 v89, v89
  v_exp_f32 v90, v90
  v_exp_f32 v91, v91
  v_cvt_pk_bf16_f32 v108, v88, v89
  v_mfma_f32_32x32x16_bf16 a[32:47], v[172:175], v[100:103], a[32:47]
  v_cvt_pk_bf16_f32 v109, v90, v91
  v_exp_f32 v92, v92
  v_exp_f32 v93, v93
  v_exp_f32 v94, v94
  v_exp_f32 v95, v95
  v_cvt_pk_bf16_f32 v110, v92, v93
  v_cvt_pk_bf16_f32 v111, v94, v95
  v_mfma_f32_32x32x16_bf16 v[80:95], v[144:147], v[200:203], 0
  ds_read_b128 v[160:163], v176 offset:7168
  v_exp_f32 v64, v64
  v_exp_f32 v65, v65
  v_exp_f32 v66, v66
  v_exp_f32 v67, v67
  v_cvt_pk_bf16_f32 v96, v64, v65
  v_mfma_f32_32x32x16_bf16 a[48:63], v[168:171], v[104:107], a[48:63]
  ds_read_b128 v[164:167], v176 offset:8192
  v_cvt_pk_bf16_f32 v97, v66, v67
  v_exp_f32 v68, v68
  v_exp_f32 v69, v69
  v_exp_f32 v70, v70
  v_exp_f32 v71, v71
  v_cvt_pk_bf16_f32 v98, v68, v69
  v_mfma_f32_32x32x8_bf16 v[80:95], v[156:157], v[204:205], v[80:95]
  v_cvt_pk_bf16_f32 v99, v70, v71
  v_exp_f32 v72, v72
  v_exp_f32 v73, v73
  v_exp_f32 v74, v74
  v_exp_f32 v75, v75
  v_cvt_pk_bf16_f32 v100, v72, v73
  v_mfma_f32_32x32x16_bf16 a[48:63], v[172:175], v[108:111], a[48:63]
  v_cvt_pk_bf16_f32 v101, v74, v75
  v_exp_f32 v76, v76
  v_exp_f32 v77, v77
  v_exp_f32 v78, v78
  v_exp_f32 v79, v79
  v_cvt_pk_bf16_f32 v102, v76, v77
  v_cvt_pk_bf16_f32 v103, v78, v79
  v_mfma_f32_32x32x16_bf16 v[64:79], v[144:147], v[208:211], 0
  s_waitcnt lgkmcnt(0)
  buffer_load_dwordx4 v238, s[16:19], s34 offen offset:2048 sc1 lds
  v_exp_f32 v80, v80
  v_exp_f32 v81, v81
  v_exp_f32 v82, v82
  v_exp_f32 v83, v83
  v_cvt_pk_bf16_f32 v104, v80, v81
  v_mfma_f32_32x32x16_bf16 a[0:15], v[160:163], v[96:99], a[0:15]
  v_cvt_pk_bf16_f32 v105, v82, v83
  v_exp_f32 v84, v84
  v_exp_f32 v85, v85
  v_exp_f32 v86, v86
  v_exp_f32 v87, v87
  v_cvt_pk_bf16_f32 v106, v84, v85
  v_mfma_f32_32x32x8_bf16 v[64:79], v[156:157], v[212:213], v[64:79]
  v_cvt_pk_bf16_f32 v107, v86, v87
  v_exp_f32 v88, v88
  v_exp_f32 v89, v89
  v_exp_f32 v90, v90
  v_exp_f32 v91, v91
  v_cvt_pk_bf16_f32 v108, v88, v89
  v_mfma_f32_32x32x16_bf16 a[0:15], v[164:167], v[100:103], a[0:15]
  v_cvt_pk_bf16_f32 v109, v90, v91
  v_exp_f32 v92, v92
  v_exp_f32 v93, v93
  v_exp_f32 v94, v94
  v_exp_f32 v95, v95
  v_cvt_pk_bf16_f32 v110, v92, v93
  v_cvt_pk_bf16_f32 v111, v94, v95
  v_mfma_f32_32x32x16_bf16 v[80:95], v[144:147], v[216:219], 0
  ds_read_b128 v[148:151], v176 offset:9216
  v_exp_f32 v64, v64
  v_exp_f32 v65, v65
  v_exp_f32 v66, v66
  v_exp_f32 v67, v67
  v_cvt_pk_bf16_f32 v96, v64, v65
  v_mfma_f32_32x32x16_bf16 a[16:31], v[160:163], v[104:107], a[16:31]
  v_cvt_pk_bf16_f32 v97, v66, v67
  v_exp_f32 v68, v68
  v_exp_f32 v69, v69
  v_exp_f32 v70, v70
  v_exp_f32 v71, v71
  v_cvt_pk_bf16_f32 v98, v68, v69
  v_mfma_f32_32x32x8_bf16 v[80:95], v[156:157], v[220:221], v[80:95]
  v_cvt_pk_bf16_f32 v99, v70, v71
  v_exp_f32 v72, v72
  v_exp_f32 v73, v73
  v_exp_f32 v74, v74
  v_exp_f32 v75, v75
  v_cvt_pk_bf16_f32 v100, v72, v73
  v_mfma_f32_32x32x16_bf16 a[16:31], v[164:167], v[108:111], a[16:31]
  s_waitcnt lgkmcnt(0)
  v_cvt_pk_bf16_f32 v101, v74, v75
  v_exp_f32 v76, v76
  v_exp_f32 v77, v77
  v_exp_f32 v78, v78
  v_exp_f32 v79, v79
  v_cvt_pk_bf16_f32 v102, v76, v77
  v_cvt_pk_bf16_f32 v103, v78, v79
  v_mfma_f32_32x32x16_bf16 v[64:79], v[148:151], v[192:195], 0
  v_exp_f32 v80, v80
  v_exp_f32 v81, v81
  v_exp_f32 v82, v82
  v_exp_f32 v83, v83
  v_cvt_pk_bf16_f32 v104, v80, v81
  v_mfma_f32_32x32x16_bf16 a[32:47], v[160:163], v[96:99], a[32:47]
  v_cvt_pk_bf16_f32 v105, v82, v83
  v_exp_f32 v84, v84
  v_exp_f32 v85, v85
  v_exp_f32 v86, v86
  v_exp_f32 v87, v87
  v_cvt_pk_bf16_f32 v106, v84, v85
  v_mfma_f32_32x32x8_bf16 v[64:79], v[158:159], v[196:197], v[64:79]
  v_cvt_pk_bf16_f32 v107, v86, v87
  v_exp_f32 v88, v88
  v_exp_f32 v89, v89
  v_exp_f32 v90, v90
  v_exp_f32 v91, v91
  v_cvt_pk_bf16_f32 v108, v88, v89
  v_mfma_f32_32x32x16_bf16 a[32:47], v[164:167], v[100:103], a[32:47]
  v_cvt_pk_bf16_f32 v109, v90, v91
  v_exp_f32 v92, v92
  v_exp_f32 v93, v93
  v_exp_f32 v94, v94
  v_exp_f32 v95, v95
  v_cvt_pk_bf16_f32 v110, v92, v93
  v_cvt_pk_bf16_f32 v111, v94, v95
  v_mfma_f32_32x32x16_bf16 v[80:95], v[148:151], v[200:203], 0
  ds_read_b128 v[168:171], v176 offset:10240
  v_exp_f32 v64, v64
  v_exp_f32 v65, v65
  v_exp_f32 v66, v66
  v_exp_f32 v67, v67
  v_cvt_pk_bf16_f32 v96, v64, v65
  v_mfma_f32_32x32x16_bf16 a[48:63], v[160:163], v[104:107], a[48:63]
  ds_read_b128 v[172:175], v176 offset:11264
  v_cvt_pk_bf16_f32 v97, v66, v67
  v_exp_f32 v68, v68
  v_exp_f32 v69, v69
  v_exp_f32 v70, v70
  v_exp_f32 v71, v71
  v_cvt_pk_bf16_f32 v98, v68, v69
  v_mfma_f32_32x32x8_bf16 v[80:95], v[158:159], v[204:205], v[80:95]
  v_cvt_pk_bf16_f32 v99, v70, v71
  v_exp_f32 v72, v72
  v_exp_f32 v73, v73
  v_exp_f32 v74, v74
  v_exp_f32 v75, v75
  v_cvt_pk_bf16_f32 v100, v72, v73
  v_mfma_f32_32x32x16_bf16 a[48:63], v[164:167], v[108:111], a[48:63]
  v_cvt_pk_bf16_f32 v101, v74, v75
  v_exp_f32 v76, v76
  v_exp_f32 v77, v77
  v_exp_f32 v78, v78
  v_exp_f32 v79, v79
  v_cvt_pk_bf16_f32 v102, v76, v77
  v_cvt_pk_bf16_f32 v103, v78, v79
  v_mfma_f32_32x32x16_bf16 v[64:79], v[148:151], v[208:211], 0
  s_waitcnt lgkmcnt(0)
  buffer_load_dwordx4 v238, s[16:19], s34 offen offset:3072 sc1 lds
  v_exp_f32 v80, v80
  v_exp_f32 v81, v81
  v_exp_f32 v82, v82
  v_exp_f32 v83, v83
  v_cvt_pk_bf16_f32 v104, v80, v81
  v_mfma_f32_32x32x16_bf16 a[0:15], v[168:171], v[96:99], a[0:15]
  s_add_u32 s34, s34, 4096
  v_cvt_pk_bf16_f32 v105, v82, v83
  v_exp_f32 v84, v84
  v_exp_f32 v85, v85
  v_exp_f32 v86, v86
  v_exp_f32 v87, v87
  v_cvt_pk_bf16_f32 v106, v84, v85
  v_mfma_f32_32x32x8_bf16 v[64:79], v[158:159], v[212:213], v[64:79]
  v_cvt_pk_bf16_f32 v107, v86, v87
  v_exp_f32 v88, v88
  v_exp_f32 v89, v89
  v_exp_f32 v90, v90
  v_exp_f32 v91, v91
  v_cvt_pk_bf16_f32 v108, v88, v89
  v_mfma_f32_32x32x16_bf16 a[0:15], v[172:175], v[100:103], a[0:15]
  v_cvt_pk_bf16_f32 v109, v90, v91
  v_exp_f32 v92, v92
  v_exp_f32 v93, v93
  v_exp_f32 v94, v94
  v_exp_f32 v95, v95
  v_cvt_pk_bf16_f32 v110, v92, v93
  v_cvt_pk_bf16_f32 v111, v94, v95
  v_mfma_f32_32x32x16_bf16 v[80:95], v[148:151], v[216:219], 0
  ds_read_b128 v[144:147], v176 offset:12288
  v_exp_f32 v64, v64
  v_exp_f32 v65, v65
  v_exp_f32 v66, v66
  v_exp_f32 v67, v67
  v_cvt_pk_bf16_f32 v96, v64, v65
  v_mfma_f32_32x32x16_bf16 a[16:31], v[168:171], v[104:107], a[16:31]
  ds_read_b128 v[152:155], v176 offset:26624
  v_cvt_pk_bf16_f32 v97, v66, v67
  v_exp_f32 v68, v68
  v_exp_f32 v69, v69
  v_exp_f32 v70, v70
  v_exp_f32 v71, v71
  v_cvt_pk_bf16_f32 v98, v68, v69
  v_mfma_f32_32x32x8_bf16 v[80:95], v[158:159], v[220:221], v[80:95]
  v_cvt_pk_bf16_f32 v99, v70, v71
  v_exp_f32 v72, v72
  v_exp_f32 v73, v73
  v_exp_f32 v74, v74
  v_exp_f32 v75, v75
  v_cvt_pk_bf16_f32 v100, v72, v73
  v_mfma_f32_32x32x16_bf16 a[16:31], v[172:175], v[108:111], a[16:31]
  s_waitcnt lgkmcnt(0)
  v_cvt_pk_bf16_f32 v101, v74, v75
  v_exp_f32 v76, v76
  v_exp_f32 v77, v77
  v_exp_f32 v78, v78
  v_exp_f32 v79, v79
  v_cvt_pk_bf16_f32 v102, v76, v77
  v_cvt_pk_bf16_f32 v103, v78, v79
  v_mfma_f32_32x32x16_bf16 v[64:79], v[144:147], v[192:195], 0
  v_exp_f32 v80, v80
  v_exp_f32 v81, v81
  v_exp_f32 v82, v82
  v_exp_f32 v83, v83
  v_cvt_pk_bf16_f32 v104, v80, v81
  v_mfma_f32_32x32x16_bf16 a[32:47], v[168:171], v[96:99], a[32:47]
  v_cvt_pk_bf16_f32 v105, v82, v83
  v_exp_f32 v84, v84
  v_exp_f32 v85, v85
  v_exp_f32 v86, v86
  v_exp_f32 v87, v87
  v_cvt_pk_bf16_f32 v106, v84, v85
  v_mfma_f32_32x32x8_bf16 v[64:79], v[152:153], v[196:197], v[64:79]
  v_cvt_pk_bf16_f32 v107, v86, v87
  v_exp_f32 v88, v88
  v_exp_f32 v89, v89
  v_exp_f32 v90, v90
  v_exp_f32 v91, v91
  v_cvt_pk_bf16_f32 v108, v88, v89
  v_mfma_f32_32x32x16_bf16 a[32:47], v[172:175], v[100:103], a[32:47]
  v_cvt_pk_bf16_f32 v109, v90, v91
  v_exp_f32 v92, v92
  v_exp_f32 v93, v93
  v_exp_f32 v94, v94
  v_exp_f32 v95, v95
  v_cvt_pk_bf16_f32 v110, v92, v93
  v_cvt_pk_bf16_f32 v111, v94, v95
  v_mfma_f32_32x32x16_bf16 v[80:95], v[144:147], v[200:203], 0
  ds_read_b128 v[160:163], v176 offset:13312
  v_exp_f32 v64, v64
  v_exp_f32 v65, v65
  v_exp_f32 v66, v66
  v_exp_f32 v67, v67
  v_cvt_pk_bf16_f32 v96, v64, v65
  v_mfma_f32_32x32x16_bf16 a[48:63], v[168:171], v[104:107], a[48:63]
  ds_read_b128 v[164:167], v176 offset:14336
  v_cvt_pk_bf16_f32 v97, v66, v67
  v_exp_f32 v68, v68
  v_exp_f32 v69, v69
  v_exp_f32 v70, v70
  v_exp_f32 v71, v71
  v_cvt_pk_bf16_f32 v98, v68, v69
  v_mfma_f32_32x32x8_bf16 v[80:95], v[152:153], v[204:205], v[80:95]
  v_cvt_pk_bf16_f32 v99, v70, v71
  v_exp_f32 v72, v72
  v_exp_f32 v73, v73
  v_exp_f32 v74, v74
  v_exp_f32 v75, v75
  v_cvt_pk_bf16_f32 v100, v72, v73
  v_mfma_f32_32x32x16_bf16 a[48:63], v[172:175], v[108:111], a[48:63]
  s_waitcnt lgkmcnt(0)
  v_cvt_pk_bf16_f32 v101, v74, v75
  v_exp_f32 v76, v76
  v_exp_f32 v77, v77
  v_exp_f32 v78, v78
  v_exp_f32 v79, v79
  v_cvt_pk_bf16_f32 v102, v76, v77
  v_cvt_pk_bf16_f32 v103, v78, v79
  v_mfma_f32_32x32x16_bf16 v[64:79], v[144:147], v[208:211], 0
  s_add_u32 m0, s33, 4096
  v_exp_f32 v80, v80
  v_exp_f32 v81, v81
  v_exp_f32 v82, v82
  v_exp_f32 v83, v83
  v_cvt_pk_bf16_f32 v104, v80, v81
  v_mfma_f32_32x32x16_bf16 a[0:15], v[160:163], v[96:99], a[0:15]
  buffer_load_dwordx4 v238, s[16:19], s34 offen offset:0 sc1 lds
  v_cvt_pk_bf16_f32 v105, v82, v83
  v_exp_f32 v84, v84
  v_exp_f32 v85, v85
  v_exp_f32 v86, v86
  v_exp_f32 v87, v87
  v_cvt_pk_bf16_f32 v106, v84, v85
  v_mfma_f32_32x32x8_bf16 v[64:79], v[152:153], v[212:213], v[64:79]
  v_cvt_pk_bf16_f32 v107, v86, v87
  v_exp_f32 v88, v88
  v_exp_f32 v89, v89
  v_exp_f32 v90, v90
  v_exp_f32 v91, v91
  v_cvt_pk_bf16_f32 v108, v88, v89
  v_mfma_f32_32x32x16_bf16 a[0:15], v[164:167], v[100:103], a[0:15]
  v_cvt_pk_bf16_f32 v109, v90, v91
  v_exp_f32 v92, v92
  v_exp_f32 v93, v93
  v_exp_f32 v94, v94
  v_exp_f32 v95, v95
  v_cvt_pk_bf16_f32 v110, v92, v93
  v_cvt_pk_bf16_f32 v111, v94, v95
  v_mfma_f32_32x32x16_bf16 v[80:95], v[144:147], v[216:219], 0
  ds_read_b128 v[148:151], v176 offset:15360
  v_exp_f32 v64, v64
  v_exp_f32 v65, v65
  v_exp_f32 v66, v66
  v_exp_f32 v67, v67
  v_cvt_pk_bf16_f32 v96, v64, v65
  v_mfma_f32_32x32x16_bf16 a[16:31], v[160:163], v[104:107], a[16:31]
  v_cvt_pk_bf16_f32 v97, v66, v67
  v_exp_f32 v68, v68
  v_exp_f32 v69, v69
  v_exp_f32 v70, v70
  v_exp_f32 v71, v71
  v_cvt_pk_bf16_f32 v98, v68, v69
  v_mfma_f32_32x32x8_bf16 v[80:95], v[152:153], v[220:221], v[80:95]
  v_cvt_pk_bf16_f32 v99, v70, v71
  v_exp_f32 v72, v72
  v_exp_f32 v73, v73
  v_exp_f32 v74, v74
  v_exp_f32 v75, v75
  v_cvt_pk_bf16_f32 v100, v72, v73
  v_mfma_f32_32x32x16_bf16 a[16:31], v[164:167], v[108:111], a[16:31]
  s_waitcnt lgkmcnt(0)
  v_cvt_pk_bf16_f32 v101, v74, v75
  v_exp_f32 v76, v76
  v_exp_f32 v77, v77
  v_exp_f32 v78, v78
  v_exp_f32 v79, v79
  v_cvt_pk_bf16_f32 v102, v76, v77
  v_cvt_pk_bf16_f32 v103, v78, v79
  v_mfma_f32_32x32x16_bf16 v[64:79], v[148:151], v[192:195], 0
  v_exp_f32 v80, v80
  v_exp_f32 v81, v81
  v_exp_f32 v82, v82
  v_exp_f32 v83, v83
  v_cvt_pk_bf16_f32 v104, v80, v81
  v_mfma_f32_32x32x16_bf16 a[32:47], v[160:163], v[96:99], a[32:47]
  v_cvt_pk_bf16_f32 v105, v82, v83
  v_exp_f32 v84, v84
  v_exp_f32 v85, v85
  v_exp_f32 v86, v86
  v_exp_f32 v87, v87
  v_cvt_pk_bf16_f32 v106, v84, v85
  v_mfma_f32_32x32x8_bf16 v[64:79], v[154:155], v[196:197], v[64:79]
  v_cvt_pk_bf16_f32 v107, v86, v87
  v_exp_f32 v88, v88
  v_exp_f32 v89, v89
  v_exp_f32 v90, v90
  v_exp_f32 v91, v91
  v_cvt_pk_bf16_f32 v108, v88, v89
  v_mfma_f32_32x32x16_bf16 a[32:47], v[164:167], v[100:103], a[32:47]
  v_cvt_pk_bf16_f32 v109, v90, v91
  v_exp_f32 v92, v92
  v_exp_f32 v93, v93
  v_exp_f32 v94, v94
  v_exp_f32 v95, v95
  v_cvt_pk_bf16_f32 v110, v92, v93
  v_cvt_pk_bf16_f32 v111, v94, v95
  v_mfma_f32_32x32x16_bf16 v[80:95], v[148:151], v[200:203], 0
  ds_read_b128 v[168:171], v176 offset:16384
  v_exp_f32 v64, v64
  v_exp_f32 v65, v65
  v_exp_f32 v66, v66
  v_exp_f32 v67, v67
  v_cvt_pk_bf16_f32 v96, v64, v65
  v_mfma_f32_32x32x16_bf16 a[48:63], v[160:163], v[104:107], a[48:63]
  ds_read_b128 v[172:175], v176 offset:17408
  v_cvt_pk_bf16_f32 v97, v66, v67
  v_exp_f32 v68, v68
  v_exp_f32 v69, v69
  v_exp_f32 v70, v70
  v_exp_f32 v71, v71
  v_cvt_pk_bf16_f32 v98, v68, v69
  v_mfma_f32_32x32x8_bf16 v[80:95], v[154:155], v[204:205], v[80:95]
  v_cvt_pk_bf16_f32 v99, v70, v71
  v_exp_f32 v72, v72
  v_exp_f32 v73, v73
  v_exp_f32 v74, v74
  v_exp_f32 v75, v75
  v_cvt_pk_bf16_f32 v100, v72, v73
  v_mfma_f32_32x32x16_bf16 a[48:63], v[164:167], v[108:111], a[48:63]
  v_cvt_pk_bf16_f32 v101, v74, v75
  v_exp_f32 v76, v76
  v_exp_f32 v77, v77
  v_exp_f32 v78, v78
  v_exp_f32 v79, v79
  v_cvt_pk_bf16_f32 v102, v76, v77
  v_cvt_pk_bf16_f32 v103, v78, v79
  v_mfma_f32_32x32x16_bf16 v[64:79], v[148:151], v[208:211], 0
  s_waitcnt lgkmcnt(0)
  buffer_load_dwordx4 v238, s[16:19], s34 offen offset:1024 sc1 lds
  v_exp_f32 v80, v80
  v_exp_f32 v81, v81
  v_exp_f32 v82, v82
  v_exp_f32 v83, v83
  v_cvt_pk_bf16_f32 v104, v80, v81
  v_mfma_f32_32x32x16_bf16 a[0:15], v[168:171], v[96:99], a[0:15]
  v_cvt_pk_bf16_f32 v105, v82, v83
  v_exp_f32 v84, v84
  v_exp_f32 v85, v85
  v_exp_f32 v86, v86
  v_exp_f32 v87, v87
  v_cvt_pk_bf16_f32 v106, v84, v85
  v_mfma_f32_32x32x8_bf16 v[64:79], v[154:155], v[212:213], v[64:79]
  v_cvt_pk_bf16_f32 v107, v86, v87
  v_exp_f32 v88, v88
  v_exp_f32 v89, v89
  v_exp_f32 v90, v90
  v_exp_f32 v91, v91
  v_cvt_pk_bf16_f32 v108, v88, v89
  v_mfma_f32_32x32x16_bf16 a[0:15], v[172:175], v[100:103], a[0:15]
  v_cvt_pk_bf16_f32 v109, v90, v91
  v_exp_f32 v92, v92
  v_exp_f32 v93, v93
  v_exp_f32 v94, v94
  v_exp_f32 v95, v95
  v_cvt_pk_bf16_f32 v110, v92, v93
  v_cvt_pk_bf16_f32 v111, v94, v95
  v_mfma_f32_32x32x16_bf16 v[80:95], v[148:151], v[216:219], 0
  ds_read_b128 v[144:147], v176 offset:18432
  v_exp_f32 v64, v64
  v_exp_f32 v65, v65
  v_exp_f32 v66, v66
  v_exp_f32 v67, v67
  v_cvt_pk_bf16_f32 v96, v64, v65
  v_mfma_f32_32x32x16_bf16 a[16:31], v[168:171], v[104:107], a[16:31]
  ds_read_b128 v[156:159], v176 offset:27648
  v_cvt_pk_bf16_f32 v97, v66, v67
  v_exp_f32 v68, v68
  v_exp_f32 v69, v69
  v_exp_f32 v70, v70
  v_exp_f32 v71, v71
  v_cvt_pk_bf16_f32 v98, v68, v69
  v_mfma_f32_32x32x8_bf16 v[80:95], v[154:155], v[220:221], v[80:95]
  v_cvt_pk_bf16_f32 v99, v70, v71
  v_exp_f32 v72, v72
  v_exp_f32 v73, v73
  v_exp_f32 v74, v74
  v_exp_f32 v75, v75
  v_cvt_pk_bf16_f32 v100, v72, v73
  v_mfma_f32_32x32x16_bf16 a[16:31], v[172:175], v[108:111], a[16:31]
  s_waitcnt lgkmcnt(0)
  v_cvt_pk_bf16_f32 v101, v74, v75
  v_exp_f32 v76, v76
  v_exp_f32 v77, v77
  v_exp_f32 v78, v78
  v_exp_f32 v79, v79
  v_cvt_pk_bf16_f32 v102, v76, v77
  v_cvt_pk_bf16_f32 v103, v78, v79
  v_mfma_f32_32x32x16_bf16 v[64:79], v[144:147], v[192:195], 0
  v_exp_f32 v80, v80
  v_exp_f32 v81, v81
  v_exp_f32 v82, v82
  v_exp_f32 v83, v83
  v_cvt_pk_bf16_f32 v104, v80, v81
  v_mfma_f32_32x32x16_bf16 a[32:47], v[168:171], v[96:99], a[32:47]
  v_cvt_pk_bf16_f32 v105, v82, v83
  v_exp_f32 v84, v84
  v_exp_f32 v85, v85
  v_exp_f32 v86, v86
  v_exp_f32 v87, v87
  v_cvt_pk_bf16_f32 v106, v84, v85
  v_mfma_f32_32x32x8_bf16 v[64:79], v[156:157], v[196:197], v[64:79]
  v_cvt_pk_bf16_f32 v107, v86, v87
  v_exp_f32 v88, v88
  v_exp_f32 v89, v89
  v_exp_f32 v90, v90
  v_exp_f32 v91, v91
  v_cvt_pk_bf16_f32 v108, v88, v89
  v_mfma_f32_32x32x16_bf16 a[32:47], v[172:175], v[100:103], a[32:47]
  v_cvt_pk_bf16_f32 v109, v90, v91
  v_exp_f32 v92, v92
  v_exp_f32 v93, v93
  v_exp_f32 v94, v94
  v_exp_f32 v95, v95
  v_cvt_pk_bf16_f32 v110, v92, v93
  v_cvt_pk_bf16_f32 v111, v94, v95
  v_mfma_f32_32x32x16_bf16 v[80:95], v[144:147], v[200:203], 0
  ds_read_b128 v[160:163], v176 offset:19456
  v_exp_f32 v64, v64
  v_exp_f32 v65, v65
  v_exp_f32 v66, v66
  v_exp_f32 v67, v67
  v_cvt_pk_bf16_f32 v96, v64, v65
  v_mfma_f32_32x32x16_bf16 a[48:63], v[168:171], v[104:107], a[48:63]
  ds_read_b128 v[164:167], v176 offset:20480
  v_cvt_pk_bf16_f32 v97, v66, v67
  v_exp_f32 v68, v68
  v_exp_f32 v69, v69
  v_exp_f32 v70, v70
  v_exp_f32 v71, v71
  v_cvt_pk_bf16_f32 v98, v68, v69
  v_mfma_f32_32x32x8_bf16 v[80:95], v[156:157], v[204:205], v[80:95]
  v_cvt_pk_bf16_f32 v99, v70, v71
  v_exp_f32 v72, v72
  v_exp_f32 v73, v73
  v_exp_f32 v74, v74
  v_exp_f32 v75, v75
  v_cvt_pk_bf16_f32 v100, v72, v73
  v_mfma_f32_32x32x16_bf16 a[48:63], v[172:175], v[108:111], a[48:63]
  v_cvt_pk_bf16_f32 v101, v74, v75
  v_exp_f32 v76, v76
  v_exp_f32 v77, v77
  v_exp_f32 v78, v78
  v_exp_f32 v79, v79
  v_cvt_pk_bf16_f32 v102, v76, v77
  v_cvt_pk_bf16_f32 v103, v78, v79
  v_mfma_f32_32x32x16_bf16 v[64:79], v[144:147], v[208:211], 0
  s_waitcnt lgkmcnt(0)
  buffer_load_dwordx4 v238, s[16:19], s34 offen offset:2048 sc1 lds
  v_exp_f32 v80, v80
  v_exp_f32 v81, v81
  v_exp_f32 v82, v82
  v_exp_f32 v83, v83
  v_cvt_pk_bf16_f32 v104, v80, v81
  v_mfma_f32_32x32x16_bf16 a[0:15], v[160:163], v[96:99], a[0:15]
  s_add_u32 s34, s34, 24576
  v_cvt_pk_bf16_f32 v105, v82, v83
  v_exp_f32 v84, v84
  v_exp_f32 v85, v85
  v_exp_f32 v86, v86
  v_exp_f32 v87, v87
  v_cvt_pk_bf16_f32 v106, v84, v85
  v_mfma_f32_32x32x8_bf16 v[64:79], v[156:157], v[212:213], v[64:79]
  v_cvt_pk_bf16_f32 v107, v86, v87
  v_exp_f32 v88, v88
  v_exp_f32 v89, v89
  v_exp_f32 v90, v90
  v_exp_f32 v91, v91
  v_cvt_pk_bf16_f32 v108, v88, v89
  v_mfma_f32_32x32x16_bf16 a[0:15], v[164:167], v[100:103], a[0:15]
  v_cvt_pk_bf16_f32 v109, v90, v91
  v_exp_f32 v92, v92
  v_exp_f32 v93, v93
  v_exp_f32 v94, v94
  v_exp_f32 v95, v95
  v_cvt_pk_bf16_f32 v110, v92, v93
  v_cvt_pk_bf16_f32 v111, v94, v95
  v_mfma_f32_32x32x16_bf16 v[80:95], v[144:147], v[216:219], 0
  ds_read_b128 v[148:151], v176 offset:21504
  v_exp_f32 v64, v64
  v_exp_f32 v65, v65
  v_exp_f32 v66, v66
  v_exp_f32 v67, v67
  v_cvt_pk_bf16_f32 v96, v64, v65
  v_mfma_f32_32x32x16_bf16 a[16:31], v[160:163], v[104:107], a[16:31]
  v_cvt_pk_bf16_f32 v97, v66, v67
  v_exp_f32 v68, v68
  v_exp_f32 v69, v69
  v_exp_f32 v70, v70
  v_exp_f32 v71, v71
  v_cvt_pk_bf16_f32 v98, v68, v69
  v_mfma_f32_32x32x8_bf16 v[80:95], v[156:157], v[220:221], v[80:95]
  v_cvt_pk_bf16_f32 v99, v70, v71
  v_exp_f32 v72, v72
  v_exp_f32 v73, v73
  v_exp_f32 v74, v74
  v_exp_f32 v75, v75
  v_cvt_pk_bf16_f32 v100, v72, v73
  v_mfma_f32_32x32x16_bf16 a[16:31], v[164:167], v[108:111], a[16:31]
  s_waitcnt lgkmcnt(0)
  v_cvt_pk_bf16_f32 v101, v74, v75
  v_exp_f32 v76, v76
  v_exp_f32 v77, v77
  v_exp_f32 v78, v78
  v_exp_f32 v79, v79
  v_cvt_pk_bf16_f32 v102, v76, v77
  v_cvt_pk_bf16_f32 v103, v78, v79
  v_mfma_f32_32x32x16_bf16 v[64:79], v[148:151], v[192:195], 0
  v_exp_f32 v80, v80
  v_exp_f32 v81, v81
  v_exp_f32 v82, v82
  v_exp_f32 v83, v83
  v_cvt_pk_bf16_f32 v104, v80, v81
  v_mfma_f32_32x32x16_bf16 a[32:47], v[160:163], v[96:99], a[32:47]
  v_cvt_pk_bf16_f32 v105, v82, v83
  v_exp_f32 v84, v84
  v_exp_f32 v85, v85
  v_exp_f32 v86, v86
  v_exp_f32 v87, v87
  v_cvt_pk_bf16_f32 v106, v84, v85
  v_mfma_f32_32x32x8_bf16 v[64:79], v[158:159], v[196:197], v[64:79]
  v_cvt_pk_bf16_f32 v107, v86, v87
  v_exp_f32 v88, v88
  v_exp_f32 v89, v89
  v_exp_f32 v90, v90
  v_exp_f32 v91, v91
  v_cvt_pk_bf16_f32 v108, v88, v89
  v_mfma_f32_32x32x16_bf16 a[32:47], v[164:167], v[100:103], a[32:47]
  v_cvt_pk_bf16_f32 v109, v90, v91
  v_exp_f32 v92, v92
  v_exp_f32 v93, v93
  v_exp_f32 v94, v94
  v_exp_f32 v95, v95
  v_cvt_pk_bf16_f32 v110, v92, v93
  v_cvt_pk_bf16_f32 v111, v94, v95
  v_mfma_f32_32x32x16_bf16 v[80:95], v[148:151], v[200:203], 0
  ds_read_b128 v[168:171], v176 offset:22528
  v_exp_f32 v64, v64
  v_exp_f32 v65, v65
  v_exp_f32 v66, v66
  v_exp_f32 v67, v67
  v_cvt_pk_bf16_f32 v96, v64, v65
  v_mfma_f32_32x32x16_bf16 a[48:63], v[160:163], v[104:107], a[48:63]
  ds_read_b128 v[172:175], v176 offset:23552
  v_cvt_pk_bf16_f32 v97, v66, v67
  v_exp_f32 v68, v68
  v_exp_f32 v69, v69
  v_exp_f32 v70, v70
  v_exp_f32 v71, v71
  v_cvt_pk_bf16_f32 v98, v68, v69
  v_mfma_f32_32x32x8_bf16 v[80:95], v[158:159], v[204:205], v[80:95]
  v_cvt_pk_bf16_f32 v99, v70, v71
  v_exp_f32 v72, v72
  v_exp_f32 v73, v73
  v_exp_f32 v74, v74
  v_exp_f32 v75, v75
  v_cvt_pk_bf16_f32 v100, v72, v73
  v_mfma_f32_32x32x16_bf16 a[48:63], v[164:167], v[108:111], a[48:63]
  v_cvt_pk_bf16_f32 v101, v74, v75
  v_exp_f32 v76, v76
  v_exp_f32 v77, v77
  v_exp_f32 v78, v78
  v_exp_f32 v79, v79
  v_cvt_pk_bf16_f32 v102, v76, v77
  v_cvt_pk_bf16_f32 v103, v78, v79
  v_mfma_f32_32x32x16_bf16 v[64:79], v[148:151], v[208:211], 0
  s_waitcnt lgkmcnt(0)
  v_exp_f32 v80, v80
  v_exp_f32 v81, v81
  v_exp_f32 v82, v82
  v_exp_f32 v83, v83
  v_cvt_pk_bf16_f32 v104, v80, v81
  v_mfma_f32_32x32x16_bf16 a[0:15], v[168:171], v[96:99], a[0:15]
  v_cvt_pk_bf16_f32 v105, v82, v83
  v_exp_f32 v84, v84
  v_exp_f32 v85, v85
  v_exp_f32 v86, v86
  v_exp_f32 v87, v87
  v_cvt_pk_bf16_f32 v106, v84, v85
  v_mfma_f32_32x32x8_bf16 v[64:79], v[158:159], v[212:213], v[64:79]
  v_cvt_pk_bf16_f32 v107, v86, v87
  v_exp_f32 v88, v88
  v_exp_f32 v89, v89
  v_exp_f32 v90, v90
  v_exp_f32 v91, v91
  v_cvt_pk_bf16_f32 v108, v88, v89
  v_mfma_f32_32x32x16_bf16 a[0:15], v[172:175], v[100:103], a[0:15]
  v_cvt_pk_bf16_f32 v109, v90, v91
  v_exp_f32 v92, v92
  v_exp_f32 v93, v93
  v_exp_f32 v94, v94
  v_exp_f32 v95, v95
  v_cvt_pk_bf16_f32 v110, v92, v93
  v_cvt_pk_bf16_f32 v111, v94, v95
  v_mfma_f32_32x32x16_bf16 v[80:95], v[148:151], v[216:219], 0
  ds_read_b128 v[144:147], v177 offset:0
  v_exp_f32 v64, v64
  v_exp_f32 v65, v65
  v_exp_f32 v66, v66
  v_exp_f32 v67, v67
  v_cvt_pk_bf16_f32 v96, v64, v65
  v_mfma_f32_32x32x16_bf16 a[16:31], v[168:171], v[104:107], a[16:31]
  ds_read_b128 v[152:155], v177 offset:24576
  v_cvt_pk_bf16_f32 v97, v66, v67
  v_exp_f32 v68, v68
  v_exp_f32 v69, v69
  v_exp_f32 v70, v70
  v_exp_f32 v71, v71
  v_cvt_pk_bf16_f32 v98, v68, v69
  v_mfma_f32_32x32x8_bf16 v[80:95], v[158:159], v[220:221], v[80:95]
  v_cvt_pk_bf16_f32 v99, v70, v71
  v_exp_f32 v72, v72
  v_exp_f32 v73, v73
  v_exp_f32 v74, v74
  v_exp_f32 v75, v75
  v_cvt_pk_bf16_f32 v100, v72, v73
  v_mfma_f32_32x32x16_bf16 a[16:31], v[172:175], v[108:111], a[16:31]
  s_waitcnt lgkmcnt(0)
  v_cvt_pk_bf16_f32 v101, v74, v75
  v_exp_f32 v76, v76
  v_exp_f32 v77, v77
  v_exp_f32 v78, v78
  v_exp_f32 v79, v79
  v_cvt_pk_bf16_f32 v102, v76, v77
  v_cvt_pk_bf16_f32 v103, v78, v79
  v_mfma_f32_32x32x16_bf16 v[64:79], v[144:147], v[192:195], 0
  v_exp_f32 v80, v80
  v_exp_f32 v81, v81
  v_exp_f32 v82, v82
  v_exp_f32 v83, v83
  v_cvt_pk_bf16_f32 v104, v80, v81
  v_mfma_f32_32x32x16_bf16 a[32:47], v[168:171], v[96:99], a[32:47]
  s_add_u32 s31, s38, 65536
  v_cvt_pk_bf16_f32 v105, v82, v83
  v_exp_f32 v84, v84
  v_exp_f32 v85, v85
  v_exp_f32 v86, v86
  v_exp_f32 v87, v87
  v_cvt_pk_bf16_f32 v106, v84, v85
  v_mfma_f32_32x32x8_bf16 v[64:79], v[152:153], v[196:197], v[64:79]
  s_and_b32 s31, s31, 0x1ffff
  v_cvt_pk_bf16_f32 v107, v86, v87
  v_exp_f32 v88, v88
  v_exp_f32 v89, v89
  v_exp_f32 v90, v90
  v_exp_f32 v91, v91
  v_cvt_pk_bf16_f32 v108, v88, v89
  v_mfma_f32_32x32x16_bf16 a[32:47], v[172:175], v[100:103], a[32:47]
  s_add_u32 s33, s38, s61
  v_cvt_pk_bf16_f32 v109, v90, v91
  v_exp_f32 v92, v92
  v_exp_f32 v93, v93
  v_exp_f32 v94, v94
  v_exp_f32 v95, v95
  v_cvt_pk_bf16_f32 v110, v92, v93
  v_cvt_pk_bf16_f32 v111, v94, v95
  v_mfma_f32_32x32x16_bf16 v[80:95], v[144:147], v[200:203], 0
  s_add_u32 s38, s38, 32768
  ds_read_b128 v[160:163], v177 offset:1024
  v_exp_f32 v64, v64
  v_exp_f32 v65, v65
  v_exp_f32 v66, v66
  v_exp_f32 v67, v67
  v_cvt_pk_bf16_f32 v96, v64, v65
  v_mfma_f32_32x32x16_bf16 a[48:63], v[168:171], v[104:107], a[48:63]
  s_and_b32 s38, s38, 0x1ffff
  ds_read_b128 v[164:167], v177 offset:2048
  v_cvt_pk_bf16_f32 v97, v66, v67
  v_exp_f32 v68, v68
  v_exp_f32 v69, v69
  v_exp_f32 v70, v70
  v_exp_f32 v71, v71
  v_cvt_pk_bf16_f32 v98, v68, v69
  v_mfma_f32_32x32x8_bf16 v[80:95], v[152:153], v[204:205], v[80:95]
  s_sub_u32 s37, s37, 1
  v_cvt_pk_bf16_f32 v99, v70, v71
  v_exp_f32 v72, v72
  v_exp_f32 v73, v73
  v_exp_f32 v74, v74
  v_exp_f32 v75, v75
  v_cvt_pk_bf16_f32 v100, v72, v73
  v_mfma_f32_32x32x16_bf16 a[48:63], v[172:175], v[108:111], a[48:63]
  s_bitcmp0_b32 s47, s37
  v_cvt_pk_bf16_f32 v101, v74, v75
  v_exp_f32 v76, v76
  v_exp_f32 v77, v77
  v_exp_f32 v78, v78
  v_exp_f32 v79, v79
  v_cvt_pk_bf16_f32 v102, v76, v77
  v_cvt_pk_bf16_f32 v103, v78, v79
  v_mov_b32 v176, v177
  v_add_u32 v177, s31, v236
  s_cbranch_scc1 L_Bloop4
  s_cmp_eq_u32 s37, 0
  s_cbranch_scc1 L_Bend
  s_cmp_eq_u32 s37, 6
  s_cbranch_scc1 L_pb4
  s_mov_b32 s32, 29696
  buffer_load_dwordx4 v[20:23], v236, s[24:27], s32 offen sc1
  buffer_load_dword v24, v9, s[24:27], s62 offen sc1
  s_branch L_Bloop4
L_pb4:
  s_cmp_eq_u32 s45, 0
  s_cbranch_scc1 L_Bloop4
  s_mov_b32 s45, 0
  s_min_u32 s31, s3, 255
  s_lshl_b32 s31, s31, 2
  s_add_u32 s31, s31, 29696
  v_mov_b32 v6, s100
  v_mov_b32 v7, 0
  s_mov_b64 exec, 1
  buffer_store_dword v6, v7, s[24:27], s31 offen offset:0 sc1
  s_mov_b64 exec, -1
  s_branch L_Bloop4
L_B5:
  s_cmp_lg_u32 s39, 0
  s_cbranch_scc1 L_Bh5
  s_mov_b32 vcc_lo, -1
  s_mov_b32 vcc_hi, 0
  v_cndmask_b32 v196, 0, v196, vcc
  v_cndmask_b32 v197, 0, v197, vcc
  v_cndmask_b32 v204, 0, v204, vcc
  v_cndmask_b32 v205, 0, v205, vcc
  v_cndmask_b32 v212, 0, v212, vcc
  v_cndmask_b32 v213, 0, v213, vcc
  v_cndmask_b32 v220, 0, v220, vcc
  v_cndmask_b32 v221, 0, v221, vcc
  v_cndmask_b32 v228, 0, v228, vcc
  v_cndmask_b32 v229, 0, v229, vcc
  v_accvgpr_write_b32 a0, 0
  v_accvgpr_write_b32 a1, 0
  v_accvgpr_write_b32 a2, 0
  v_accvgpr_write_b32 a3, 0
  v_accvgpr_write_b32 a4, 0
  v_accvgpr_write_b32 a5, 0
  v_accvgpr_write_b32 a6, 0
  v_accvgpr_write_b32 a7, 0
  v_accvgpr_write_b32 a8, 0
  v_accvgpr_write_b32 a9, 0
  v_accvgpr_write_b32 a10, 0
  v_accvgpr_write_b32 a11, 0
  s_waitcnt lgkmcnt(0)
  v_mfma_f32_32x32x16_bf16 v[64:79], v[144:147], v[192:195], 0
  buffer_store_dwordx4 v[28:31], v236, s[64:67], s44 offen offset:0 sc1
  v_accvgpr_write_b32 a12, 0
  v_accvgpr_write_b32 a13, 0
  v_accvgpr_write_b32 a14, 0
  v_accvgpr_write_b32 a15, 0
  v_accvgpr_write_b32 a16, 0
  v_accvgpr_write_b32 a17, 0
  v_accvgpr_write_b32 a18, 0
  v_accvgpr_write_b32 a19, 0
  v_accvgpr_write_b32 a20, 0
  v_accvgpr_write_b32 a21, 0
  v_accvgpr_write_b32 a22, 0
  v_accvgpr_write_b32 a23, 0
  v_accvgpr_write_b32 a24, 0
  buffer_store_dwordx4 v[32:35], v236, s[64:67], s44 offen offset:1024 sc1
  v_accvgpr_write_b32 a25, 0
  v_mfma_f32_32x32x16_bf16 v[80:95], v[144:147], v[200:203], 0
  v_accvgpr_write_b32 a26, 0
  v_accvgpr_write_b32 a27, 0
  v_accvgpr_write_b32 a28, 0
  v_accvgpr_write_b32 a29, 0
  v_accvgpr_write_b32 a30, 0
  v_accvgpr_write_b32 a31, 0
  v_accvgpr_write_b32 a32, 0
  v_accvgpr_write_b32 a33, 0
  v_accvgpr_write_b32 a34, 0
  v_accvgpr_write_b32 a35, 0
  v_accvgpr_write_b32 a36, 0
  v_accvgpr_write_b32 a37, 0
  buffer_store_dwordx4 v[36:39], v236, s[64:67], s44 offen offset:2048 sc1
  v_accvgpr_write_b32 a38, 0
  v_accvgpr_write_b32 a39, 0
  v_accvgpr_write_b32 a40, 0
  v_mfma_f32_32x32x16_bf16 v[96:111], v[144:147], v[208:211], 0
  v_accvgpr_write_b32 a41, 0
  v_accvgpr_write_b32 a42, 0
  v_accvgpr_write_b32 a43, 0
  v_accvgpr_write_b32 a44, 0
  v_accvgpr_write_b32 a45, 0
  v_accvgpr_write_b32 a46, 0
  v_accvgpr_write_b32 a47, 0
  v_accvgpr_write_b32 a48, 0
  v_accvgpr_write_b32 a49, 0
  v_accvgpr_write_b32 a50, 0
  buffer_store_dwordx4 v[40:43], v236, s[64:67], s44 offen offset:3072 sc1
  v_accvgpr_write_b32 a51, 0
  v_accvgpr_write_b32 a52, 0
  v_accvgpr_write_b32 a53, 0
  v_accvgpr_write_b32 a54, 0
  v_accvgpr_write_b32 a55, 0
  v_mfma_f32_32x32x16_bf16 v[112:127], v[144:147], v[216:219], 0
  v_accvgpr_write_b32 a56, 0
  v_accvgpr_write_b32 a57, 0
  v_accvgpr_write_b32 a58, 0
  v_accvgpr_write_b32 a59, 0
  v_accvgpr_write_b32 a60, 0
  v_accvgpr_write_b32 a61, 0
  v_accvgpr_write_b32 a62, 0
  v_accvgpr_write_b32 a63, 0
  buffer_store_dwordx4 v[44:47], v27, s[64:67], s44 offen sc1
  v_accvgpr_write_b32 a64, 0
  v_accvgpr_write_b32 a65, 0
  v_accvgpr_write_b32 a66, 0
  v_accvgpr_write_b32 a67, 0
  v_accvgpr_write_b32 a68, 0
  v_accvgpr_write_b32 a69, 0
  v_accvgpr_write_b32 a70, 0
  v_mfma_f32_32x32x16_bf16 v[128:143], v[144:147], v[224:227], 0
  v_accvgpr_write_b32 a71, 0
  v_accvgpr_write_b32 a72, 0
  v_accvgpr_write_b32 a73, 0
  v_accvgpr_write_b32 a74, 0
  v_accvgpr_write_b32 a75, 0
  v_accvgpr_write_b32 a76, 0
  s_add_u32 s44, s44, 757760
  v_accvgpr_write_b32 a77, 0
  v_accvgpr_write_b32 a78, 0
  v_accvgpr_write_b32 a79, 0
  s_add_u32 s31, s2, s100
  s_and_b32 s48, s31, 3
  s_lshr_b32 s32, s31, 2
  s_xor_b32 s31, s31, s32
  s_and_b32 s31, s31, 1
  s_lshl_b32 s49, s31, 3
  v_mfma_f32_32x32x8_bf16 v[64:79], v[152:153], v[196:197], v[64:79]
  s_mov_b32 s56, 0
  s_mov_b32 s57, 0
  s_cmp_eq_u32 s48, 1
  s_cselect_b32 s56, 470618644, s56
  s_cselect_b32 s57, 134746129, s57
  buffer_store_dwordx4 v[48:51], v236, s[64:67], s44 offen offset:0 sc1
  s_cmp_eq_u32 s48, 2
  s_cselect_b32 s56, 606020380, s56
  s_cselect_b32 s57, 605822241, s57
  s_cmp_eq_u32 s48, 3
  s_cselect_b32 s56, 942682936, s56
  s_cselect_b32 s57, 740568878, s57
  s_lshl_b32 s31, s29, 3
  s_lshr_b64 s[56:57], s[56:57], s31
  s_and_b32 s54, s56, 255
  s_mov_b32 s56, 135269640
  v_mfma_f32_32x32x8_bf16 v[80:95], v[152:153], v[204:205], v[80:95]
  s_mov_b32 s57, 337383698
  s_lshr_b64 s[56:57], s[56:57], s31
  buffer_store_dwordx4 v[52:55], v236, s[64:67], s44 offen offset:1024 sc1
  s_and_b32 s55, s56, 255
  s_cmp_eq_u32 s49, 0
  s_cselect_b32 s32, 3, 2
  s_bitcmp1_b32 s48, 0
  s_cselect_b32 s33, s32, 0
  s_add_u32 s54, s54, s33
  s_lshl_b32 s33, s33, 1
  s_sub_u32 s32, s32, s33
  s_add_u32 s55, s55, s32
  s_lshl_b32 s31, s29, 2
  s_lshr_b32 s31, 544478803, s31
  s_sub_u32 s32, s31, s48
  s_and_b32 s32, s32, 3
  v_mfma_f32_32x32x8_bf16 v[96:111], v[152:153], v[212:213], v[96:111]
  buffer_store_dwordx4 v[56:59], v236, s[64:67], s44 offen offset:2048 sc1
  s_and_b32 s31, s31, 4
  s_or_b32 s31, s31, s32
  s_and_b32 s50, s31, 2
  s_bfe_u32 s32, s28, 0x10001
  s_or_b32 s50, s50, s32
  s_and_b32 s32, s31, 1
  s_lshl_b32 s32, s32, 1
  s_and_b32 s31, s31, 4
  s_or_b32 s31, s31, s32
  s_and_b32 s32, s28, 1
  s_or_b32 s31, s31, s32
  s_lshl_b32 s31, s31, 2
  s_lshr_b32 s31, 1980781618, s31
  buffer_store_dwordx4 v[60:63], v236, s[64:67], s44 offen offset:3072 sc1
  s_and_b32 s31, s31, 7
  v_mfma_f32_32x32x8_bf16 v[112:127], v[152:153], v[220:221], v[112:127]
  s_add_u32 s49, s49, s31
  s_lshl_b32 s51, s49, 2
  s_add_u32 s51, s51, s50
  s_and_b32 s52, s30, 1
  s_lshr_b32 s53, s30, 1
  v_and_b32 v9, 31, v2
  v_lshlrev_b32 v9, 2, v9
  s_lshr_b32 s62, s49, 1
  s_lshl_b32 s62, s62, 7
  s_add_u32 s62, s62, 4096
  s_lshr_b32 s31, s54, 1
  s_add_u32 s32, s54, s55
  buffer_store_dwordx4 v[180:183], v27, s[64:67], s44 offen sc1
  s_add_u32 s32, s32, 1
  s_lshr_b32 s32, s32, 1
  s_sub_u32 s32, s32, s31
  v_mfma_f32_32x32x8_bf16 v[128:143], v[152:153], v[228:229], v[128:143]
  s_add_u32 m0, s61, 65536
  s_mov_b32 s60, 57344
  buffer_load_dwordx4 v238, s[16:19], s60 offen offset:0 sc1 lds
  s_bfm_b32 s63, s32, s31
  s_lshl_b32 s31, s50, 1
  s_add_u32 s31, s31, s53
  s_mul_i32 s31, s31, 148
  s_lshl_b32 s32, s54, 1
  s_add_u32 s31, s31, s32
  s_add_u32 s31, s31, s52
  s_mul_i32 s58, s31, 5120
  s_lshl_b32 s31, s49, 3
  s_lshl_b32 s33, s30, 1
  s_add_u32 s31, s31, s33
  s_mul_i32 s31, s31, 148
  s_add_u32 s31, s31, s32
  s_lshl_b32 s59, s31, 10
  s_cmp_eq_u32 s30, 0
  s_cselect_b32 s47, 0x43, 1
  v_max3_f32 v240, v64, v65, v66
  v_max3_f32 v240, v240, v67, v68
  v_max3_f32 v240, v240, v69, v70
  v_max3_f32 v240, v240, v71, v72
  v_max3_f32 v240, v240, v73, v74
  v_max3_f32 v240, v240, v75, v76
  v_max3_f32 v240, v240, v77, v78
  v_max_f32 v240, v240, v79
  v_max3_f32 v241, v80, v81, v82
  v_max3_f32 v241, v241, v83, v84
  v_max3_f32 v241, v241, v85, v86
  v_max3_f32 v241, v241, v87, v88
  v_max3_f32 v241, v241, v89, v90
  v_max3_f32 v241, v241, v91, v92
  buffer_load_dwordx4 v238, s[16:19], s60 offen offset:1024 sc1 lds
  v_max3_f32 v241, v241, v93, v94
  v_max_f32 v241, v241, v95
  v_max3_f32 v242, v96, v97, v98
  v_max3_f32 v242, v242, v99, v100
  v_max3_f32 v242, v242, v101, v102
  v_max3_f32 v242, v242, v103, v104
  v_max3_f32 v242, v242, v105, v106
  v_max3_f32 v242, v242, v107, v108
  v_max3_f32 v242, v242, v109, v110
  v_max_f32 v242, v242, v111
  v_max3_f32 v243, v112, v113, v114
  v_max3_f32 v243, v243, v115, v116
  v_max3_f32 v243, v243, v117, v118
  v_max3_f32 v243, v243, v119, v120
  v_max3_f32 v243, v243, v121, v122
  buffer_load_dwordx4 v238, s[16:19], s60 offen offset:2048 sc1 lds
  v_max3_f32 v243, v243, v123, v124
  v_max3_f32 v243, v243, v125, v126
  v_max_f32 v243, v243, v127
  v_max3_f32 v244, v128, v129, v130
  v_max3_f32 v244, v244, v131, v132
  v_max3_f32 v244, v244, v133, v134
  v_max3_f32 v244, v244, v135, v136
  v_max3_f32 v244, v244, v137, v138
  v_max3_f32 v244, v244, v139, v140
  v_max3_f32 v244, v244, v141, v142
  v_max_f32 v244, v244, v143
  s_mov_b32 vcc_lo, -1
  s_mov_b32 vcc_hi, 0
  v_mov_b32 v248, v240
  v_mov_b32 v249, v241
  buffer_load_dwordx4 v238, s[16:19], s60 offen offset:3072 sc1 lds
  v_mov_b32 v250, v242
  v_mov_b32 v251, v243
  v_mov_b32 v252, v244
  v_permlane32_swap_b32 v240, v248
  v_permlane32_swap_b32 v241, v249
  v_permlane32_swap_b32 v242, v250
  v_permlane32_swap_b32 v243, v251
  v_permlane32_swap_b32 v244, v252
  v_max_f32 v240, v240, v248
  v_sub_f32 v240, 0, v240
  v_and_b32 v248, 0xffff0000, v240
  v_sub_f32 v240, v240, v248
  v_lshrrev_b32 v248, 16, v248
  v_and_b32 v6, 0xffff0000, v240
  v_or_b32 v248, v248, v6
  s_add_u32 m0, s61, 69632
  s_mov_b32 s60, 61440
  buffer_load_dwordx4 v238, s[16:19], s60 offen offset:0 sc1 lds
  v_sub_f32 v240, v240, v6
  v_lshrrev_b32 v240, 16, v240
  v_cndmask_b32 v196, v248, v196, vcc
  v_cndmask_b32 v197, v240, v197, vcc
  v_max_f32 v241, v241, v249
  v_sub_f32 v241, 0, v241
  v_and_b32 v249, 0xffff0000, v241
  v_sub_f32 v241, v241, v249
  v_lshrrev_b32 v249, 16, v249
  v_and_b32 v6, 0xffff0000, v241
  v_or_b32 v249, v249, v6
  v_sub_f32 v241, v241, v6
  v_lshrrev_b32 v241, 16, v241
  v_cndmask_b32 v204, v249, v204, vcc
  v_cndmask_b32 v205, v241, v205, vcc
  buffer_load_dwordx4 v238, s[16:19], s60 offen offset:1024 sc1 lds
  v_max_f32 v242, v242, v250
  v_sub_f32 v242, 0, v242
  v_and_b32 v250, 0xffff0000, v242
  v_sub_f32 v242, v242, v250
  v_lshrrev_b32 v250, 16, v250
  v_and_b32 v6, 0xffff0000, v242
  v_or_b32 v250, v250, v6
  v_sub_f32 v242, v242, v6
  v_lshrrev_b32 v242, 16, v242
  v_cndmask_b32 v212, v250, v212, vcc
  v_cndmask_b32 v213, v242, v213, vcc
  v_max_f32 v243, v243, v251
  v_sub_f32 v243, 0, v243
  v_and_b32 v251, 0xffff0000, v243
  v_sub_f32 v243, v243, v251
  buffer_load_dwordx4 v238, s[16:19], s60 offen offset:2048 sc1 lds
  v_lshrrev_b32 v251, 16, v251
  v_and_b32 v6, 0xffff0000, v243
  v_or_b32 v251, v251, v6
  v_sub_f32 v243, v243, v6
  v_lshrrev_b32 v243, 16, v243
  v_cndmask_b32 v220, v251, v220, vcc
  v_cndmask_b32 v221, v243, v221, vcc
  v_max_f32 v244, v244, v252
  v_sub_f32 v244, 0, v244
  v_and_b32 v252, 0xffff0000, v244
  v_sub_f32 v244, v244, v252
  v_lshrrev_b32 v252, 16, v252
  v_and_b32 v6, 0xffff0000, v244
  v_or_b32 v252, v252, v6
  v_sub_f32 v244, v244, v6
  v_lshrrev_b32 v244, 16, v244
  v_cndmask_b32 v228, v252, v228, vcc
  v_cndmask_b32 v229, v244, v229, vcc
L_Bh5:
  v_mov_b32 v176, v236
  v_add_u32 v177, 0x8000, v236
  s_add_u32 s33, s61, 98304
  s_waitcnt lgkmcnt(0)
  v_mfma_f32_32x32x16_bf16 v[64:79], v[144:147], v[192:195], 0
  v_mfma_f32_32x32x8_bf16 v[64:79], v[152:153], v[196:197], v[64:79]
  v_mfma_f32_32x32x16_bf16 v[80:95], v[144:147], v[200:203], 0
  ds_read_b128 v[160:163], v176 offset:1024
  s_nop 9
  v_exp_f32 v64, v64
  v_exp_f32 v65, v65
  v_exp_f32 v66, v66
  v_exp_f32 v67, v67
  v_cvt_pk_bf16_f32 v96, v64, v65
  v_mfma_f32_32x32x8_bf16 v[80:95], v[152:153], v[204:205], v[80:95]
  ds_read_b128 v[164:167], v176 offset:2048
  v_cvt_pk_bf16_f32 v97, v66, v67
  v_exp_f32 v68, v68
  v_exp_f32 v69, v69
  v_exp_f32 v70, v70
  v_exp_f32 v71, v71
  v_cvt_pk_bf16_f32 v98, v68, v69
  v_cvt_pk_bf16_f32 v99, v70, v71
  v_exp_f32 v72, v72
  v_exp_f32 v73, v73
  v_exp_f32 v74, v74
  v_exp_f32 v75, v75
  v_cvt_pk_bf16_f32 v100, v72, v73
  v_cvt_pk_bf16_f32 v101, v74, v75
  v_exp_f32 v76, v76
  v_exp_f32 v77, v77
  v_exp_f32 v78, v78
  v_exp_f32 v79, v79
  v_cvt_pk_bf16_f32 v102, v76, v77
  v_cvt_pk_bf16_f32 v103, v78, v79
  s_waitcnt vmcnt(17) lgkmcnt(0)
  v_mfma_f32_32x32x16_bf16 v[64:79], v[144:147], v[208:211], 0
  s_barrier
  s_cmp_lg_u32 s30, 0
  s_cbranch_scc1 L_cf5
  s_mov_b32 s46, s33
  s_lshl_b32 s31, s29, 7
  s_lshl_b32 s33, s28, 2
  s_add_u32 s31, s31, s33
  s_add_u32 s31, s31, 4096
  v_mov_b32 v6, s100
  v_mov_b32 v7, 0
  s_mov_b64 exec, 1
  buffer_store_dword v6, v7, s[24:27], s31 offen offset:0 sc1
  s_mov_b64 exec, -1
  s_mov_b32 s33, s46
L_cf5:
  s_branch L_Bin5
  .p2align 6
L_Bloop5:
  v_mfma_f32_32x32x16_bf16 v[64:79], v[144:147], v[208:211], 0
  s_waitcnt vmcnt(7) lgkmcnt(0)
  s_barrier
L_Bin5:
  s_mov_b32 m0, s33
  v_exp_f32 v80, v80
  v_exp_f32 v81, v81
  v_exp_f32 v82, v82
  v_exp_f32 v83, v83
  v_cvt_pk_bf16_f32 v104, v80, v81
  v_mfma_f32_32x32x16_bf16 a[0:15], v[160:163], v[96:99], a[0:15]
  buffer_load_dwordx4 v238, s[16:19], s34 offen offset:0 sc1 lds
  v_cvt_pk_bf16_f32 v105, v82, v83
  v_exp_f32 v84, v84
  v_exp_f32 v85, v85
  v_exp_f32 v86, v86
  v_exp_f32 v87, v87
  v_cvt_pk_bf16_f32 v106, v84, v85
  v_mfma_f32_32x32x8_bf16 v[64:79], v[152:153], v[212:213], v[64:79]
  v_cvt_pk_bf16_f32 v107, v86, v87
  v_exp_f32 v88, v88
  v_exp_f32 v89, v89
  v_exp_f32 v90, v90
  v_exp_f32 v91, v91
  v_cvt_pk_bf16_f32 v108, v88, v89
  v_mfma_f32_32x32x16_bf16 a[0:15], v[164:167], v[100:103], a[0:15]
  v_cvt_pk_bf16_f32 v109, v90, v91
  v_exp_f32 v92, v92
  v_exp_f32 v93, v93
  v_exp_f32 v94, v94
  v_exp_f32 v95, v95
  v_cvt_pk_bf16_f32 v110, v92, v93
  v_cvt_pk_bf16_f32 v111, v94, v95
  v_mfma_f32_32x32x16_bf16 v[80:95], v[144:147], v[216:219], 0
  v_exp_f32 v64, v64
  v_exp_f32 v65, v65
  v_exp_f32 v66, v66
  v_exp_f32 v67, v67
  v_cvt_pk_bf16_f32 v96, v64, v65
  v_mfma_f32_32x32x16_bf16 a[16:31], v[160:163], v[104:107], a[16:31]
  v_cvt_pk_bf16_f32 v97, v66, v67
  v_exp_f32 v68, v68
  v_exp_f32 v69, v69
  v_exp_f32 v70, v70
  v_exp_f32 v71, v71
  v_cvt_pk_bf16_f32 v98, v68, v69
  v_mfma_f32_32x32x8_bf16 v[80:95], v[152:153], v[220:221], v[80:95]
  v_cvt_pk_bf16_f32 v99, v70, v71
  v_exp_f32 v72, v72
  v_exp_f32 v73, v73
  v_exp_f32 v74, v74
  v_exp_f32 v75, v75
  v_cvt_pk_bf16_f32 v100, v72, v73
  v_mfma_f32_32x32x16_bf16 a[16:31], v[164:167], v[108:111], a[16:31]
  v_cvt_pk_bf16_f32 v101, v74, v75
  v_exp_f32 v76, v76
  v_exp_f32 v77, v77
  v_exp_f32 v78, v78
  v_exp_f32 v79, v79
  v_cvt_pk_bf16_f32 v102, v76, v77
  v_cvt_pk_bf16_f32 v103, v78, v79
  v_mfma_f32_32x32x16_bf16 v[64:79], v[144:147], v[224:227], 0
  ds_read_b128 v[148:151], v176 offset:3072
  v_exp_f32 v80, v80
  v_exp_f32 v81, v81
  v_exp_f32 v82, v82
  v_exp_f32 v83, v83
  v_cvt_pk_bf16_f32 v104, v80, v81
  v_mfma_f32_32x32x16_bf16 a[32:47], v[160:163], v[96:99], a[32:47]
  v_cvt_pk_bf16_f32 v105, v82, v83
  v_exp_f32 v84, v84
  v_exp_f32 v85, v85
  v_exp_f32 v86, v86
  v_exp_f32 v87, v87
  v_cvt_pk_bf16_f32 v106, v84, v85
  v_mfma_f32_32x32x8_bf16 v[64:79], v[152:153], v[228:229], v[64:79]
  v_cvt_pk_bf16_f32 v107, v86, v87
  v_exp_f32 v88, v88
  v_exp_f32 v89, v89
  v_exp_f32 v90, v90
  v_exp_f32 v91, v91
  v_cvt_pk_bf16_f32 v108, v88, v89
  v_mfma_f32_32x32x16_bf16 a[32:47], v[164:167], v[100:103], a[32:47]
  s_waitcnt lgkmcnt(0)
  v_cvt_pk_bf16_f32 v109, v90, v91
  v_exp_f32 v92, v92
  v_exp_f32 v93, v93
  v_exp_f32 v94, v94
  v_exp_f32 v95, v95
  v_cvt_pk_bf16_f32 v110, v92, v93
  v_cvt_pk_bf16_f32 v111, v94, v95
  v_mfma_f32_32x32x16_bf16 v[80:95], v[148:151], v[192:195], 0
  v_exp_f32 v64, v64
  v_exp_f32 v65, v65
  v_exp_f32 v66, v66
  v_exp_f32 v67, v67
  v_cvt_pk_bf16_f32 v96, v64, v65
  v_mfma_f32_32x32x16_bf16 a[48:63], v[160:163], v[104:107], a[48:63]
  v_cvt_pk_bf16_f32 v97, v66, v67
  v_exp_f32 v68, v68
  v_exp_f32 v69, v69
  v_exp_f32 v70, v70
  v_exp_f32 v71, v71
  v_cvt_pk_bf16_f32 v98, v68, v69
  v_mfma_f32_32x32x8_bf16 v[80:95], v[154:155], v[196:197], v[80:95]
  v_cvt_pk_bf16_f32 v99, v70, v71
  v_exp_f32 v72, v72
  v_exp_f32 v73, v73
  v_exp_f32 v74, v74
  v_exp_f32 v75, v75
  v_cvt_pk_bf16_f32 v100, v72, v73
  v_mfma_f32_32x32x16_bf16 a[48:63], v[164:167], v[108:111], a[48:63]
  v_cvt_pk_bf16_f32 v101, v74, v75
  v_exp_f32 v76, v76
  v_exp_f32 v77, v77
  v_exp_f32 v78, v78
  v_exp_f32 v79, v79
  v_cvt_pk_bf16_f32 v102, v76, v77
  v_cvt_pk_bf16_f32 v103, v78, v79
  v_mfma_f32_32x32x16_bf16 v[64:79], v[148:151], v[200:203], 0
  ds_read_b128 v[168:171], v176 offset:4096
  v_exp_f32 v80, v80
  v_exp_f32 v81, v81
  v_exp_f32 v82, v82
  v_exp_f32 v83, v83
  v_cvt_pk_bf16_f32 v104, v80, v81
  v_mfma_f32_32x32x16_bf16 a[64:79], v[160:163], v[96:99], a[64:79]
  ds_read_b128 v[172:175], v176 offset:5120
  v_cvt_pk_bf16_f32 v105, v82, v83
  v_exp_f32 v84, v84
  v_exp_f32 v85, v85
  v_exp_f32 v86, v86
  v_exp_f32 v87, v87
  v_cvt_pk_bf16_f32 v106, v84, v85
  v_mfma_f32_32x32x8_bf16 v[64:79], v[154:155], v[204:205], v[64:79]
  v_cvt_pk_bf16_f32 v107, v86, v87
  v_exp_f32 v88, v88
  v_exp_f32 v89, v89
  v_exp_f32 v90, v90
  v_exp_f32 v91, v91
  v_cvt_pk_bf16_f32 v108, v88, v89
  v_mfma_f32_32x32x16_bf16 a[64:79], v[164:167], v[100:103], a[64:79]
  v_cvt_pk_bf16_f32 v109, v90, v91
  v_exp_f32 v92, v92
  v_exp_f32 v93, v93
  v_exp_f32 v94, v94
  v_exp_f32 v95, v95
  v_cvt_pk_bf16_f32 v110, v92, v93
  v_cvt_pk_bf16_f32 v111, v94, v95
  v_mfma_f32_32x32x16_bf16 v[80:95], v[148:151], v[208:211], 0
  s_waitcnt lgkmcnt(0)
  buffer_load_dwordx4 v238, s[16:19], s34 offen offset:1024 sc1 lds
  v_exp_f32 v64, v64
  v_exp_f32 v65, v65
  v_exp_f32 v66, v66
  v_exp_f32 v67, v67
  v_cvt_pk_bf16_f32 v96, v64, v65
  v_mfma_f32_32x32x16_bf16 a[0:15], v[168:171], v[104:107], a[0:15]
  v_cvt_pk_bf16_f32 v97, v66, v67
  v_exp_f32 v68, v68
  v_exp_f32 v69, v69
  v_exp_f32 v70, v70
  v_exp_f32 v71, v71
  v_cvt_pk_bf16_f32 v98, v68, v69
  v_mfma_f32_32x32x8_bf16 v[80:95], v[154:155], v[212:213], v[80:95]
  v_cvt_pk_bf16_f32 v99, v70, v71
  v_exp_f32 v72, v72
  v_exp_f32 v73, v73
  v_exp_f32 v74, v74
  v_exp_f32 v75, v75
  v_cvt_pk_bf16_f32 v100, v72, v73
  v_mfma_f32_32x32x16_bf16 a[0:15], v[172:175], v[108:111], a[0:15]
  v_cvt_pk_bf16_f32 v101, v74, v75
  v_exp_f32 v76, v76
  v_exp_f32 v77, v77
  v_exp_f32 v78, v78
  v_exp_f32 v79, v79
  v_cvt_pk_bf16_f32 v102, v76, v77
  v_cvt_pk_bf16_f32 v103, v78, v79
  v_mfma_f32_32x32x16_bf16 v[64:79], v[148:151], v[216:219], 0
  v_exp_f32 v80, v80
  v_exp_f32 v81, v81
  v_exp_f32 v82, v82
  v_exp_f32 v83, v83
  v_cvt_pk_bf16_f32 v104, v80, v81
  v_mfma_f32_32x32x16_bf16 a[16:31], v[168:171], v[96:99], a[16:31]
  v_cvt_pk_bf16_f32 v105, v82, v83
  v_exp_f32 v84, v84
  v_exp_f32 v85, v85
  v_exp_f32 v86, v86
  v_exp_f32 v87, v87
  v_cvt_pk_bf16_f32 v106, v84, v85
  v_mfma_f32_32x32x8_bf16 v[64:79], v[154:155], v[220:221], v[64:79]
  v_cvt_pk_bf16_f32 v107, v86, v87
  v_exp_f32 v88, v88
  v_exp_f32 v89, v89
  v_exp_f32 v90, v90
  v_exp_f32 v91, v91
  v_cvt_pk_bf16_f32 v108, v88, v89
  v_mfma_f32_32x32x16_bf16 a[16:31], v[172:175], v[100:103], a[16:31]
  v_cvt_pk_bf16_f32 v109, v90, v91
  v_exp_f32 v92, v92
  v_exp_f32 v93, v93
  v_exp_f32 v94, v94
  v_exp_f32 v95, v95
  v_cvt_pk_bf16_f32 v110, v92, v93
  v_cvt_pk_bf16_f32 v111, v94, v95
  v_mfma_f32_32x32x16_bf16 v[80:95], v[148:151], v[224:227], 0
  ds_read_b128 v[144:147], v176 offset:6144
  v_exp_f32 v64, v64
  v_exp_f32 v65, v65
  v_exp_f32 v66, v66
  v_exp_f32 v67, v67
  v_cvt_pk_bf16_f32 v96, v64, v65
  v_mfma_f32_32x32x16_bf16 a[32:47], v[168:171], v[104:107], a[32:47]
  ds_read_b128 v[156:159], v176 offset:25600
  v_cvt_pk_bf16_f32 v97, v66, v67
  v_exp_f32 v68, v68
  v_exp_f32 v69, v69
  v_exp_f32 v70, v70
  v_exp_f32 v71, v71
  v_cvt_pk_bf16_f32 v98, v68, v69
  v_mfma_f32_32x32x8_bf16 v[80:95], v[154:155], v[228:229], v[80:95]
  v_cvt_pk_bf16_f32 v99, v70, v71
  v_exp_f32 v72, v72
  v_exp_f32 v73, v73
  v_exp_f32 v74, v74
  v_exp_f32 v75, v75
  v_cvt_pk_bf16_f32 v100, v72, v73
  v_mfma_f32_32x32x16_bf16 a[32:47], v[172:175], v[108:111], a[32:47]
  s_waitcnt lgkmcnt(0)
  v_cvt_pk_bf16_f32 v101, v74, v75
  v_exp_f32 v76, v76
  v_exp_f32 v77, v77
  v_exp_f32 v78, v78
  v_exp_f32 v79, v79
  v_cvt_pk_bf16_f32 v102, v76, v77
  v_cvt_pk_bf16_f32 v103, v78, v79
  v_mfma_f32_32x32x16_bf16 v[64:79], v[144:147], v[192:195], 0
  v_exp_f32 v80, v80
  v_exp_f32 v81, v81
  v_exp_f32 v82, v82
  v_exp_f32 v83, v83
  v_cvt_pk_bf16_f32 v104, v80, v81
  v_mfma_f32_32x32x16_bf16 a[48:63], v[168:171], v[96:99], a[48:63]
  v_cvt_pk_bf16_f32 v105, v82, v83
  v_exp_f32 v84, v84
  v_exp_f32 v85, v85
  v_exp_f32 v86, v86
  v_exp_f32 v87, v87
  v_cvt_pk_bf16_f32 v106, v84, v85
  v_mfma_f32_32x32x8_bf16 v[64:79], v[156:157], v[196:197], v[64:79]
  v_cvt_pk_bf16_f32 v107, v86, v87
  v_exp_f32 v88, v88
  v_exp_f32 v89, v89
  v_exp_f32 v90, v90
  v_exp_f32 v91, v91
  v_cvt_pk_bf16_f32 v108, v88, v89
  v_mfma_f32_32x32x16_bf16 a[48:63], v[172:175], v[100:103], a[48:63]
  v_cvt_pk_bf16_f32 v109, v90, v91
  v_exp_f32 v92, v92
  v_exp_f32 v93, v93
  v_exp_f32 v94, v94
  v_exp_f32 v95, v95
  v_cvt_pk_bf16_f32 v110, v92, v93
  v_cvt_pk_bf16_f32 v111, v94, v95
  v_mfma_f32_32x32x16_bf16 v[80:95], v[144:147], v[200:203], 0
  ds_read_b128 v[160:163], v176 offset:7168
  v_exp_f32 v64, v64
  v_exp_f32 v65, v65
  v_exp_f32 v66, v66
  v_exp_f32 v67, v67
  v_cvt_pk_bf16_f32 v96, v64, v65
  v_mfma_f32_32x32x16_bf16 a[64:79], v[168:171], v[104:107], a[64:79]
  ds_read_b128 v[164:167], v176 offset:8192
  v_cvt_pk_bf16_f32 v97, v66, v67
  v_exp_f32 v68, v68
  v_exp_f32 v69, v69
  v_exp_f32 v70, v70
  v_exp_f32 v71, v71
  v_cvt_pk_bf16_f32 v98, v68, v69
  v_mfma_f32_32x32x8_bf16 v[80:95], v[156:157], v[204:205], v[80:95]
  v_cvt_pk_bf16_f32 v99, v70, v71
  v_exp_f32 v72, v72
  v_exp_f32 v73, v73
  v_exp_f32 v74, v74
  v_exp_f32 v75, v75
  v_cvt_pk_bf16_f32 v100, v72, v73
  v_mfma_f32_32x32x16_bf16 a[64:79], v[172:175], v[108:111], a[64:79]
  v_cvt_pk_bf16_f32 v101, v74, v75
  v_exp_f32 v76, v76
  v_exp_f32 v77, v77
  v_exp_f32 v78, v78
  v_exp_f32 v79, v79
  v_cvt_pk_bf16_f32 v102, v76, v77
  v_cvt_pk_bf16_f32 v103, v78, v79
  v_mfma_f32_32x32x16_bf16 v[64:79], v[144:147], v[208:211], 0
  s_waitcnt lgkmcnt(0)
  buffer_load_dwordx4 v238, s[16:19], s34 offen offset:2048 sc1 lds
  v_exp_f32 v80, v80
  v_exp_f32 v81, v81
  v_exp_f32 v82, v82
  v_exp_f32 v83, v83
  v_cvt_pk_bf16_f32 v104, v80, v81
  v_mfma_f32_32x32x16_bf16 a[0:15], v[160:163], v[96:99], a[0:15]
  v_cvt_pk_bf16_f32 v105, v82, v83
  v_exp_f32 v84, v84
  v_exp_f32 v85, v85
  v_exp_f32 v86, v86
  v_exp_f32 v87, v87
  v_cvt_pk_bf16_f32 v106, v84, v85
  v_mfma_f32_32x32x8_bf16 v[64:79], v[156:157], v[212:213], v[64:79]
  v_cvt_pk_bf16_f32 v107, v86, v87
  v_exp_f32 v88, v88
  v_exp_f32 v89, v89
  v_exp_f32 v90, v90
  v_exp_f32 v91, v91
  v_cvt_pk_bf16_f32 v108, v88, v89
  v_mfma_f32_32x32x16_bf16 a[0:15], v[164:167], v[100:103], a[0:15]
  v_cvt_pk_bf16_f32 v109, v90, v91
  v_exp_f32 v92, v92
  v_exp_f32 v93, v93
  v_exp_f32 v94, v94
  v_exp_f32 v95, v95
  v_cvt_pk_bf16_f32 v110, v92, v93
  v_cvt_pk_bf16_f32 v111, v94, v95
  v_mfma_f32_32x32x16_bf16 v[80:95], v[144:147], v[216:219], 0
  v_exp_f32 v64, v64
  v_exp_f32 v65, v65
  v_exp_f32 v66, v66
  v_exp_f32 v67, v67
  v_cvt_pk_bf16_f32 v96, v64, v65
  v_mfma_f32_32x32x16_bf16 a[16:31], v[160:163], v[104:107], a[16:31]
  v_cvt_pk_bf16_f32 v97, v66, v67
  v_exp_f32 v68, v68
  v_exp_f32 v69, v69
  v_exp_f32 v70, v70
  v_exp_f32 v71, v71
  v_cvt_pk_bf16_f32 v98, v68, v69
  v_mfma_f32_32x32x8_bf16 v[80:95], v[156:157], v[220:221], v[80:95]
  v_cvt_pk_bf16_f32 v99, v70, v71
  v_exp_f32 v72, v72
  v_exp_f32 v73, v73
  v_exp_f32 v74, v74
  v_exp_f32 v75, v75
  v_cvt_pk_bf16_f32 v100, v72, v73
  v_mfma_f32_32x32x16_bf16 a[16:31], v[164:167], v[108:111], a[16:31]
  v_cvt_pk_bf16_f32 v101, v74, v75
  v_exp_f32 v76, v76
  v_exp_f32 v77, v77
  v_exp_f32 v78, v78
  v_exp_f32 v79, v79
  v_cvt_pk_bf16_f32 v102, v76, v77
  v_cvt_pk_bf16_f32 v103, v78, v79
  v_mfma_f32_32x32x16_bf16 v[64:79], v[144:147], v[224:227], 0
  ds_read_b128 v[148:151], v176 offset:9216
  v_exp_f32 v80, v80
  v_exp_f32 v81, v81
  v_exp_f32 v82, v82
  v_exp_f32 v83, v83
  v_cvt_pk_bf16_f32 v104, v80, v81
  v_mfma_f32_32x32x16_bf16 a[32:47], v[160:163], v[96:99], a[32:47]
  v_cvt_pk_bf16_f32 v105, v82, v83
  v_exp_f32 v84, v84
  v_exp_f32 v85, v85
  v_exp_f32 v86, v86
  v_exp_f32 v87, v87
  v_cvt_pk_bf16_f32 v106, v84, v85
  v_mfma_f32_32x32x8_bf16 v[64:79], v[156:157], v[228:229], v[64:79]
  v_cvt_pk_bf16_f32 v107, v86, v87
  v_exp_f32 v88, v88
  v_exp_f32 v89, v89
  v_exp_f32 v90, v90
  v_exp_f32 v91, v91
  v_cvt_pk_bf16_f32 v108, v88, v89
  v_mfma_f32_32x32x16_bf16 a[32:47], v[164:167], v[100:103], a[32:47]
  s_waitcnt lgkmcnt(0)
  v_cvt_pk_bf16_f32 v109, v90, v91
  v_exp_f32 v92, v92
  v_exp_f32 v93, v93
  v_exp_f32 v94, v94
  v_exp_f32 v95, v95
  v_cvt_pk_bf16_f32 v110, v92, v93
  v_cvt_pk_bf16_f32 v111, v94, v95
  v_mfma_f32_32x32x16_bf16 v[80:95], v[148:151], v[192:195], 0
  v_exp_f32 v64, v64
  v_exp_f32 v65, v65
  v_exp_f32 v66, v66
  v_exp_f32 v67, v67
  v_cvt_pk_bf16_f32 v96, v64, v65
  v_mfma_f32_32x32x16_bf16 a[48:63], v[160:163], v[104:107], a[48:63]
  v_cvt_pk_bf16_f32 v97, v66, v67
  v_exp_f32 v68, v68
  v_exp_f32 v69, v69
  v_exp_f32 v70, v70
  v_exp_f32 v71, v71
  v_cvt_pk_bf16_f32 v98, v68, v69
  v_mfma_f32_32x32x8_bf16 v[80:95], v[158:159], v[196:197], v[80:95]
  v_cvt_pk_bf16_f32 v99, v70, v71
  v_exp_f32 v72, v72
  v_exp_f32 v73, v73
  v_exp_f32 v74, v74
  v_exp_f32 v75, v75
  v_cvt_pk_bf16_f32 v100, v72, v73
  v_mfma_f32_32x32x16_bf16 a[48:63], v[164:167], v[108:111], a[48:63]
  v_cvt_pk_bf16_f32 v101, v74, v75
  v_exp_f32 v76, v76
  v_exp_f32 v77, v77
  v_exp_f32 v78, v78
  v_exp_f32 v79, v79
  v_cvt_pk_bf16_f32 v102, v76, v77
  v_cvt_pk_bf16_f32 v103, v78, v79
  v_mfma_f32_32x32x16_bf16 v[64:79], v[148:151], v[200:203], 0
  ds_read_b128 v[168:171], v176 offset:10240
  v_exp_f32 v80, v80
  v_exp_f32 v81, v81
  v_exp_f32 v82, v82
  v_exp_f32 v83, v83
  v_cvt_pk_bf16_f32 v104, v80, v81
  v_mfma_f32_32x32x16_bf16 a[64:79], v[160:163], v[96:99], a[64:79]
  ds_read_b128 v[172:175], v176 offset:11264
  v_cvt_pk_bf16_f32 v105, v82, v83
  v_exp_f32 v84, v84
  v_exp_f32 v85, v85
  v_exp_f32 v86, v86
  v_exp_f32 v87, v87
  v_cvt_pk_bf16_f32 v106, v84, v85
  v_mfma_f32_32x32x8_bf16 v[64:79], v[158:159], v[204:205], v[64:79]
  v_cvt_pk_bf16_f32 v107, v86, v87
  v_exp_f32 v88, v88
  v_exp_f32 v89, v89
  v_exp_f32 v90, v90
  v_exp_f32 v91, v91
  v_cvt_pk_bf16_f32 v108, v88, v89
  v_mfma_f32_32x32x16_bf16 a[64:79], v[164:167], v[100:103], a[64:79]
  v_cvt_pk_bf16_f32 v109, v90, v91
  v_exp_f32 v92, v92
  v_exp_f32 v93, v93
  v_exp_f32 v94, v94
  v_exp_f32 v95, v95
  v_cvt_pk_bf16_f32 v110, v92, v93
  v_cvt_pk_bf16_f32 v111, v94, v95
  v_mfma_f32_32x32x16_bf16 v[80:95], v[148:151], v[208:211], 0
  s_waitcnt lgkmcnt(0)
  buffer_load_dwordx4 v238, s[16:19], s34 offen offset:3072 sc1 lds
  v_exp_f32 v64, v64
  v_exp_f32 v65, v65
  v_exp_f32 v66, v66
  v_exp_f32 v67, v67
  v_cvt_pk_bf16_f32 v96, v64, v65
  v_mfma_f32_32x32x16_bf16 a[0:15], v[168:171], v[104:107], a[0:15]
  s_add_u32 s34, s34, 4096
  v_cvt_pk_bf16_f32 v97, v66, v67
  v_exp_f32 v68, v68
  v_exp_f32 v69, v69
  v_exp_f32 v70, v70
  v_exp_f32 v71, v71
  v_cvt_pk_bf16_f32 v98, v68, v69
  v_mfma_f32_32x32x8_bf16 v[80:95], v[158:159], v[212:213], v[80:95]
  v_cvt_pk_bf16_f32 v99, v70, v71
  v_exp_f32 v72, v72
  v_exp_f32 v73, v73
  v_exp_f32 v74, v74
  v_exp_f32 v75, v75
  v_cvt_pk_bf16_f32 v100, v72, v73
  v_mfma_f32_32x32x16_bf16 a[0:15], v[172:175], v[108:111], a[0:15]
  v_cvt_pk_bf16_f32 v101, v74, v75
  v_exp_f32 v76, v76
  v_exp_f32 v77, v77
  v_exp_f32 v78, v78
  v_exp_f32 v79, v79
  v_cvt_pk_bf16_f32 v102, v76, v77
  v_cvt_pk_bf16_f32 v103, v78, v79
  v_mfma_f32_32x32x16_bf16 v[64:79], v[148:151], v[216:219], 0
  v_exp_f32 v80, v80
  v_exp_f32 v81, v81
  v_exp_f32 v82, v82
  v_exp_f32 v83, v83
  v_cvt_pk_bf16_f32 v104, v80, v81
  v_mfma_f32_32x32x16_bf16 a[16:31], v[168:171], v[96:99], a[16:31]
  v_cvt_pk_bf16_f32 v105, v82, v83
  v_exp_f32 v84, v84
  v_exp_f32 v85, v85
  v_exp_f32 v86, v86
  v_exp_f32 v87, v87
  v_cvt_pk_bf16_f32 v106, v84, v85
  v_mfma_f32_32x32x8_bf16 v[64:79], v[158:159], v[220:221], v[64:79]
  v_cvt_pk_bf16_f32 v107, v86, v87
  v_exp_f32 v88, v88
  v_exp_f32 v89, v89
  v_exp_f32 v90, v90
  v_exp_f32 v91, v91
  v_cvt_pk_bf16_f32 v108, v88, v89
  v_mfma_f32_32x32x16_bf16 a[16:31], v[172:175], v[100:103], a[16:31]
  v_cvt_pk_bf16_f32 v109, v90, v91
  v_exp_f32 v92, v92
  v_exp_f32 v93, v93
  v_exp_f32 v94, v94
  v_exp_f32 v95, v95
  v_cvt_pk_bf16_f32 v110, v92, v93
  v_cvt_pk_bf16_f32 v111, v94, v95
  v_mfma_f32_32x32x16_bf16 v[80:95], v[148:151], v[224:227], 0
  ds_read_b128 v[144:147], v176 offset:12288
  v_exp_f32 v64, v64
  v_exp_f32 v65, v65
  v_exp_f32 v66, v66
  v_exp_f32 v67, v67
  v_cvt_pk_bf16_f32 v96, v64, v65
  v_mfma_f32_32x32x16_bf16 a[32:47], v[168:171], v[104:107], a[32:47]
  ds_read_b128 v[152:155], v176 offset:26624
  v_cvt_pk_bf16_f32 v97, v66, v67
  v_exp_f32 v68, v68
  v_exp_f32 v69, v69
  v_exp_f32 v70, v70
  v_exp_f32 v71, v71
  v_cvt_pk_bf16_f32 v98, v68, v69
  v_mfma_f32_32x32x8_bf16 v[80:95], v[158:159], v[228:229], v[80:95]
  v_cvt_pk_bf16_f32 v99, v70, v71
  v_exp_f32 v72, v72
  v_exp_f32 v73, v73
  v_exp_f32 v74, v74
  v_exp_f32 v75, v75
  v_cvt_pk_bf16_f32 v100, v72, v73
  v_mfma_f32_32x32x16_bf16 a[32:47], v[172:175], v[108:111], a[32:47]
  s_waitcnt lgkmcnt(0)
  v_cvt_pk_bf16_f32 v101, v74, v75
  v_exp_f32 v76, v76
  v_exp_f32 v77, v77
  v_exp_f32 v78, v78
  v_exp_f32 v79, v79
  v_cvt_pk_bf16_f32 v102, v76, v77
  v_cvt_pk_bf16_f32 v103, v78, v79
  v_mfma_f32_32x32x16_bf16 v[64:79], v[144:147], v[192:195], 0
  v_exp_f32 v80, v80
  v_exp_f32 v81, v81
  v_exp_f32 v82, v82
  v_exp_f32 v83, v83
  v_cvt_pk_bf16_f32 v104, v80, v81
  v_mfma_f32_32x32x16_bf16 a[48:63], v[168:171], v[96:99], a[48:63]
  v_cvt_pk_bf16_f32 v105, v82, v83
  v_exp_f32 v84, v84
  v_exp_f32 v85, v85
  v_exp_f32 v86, v86
  v_exp_f32 v87, v87
  v_cvt_pk_bf16_f32 v106, v84, v85
  v_mfma_f32_32x32x8_bf16 v[64:79], v[152:153], v[196:197], v[64:79]
  v_cvt_pk_bf16_f32 v107, v86, v87
  v_exp_f32 v88, v88
  v_exp_f32 v89, v89
  v_exp_f32 v90, v90
  v_exp_f32 v91, v91
  v_cvt_pk_bf16_f32 v108, v88, v89
  v_mfma_f32_32x32x16_bf16 a[48:63], v[172:175], v[100:103], a[48:63]
  v_cvt_pk_bf16_f32 v109, v90, v91
  v_exp_f32 v92, v92
  v_exp_f32 v93, v93
  v_exp_f32 v94, v94
  v_exp_f32 v95, v95
  v_cvt_pk_bf16_f32 v110, v92, v93
  v_cvt_pk_bf16_f32 v111, v94, v95
  v_mfma_f32_32x32x16_bf16 v[80:95], v[144:147], v[200:203], 0
  ds_read_b128 v[160:163], v176 offset:13312
  v_exp_f32 v64, v64
  v_exp_f32 v65, v65
  v_exp_f32 v66, v66
  v_exp_f32 v67, v67
  v_cvt_pk_bf16_f32 v96, v64, v65
  v_mfma_f32_32x32x16_bf16 a[64:79], v[168:171], v[104:107], a[64:79]
  ds_read_b128 v[164:167], v176 offset:14336
  v_cvt_pk_bf16_f32 v97, v66, v67
  v_exp_f32 v68, v68
  v_exp_f32 v69, v69
  v_exp_f32 v70, v70
  v_exp_f32 v71, v71
  v_cvt_pk_bf16_f32 v98, v68, v69
  v_mfma_f32_32x32x8_bf16 v[80:95], v[152:153], v[204:205], v[80:95]
  v_cvt_pk_bf16_f32 v99, v70, v71
  v_exp_f32 v72, v72
  v_exp_f32 v73, v73
  v_exp_f32 v74, v74
  v_exp_f32 v75, v75
  v_cvt_pk_bf16_f32 v100, v72, v73
  v_mfma_f32_32x32x16_bf16 a[64:79], v[172:175], v[108:111], a[64:79]
  s_waitcnt lgkmcnt(0)
  v_cvt_pk_bf16_f32 v101, v74, v75
  v_exp_f32 v76, v76
  v_exp_f32 v77, v77
  v_exp_f32 v78, v78
  v_exp_f32 v79, v79
  v_cvt_pk_bf16_f32 v102, v76, v77
  v_cvt_pk_bf16_f32 v103, v78, v79
  v_mfma_f32_32x32x16_bf16 v[64:79], v[144:147], v[208:211], 0
  s_add_u32 m0, s33, 4096
  v_exp_f32 v80, v80
  v_exp_f32 v81, v81
  v_exp_f32 v82, v82
  v_exp_f32 v83, v83
  v_cvt_pk_bf16_f32 v104, v80, v81
  v_mfma_f32_32x32x16_bf16 a[0:15], v[160:163], v[96:99], a[0:15]
  buffer_load_dwordx4 v238, s[16:19], s34 offen offset:0 sc1 lds
  v_cvt_pk_bf16_f32 v105, v82, v83
  v_exp_f32 v84, v84
  v_exp_f32 v85, v85
  v_exp_f32 v86, v86
  v_exp_f32 v87, v87
  v_cvt_pk_bf16_f32 v106, v84, v85
  v_mfma_f32_32x32x8_bf16 v[64:79], v[152:153], v[212:213], v[64:79]
  v_cvt_pk_bf16_f32 v107, v86, v87
  v_exp_f32 v88, v88
  v_exp_f32 v89, v89
  v_exp_f32 v90, v90
  v_exp_f32 v91, v91
  v_cvt_pk_bf16_f32 v108, v88, v89
  v_mfma_f32_32x32x16_bf16 a[0:15], v[164:167], v[100:103], a[0:15]
  v_cvt_pk_bf16_f32 v109, v90, v91
  v_exp_f32 v92, v92
  v_exp_f32 v93, v93
  v_exp_f32 v94, v94
  v_exp_f32 v95, v95
  v_cvt_pk_bf16_f32 v110, v92, v93
  v_cvt_pk_bf16_f32 v111, v94, v95
  v_mfma_f32_32x32x16_bf16 v[80:95], v[144:147], v[216:219], 0
  v_exp_f32 v64, v64
  v_exp_f32 v65, v65
  v_exp_f32 v66, v66
  v_exp_f32 v67, v67
  v_cvt_pk_bf16_f32 v96, v64, v65
  v_mfma_f32_32x32x16_bf16 a[16:31], v[160:163], v[104:107], a[16:31]
  v_cvt_pk_bf16_f32 v97, v66, v67
  v_exp_f32 v68, v68
  v_exp_f32 v69, v69
  v_exp_f32 v70, v70
  v_exp_f32 v71, v71
  v_cvt_pk_bf16_f32 v98, v68, v69
  v_mfma_f32_32x32x8_bf16 v[80:95], v[152:153], v[220:221], v[80:95]
  v_cvt_pk_bf16_f32 v99, v70, v71
  v_exp_f32 v72, v72
  v_exp_f32 v73, v73
  v_exp_f32 v74, v74
  v_exp_f32 v75, v75
  v_cvt_pk_bf16_f32 v100, v72, v73
  v_mfma_f32_32x32x16_bf16 a[16:31], v[164:167], v[108:111], a[16:31]
  v_cvt_pk_bf16_f32 v101, v74, v75
  v_exp_f32 v76, v76
  v_exp_f32 v77, v77
  v_exp_f32 v78, v78
  v_exp_f32 v79, v79
  v_cvt_pk_bf16_f32 v102, v76, v77
  v_cvt_pk_bf16_f32 v103, v78, v79
  v_mfma_f32_32x32x16_bf16 v[64:79], v[144:147], v[224:227], 0
  ds_read_b128 v[148:151], v176 offset:15360
  v_exp_f32 v80, v80
  v_exp_f32 v81, v81
  v_exp_f32 v82, v82
  v_exp_f32 v83, v83
  v_cvt_pk_bf16_f32 v104, v80, v81
  v_mfma_f32_32x32x16_bf16 a[32:47], v[160:163], v[96:99], a[32:47]
  v_cvt_pk_bf16_f32 v105, v82, v83
  v_exp_f32 v84, v84
  v_exp_f32 v85, v85
  v_exp_f32 v86, v86
  v_exp_f32 v87, v87
  v_cvt_pk_bf16_f32 v106, v84, v85
  v_mfma_f32_32x32x8_bf16 v[64:79], v[152:153], v[228:229], v[64:79]
  v_cvt_pk_bf16_f32 v107, v86, v87
  v_exp_f32 v88, v88
  v_exp_f32 v89, v89
  v_exp_f32 v90, v90
  v_exp_f32 v91, v91
  v_cvt_pk_bf16_f32 v108, v88, v89
  v_mfma_f32_32x32x16_bf16 a[32:47], v[164:167], v[100:103], a[32:47]
  s_waitcnt lgkmcnt(0)
  v_cvt_pk_bf16_f32 v109, v90, v91
  v_exp_f32 v92, v92
  v_exp_f32 v93, v93
  v_exp_f32 v94, v94
  v_exp_f32 v95, v95
  v_cvt_pk_bf16_f32 v110, v92, v93
  v_cvt_pk_bf16_f32 v111, v94, v95
  v_mfma_f32_32x32x16_bf16 v[80:95], v[148:151], v[192:195], 0
  v_exp_f32 v64, v64
  v_exp_f32 v65, v65
  v_exp_f32 v66, v66
  v_exp_f32 v67, v67
  v_cvt_pk_bf16_f32 v96, v64, v65
  v_mfma_f32_32x32x16_bf16 a[48:63], v[160:163], v[104:107], a[48:63]
  v_cvt_pk_bf16_f32 v97, v66, v67
  v_exp_f32 v68, v68
  v_exp_f32 v69, v69
  v_exp_f32 v70, v70
  v_exp_f32 v71, v71
  v_cvt_pk_bf16_f32 v98, v68, v69
  v_mfma_f32_32x32x8_bf16 v[80:95], v[154:155], v[196:197], v[80:95]
  v_cvt_pk_bf16_f32 v99, v70, v71
  v_exp_f32 v72, v72
  v_exp_f32 v73, v73
  v_exp_f32 v74, v74
  v_exp_f32 v75, v75
  v_cvt_pk_bf16_f32 v100, v72, v73
  v_mfma_f32_32x32x16_bf16 a[48:63], v[164:167], v[108:111], a[48:63]
  v_cvt_pk_bf16_f32 v101, v74, v75
  v_exp_f32 v76, v76
  v_exp_f32 v77, v77
  v_exp_f32 v78, v78
  v_exp_f32 v79, v79
  v_cvt_pk_bf16_f32 v102, v76, v77
  v_cvt_pk_bf16_f32 v103, v78, v79
  v_mfma_f32_32x32x16_bf16 v[64:79], v[148:151], v[200:203], 0
  ds_read_b128 v[168:171], v176 offset:16384
  v_exp_f32 v80, v80
  v_exp_f32 v81, v81
  v_exp_f32 v82, v82
  v_exp_f32 v83, v83
  v_cvt_pk_bf16_f32 v104, v80, v81
  v_mfma_f32_32x32x16_bf16 a[64:79], v[160:163], v[96:99], a[64:79]
  ds_read_b128 v[172:175], v176 offset:17408
  v_cvt_pk_bf16_f32 v105, v82, v83
  v_exp_f32 v84, v84
  v_exp_f32 v85, v85
  v_exp_f32 v86, v86
  v_exp_f32 v87, v87
  v_cvt_pk_bf16_f32 v106, v84, v85
  v_mfma_f32_32x32x8_bf16 v[64:79], v[154:155], v[204:205], v[64:79]
  v_cvt_pk_bf16_f32 v107, v86, v87
  v_exp_f32 v88, v88
  v_exp_f32 v89, v89
  v_exp_f32 v90, v90
  v_exp_f32 v91, v91
  v_cvt_pk_bf16_f32 v108, v88, v89
  v_mfma_f32_32x32x16_bf16 a[64:79], v[164:167], v[100:103], a[64:79]
  v_cvt_pk_bf16_f32 v109, v90, v91
  v_exp_f32 v92, v92
  v_exp_f32 v93, v93
  v_exp_f32 v94, v94
  v_exp_f32 v95, v95
  v_cvt_pk_bf16_f32 v110, v92, v93
  v_cvt_pk_bf16_f32 v111, v94, v95
  v_mfma_f32_32x32x16_bf16 v[80:95], v[148:151], v[208:211], 0
  s_waitcnt lgkmcnt(0)
  buffer_load_dwordx4 v238, s[16:19], s34 offen offset:1024 sc1 lds
  v_exp_f32 v64, v64
  v_exp_f32 v65, v65
  v_exp_f32 v66, v66
  v_exp_f32 v67, v67
  v_cvt_pk_bf16_f32 v96, v64, v65
  v_mfma_f32_32x32x16_bf16 a[0:15], v[168:171], v[104:107], a[0:15]
  v_cvt_pk_bf16_f32 v97, v66, v67
  v_exp_f32 v68, v68
  v_exp_f32 v69, v69
  v_exp_f32 v70, v70
  v_exp_f32 v71, v71
  v_cvt_pk_bf16_f32 v98, v68, v69
  v_mfma_f32_32x32x8_bf16 v[80:95], v[154:155], v[212:213], v[80:95]
  v_cvt_pk_bf16_f32 v99, v70, v71
  v_exp_f32 v72, v72
  v_exp_f32 v73, v73
  v_exp_f32 v74, v74
  v_exp_f32 v75, v75
  v_cvt_pk_bf16_f32 v100, v72, v73
  v_mfma_f32_32x32x16_bf16 a[0:15], v[172:175], v[108:111], a[0:15]
  v_cvt_pk_bf16_f32 v101, v74, v75
  v_exp_f32 v76, v76
  v_exp_f32 v77, v77
  v_exp_f32 v78, v78
  v_exp_f32 v79, v79
  v_cvt_pk_bf16_f32 v102, v76, v77
  v_cvt_pk_bf16_f32 v103, v78, v79
  v_mfma_f32_32x32x16_bf16 v[64:79], v[148:151], v[216:219], 0
  v_exp_f32 v80, v80
  v_exp_f32 v81, v81
  v_exp_f32 v82, v82
  v_exp_f32 v83, v83
  v_cvt_pk_bf16_f32 v104, v80, v81
  v_mfma_f32_32x32x16_bf16 a[16:31], v[168:171], v[96:99], a[16:31]
  v_cvt_pk_bf16_f32 v105, v82, v83
  v_exp_f32 v84, v84
  v_exp_f32 v85, v85
  v_exp_f32 v86, v86
  v_exp_f32 v87, v87
  v_cvt_pk_bf16_f32 v106, v84, v85
  v_mfma_f32_32x32x8_bf16 v[64:79], v[154:155], v[220:221], v[64:79]
  v_cvt_pk_bf16_f32 v107, v86, v87
  v_exp_f32 v88, v88
  v_exp_f32 v89, v89
  v_exp_f32 v90, v90
  v_exp_f32 v91, v91
  v_cvt_pk_bf16_f32 v108, v88, v89
  v_mfma_f32_32x32x16_bf16 a[16:31], v[172:175], v[100:103], a[16:31]
  v_cvt_pk_bf16_f32 v109, v90, v91
  v_exp_f32 v92, v92
  v_exp_f32 v93, v93
  v_exp_f32 v94, v94
  v_exp_f32 v95, v95
  v_cvt_pk_bf16_f32 v110, v92, v93
  v_cvt_pk_bf16_f32 v111, v94, v95
  v_mfma_f32_32x32x16_bf16 v[80:95], v[148:151], v[224:227], 0
  ds_read_b128 v[144:147], v176 offset:18432
  v_exp_f32 v64, v64
  v_exp_f32 v65, v65
  v_exp_f32 v66, v66
  v_exp_f32 v67, v67
  v_cvt_pk_bf16_f32 v96, v64, v65
  v_mfma_f32_32x32x16_bf16 a[32:47], v[168:171], v[104:107], a[32:47]
  ds_read_b128 v[156:159], v176 offset:27648
  v_cvt_pk_bf16_f32 v97, v66, v67
  v_exp_f32 v68, v68
  v_exp_f32 v69, v69
  v_exp_f32 v70, v70
  v_exp_f32 v71, v71
  v_cvt_pk_bf16_f32 v98, v68, v69
  v_mfma_f32_32x32x8_bf16 v[80:95], v[154:155], v[228:229], v[80:95]
  v_cvt_pk_bf16_f32 v99, v70, v71
  v_exp_f32 v72, v72
  v_exp_f32 v73, v73
  v_exp_f32 v74, v74
  v_exp_f32 v75, v75
  v_cvt_pk_bf16_f32 v100, v72, v73
  v_mfma_f32_32x32x16_bf16 a[32:47], v[172:175], v[108:111], a[32:47]
  s_waitcnt lgkmcnt(0)
  v_cvt_pk_bf16_f32 v101, v74, v75
  v_exp_f32 v76, v76
  v_exp_f32 v77, v77
  v_exp_f32 v78, v78
  v_exp_f32 v79, v79
  v_cvt_pk_bf16_f32 v102, v76, v77
  v_cvt_pk_bf16_f32 v103, v78, v79
  v_mfma_f32_32x32x16_bf16 v[64:79], v[144:147], v[192:195], 0
  v_exp_f32 v80, v80
  v_exp_f32 v81, v81
  v_exp_f32 v82, v82
  v_exp_f32 v83, v83
  v_cvt_pk_bf16_f32 v104, v80, v81
  v_mfma_f32_32x32x16_bf16 a[48:63], v[168:171], v[96:99], a[48:63]
  v_cvt_pk_bf16_f32 v105, v82, v83
  v_exp_f32 v84, v84
  v_exp_f32 v85, v85
  v_exp_f32 v86, v86
  v_exp_f32 v87, v87
  v_cvt_pk_bf16_f32 v106, v84, v85
  v_mfma_f32_32x32x8_bf16 v[64:79], v[156:157], v[196:197], v[64:79]
  v_cvt_pk_bf16_f32 v107, v86, v87
  v_exp_f32 v88, v88
  v_exp_f32 v89, v89
  v_exp_f32 v90, v90
  v_exp_f32 v91, v91
  v_cvt_pk_bf16_f32 v108, v88, v89
  v_mfma_f32_32x32x16_bf16 a[48:63], v[172:175], v[100:103], a[48:63]
  v_cvt_pk_bf16_f32 v109, v90, v91
  v_exp_f32 v92, v92
  v_exp_f32 v93, v93
  v_exp_f32 v94, v94
  v_exp_f32 v95, v95
  v_cvt_pk_bf16_f32 v110, v92, v93
  v_cvt_pk_bf16_f32 v111, v94, v95
  v_mfma_f32_32x32x16_bf16 v[80:95], v[144:147], v[200:203], 0
  ds_read_b128 v[160:163], v176 offset:19456
  v_exp_f32 v64, v64
  v_exp_f32 v65, v65
  v_exp_f32 v66, v66
  v_exp_f32 v67, v67
  v_cvt_pk_bf16_f32 v96, v64, v65
  v_mfma_f32_32x32x16_bf16 a[64:79], v[168:171], v[104:107], a[64:79]
  ds_read_b128 v[164:167], v176 offset:20480
  v_cvt_pk_bf16_f32 v97, v66, v67
  v_exp_f32 v68, v68
  v_exp_f32 v69, v69
  v_exp_f32 v70, v70
  v_exp_f32 v71, v71
  v_cvt_pk_bf16_f32 v98, v68, v69
  v_mfma_f32_32x32x8_bf16 v[80:95], v[156:157], v[204:205], v[80:95]
  v_cvt_pk_bf16_f32 v99, v70, v71
  v_exp_f32 v72, v72
  v_exp_f32 v73, v73
  v_exp_f32 v74, v74
  v_exp_f32 v75, v75
  v_cvt_pk_bf16_f32 v100, v72, v73
  v_mfma_f32_32x32x16_bf16 a[64:79], v[172:175], v[108:111], a[64:79]
  v_cvt_pk_bf16_f32 v101, v74, v75
  v_exp_f32 v76, v76
  v_exp_f32 v77, v77
  v_exp_f32 v78, v78
  v_exp_f32 v79, v79
  v_cvt_pk_bf16_f32 v102, v76, v77
  v_cvt_pk_bf16_f32 v103, v78, v79
  v_mfma_f32_32x32x16_bf16 v[64:79], v[144:147], v[208:211], 0
  s_waitcnt lgkmcnt(0)
  buffer_load_dwordx4 v238, s[16:19], s34 offen offset:2048 sc1 lds
  v_exp_f32 v80, v80
  v_exp_f32 v81, v81
  v_exp_f32 v82, v82
  v_exp_f32 v83, v83
  v_cvt_pk_bf16_f32 v104, v80, v81
  v_mfma_f32_32x32x16_bf16 a[0:15], v[160:163], v[96:99], a[0:15]
  s_add_u32 s34, s34, 24576
  v_cvt_pk_bf16_f32 v105, v82, v83
  v_exp_f32 v84, v84
  v_exp_f32 v85, v85
  v_exp_f32 v86, v86
  v_exp_f32 v87, v87
  v_cvt_pk_bf16_f32 v106, v84, v85
  v_mfma_f32_32x32x8_bf16 v[64:79], v[156:157], v[212:213], v[64:79]
  v_cvt_pk_bf16_f32 v107, v86, v87
  v_exp_f32 v88, v88
  v_exp_f32 v89, v89
  v_exp_f32 v90, v90
  v_exp_f32 v91, v91
  v_cvt_pk_bf16_f32 v108, v88, v89
  v_mfma_f32_32x32x16_bf16 a[0:15], v[164:167], v[100:103], a[0:15]
  v_cvt_pk_bf16_f32 v109, v90, v91
  v_exp_f32 v92, v92
  v_exp_f32 v93, v93
  v_exp_f32 v94, v94
  v_exp_f32 v95, v95
  v_cvt_pk_bf16_f32 v110, v92, v93
  v_cvt_pk_bf16_f32 v111, v94, v95
  v_mfma_f32_32x32x16_bf16 v[80:95], v[144:147], v[216:219], 0
  v_exp_f32 v64, v64
  v_exp_f32 v65, v65
  v_exp_f32 v66, v66
  v_exp_f32 v67, v67
  v_cvt_pk_bf16_f32 v96, v64, v65
  v_mfma_f32_32x32x16_bf16 a[16:31], v[160:163], v[104:107], a[16:31]
  v_cvt_pk_bf16_f32 v97, v66, v67
  v_exp_f32 v68, v68
  v_exp_f32 v69, v69
  v_exp_f32 v70, v70
  v_exp_f32 v71, v71
  v_cvt_pk_bf16_f32 v98, v68, v69
  v_mfma_f32_32x32x8_bf16 v[80:95], v[156:157], v[220:221], v[80:95]
  v_cvt_pk_bf16_f32 v99, v70, v71
  v_exp_f32 v72, v72
  v_exp_f32 v73, v73
  v_exp_f32 v74, v74
  v_exp_f32 v75, v75
  v_cvt_pk_bf16_f32 v100, v72, v73
  v_mfma_f32_32x32x16_bf16 a[16:31], v[164:167], v[108:111], a[16:31]
  v_cvt_pk_bf16_f32 v101, v74, v75
  v_exp_f32 v76, v76
  v_exp_f32 v77, v77
  v_exp_f32 v78, v78
  v_exp_f32 v79, v79
  v_cvt_pk_bf16_f32 v102, v76, v77
  v_cvt_pk_bf16_f32 v103, v78, v79
  v_mfma_f32_32x32x16_bf16 v[64:79], v[144:147], v[224:227], 0
  ds_read_b128 v[148:151], v176 offset:21504
  v_exp_f32 v80, v80
  v_exp_f32 v81, v81
  v_exp_f32 v82, v82
  v_exp_f32 v83, v83
  v_cvt_pk_bf16_f32 v104, v80, v81
  v_mfma_f32_32x32x16_bf16 a[32:47], v[160:163], v[96:99], a[32:47]
  v_cvt_pk_bf16_f32 v105, v82, v83
  v_exp_f32 v84, v84
  v_exp_f32 v85, v85
  v_exp_f32 v86, v86
  v_exp_f32 v87, v87
  v_cvt_pk_bf16_f32 v106, v84, v85
  v_mfma_f32_32x32x8_bf16 v[64:79], v[156:157], v[228:229], v[64:79]
  v_cvt_pk_bf16_f32 v107, v86, v87
  v_exp_f32 v88, v88
  v_exp_f32 v89, v89
  v_exp_f32 v90, v90
  v_exp_f32 v91, v91
  v_cvt_pk_bf16_f32 v108, v88, v89
  v_mfma_f32_32x32x16_bf16 a[32:47], v[164:167], v[100:103], a[32:47]
  s_waitcnt lgkmcnt(0)
  v_cvt_pk_bf16_f32 v109, v90, v91
  v_exp_f32 v92, v92
  v_exp_f32 v93, v93
  v_exp_f32 v94, v94
  v_exp_f32 v95, v95
  v_cvt_pk_bf16_f32 v110, v92, v93
  v_cvt_pk_bf16_f32 v111, v94, v95
  v_mfma_f32_32x32x16_bf16 v[80:95], v[148:151], v[192:195], 0
  v_exp_f32 v64, v64
  v_exp_f32 v65, v65
  v_exp_f32 v66, v66
  v_exp_f32 v67, v67
  v_cvt_pk_bf16_f32 v96, v64, v65
  v_mfma_f32_32x32x16_bf16 a[48:63], v[160:163], v[104:107], a[48:63]
  v_cvt_pk_bf16_f32 v97, v66, v67
  v_exp_f32 v68, v68
  v_exp_f32 v69, v69
  v_exp_f32 v70, v70
  v_exp_f32 v71, v71
  v_cvt_pk_bf16_f32 v98, v68, v69
  v_mfma_f32_32x32x8_bf16 v[80:95], v[158:159], v[196:197], v[80:95]
  v_cvt_pk_bf16_f32 v99, v70, v71
  v_exp_f32 v72, v72
  v_exp_f32 v73, v73
  v_exp_f32 v74, v74
  v_exp_f32 v75, v75
  v_cvt_pk_bf16_f32 v100, v72, v73
  v_mfma_f32_32x32x16_bf16 a[48:63], v[164:167], v[108:111], a[48:63]
  v_cvt_pk_bf16_f32 v101, v74, v75
  v_exp_f32 v76, v76
  v_exp_f32 v77, v77
  v_exp_f32 v78, v78
  v_exp_f32 v79, v79
  v_cvt_pk_bf16_f32 v102, v76, v77
  v_cvt_pk_bf16_f32 v103, v78, v79
  v_mfma_f32_32x32x16_bf16 v[64:79], v[148:151], v[200:203], 0
  ds_read_b128 v[168:171], v176 offset:22528
  v_exp_f32 v80, v80
  v_exp_f32 v81, v81
  v_exp_f32 v82, v82
  v_exp_f32 v83, v83
  v_cvt_pk_bf16_f32 v104, v80, v81
  v_mfma_f32_32x32x16_bf16 a[64:79], v[160:163], v[96:99], a[64:79]
  ds_read_b128 v[172:175], v176 offset:23552
  v_cvt_pk_bf16_f32 v105, v82, v83
  v_exp_f32 v84, v84
  v_exp_f32 v85, v85
  v_exp_f32 v86, v86
  v_exp_f32 v87, v87
  v_cvt_pk_bf16_f32 v106, v84, v85
  v_mfma_f32_32x32x8_bf16 v[64:79], v[158:159], v[204:205], v[64:79]
  v_cvt_pk_bf16_f32 v107, v86, v87
  v_exp_f32 v88, v88
  v_exp_f32 v89, v89
  v_exp_f32 v90, v90
  v_exp_f32 v91, v91
  v_cvt_pk_bf16_f32 v108, v88, v89
  v_mfma_f32_32x32x16_bf16 a[64:79], v[164:167], v[100:103], a[64:79]
  v_cvt_pk_bf16_f32 v109, v90, v91
  v_exp_f32 v92, v92
  v_exp_f32 v93, v93
  v_exp_f32 v94, v94
  v_exp_f32 v95, v95
  v_cvt_pk_bf16_f32 v110, v92, v93
  v_cvt_pk_bf16_f32 v111, v94, v95
  v_mfma_f32_32x32x16_bf16 v[80:95], v[148:151], v[208:211], 0
  s_waitcnt lgkmcnt(0)
  v_exp_f32 v64, v64
  v_exp_f32 v65, v65
  v_exp_f32 v66, v66
  v_exp_f32 v67, v67
  v_cvt_pk_bf16_f32 v96, v64, v65
  v_mfma_f32_32x32x16_bf16 a[0:15], v[168:171], v[104:107], a[0:15]
  v_cvt_pk_bf16_f32 v97, v66, v67
  v_exp_f32 v68, v68
  v_exp_f32 v69, v69
  v_exp_f32 v70, v70
  v_exp_f32 v71, v71
  v_cvt_pk_bf16_f32 v98, v68, v69
  v_mfma_f32_32x32x8_bf16 v[80:95], v[158:159], v[212:213], v[80:95]
  v_cvt_pk_bf16_f32 v99, v70, v71
  v_exp_f32 v72, v72
  v_exp_f32 v73, v73
  v_exp_f32 v74, v74
  v_exp_f32 v75, v75
  v_cvt_pk_bf16_f32 v100, v72, v73
  v_mfma_f32_32x32x16_bf16 a[0:15], v[172:175], v[108:111], a[0:15]
  v_cvt_pk_bf16_f32 v101, v74, v75
  v_exp_f32 v76, v76
  v_exp_f32 v77, v77
  v_exp_f32 v78, v78
  v_exp_f32 v79, v79
  v_cvt_pk_bf16_f32 v102, v76, v77
  v_cvt_pk_bf16_f32 v103, v78, v79
  v_mfma_f32_32x32x16_bf16 v[64:79], v[148:151], v[216:219], 0
  v_exp_f32 v80, v80
  v_exp_f32 v81, v81
  v_exp_f32 v82, v82
  v_exp_f32 v83, v83
  v_cvt_pk_bf16_f32 v104, v80, v81
  v_mfma_f32_32x32x16_bf16 a[16:31], v[168:171], v[96:99], a[16:31]
  v_cvt_pk_bf16_f32 v105, v82, v83
  v_exp_f32 v84, v84
  v_exp_f32 v85, v85
  v_exp_f32 v86, v86
  v_exp_f32 v87, v87
  v_cvt_pk_bf16_f32 v106, v84, v85
  v_mfma_f32_32x32x8_bf16 v[64:79], v[158:159], v[220:221], v[64:79]
  v_cvt_pk_bf16_f32 v107, v86, v87
  v_exp_f32 v88, v88
  v_exp_f32 v89, v89
  v_exp_f32 v90, v90
  v_exp_f32 v91, v91
  v_cvt_pk_bf16_f32 v108, v88, v89
  v_mfma_f32_32x32x16_bf16 a[16:31], v[172:175], v[100:103], a[16:31]
  v_cvt_pk_bf16_f32 v109, v90, v91
  v_exp_f32 v92, v92
  v_exp_f32 v93, v93
  v_exp_f32 v94, v94
  v_exp_f32 v95, v95
  v_cvt_pk_bf16_f32 v110, v92, v93
  v_cvt_pk_bf16_f32 v111, v94, v95
  v_mfma_f32_32x32x16_bf16 v[80:95], v[148:151], v[224:227], 0
  ds_read_b128 v[144:147], v177 offset:0
  v_exp_f32 v64, v64
  v_exp_f32 v65, v65
  v_exp_f32 v66, v66
  v_exp_f32 v67, v67
  v_cvt_pk_bf16_f32 v96, v64, v65
  v_mfma_f32_32x32x16_bf16 a[32:47], v[168:171], v[104:107], a[32:47]
  ds_read_b128 v[152:155], v177 offset:24576
  v_cvt_pk_bf16_f32 v97, v66, v67
  v_exp_f32 v68, v68
  v_exp_f32 v69, v69
  v_exp_f32 v70, v70
  v_exp_f32 v71, v71
  v_cvt_pk_bf16_f32 v98, v68, v69
  v_mfma_f32_32x32x8_bf16 v[80:95], v[158:159], v[228:229], v[80:95]
  v_cvt_pk_bf16_f32 v99, v70, v71
  v_exp_f32 v72, v72
  v_exp_f32 v73, v73
  v_exp_f32 v74, v74
  v_exp_f32 v75, v75
  v_cvt_pk_bf16_f32 v100, v72, v73
  v_mfma_f32_32x32x16_bf16 a[32:47], v[172:175], v[108:111], a[32:47]
  s_waitcnt lgkmcnt(0)
  v_cvt_pk_bf16_f32 v101, v74, v75
  v_exp_f32 v76, v76
  v_exp_f32 v77, v77
  v_exp_f32 v78, v78
  v_exp_f32 v79, v79
  v_cvt_pk_bf16_f32 v102, v76, v77
  v_cvt_pk_bf16_f32 v103, v78, v79
  v_mfma_f32_32x32x16_bf16 v[64:79], v[144:147], v[192:195], 0
  v_exp_f32 v80, v80
  v_exp_f32 v81, v81
  v_exp_f32 v82, v82
  v_exp_f32 v83, v83
  v_cvt_pk_bf16_f32 v104, v80, v81
  v_mfma_f32_32x32x16_bf16 a[48:63], v[168:171], v[96:99], a[48:63]
  s_add_u32 s31, s38, 65536
  v_cvt_pk_bf16_f32 v105, v82, v83
  v_exp_f32 v84, v84
  v_exp_f32 v85, v85
  v_exp_f32 v86, v86
  v_exp_f32 v87, v87
  v_cvt_pk_bf16_f32 v106, v84, v85
  v_mfma_f32_32x32x8_bf16 v[64:79], v[152:153], v[196:197], v[64:79]
  s_and_b32 s31, s31, 0x1ffff
  v_cvt_pk_bf16_f32 v107, v86, v87
  v_exp_f32 v88, v88
  v_exp_f32 v89, v89
  v_exp_f32 v90, v90
  v_exp_f32 v91, v91
  v_cvt_pk_bf16_f32 v108, v88, v89
  v_mfma_f32_32x32x16_bf16 a[48:63], v[172:175], v[100:103], a[48:63]
  s_add_u32 s33, s38, s61
  v_cvt_pk_bf16_f32 v109, v90, v91
  v_exp_f32 v92, v92
  v_exp_f32 v93, v93
  v_exp_f32 v94, v94
  v_exp_f32 v95, v95
  v_cvt_pk_bf16_f32 v110, v92, v93
  v_cvt_pk_bf16_f32 v111, v94, v95
  v_mfma_f32_32x32x16_bf16 v[80:95], v[144:147], v[200:203], 0
  s_add_u32 s38, s38, 32768
  ds_read_b128 v[160:163], v177 offset:1024
  v_exp_f32 v64, v64
  v_exp_f32 v65, v65
  v_exp_f32 v66, v66
  v_exp_f32 v67, v67
  v_cvt_pk_bf16_f32 v96, v64, v65
  v_mfma_f32_32x32x16_bf16 a[64:79], v[168:171], v[104:107], a[64:79]
  s_and_b32 s38, s38, 0x1ffff
  ds_read_b128 v[164:167], v177 offset:2048
  v_cvt_pk_bf16_f32 v97, v66, v67
  v_exp_f32 v68, v68
  v_exp_f32 v69, v69
  v_exp_f32 v70, v70
  v_exp_f32 v71, v71
  v_cvt_pk_bf16_f32 v98, v68, v69
  v_mfma_f32_32x32x8_bf16 v[80:95], v[152:153], v[204:205], v[80:95]
  s_sub_u32 s37, s37, 1
  v_cvt_pk_bf16_f32 v99, v70, v71
  v_exp_f32 v72, v72
  v_exp_f32 v73, v73
  v_exp_f32 v74, v74
  v_exp_f32 v75, v75
  v_cvt_pk_bf16_f32 v100, v72, v73
  v_mfma_f32_32x32x16_bf16 a[64:79], v[172:175], v[108:111], a[64:79]
  s_bitcmp0_b32 s47, s37
  v_cvt_pk_bf16_f32 v101, v74, v75
  v_exp_f32 v76, v76
  v_exp_f32 v77, v77
  v_exp_f32 v78, v78
  v_exp_f32 v79, v79
  v_cvt_pk_bf16_f32 v102, v76, v77
  v_cvt_pk_bf16_f32 v103, v78, v79
  v_mov_b32 v176, v177
  v_add_u32 v177, s31, v236
  s_cbranch_scc1 L_Bloop5
  s_cmp_eq_u32 s37, 0
  s_cbranch_scc1 L_Bend
  s_cmp_eq_u32 s37, 6
  s_cbranch_scc1 L_pb5
  s_mov_b32 s32, 29696
  buffer_load_dwordx4 v[20:23], v236, s[24:27], s32 offen sc1
  buffer_load_dword v24, v9, s[24:27], s62 offen sc1
  s_branch L_Bloop5
L_pb5:
  s_cmp_eq_u32 s45, 0
  s_cbranch_scc1 L_Bloop5
  s_mov_b32 s45, 0
  s_min_u32 s31, s3, 255
  s_lshl_b32 s31, s31, 2
  s_add_u32 s31, s31, 29696
  v_mov_b32 v6, s100
  v_mov_b32 v7, 0
  s_mov_b64 exec, 1
  buffer_store_dword v6, v7, s[24:27], s31 offen offset:0 sc1
  s_mov_b64 exec, -1
  s_branch L_Bloop5
L_Bend:
  s_cmp_lg_u32 s30, 0
  s_cbranch_scc1 L_Bend2
  s_waitcnt vmcnt(0)
  v_xor_b32 v20, s100, v20
  v_xor_b32 v21, s100, v21
  v_xor_b32 v22, s100, v22
  v_xor_b32 v23, s100, v23
  v_or3_b32 v20, v20, v21, v22
  v_or_b32 v20, v20, v23
  v_cmp_ne_u32 vcc, 0, v20
  v_cmp_eq_u32 s[56:57], s100, v24
  s_nop 0
  s_andn2_b32 s31, s63, s56
  s_or_b32 s31, s31, vcc_lo
  s_cbranch_scc0 L_Bend2
  s_mov_b32 s34, 262144
L_Bend2l:
  s_mov_b32 s32, 29696
  buffer_load_dwordx4 v[20:23], v236, s[24:27], s32 offen sc1
  buffer_load_dword v24, v9, s[24:27], s62 offen sc1
  s_sub_u32 s34, s34, 1
  s_cbranch_scc1 L_Bend2
  s_waitcnt vmcnt(0)
  v_xor_b32 v20, s100, v20
  v_xor_b32 v21, s100, v21
  v_xor_b32 v22, s100, v22
  v_xor_b32 v23, s100, v23
  v_or3_b32 v20, v20, v21, v22
  v_or_b32 v20, v20, v23
  v_cmp_ne_u32 vcc, 0, v20
  v_cmp_eq_u32 s[56:57], s100, v24
  s_nop 0
  s_andn2_b32 s31, s63, s56
  s_or_b32 s31, s31, vcc_lo
  s_cbranch_scc1 L_Bend2l
  s_branch L_Bend2
L_Bend2:
  s_waitcnt vmcnt(0) lgkmcnt(0)
  s_barrier
L_epiB:
  s_add_u32 s64, s6, 54525952
  s_addc_u32 s65, s7, 0
  s_and_b32 s65, s65, 0xffff
  s_mov_b32 s66, 6062080
  s_mov_b32 s67, 0x20000
  v_mov_b32 v10, v236
  v_add_u32 v11, 149504, v236
  v_add_u32 v27, 4096, v236
  s_mul_i32 s38, s30, 5120
  s_add_u32 s38, s38, 16384
  s_lshl_b32 s46, s30, 12
  s_add_u32 m0, s38, 0
  s_nop 0
  buffer_load_dwordx4 v10, s[64:67], s58 offen offset:0 sc1 lds
  buffer_load_dwordx4 v10, s[64:67], s58 offen offset:1024 sc1 lds
  buffer_load_dwordx4 v10, s[64:67], s58 offen offset:2048 sc1 lds
  buffer_load_dwordx4 v10, s[64:67], s58 offen offset:3072 sc1 lds
  s_add_u32 m0, s38, 4096
  s_nop 0
  buffer_load_dwordx4 v27, s[64:67], s58 offen sc1 lds
  s_add_u32 s58, s58, 10240
  s_add_u32 m0, s46, 0
  s_nop 0
  buffer_load_dwordx4 v10, s[12:15], s59 offen offset:0 sc1 lds
  buffer_load_dwordx4 v10, s[12:15], s59 offen offset:1024 sc1 lds
  buffer_load_dwordx4 v11, s[12:15], s59 offen offset:2048 sc1 lds
  buffer_load_dwordx4 v11, s[12:15], s59 offen offset:3072 sc1 lds
  s_add_u32 s59, s59, 2048
  s_mov_b32 s31, 1904214016
  s_mov_b64 s[56:57], 0
  s_cmp_le_u32 s40, 0
  s_cbranch_scc1 L_B_chk
  v_accvgpr_read_b32 v240, a10
  v_cmp_ngt_f32 vcc, s31, v240
  s_nop 1
  s_or_b64 s[56:57], s[56:57], vcc
  v_cmp_nlt_f32 vcc, 0.5, v240
  s_nop 1
  s_or_b64 s[56:57], s[56:57], vcc
  s_cmp_le_u32 s40, 1
  s_cbranch_scc1 L_B_chk
  v_accvgpr_read_b32 v241, a26
  v_cmp_ngt_f32 vcc, s31, v241
  s_nop 1
  s_or_b64 s[56:57], s[56:57], vcc
  v_cmp_nlt_f32 vcc, 0.5, v241
  s_nop 1
  s_or_b64 s[56:57], s[56:57], vcc
  s_cmp_le_u32 s40, 2
  s_cbranch_scc1 L_B_chk
  v_accvgpr_read_b32 v242, a42
  v_cmp_ngt_f32 vcc, s31, v242
  s_nop 1
  s_or_b64 s[56:57], s[56:57], vcc
  v_cmp_nlt_f32 vcc, 0.5, v242
  s_nop 1
  s_or_b64 s[56:57], s[56:57], vcc
  s_cmp_le_u32 s40, 3
  s_cbranch_scc1 L_B_chk
  v_accvgpr_read_b32 v243, a58
  v_cmp_ngt_f32 vcc, s31, v243
  s_nop 1
  s_or_b64 s[56:57], s[56:57], vcc
  v_cmp_nlt_f32 vcc, 0.5, v243
  s_nop 1
  s_or_b64 s[56:57], s[56:57], vcc
  s_cmp_le_u32 s40, 4
  s_cbranch_scc1 L_B_chk
  v_accvgpr_read_b32 v244, a74
  v_cmp_ngt_f32 vcc, s31, v244
  s_nop 1
  s_or_b64 s[56:57], s[56:57], vcc
  v_cmp_nlt_f32 vcc, 0.5, v244
  s_nop 1
  s_or_b64 s[56:57], s[56:57], vcc
L_B_chk:
  s_cmp_lg_u64 s[56:57], 0
  s_cselect_b32 s31, 1, 0
  v_mov_b32 v7, s31
  s_lshl_b32 s31, s30, 2
  s_add_u32 s31, s31, 163824
  v_mov_b32 v6, s31
  ds_write_b32 v6, v7
  v_and_b32 v3, 31, v2
  v_lshlrev_b32 v3, 4, v3
  v_add_u32 v3, 110592, v3
  v_lshrrev_b32 v12, 5, v2
  v_mul_u32_u24 v12, 5, v12
  s_mul_i32 s31, s30, s40
  s_mul_i32 s31, s31, 10
  v_add_u32 v12, s31, v12
  s_cmp_le_u32 s40, 0
  s_cbranch_scc1 L_cu1
  s_add_u32 m0, s38, 36864
  v_rcp_f32 v13, v240
  v_accvgpr_read_b32 v64, a0
  v_accvgpr_read_b32 v65, a1
  buffer_load_dwordx4 v10, s[64:67], s58 offen offset:0 sc1 lds
  v_accvgpr_read_b32 v66, a2
  v_accvgpr_read_b32 v67, a3
  v_accvgpr_read_b32 v68, a4
  v_accvgpr_read_b32 v69, a5
  v_accvgpr_read_b32 v70, a6
  v_accvgpr_read_b32 v71, a7
  v_accvgpr_read_b32 v72, a8
  v_accvgpr_read_b32 v73, a9
  v_mul_f32 v64, v64, v13
  v_mul_f32 v65, v65, v13
  buffer_load_dwordx4 v10, s[64:67], s58 offen offset:1024 sc1 lds
  v_mul_f32 v66, v66, v13
  v_mul_f32 v67, v67, v13
  v_mul_f32 v68, v68, v13
  v_mul_f32 v69, v69, v13
  v_mul_f32 v70, v70, v13
  v_mul_f32 v71, v71, v13
  v_mul_f32 v72, v72, v13
  v_mul_f32 v73, v73, v13
  v_cvt_pk_bf16_f32 v74, v64, v65
  v_add_u32 v14, 0, v12
  buffer_load_dwordx4 v10, s[64:67], s58 offen offset:2048 sc1 lds
  v_lshrrev_b32 v15, 2, v14
  v_and_b32 v14, 3, v14
  v_lshl_add_u32 v15, v15, 9, v3
  v_lshl_add_u32 v80, v14, 2, v15
  ds_write_b32 v80, v74
  v_cvt_pk_bf16_f32 v75, v66, v67
  v_add_u32 v14, 1, v12
  v_lshrrev_b32 v15, 2, v14
  v_and_b32 v14, 3, v14
  v_lshl_add_u32 v15, v15, 9, v3
  buffer_load_dwordx4 v10, s[64:67], s58 offen offset:3072 sc1 lds
  v_lshl_add_u32 v81, v14, 2, v15
  ds_write_b32 v81, v75
  v_cvt_pk_bf16_f32 v76, v68, v69
  v_add_u32 v14, 2, v12
  v_lshrrev_b32 v15, 2, v14
  v_and_b32 v14, 3, v14
  v_lshl_add_u32 v15, v15, 9, v3
  s_add_u32 m0, s38, 40960
  v_lshl_add_u32 v82, v14, 2, v15
  ds_write_b32 v82, v76
  v_cvt_pk_bf16_f32 v77, v70, v71
  buffer_load_dwordx4 v27, s[64:67], s58 offen sc1 lds
  v_add_u32 v14, 3, v12
  v_lshrrev_b32 v15, 2, v14
  v_and_b32 v14, 3, v14
  v_lshl_add_u32 v15, v15, 9, v3
  v_lshl_add_u32 v83, v14, 2, v15
  ds_write_b32 v83, v77
  v_cvt_pk_bf16_f32 v78, v72, v73
  s_add_u32 s58, s58, 10240
  v_add_u32 v14, 4, v12
  v_lshrrev_b32 v15, 2, v14
  v_and_b32 v14, 3, v14
  v_lshl_add_u32 v15, v15, 9, v3
  v_lshl_add_u32 v84, v14, 2, v15
  ds_write_b32 v84, v78
  s_cmp_le_u32 s40, 1
  s_cbranch_scc1 L_cu1
  s_add_u32 m0, s46, 36864
  v_rcp_f32 v13, v241
  v_accvgpr_read_b32 v96, a16
  v_accvgpr_read_b32 v97, a17
  buffer_load_dwordx4 v10, s[12:15], s59 offen offset:0 sc1 lds
  v_accvgpr_read_b32 v98, a18
  v_accvgpr_read_b32 v99, a19
  v_accvgpr_read_b32 v100, a20
  v_accvgpr_read_b32 v101, a21
  v_accvgpr_read_b32 v102, a22
  v_accvgpr_read_b32 v103, a23
  v_accvgpr_read_b32 v104, a24
  v_accvgpr_read_b32 v105, a25
  v_mul_f32 v96, v96, v13
  v_mul_f32 v97, v97, v13
  buffer_load_dwordx4 v10, s[12:15], s59 offen offset:1024 sc1 lds
  v_mul_f32 v98, v98, v13
  v_mul_f32 v99, v99, v13
  v_mul_f32 v100, v100, v13
  v_mul_f32 v101, v101, v13
  v_mul_f32 v102, v102, v13
  v_mul_f32 v103, v103, v13
  v_mul_f32 v104, v104, v13
  v_mul_f32 v105, v105, v13
  v_cvt_pk_bf16_f32 v106, v96, v97
  v_add_u32 v14, 10, v12
  buffer_load_dwordx4 v11, s[12:15], s59 offen offset:2048 sc1 lds
  v_lshrrev_b32 v15, 2, v14
  v_and_b32 v14, 3, v14
  v_lshl_add_u32 v15, v15, 9, v3
  v_lshl_add_u32 v112, v14, 2, v15
  ds_write_b32 v112, v106
  v_cvt_pk_bf16_f32 v107, v98, v99
  v_add_u32 v14, 11, v12
  v_lshrrev_b32 v15, 2, v14
  v_and_b32 v14, 3, v14
  v_lshl_add_u32 v15, v15, 9, v3
  buffer_load_dwordx4 v11, s[12:15], s59 offen offset:3072 sc1 lds
  v_lshl_add_u32 v113, v14, 2, v15
  ds_write_b32 v113, v107
  v_cvt_pk_bf16_f32 v108, v100, v101
  v_add_u32 v14, 12, v12
  v_lshrrev_b32 v15, 2, v14
  v_and_b32 v14, 3, v14
  v_lshl_add_u32 v15, v15, 9, v3
  s_add_u32 s59, s59, 2048
  v_lshl_add_u32 v114, v14, 2, v15
  ds_write_b32 v114, v108
  v_cvt_pk_bf16_f32 v109, v102, v103
  v_add_u32 v14, 13, v12
  v_lshrrev_b32 v15, 2, v14
  v_and_b32 v14, 3, v14
  v_lshl_add_u32 v15, v15, 9, v3
  v_lshl_add_u32 v115, v14, 2, v15
  ds_write_b32 v115, v109
  v_cvt_pk_bf16_f32 v110, v104, v105
  v_add_u32 v14, 14, v12
  v_lshrrev_b32 v15, 2, v14
  v_and_b32 v14, 3, v14
  v_lshl_add_u32 v15, v15, 9, v3
  v_lshl_add_u32 v116, v14, 2, v15
  ds_write_b32 v116, v110
  s_cmp_le_u32 s40, 2
  s_cbranch_scc1 L_join
  v_rcp_f32 v13, v242
  v_accvgpr_read_b32 v64, a32
  v_accvgpr_read_b32 v65, a33
  v_accvgpr_read_b32 v66, a34
  v_accvgpr_read_b32 v67, a35
  v_accvgpr_read_b32 v68, a36
  v_accvgpr_read_b32 v69, a37
  v_accvgpr_read_b32 v70, a38
  v_accvgpr_read_b32 v71, a39
  v_accvgpr_read_b32 v72, a40
  v_accvgpr_read_b32 v73, a41
  v_mul_f32 v64, v64, v13
  v_mul_f32 v65, v65, v13
  v_mul_f32 v66, v66, v13
  v_mul_f32 v67, v67, v13
  v_mul_f32 v68, v68, v13
  v_mul_f32 v69, v69, v13
  v_mul_f32 v70, v70, v13
  v_mul_f32 v71, v71, v13
  v_mul_f32 v72, v72, v13
  v_mul_f32 v73, v73, v13
  v_cvt_pk_bf16_f32 v74, v64, v65
  v_add_u32 v14, 20, v12
  v_lshrrev_b32 v15, 2, v14
  v_and_b32 v14, 3, v14
  v_lshl_add_u32 v15, v15, 9, v3
  v_lshl_add_u32 v80, v14, 2, v15
  ds_write_b32 v80, v74
  v_cvt_pk_bf16_f32 v75, v66, v67
  v_add_u32 v14, 21, v12
  v_lshrrev_b32 v15, 2, v14
  v_and_b32 v14, 3, v14
  v_lshl_add_u32 v15, v15, 9, v3
  v_lshl_add_u32 v81, v14, 2, v15
  ds_write_b32 v81, v75
  v_cvt_pk_bf16_f32 v76, v68, v69
  v_add_u32 v14, 22, v12
  v_lshrrev_b32 v15, 2, v14
  v_and_b32 v14, 3, v14
  v_lshl_add_u32 v15, v15, 9, v3
  v_lshl_add_u32 v82, v14, 2, v15
  ds_write_b32 v82, v76
  v_cvt_pk_bf16_f32 v77, v70, v71
  v_add_u32 v14, 23, v12
  v_lshrrev_b32 v15, 2, v14
  v_and_b32 v14, 3, v14
  v_lshl_add_u32 v15, v15, 9, v3
  v_lshl_add_u32 v83, v14, 2, v15
  ds_write_b32 v83, v77
  v_cvt_pk_bf16_f32 v78, v72, v73
  v_add_u32 v14, 24, v12
  v_lshrrev_b32 v15, 2, v14
  v_and_b32 v14, 3, v14
  v_lshl_add_u32 v15, v15, 9, v3
  v_lshl_add_u32 v84, v14, 2, v15
  ds_write_b32 v84, v78
  s_cmp_le_u32 s40, 3
  s_cbranch_scc1 L_join
  v_rcp_f32 v13, v243
  v_accvgpr_read_b32 v96, a48
  v_accvgpr_read_b32 v97, a49
  v_accvgpr_read_b32 v98, a50
  v_accvgpr_read_b32 v99, a51
  v_accvgpr_read_b32 v100, a52
  v_accvgpr_read_b32 v101, a53
  v_accvgpr_read_b32 v102, a54
  v_accvgpr_read_b32 v103, a55
  v_accvgpr_read_b32 v104, a56
  v_accvgpr_read_b32 v105, a57
  v_mul_f32 v96, v96, v13
  v_mul_f32 v97, v97, v13
  v_mul_f32 v98, v98, v13
  v_mul_f32 v99, v99, v13
  v_mul_f32 v100, v100, v13
  v_mul_f32 v101, v101, v13
  v_mul_f32 v102, v102, v13
  v_mul_f32 v103, v103, v13
  v_mul_f32 v104, v104, v13
  v_mul_f32 v105, v105, v13
  v_cvt_pk_bf16_f32 v106, v96, v97
  v_add_u32 v14, 30, v12
  v_lshrrev_b32 v15, 2, v14
  v_and_b32 v14, 3, v14
  v_lshl_add_u32 v15, v15, 9, v3
  v_lshl_add_u32 v112, v14, 2, v15
  ds_write_b32 v112, v106
  v_cvt_pk_bf16_f32 v107, v98, v99
  v_add_u32 v14, 31, v12
  v_lshrrev_b32 v15, 2, v14
  v_and_b32 v14, 3, v14
  v_lshl_add_u32 v15, v15, 9, v3
  v_lshl_add_u32 v113, v14, 2, v15
  ds_write_b32 v113, v107
  v_cvt_pk_bf16_f32 v108, v100, v101
  v_add_u32 v14, 32, v12
  v_lshrrev_b32 v15, 2, v14
  v_and_b32 v14, 3, v14
  v_lshl_add_u32 v15, v15, 9, v3
  v_lshl_add_u32 v114, v14, 2, v15
  ds_write_b32 v114, v108
  v_cvt_pk_bf16_f32 v109, v102, v103
  v_add_u32 v14, 33, v12
  v_lshrrev_b32 v15, 2, v14
  v_and_b32 v14, 3, v14
  v_lshl_add_u32 v15, v15, 9, v3
  v_lshl_add_u32 v115, v14, 2, v15
  ds_write_b32 v115, v109
  v_cvt_pk_bf16_f32 v110, v104, v105
  v_add_u32 v14, 34, v12
  v_lshrrev_b32 v15, 2, v14
  v_and_b32 v14, 3, v14
  v_lshl_add_u32 v15, v15, 9, v3
  v_lshl_add_u32 v116, v14, 2, v15
  ds_write_b32 v116, v110
  s_cmp_le_u32 s40, 4
  s_cbranch_scc1 L_join
  v_rcp_f32 v13, v244
  v_accvgpr_read_b32 v64, a64
  v_accvgpr_read_b32 v65, a65
  v_accvgpr_read_b32 v66, a66
  v_accvgpr_read_b32 v67, a67
  v_accvgpr_read_b32 v68, a68
  v_accvgpr_read_b32 v69, a69
  v_accvgpr_read_b32 v70, a70
  v_accvgpr_read_b32 v71, a71
  v_accvgpr_read_b32 v72, a72
  v_accvgpr_read_b32 v73, a73
  v_mul_f32 v64, v64, v13
  v_mul_f32 v65, v65, v13
  v_mul_f32 v66, v66, v13
  v_mul_f32 v67, v67, v13
  v_mul_f32 v68, v68, v13
  v_mul_f32 v69, v69, v13
  v_mul_f32 v70, v70, v13
  v_mul_f32 v71, v71, v13
  v_mul_f32 v72, v72, v13
  v_mul_f32 v73, v73, v13
  v_cvt_pk_bf16_f32 v74, v64, v65
  v_add_u32 v14, 40, v12
  v_lshrrev_b32 v15, 2, v14
  v_and_b32 v14, 3, v14
  v_lshl_add_u32 v15, v15, 9, v3
  v_lshl_add_u32 v80, v14, 2, v15
  ds_write_b32 v80, v74
  v_cvt_pk_bf16_f32 v75, v66, v67
  v_add_u32 v14, 41, v12
  v_lshrrev_b32 v15, 2, v14
  v_and_b32 v14, 3, v14
  v_lshl_add_u32 v15, v15, 9, v3
  v_lshl_add_u32 v81, v14, 2, v15
  ds_write_b32 v81, v75
  v_cvt_pk_bf16_f32 v76, v68, v69
  v_add_u32 v14, 42, v12
  v_lshrrev_b32 v15, 2, v14
  v_and_b32 v14, 3, v14
  v_lshl_add_u32 v15, v15, 9, v3
  v_lshl_add_u32 v82, v14, 2, v15
  ds_write_b32 v82, v76
  v_cvt_pk_bf16_f32 v77, v70, v71
  v_add_u32 v14, 43, v12
  v_lshrrev_b32 v15, 2, v14
  v_and_b32 v14, 3, v14
  v_lshl_add_u32 v15, v15, 9, v3
  v_lshl_add_u32 v83, v14, 2, v15
  ds_write_b32 v83, v77
  v_cvt_pk_bf16_f32 v78, v72, v73
  v_add_u32 v14, 44, v12
  v_lshrrev_b32 v15, 2, v14
  v_and_b32 v14, 3, v14
  v_lshl_add_u32 v15, v15, 9, v3
  v_lshl_add_u32 v84, v14, 2, v15
  ds_write_b32 v84, v78
L_join:
  s_waitcnt lgkmcnt(0)
  s_barrier
  v_mov_b32 v6, 163824
  ds_read_b128 v[12:15], v6
  s_waitcnt lgkmcnt(0)
  v_or3_b32 v12, v12, v13, v14
  v_or_b32 v12, v12, v15
  s_nop 0
  v_readfirstlane_b32 s31, v12
  s_nop 0
  s_cmp_lg_u32 s39, 0
  s_cselect_b32 s31, 0, s31
  s_cmp_lg_u32 s31, 0
  s_cbranch_scc1 L_fbB
L_p4:
  v_mov_b32 v3, v236
  v_mov_b32 v12, v27
  s_add_u32 m0, s38, 73728
  s_lshl_b32 s31, s30, 10
  s_add_u32 s31, s31, 110592
  buffer_load_dwordx4 v10, s[64:67], s58 offen offset:0 sc1 lds
  v_add_u32 v13, s31, v236
  ds_read_b128 v[32:35], v13 offset:0
  ds_read_b128 v[36:39], v13 offset:4096
  ds_read_b128 v[40:43], v13 offset:8192
  ds_read_b128 v[44:47], v13 offset:12288
  ds_read_b128 v[48:51], v13 offset:16384
  ds_read_b128 v[52:55], v13 offset:20480
  ds_read_b128 v[56:59], v13 offset:24576
  v_bfe_u32 v13, v2, 4, 1
  s_mov_b32 s33, 151552
  v_mul_lo_u32 v13, s33, v13
  v_lshlrev_b32 v14, 4, v4
  v_lshrrev_b32 v15, 5, v2
  v_lshlrev_b32 v15, 8, v15
  v_add3_u32 v13, v13, v14, v15
  s_mul_i32 s31, s30, s40
  s_sub_u32 s31, s43, s31
  s_mul_i32 s31, s31, 640
  s_mul_i32 s32, s42, 303104
  s_add_u32 s31, s31, s32
  s_lshl_b32 s32, s30, 9
  buffer_load_dwordx4 v10, s[64:67], s58 offen offset:1024 sc1 lds
  s_add_u32 s31, s31, s32
  s_add_u32 s31, s31, 131072
  s_mul_i32 s32, s40, 5
  s_sub_u32 s32, s32, s30
  s_add_u32 s33, s48, 0
  s_and_b32 s33, s33, 3
  s_lshl_b32 s34, s52, 2
  s_add_u32 s33, s33, s34
  s_lshl_b32 s33, s33, 11
  v_add_u32 v16, s33, v3
  s_add_u32 s33, s48, 1
  s_and_b32 s33, s33, 3
  s_lshl_b32 s34, s52, 2
  s_add_u32 s33, s33, s34
  s_lshl_b32 s33, s33, 11
  v_add_u32 v17, s33, v3
  s_add_u32 s33, s48, 2
  s_and_b32 s33, s33, 3
  s_lshl_b32 s34, s52, 2
  s_add_u32 s33, s33, s34
  s_lshl_b32 s33, s33, 11
  buffer_load_dwordx4 v10, s[64:67], s58 offen offset:2048 sc1 lds
  v_add_u32 v18, s33, v3
  s_add_u32 s33, s48, 3
  s_and_b32 s33, s33, 3
  s_lshl_b32 s34, s52, 2
  s_add_u32 s33, s33, s34
  s_lshl_b32 s33, s33, 11
  v_add_u32 v19, s33, v3
  s_mul_i32 s33, s53, 10240
  s_add_u32 s33, s33, 16384
  v_add_u32 v20, s33, v3
  v_add_u32 v21, 73728, v16
  v_add_u32 v22, 73728, v17
  v_add_u32 v23, 73728, v18
  v_add_u32 v24, 73728, v19
  v_add_u32 v25, 73728, v20
  v_accvgpr_write_b32 a0, 0
  v_accvgpr_write_b32 a1, 0
  v_accvgpr_write_b32 a2, 0
  v_accvgpr_write_b32 a3, 0
  v_accvgpr_write_b32 a4, 0
  v_accvgpr_write_b32 a5, 0
  buffer_load_dwordx4 v10, s[64:67], s58 offen offset:3072 sc1 lds
  v_accvgpr_write_b32 a6, 0
  v_accvgpr_write_b32 a7, 0
  v_accvgpr_write_b32 a8, 0
  v_accvgpr_write_b32 a9, 0
  v_accvgpr_write_b32 a10, 0
  v_accvgpr_write_b32 a11, 0
  v_accvgpr_write_b32 a12, 0
  v_accvgpr_write_b32 a13, 0
  v_accvgpr_write_b32 a14, 0
  v_accvgpr_write_b32 a15, 0
  v_accvgpr_write_b32 a16, 0
  v_accvgpr_write_b32 a17, 0
  v_accvgpr_write_b32 a18, 0
  v_accvgpr_write_b32 a19, 0
  v_accvgpr_write_b32 a20, 0
  v_accvgpr_write_b32 a21, 0
  v_accvgpr_write_b32 a22, 0
  v_accvgpr_write_b32 a23, 0
  v_accvgpr_write_b32 a24, 0
  s_add_u32 m0, s38, 77824
  v_accvgpr_write_b32 a25, 0
  v_accvgpr_write_b32 a26, 0
  buffer_load_dwordx4 v27, s[64:67], s58 offen sc1 lds
  v_accvgpr_write_b32 a27, 0
  v_accvgpr_write_b32 a28, 0
  v_accvgpr_write_b32 a29, 0
  v_accvgpr_write_b32 a30, 0
  v_accvgpr_write_b32 a31, 0
  v_accvgpr_write_b32 a32, 0
  v_accvgpr_write_b32 a33, 0
  v_accvgpr_write_b32 a34, 0
  v_accvgpr_write_b32 a35, 0
  v_accvgpr_write_b32 a36, 0
  v_accvgpr_write_b32 a37, 0
  v_accvgpr_write_b32 a38, 0
  v_accvgpr_write_b32 a39, 0
  v_accvgpr_write_b32 a40, 0
  v_accvgpr_write_b32 a41, 0
  v_accvgpr_write_b32 a42, 0
  v_accvgpr_write_b32 a43, 0
  v_accvgpr_write_b32 a44, 0
  v_accvgpr_write_b32 a45, 0
  s_add_u32 s58, s58, 10240
  s_add_u32 m0, s46, 73728
  v_accvgpr_write_b32 a46, 0
  v_accvgpr_write_b32 a47, 0
  buffer_load_dwordx4 v10, s[12:15], s59 offen offset:0 sc1 lds
  v_accvgpr_write_b32 a48, 0
  v_accvgpr_write_b32 a49, 0
  v_accvgpr_write_b32 a50, 0
  v_accvgpr_write_b32 a51, 0
  v_accvgpr_write_b32 a52, 0
  v_accvgpr_write_b32 a53, 0
  v_accvgpr_write_b32 a54, 0
  v_accvgpr_write_b32 a55, 0
  v_accvgpr_write_b32 a56, 0
  v_accvgpr_write_b32 a57, 0
  v_accvgpr_write_b32 a58, 0
  v_accvgpr_write_b32 a59, 0
  v_accvgpr_write_b32 a60, 0
  v_accvgpr_write_b32 a61, 0
  v_accvgpr_write_b32 a62, 0
  v_accvgpr_write_b32 a63, 0
  v_accvgpr_write_b32 a64, 0
  v_accvgpr_write_b32 a65, 0
  v_accvgpr_write_b32 a66, 0
  v_accvgpr_write_b32 a67, 0
  v_accvgpr_write_b32 a68, 0
  buffer_load_dwordx4 v10, s[12:15], s59 offen offset:1024 sc1 lds
  v_accvgpr_write_b32 a69, 0
  v_accvgpr_write_b32 a70, 0
  v_accvgpr_write_b32 a71, 0
  v_accvgpr_write_b32 a72, 0
  v_accvgpr_write_b32 a73, 0
  v_accvgpr_write_b32 a74, 0
  v_accvgpr_write_b32 a75, 0
  v_accvgpr_write_b32 a76, 0
  v_accvgpr_write_b32 a77, 0
  v_accvgpr_write_b32 a78, 0
  v_accvgpr_write_b32 a79, 0
  v_accvgpr_write_b32 a80, 0
  v_accvgpr_write_b32 a81, 0
  v_accvgpr_write_b32 a82, 0
  v_accvgpr_write_b32 a83, 0
  v_accvgpr_write_b32 a84, 0
  v_accvgpr_write_b32 a85, 0
  v_accvgpr_write_b32 a86, 0
  v_accvgpr_write_b32 a87, 0
  v_accvgpr_write_b32 a88, 0
  v_accvgpr_write_b32 a89, 0
  buffer_load_dwordx4 v11, s[12:15], s59 offen offset:2048 sc1 lds
  v_accvgpr_write_b32 a90, 0
  v_accvgpr_write_b32 a91, 0
  v_accvgpr_write_b32 a92, 0
  v_accvgpr_write_b32 a93, 0
  v_accvgpr_write_b32 a94, 0
  v_accvgpr_write_b32 a95, 0
  v_accvgpr_write_b32 a96, 0
  v_accvgpr_write_b32 a97, 0
  v_accvgpr_write_b32 a98, 0
  v_accvgpr_write_b32 a99, 0
  v_accvgpr_write_b32 a100, 0
  v_accvgpr_write_b32 a101, 0
  v_accvgpr_write_b32 a102, 0
  v_accvgpr_write_b32 a103, 0
  v_accvgpr_write_b32 a104, 0
  v_accvgpr_write_b32 a105, 0
  v_accvgpr_write_b32 a106, 0
  v_accvgpr_write_b32 a107, 0
  v_accvgpr_write_b32 a108, 0
  v_accvgpr_write_b32 a109, 0
  v_accvgpr_write_b32 a110, 0
  buffer_load_dwordx4 v11, s[12:15], s59 offen offset:3072 sc1 lds
  v_accvgpr_write_b32 a111, 0
  v_accvgpr_write_b32 a112, 0
  v_accvgpr_write_b32 a113, 0
  v_accvgpr_write_b32 a114, 0
  v_accvgpr_write_b32 a115, 0
  v_accvgpr_write_b32 a116, 0
  v_accvgpr_write_b32 a117, 0
  v_accvgpr_write_b32 a118, 0
  v_accvgpr_write_b32 a119, 0
  v_accvgpr_write_b32 a120, 0
  v_accvgpr_write_b32 a121, 0
  v_accvgpr_write_b32 a122, 0
  v_accvgpr_write_b32 a123, 0
  v_accvgpr_write_b32 a124, 0
  v_accvgpr_write_b32 a125, 0
  v_accvgpr_write_b32 a126, 0
  v_accvgpr_write_b32 a127, 0
  v_accvgpr_write_b32 a128, 0
  v_accvgpr_write_b32 a129, 0
  s_add_u32 s59, s59, 2048
  v_accvgpr_write_b32 a130, 0
  v_accvgpr_write_b32 a131, 0
  v_accvgpr_write_b32 a132, 0
  v_accvgpr_write_b32 a133, 0
  v_accvgpr_write_b32 a134, 0
  v_accvgpr_write_b32 a135, 0
  v_accvgpr_write_b32 a136, 0
  v_accvgpr_write_b32 a137, 0
  v_accvgpr_write_b32 a138, 0
  v_accvgpr_write_b32 a139, 0
  v_accvgpr_write_b32 a140, 0
  v_accvgpr_write_b32 a141, 0
  v_accvgpr_write_b32 a142, 0
  v_accvgpr_write_b32 a143, 0
  v_accvgpr_write_b32 a144, 0
  v_accvgpr_write_b32 a145, 0
  v_accvgpr_write_b32 a146, 0
  v_accvgpr_write_b32 a147, 0
  v_accvgpr_write_b32 a148, 0
  v_accvgpr_write_b32 a149, 0
  v_accvgpr_write_b32 a150, 0
  v_accvgpr_write_b32 a151, 0
  v_accvgpr_write_b32 a152, 0
  v_accvgpr_write_b32 a153, 0
  v_accvgpr_write_b32 a154, 0
  v_accvgpr_write_b32 a155, 0
  v_accvgpr_write_b32 a156, 0
  v_accvgpr_write_b32 a157, 0
  v_accvgpr_write_b32 a158, 0
  v_accvgpr_write_b32 a159, 0
  s_waitcnt lgkmcnt(0)
  s_cmp_gt_i32 s32, 0
  s_cselect_b32 s33, s31, 0x7fff0000
  buffer_store_dwordx4 v[32:35], v13, s[12:15], s33 offen sc1
  s_add_u32 s31, s31, 2048
  s_cmp_gt_i32 s32, 4
  s_cselect_b32 s33, s31, 0x7fff0000
  buffer_store_dwordx4 v[36:39], v13, s[12:15], s33 offen sc1
  s_add_u32 s31, s31, 2048
  s_cmp_gt_i32 s32, 8
  s_cselect_b32 s33, s31, 0x7fff0000
  buffer_store_dwordx4 v[40:43], v13, s[12:15], s33 offen sc1
  s_add_u32 s31, s31, 2048
  s_cmp_gt_i32 s32, 12
  s_cselect_b32 s33, s31, 0x7fff0000
  buffer_store_dwordx4 v[44:47], v13, s[12:15], s33 offen sc1
  s_add_u32 s31, s31, 2048
  s_cmp_gt_i32 s32, 16
  s_cselect_b32 s33, s31, 0x7fff0000
  buffer_store_dwordx4 v[48:51], v13, s[12:15], s33 offen sc1
  s_add_u32 s31, s31, 2048
  s_cmp_gt_i32 s32, 20
  s_cselect_b32 s33, s31, 0x7fff0000
  buffer_store_dwordx4 v[52:55], v13, s[12:15], s33 offen sc1
  s_add_u32 s31, s31, 2048
  s_cmp_gt_i32 s32, 24
  s_cselect_b32 s33, s31, 0x7fff0000
  buffer_store_dwordx4 v[56:59], v13, s[12:15], s33 offen sc1
  s_add_u32 s31, s31, 2048
  s_cmp_eq_u32 s30, 0
  s_cselect_b32 s45, s40, 0
  s_lshl_b32 s62, s28, 7
  s_add_u32 s62, s62, 8192
  s_mov_b32 s63, 30208
  s_waitcnt vmcnt(25)
  s_barrier
  ds_read_b128 v[48:51], v20 offset:0
  ds_read_b128 v[32:35], v16 offset:0
  ds_read_b128 v[36:39], v17 offset:0
  ds_read_b128 v[40:43], v18 offset:0
  ds_read_b128 v[44:47], v19 offset:0
  ds_read_b128 v[52:55], v20 offset:1024
  ds_read_b128 v[56:59], v20 offset:2048
  ds_read_b128 v[60:63], v20 offset:3072
  ds_read_b128 v[64:67], v20 offset:4096
  s_cmp_lg_u32 s30, 0
  s_cbranch_scc1 L_p4l0
  buffer_load_dword v26, v9, s[24:27], s63 offen sc1
L_p4l0:
  s_mov_b32 s54, 0
  s_add_u32 m0, s38, 110592
  s_nop 0
  buffer_load_dwordx4 v10, s[64:67], s58 offen offset:0 sc1 lds
  buffer_load_dwordx4 v10, s[64:67], s58 offen offset:1024 sc1 lds
  buffer_load_dwordx4 v10, s[64:67], s58 offen offset:2048 sc1 lds
  buffer_load_dwordx4 v10, s[64:67], s58 offen offset:3072 sc1 lds
  s_add_u32 m0, s38, 114688
  s_nop 0
  buffer_load_dwordx4 v27, s[64:67], s58 offen sc1 lds
  s_add_u32 s58, s58, 10240
  s_waitcnt lgkmcnt(0)
  .p2align 6
L_p4loop:
  s_waitcnt lgkmcnt(5)
  v_mfma_f32_16x16x32_bf16 a[0:3], v[48:51], v[32:35], a[0:3]
  s_add_u32 m0, s46, 110592
  ds_read_b128 v[84:87], v20 offset:5120
  v_mfma_f32_16x16x32_bf16 a[20:23], v[48:51], v[36:39], a[20:23]
  v_mfma_f32_16x16x32_bf16 a[40:43], v[48:51], v[40:43], a[40:43]
  s_waitcnt lgkmcnt(5)
  ds_read_b128 v[68:71], v16 offset:1024
  v_mfma_f32_16x16x32_bf16 a[60:63], v[48:51], v[44:47], a[60:63]
  s_waitcnt lgkmcnt(5)
  buffer_load_dwordx4 v10, s[12:15], s59 offen offset:0 sc1 lds
  v_mfma_f32_16x16x32_bf16 a[4:7], v[52:55], v[32:35], a[4:7]
  ds_read_b128 v[72:75], v17 offset:1024
  v_mfma_f32_16x16x32_bf16 a[24:27], v[52:55], v[36:39], a[24:27]
  v_mfma_f32_16x16x32_bf16 a[44:47], v[52:55], v[40:43], a[44:47]
  ds_read_b128 v[76:79], v18 offset:1024
  v_mfma_f32_16x16x32_bf16 a[64:67], v[52:55], v[44:47], a[64:67]
  s_waitcnt lgkmcnt(5)
  buffer_load_dwordx4 v10, s[12:15], s59 offen offset:1024 sc1 lds
  v_mfma_f32_16x16x32_bf16 a[8:11], v[56:59], v[32:35], a[8:11]
  ds_read_b128 v[80:83], v19 offset:1024
  v_mfma_f32_16x16x32_bf16 a[28:31], v[56:59], v[36:39], a[28:31]
  v_mfma_f32_16x16x32_bf16 a[48:51], v[56:59], v[40:43], a[48:51]
  ds_read_b128 v[88:91], v20 offset:6144
  v_mfma_f32_16x16x32_bf16 a[68:71], v[56:59], v[44:47], a[68:71]
  buffer_load_dwordx4 v11, s[12:15], s59 offen offset:2048 sc1 lds
  v_mfma_f32_16x16x32_bf16 a[12:15], v[60:63], v[32:35], a[12:15]
  ds_read_b128 v[92:95], v20 offset:7168
  v_mfma_f32_16x16x32_bf16 a[32:35], v[60:63], v[36:39], a[32:35]
  v_mfma_f32_16x16x32_bf16 a[52:55], v[60:63], v[40:43], a[52:55]
  ds_read_b128 v[96:99], v20 offset:8192
  v_mfma_f32_16x16x32_bf16 a[72:75], v[60:63], v[44:47], a[72:75]
  s_waitcnt lgkmcnt(6)
  buffer_load_dwordx4 v11, s[12:15], s59 offen offset:3072 sc1 lds
  v_mfma_f32_16x16x32_bf16 a[16:19], v[64:67], v[32:35], a[16:19]
  s_add_u32 s59, s59, 2048
  ds_read_b128 v[100:103], v20 offset:9216
  v_mfma_f32_16x16x32_bf16 a[36:39], v[64:67], v[36:39], a[36:39]
  v_mfma_f32_16x16x32_bf16 a[56:59], v[64:67], v[40:43], a[56:59]
  v_mfma_f32_16x16x32_bf16 a[76:79], v[64:67], v[44:47], a[76:79]
  v_mfma_f32_16x16x32_bf16 a[0:3], v[84:87], v[68:71], a[0:3]
  s_waitcnt lgkmcnt(5)
  v_mfma_f32_16x16x32_bf16 a[20:23], v[84:87], v[72:75], a[20:23]
  s_waitcnt vmcnt(18) lgkmcnt(0)
  s_barrier
  v_mfma_f32_16x16x32_bf16 a[40:43], v[84:87], v[76:79], a[40:43]
  s_sub_u32 s55, s55, 1
  s_mov_b32 s37, 36864
  ds_read_b128 v[48:51], v20 offset:36864
  v_mfma_f32_16x16x32_bf16 a[60:63], v[84:87], v[80:83], a[60:63]
  s_add_u32 m0, s38, 0
  v_mfma_f32_16x16x32_bf16 a[4:7], v[88:91], v[68:71], a[4:7]
  ds_read_b128 v[32:35], v16 offset:36864
  v_mfma_f32_16x16x32_bf16 a[24:27], v[88:91], v[72:75], a[24:27]
  buffer_load_dwordx4 v10, s[64:67], s58 offen offset:0 sc1 lds
  v_mfma_f32_16x16x32_bf16 a[44:47], v[88:91], v[76:79], a[44:47]
  ds_read_b128 v[36:39], v17 offset:36864
  v_mfma_f32_16x16x32_bf16 a[64:67], v[88:91], v[80:83], a[64:67]
  buffer_load_dwordx4 v10, s[64:67], s58 offen offset:1024 sc1 lds
  v_mfma_f32_16x16x32_bf16 a[8:11], v[92:95], v[68:71], a[8:11]
  ds_read_b128 v[40:43], v18 offset:36864
  v_mfma_f32_16x16x32_bf16 a[28:31], v[92:95], v[72:75], a[28:31]
  v_mfma_f32_16x16x32_bf16 a[48:51], v[92:95], v[76:79], a[48:51]
  ds_read_b128 v[44:47], v19 offset:36864
  v_mfma_f32_16x16x32_bf16 a[68:71], v[92:95], v[80:83], a[68:71]
  buffer_load_dwordx4 v10, s[64:67], s58 offen offset:2048 sc1 lds
  v_mfma_f32_16x16x32_bf16 a[12:15], v[96:99], v[68:71], a[12:15]
  ds_read_b128 v[52:55], v20 offset:37888
  v_mfma_f32_16x16x32_bf16 a[32:35], v[96:99], v[72:75], a[32:35]
  v_mfma_f32_16x16x32_bf16 a[52:55], v[96:99], v[76:79], a[52:55]
  ds_read_b128 v[56:59], v20 offset:38912
  v_mfma_f32_16x16x32_bf16 a[72:75], v[96:99], v[80:83], a[72:75]
  buffer_load_dwordx4 v10, s[64:67], s58 offen offset:3072 sc1 lds
  v_mfma_f32_16x16x32_bf16 a[16:19], v[100:103], v[68:71], a[16:19]
  ds_read_b128 v[60:63], v20 offset:39936
  v_mfma_f32_16x16x32_bf16 a[36:39], v[100:103], v[72:75], a[36:39]
  s_add_u32 m0, s38, 4096
  v_mfma_f32_16x16x32_bf16 a[56:59], v[100:103], v[76:79], a[56:59]
  ds_read_b128 v[64:67], v20 offset:40960
  v_mfma_f32_16x16x32_bf16 a[76:79], v[100:103], v[80:83], a[76:79]
  buffer_load_dwordx4 v27, s[64:67], s58 offen sc1 lds
  s_add_u32 s58, s58, 10240
  s_cmp_eq_u32 s55, 4
  s_cbranch_scc1 L_p4e
  s_waitcnt lgkmcnt(5)
  v_mfma_f32_16x16x32_bf16 a[0:3], v[48:51], v[32:35], a[0:3]
  s_add_u32 m0, s46, 0
  ds_read_b128 v[84:87], v20 offset:41984
  v_mfma_f32_16x16x32_bf16 a[20:23], v[48:51], v[36:39], a[20:23]
  v_mfma_f32_16x16x32_bf16 a[40:43], v[48:51], v[40:43], a[40:43]
  s_waitcnt lgkmcnt(5)
  ds_read_b128 v[68:71], v16 offset:37888
  v_mfma_f32_16x16x32_bf16 a[60:63], v[48:51], v[44:47], a[60:63]
  s_waitcnt lgkmcnt(5)
  buffer_load_dwordx4 v10, s[12:15], s59 offen offset:0 sc1 lds
  v_mfma_f32_16x16x32_bf16 a[4:7], v[52:55], v[32:35], a[4:7]
  ds_read_b128 v[72:75], v17 offset:37888
  v_mfma_f32_16x16x32_bf16 a[24:27], v[52:55], v[36:39], a[24:27]
  v_mfma_f32_16x16x32_bf16 a[44:47], v[52:55], v[40:43], a[44:47]
  ds_read_b128 v[76:79], v18 offset:37888
  v_mfma_f32_16x16x32_bf16 a[64:67], v[52:55], v[44:47], a[64:67]
  s_waitcnt lgkmcnt(5)
  buffer_load_dwordx4 v10, s[12:15], s59 offen offset:1024 sc1 lds
  v_mfma_f32_16x16x32_bf16 a[8:11], v[56:59], v[32:35], a[8:11]
  ds_read_b128 v[80:83], v19 offset:37888
  v_mfma_f32_16x16x32_bf16 a[28:31], v[56:59], v[36:39], a[28:31]
  v_mfma_f32_16x16x32_bf16 a[48:51], v[56:59], v[40:43], a[48:51]
  ds_read_b128 v[88:91], v20 offset:43008
  v_mfma_f32_16x16x32_bf16 a[68:71], v[56:59], v[44:47], a[68:71]
  buffer_load_dwordx4 v11, s[12:15], s59 offen offset:2048 sc1 lds
  v_mfma_f32_16x16x32_bf16 a[12:15], v[60:63], v[32:35], a[12:15]
  ds_read_b128 v[92:95], v20 offset:44032
  v_mfma_f32_16x16x32_bf16 a[32:35], v[60:63], v[36:39], a[32:35]
  v_mfma_f32_16x16x32_bf16 a[52:55], v[60:63], v[40:43], a[52:55]
  ds_read_b128 v[96:99], v20 offset:45056
  v_mfma_f32_16x16x32_bf16 a[72:75], v[60:63], v[44:47], a[72:75]
  s_waitcnt lgkmcnt(6)
  buffer_load_dwordx4 v11, s[12:15], s59 offen offset:3072 sc1 lds
  v_mfma_f32_16x16x32_bf16 a[16:19], v[64:67], v[32:35], a[16:19]
  s_add_u32 s59, s59, 2048
  ds_read_b128 v[100:103], v20 offset:46080
  v_mfma_f32_16x16x32_bf16 a[36:39], v[64:67], v[36:39], a[36:39]
  v_mfma_f32_16x16x32_bf16 a[56:59], v[64:67], v[40:43], a[56:59]
  v_mfma_f32_16x16x32_bf16 a[76:79], v[64:67], v[44:47], a[76:79]
  v_mfma_f32_16x16x32_bf16 a[0:3], v[84:87], v[68:71], a[0:3]
  s_waitcnt lgkmcnt(5)
  v_mfma_f32_16x16x32_bf16 a[20:23], v[84:87], v[72:75], a[20:23]
  s_waitcnt vmcnt(18) lgkmcnt(0)
  s_barrier
  v_mfma_f32_16x16x32_bf16 a[40:43], v[84:87], v[76:79], a[40:43]
  s_sub_u32 s55, s55, 1
  s_mov_b32 s37, 73728
  ds_read_b128 v[48:51], v25 offset:0
  v_mfma_f32_16x16x32_bf16 a[60:63], v[84:87], v[80:83], a[60:63]
  s_add_u32 m0, s38, 36864
  v_mfma_f32_16x16x32_bf16 a[4:7], v[88:91], v[68:71], a[4:7]
  ds_read_b128 v[32:35], v21 offset:0
  v_mfma_f32_16x16x32_bf16 a[24:27], v[88:91], v[72:75], a[24:27]
  buffer_load_dwordx4 v10, s[64:67], s58 offen offset:0 sc1 lds
  v_mfma_f32_16x16x32_bf16 a[44:47], v[88:91], v[76:79], a[44:47]
  ds_read_b128 v[36:39], v22 offset:0
  v_mfma_f32_16x16x32_bf16 a[64:67], v[88:91], v[80:83], a[64:67]
  buffer_load_dwordx4 v10, s[64:67], s58 offen offset:1024 sc1 lds
  v_mfma_f32_16x16x32_bf16 a[8:11], v[92:95], v[68:71], a[8:11]
  ds_read_b128 v[40:43], v23 offset:0
  v_mfma_f32_16x16x32_bf16 a[28:31], v[92:95], v[72:75], a[28:31]
  v_mfma_f32_16x16x32_bf16 a[48:51], v[92:95], v[76:79], a[48:51]
  ds_read_b128 v[44:47], v24 offset:0
  v_mfma_f32_16x16x32_bf16 a[68:71], v[92:95], v[80:83], a[68:71]
  buffer_load_dwordx4 v10, s[64:67], s58 offen offset:2048 sc1 lds
  v_mfma_f32_16x16x32_bf16 a[12:15], v[96:99], v[68:71], a[12:15]
  ds_read_b128 v[52:55], v25 offset:1024
  v_mfma_f32_16x16x32_bf16 a[32:35], v[96:99], v[72:75], a[32:35]
  v_mfma_f32_16x16x32_bf16 a[52:55], v[96:99], v[76:79], a[52:55]
  ds_read_b128 v[56:59], v25 offset:2048
  v_mfma_f32_16x16x32_bf16 a[72:75], v[96:99], v[80:83], a[72:75]
  buffer_load_dwordx4 v10, s[64:67], s58 offen offset:3072 sc1 lds
  v_mfma_f32_16x16x32_bf16 a[16:19], v[100:103], v[68:71], a[16:19]
  ds_read_b128 v[60:63], v25 offset:3072
  v_mfma_f32_16x16x32_bf16 a[36:39], v[100:103], v[72:75], a[36:39]
  s_add_u32 m0, s38, 40960
  v_mfma_f32_16x16x32_bf16 a[56:59], v[100:103], v[76:79], a[56:59]
  ds_read_b128 v[64:67], v25 offset:4096
  v_mfma_f32_16x16x32_bf16 a[76:79], v[100:103], v[80:83], a[76:79]
  buffer_load_dwordx4 v27, s[64:67], s58 offen sc1 lds
  s_add_u32 s58, s58, 10240
  s_cmp_eq_u32 s55, 4
  s_cbranch_scc1 L_p4e
  s_waitcnt lgkmcnt(5)
  v_mfma_f32_16x16x32_bf16 a[0:3], v[48:51], v[32:35], a[0:3]
  s_add_u32 m0, s46, 36864
  ds_read_b128 v[84:87], v25 offset:5120
  v_mfma_f32_16x16x32_bf16 a[20:23], v[48:51], v[36:39], a[20:23]
  v_mfma_f32_16x16x32_bf16 a[40:43], v[48:51], v[40:43], a[40:43]
  s_waitcnt lgkmcnt(5)
  ds_read_b128 v[68:71], v21 offset:1024
  v_mfma_f32_16x16x32_bf16 a[60:63], v[48:51], v[44:47], a[60:63]
  s_waitcnt lgkmcnt(5)
  buffer_load_dwordx4 v10, s[12:15], s59 offen offset:0 sc1 lds
  v_mfma_f32_16x16x32_bf16 a[4:7], v[52:55], v[32:35], a[4:7]
  ds_read_b128 v[72:75], v22 offset:1024
  v_mfma_f32_16x16x32_bf16 a[24:27], v[52:55], v[36:39], a[24:27]
  v_mfma_f32_16x16x32_bf16 a[44:47], v[52:55], v[40:43], a[44:47]
  ds_read_b128 v[76:79], v23 offset:1024
  v_mfma_f32_16x16x32_bf16 a[64:67], v[52:55], v[44:47], a[64:67]
  s_waitcnt lgkmcnt(5)
  buffer_load_dwordx4 v10, s[12:15], s59 offen offset:1024 sc1 lds
  v_mfma_f32_16x16x32_bf16 a[8:11], v[56:59], v[32:35], a[8:11]
  ds_read_b128 v[80:83], v24 offset:1024
  v_mfma_f32_16x16x32_bf16 a[28:31], v[56:59], v[36:39], a[28:31]
  v_mfma_f32_16x16x32_bf16 a[48:51], v[56:59], v[40:43], a[48:51]
  ds_read_b128 v[88:91], v25 offset:6144
  v_mfma_f32_16x16x32_bf16 a[68:71], v[56:59], v[44:47], a[68:71]
  buffer_load_dwordx4 v11, s[12:15], s59 offen offset:2048 sc1 lds
  v_mfma_f32_16x16x32_bf16 a[12:15], v[60:63], v[32:35], a[12:15]
  ds_read_b128 v[92:95], v25 offset:7168
  v_mfma_f32_16x16x32_bf16 a[32:35], v[60:63], v[36:39], a[32:35]
  v_mfma_f32_16x16x32_bf16 a[52:55], v[60:63], v[40:43], a[52:55]
  ds_read_b128 v[96:99], v25 offset:8192
  v_mfma_f32_16x16x32_bf16 a[72:75], v[60:63], v[44:47], a[72:75]
  s_waitcnt lgkmcnt(6)
  buffer_load_dwordx4 v11, s[12:15], s59 offen offset:3072 sc1 lds
  v_mfma_f32_16x16x32_bf16 a[16:19], v[64:67], v[32:35], a[16:19]
  s_add_u32 s59, s59, 2048
  ds_read_b128 v[100:103], v25 offset:9216
  v_mfma_f32_16x16x32_bf16 a[36:39], v[64:67], v[36:39], a[36:39]
  v_mfma_f32_16x16x32_bf16 a[56:59], v[64:67], v[40:43], a[56:59]
  v_mfma_f32_16x16x32_bf16 a[76:79], v[64:67], v[44:47], a[76:79]
  v_mfma_f32_16x16x32_bf16 a[0:3], v[84:87], v[68:71], a[0:3]
  s_waitcnt lgkmcnt(5)
  v_mfma_f32_16x16x32_bf16 a[20:23], v[84:87], v[72:75], a[20:23]
  s_waitcnt vmcnt(18) lgkmcnt(0)
  s_barrier
  v_mfma_f32_16x16x32_bf16 a[40:43], v[84:87], v[76:79], a[40:43]
  s_sub_u32 s55, s55, 1
  s_mov_b32 s37, 110592
  ds_read_b128 v[48:51], v25 offset:36864
  v_mfma_f32_16x16x32_bf16 a[60:63], v[84:87], v[80:83], a[60:63]
  s_add_u32 m0, s38, 73728
  v_mfma_f32_16x16x32_bf16 a[4:7], v[88:91], v[68:71], a[4:7]
  ds_read_b128 v[32:35], v21 offset:36864
  v_mfma_f32_16x16x32_bf16 a[24:27], v[88:91], v[72:75], a[24:27]
  buffer_load_dwordx4 v10, s[64:67], s58 offen offset:0 sc1 lds
  v_mfma_f32_16x16x32_bf16 a[44:47], v[88:91], v[76:79], a[44:47]
  ds_read_b128 v[36:39], v22 offset:36864
  v_mfma_f32_16x16x32_bf16 a[64:67], v[88:91], v[80:83], a[64:67]
  buffer_load_dwordx4 v10, s[64:67], s58 offen offset:1024 sc1 lds
  v_mfma_f32_16x16x32_bf16 a[8:11], v[92:95], v[68:71], a[8:11]
  ds_read_b128 v[40:43], v23 offset:36864
  v_mfma_f32_16x16x32_bf16 a[28:31], v[92:95], v[72:75], a[28:31]
  v_mfma_f32_16x16x32_bf16 a[48:51], v[92:95], v[76:79], a[48:51]
  ds_read_b128 v[44:47], v24 offset:36864
  v_mfma_f32_16x16x32_bf16 a[68:71], v[92:95], v[80:83], a[68:71]
  buffer_load_dwordx4 v10, s[64:67], s58 offen offset:2048 sc1 lds
  v_mfma_f32_16x16x32_bf16 a[12:15], v[96:99], v[68:71], a[12:15]
  ds_read_b128 v[52:55], v25 offset:37888
  v_mfma_f32_16x16x32_bf16 a[32:35], v[96:99], v[72:75], a[32:35]
  v_mfma_f32_16x16x32_bf16 a[52:55], v[96:99], v[76:79], a[52:55]
  ds_read_b128 v[56:59], v25 offset:38912
  v_mfma_f32_16x16x32_bf16 a[72:75], v[96:99], v[80:83], a[72:75]
  buffer_load_dwordx4 v10, s[64:67], s58 offen offset:3072 sc1 lds
  v_mfma_f32_16x16x32_bf16 a[16:19], v[100:103], v[68:71], a[16:19]
  ds_read_b128 v[60:63], v25 offset:39936
  v_mfma_f32_16x16x32_bf16 a[36:39], v[100:103], v[72:75], a[36:39]
  s_add_u32 m0, s38, 77824
  v_mfma_f32_16x16x32_bf16 a[56:59], v[100:103], v[76:79], a[56:59]
  ds_read_b128 v[64:67], v25 offset:40960
  v_mfma_f32_16x16x32_bf16 a[76:79], v[100:103], v[80:83], a[76:79]
  buffer_load_dwordx4 v27, s[64:67], s58 offen sc1 lds
  s_add_u32 s58, s58, 10240
  s_cmp_eq_u32 s55, 4
  s_cbranch_scc1 L_p4e
  s_waitcnt lgkmcnt(5)
  v_mfma_f32_16x16x32_bf16 a[0:3], v[48:51], v[32:35], a[0:3]
  s_add_u32 m0, s46, 73728
  ds_read_b128 v[84:87], v25 offset:41984
  v_mfma_f32_16x16x32_bf16 a[20:23], v[48:51], v[36:39], a[20:23]
  v_mfma_f32_16x16x32_bf16 a[40:43], v[48:51], v[40:43], a[40:43]
  s_waitcnt lgkmcnt(5)
  ds_read_b128 v[68:71], v21 offset:37888
  v_mfma_f32_16x16x32_bf16 a[60:63], v[48:51], v[44:47], a[60:63]
  s_waitcnt lgkmcnt(5)
  buffer_load_dwordx4 v10, s[12:15], s59 offen offset:0 sc1 lds
  v_mfma_f32_16x16x32_bf16 a[4:7], v[52:55], v[32:35], a[4:7]
  ds_read_b128 v[72:75], v22 offset:37888
  v_mfma_f32_16x16x32_bf16 a[24:27], v[52:55], v[36:39], a[24:27]
  v_mfma_f32_16x16x32_bf16 a[44:47], v[52:55], v[40:43], a[44:47]
  ds_read_b128 v[76:79], v23 offset:37888
  v_mfma_f32_16x16x32_bf16 a[64:67], v[52:55], v[44:47], a[64:67]
  s_waitcnt lgkmcnt(5)
  buffer_load_dwordx4 v10, s[12:15], s59 offen offset:1024 sc1 lds
  v_mfma_f32_16x16x32_bf16 a[8:11], v[56:59], v[32:35], a[8:11]
  ds_read_b128 v[80:83], v24 offset:37888
  v_mfma_f32_16x16x32_bf16 a[28:31], v[56:59], v[36:39], a[28:31]
  v_mfma_f32_16x16x32_bf16 a[48:51], v[56:59], v[40:43], a[48:51]
  ds_read_b128 v[88:91], v25 offset:43008
  v_mfma_f32_16x16x32_bf16 a[68:71], v[56:59], v[44:47], a[68:71]
  buffer_load_dwordx4 v11, s[12:15], s59 offen offset:2048 sc1 lds
  v_mfma_f32_16x16x32_bf16 a[12:15], v[60:63], v[32:35], a[12:15]
  ds_read_b128 v[92:95], v25 offset:44032
  v_mfma_f32_16x16x32_bf16 a[32:35], v[60:63], v[36:39], a[32:35]
  v_mfma_f32_16x16x32_bf16 a[52:55], v[60:63], v[40:43], a[52:55]
  ds_read_b128 v[96:99], v25 offset:45056
  v_mfma_f32_16x16x32_bf16 a[72:75], v[60:63], v[44:47], a[72:75]
  s_waitcnt lgkmcnt(6)
  buffer_load_dwordx4 v11, s[12:15], s59 offen offset:3072 sc1 lds
  v_mfma_f32_16x16x32_bf16 a[16:19], v[64:67], v[32:35], a[16:19]
  s_add_u32 s59, s59, 2048
  ds_read_b128 v[100:103], v25 offset:46080
  v_mfma_f32_16x16x32_bf16 a[36:39], v[64:67], v[36:39], a[36:39]
  v_mfma_f32_16x16x32_bf16 a[56:59], v[64:67], v[40:43], a[56:59]
  v_mfma_f32_16x16x32_bf16 a[76:79], v[64:67], v[44:47], a[76:79]
  v_mfma_f32_16x16x32_bf16 a[0:3], v[84:87], v[68:71], a[0:3]
  s_waitcnt lgkmcnt(5)
  v_mfma_f32_16x16x32_bf16 a[20:23], v[84:87], v[72:75], a[20:23]
  s_waitcnt vmcnt(18) lgkmcnt(0)
  s_barrier
  v_mfma_f32_16x16x32_bf16 a[40:43], v[84:87], v[76:79], a[40:43]
  s_sub_u32 s55, s55, 1
  s_mov_b32 s37, 0
  ds_read_b128 v[48:51], v20 offset:0
  v_mfma_f32_16x16x32_bf16 a[60:63], v[84:87], v[80:83], a[60:63]
  s_add_u32 m0, s38, 110592
  v_mfma_f32_16x16x32_bf16 a[4:7], v[88:91], v[68:71], a[4:7]
  ds_read_b128 v[32:35], v16 offset:0
  v_mfma_f32_16x16x32_bf16 a[24:27], v[88:91], v[72:75], a[24:27]
  buffer_load_dwordx4 v10, s[64:67], s58 offen offset:0 sc1 lds
  v_mfma_f32_16x16x32_bf16 a[44:47], v[88:91], v[76:79], a[44:47]
  ds_read_b128 v[36:39], v17 offset:0
  v_mfma_f32_16x16x32_bf16 a[64:67], v[88:91], v[80:83], a[64:67]
  buffer_load_dwordx4 v10, s[64:67], s58 offen offset:1024 sc1 lds
  v_mfma_f32_16x16x32_bf16 a[8:11], v[92:95], v[68:71], a[8:11]
  ds_read_b128 v[40:43], v18 offset:0
  v_mfma_f32_16x16x32_bf16 a[28:31], v[92:95], v[72:75], a[28:31]
  v_mfma_f32_16x16x32_bf16 a[48:51], v[92:95], v[76:79], a[48:51]
  ds_read_b128 v[44:47], v19 offset:0
  v_mfma_f32_16x16x32_bf16 a[68:71], v[92:95], v[80:83], a[68:71]
  buffer_load_dwordx4 v10, s[64:67], s58 offen offset:2048 sc1 lds
  v_mfma_f32_16x16x32_bf16 a[12:15], v[96:99], v[68:71], a[12:15]
  ds_read_b128 v[52:55], v20 offset:1024
  v_mfma_f32_16x16x32_bf16 a[32:35], v[96:99], v[72:75], a[32:35]
  v_mfma_f32_16x16x32_bf16 a[52:55], v[96:99], v[76:79], a[52:55]
  ds_read_b128 v[56:59], v20 offset:2048
  v_mfma_f32_16x16x32_bf16 a[72:75], v[96:99], v[80:83], a[72:75]
  buffer_load_dwordx4 v10, s[64:67], s58 offen offset:3072 sc1 lds
  v_mfma_f32_16x16x32_bf16 a[16:19], v[100:103], v[68:71], a[16:19]
  ds_read_b128 v[60:63], v20 offset:3072
  v_mfma_f32_16x16x32_bf16 a[36:39], v[100:103], v[72:75], a[36:39]
  s_add_u32 m0, s38, 114688
  v_mfma_f32_16x16x32_bf16 a[56:59], v[100:103], v[76:79], a[56:59]
  ds_read_b128 v[64:67], v20 offset:4096
  v_mfma_f32_16x16x32_bf16 a[76:79], v[100:103], v[80:83], a[76:79]
  buffer_load_dwordx4 v27, s[64:67], s58 offen sc1 lds
  s_add_u32 s58, s58, 10240
  s_cmp_eq_u32 s55, 4
  s_cbranch_scc1 L_p4e
  s_cmp_lg_u32 s30, 0
  s_cbranch_scc1 L_p4loop
  v_cmp_eq_u32 vcc, s100, v26
  s_mov_b32 s33, 0xfffff
  s_nop 0
  s_andn2_b32 s31, s33, vcc_lo
  s_cselect_b32 s54, 2, 1
  s_cbranch_scc0 L_p4b1
  buffer_load_dword v26, v9, s[24:27], s63 offen sc1
L_p4b1:
  s_cmp_eq_u32 s45, 0
  s_cbranch_scc1 L_p4loop
  s_mov_b32 s45, 0
  s_lshl_b32 s31, s28, 7
  s_lshl_b32 s33, s29, 2
  s_add_u32 s31, s31, s33
  s_add_u32 s31, s31, 8192
  v_mov_b32 v6, s100
  v_mov_b32 v7, 0
  s_mov_b64 exec, 1
  buffer_store_dword v6, v7, s[24:27], s31 offen offset:0 sc1
  s_mov_b64 exec, -1
  s_branch L_p4loop
L_p4e:
  s_cmp_lg_u32 s30, 0
  s_cbranch_scc1 L_p4w1
  s_cmp_eq_u32 s54, 1
  s_cbranch_scc1 L_p4w1
  s_cmp_eq_u32 s54, 2
  s_cbranch_scc1 L_p4s0
  s_waitcnt vmcnt(14)
  v_cmp_eq_u32 vcc, s100, v26
  s_mov_b32 s33, 0xfffff
  s_nop 0
  s_andn2_b32 s31, s33, vcc_lo
  s_cbranch_scc0 L_p4w1
L_p4s0:
  s_mov_b32 s34, 262144
  s_waitcnt vmcnt(0)
L_p4s1:
  buffer_load_dword v26, v9, s[24:27], s63 offen sc1
  s_sub_u32 s34, s34, 1
  s_cbranch_scc1 L_p4w1
  s_waitcnt vmcnt(0)
  v_cmp_eq_u32 vcc, s100, v26
  s_mov_b32 s33, 0xfffff
  s_nop 0
  s_andn2_b32 s31, s33, vcc_lo
  s_cbranch_scc1 L_p4s1
L_p4w1:
  v_add_u32 v232, s37, v16
  v_add_u32 v233, s37, v17
  v_add_u32 v234, s37, v18
  v_add_u32 v235, s37, v19
  v_add_u32 v236, s37, v20
  s_add_u32 s34, s37, 110592
  s_cmp_ge_u32 s34, 147456
  s_cselect_b32 s33, 147456, 0
  s_sub_u32 s34, s34, s33
  s_add_u32 m0, s34, s46
  s_waitcnt lgkmcnt(0)
  v_mfma_f32_16x16x32_bf16 a[0:3], v[48:51], v[32:35], a[0:3]
  s_add_u32 s31, s37, 36864
  s_cmp_ge_u32 s31, 147456
  ds_read_b128 v[84:87], v236 offset:5120
  v_mfma_f32_16x16x32_bf16 a[20:23], v[48:51], v[36:39], a[20:23]
  s_cselect_b32 s33, 147456, 0
  buffer_load_dwordx4 v10, s[12:15], s59 offen offset:0 sc1 lds
  v_mfma_f32_16x16x32_bf16 a[40:43], v[48:51], v[40:43], a[40:43]
  s_sub_u32 s31, s31, s33
  ds_read_b128 v[68:71], v232 offset:1024
  v_add_u32 v237, s31, v16
  v_mfma_f32_16x16x32_bf16 a[60:63], v[48:51], v[44:47], a[60:63]
  v_add_u32 v238, s31, v17
  v_add_u32 v239, s31, v18
  v_mfma_f32_16x16x32_bf16 a[4:7], v[52:55], v[32:35], a[4:7]
  ds_read_b128 v[72:75], v233 offset:1024
  v_add_u32 v240, s31, v19
  v_mfma_f32_16x16x32_bf16 a[24:27], v[52:55], v[36:39], a[24:27]
  buffer_load_dwordx4 v10, s[12:15], s59 offen offset:1024 sc1 lds
  v_mfma_f32_16x16x32_bf16 a[44:47], v[52:55], v[40:43], a[44:47]
  ds_read_b128 v[76:79], v234 offset:1024
  v_add_u32 v241, s31, v20
  v_mfma_f32_16x16x32_bf16 a[64:67], v[52:55], v[44:47], a[64:67]
  s_add_u32 s31, s37, 73728
  s_cmp_ge_u32 s31, 147456
  s_cselect_b32 s33, 147456, 0
  v_mfma_f32_16x16x32_bf16 a[8:11], v[56:59], v[32:35], a[8:11]
  s_sub_u32 s31, s31, s33
  ds_read_b128 v[80:83], v235 offset:1024
  v_add_u32 v242, s31, v16
  v_mfma_f32_16x16x32_bf16 a[28:31], v[56:59], v[36:39], a[28:31]
  buffer_load_dwordx4 v11, s[12:15], s59 offen offset:2048 sc1 lds
  v_mfma_f32_16x16x32_bf16 a[48:51], v[56:59], v[40:43], a[48:51]
  ds_read_b128 v[88:91], v236 offset:6144
  v_add_u32 v243, s31, v17
  v_mfma_f32_16x16x32_bf16 a[68:71], v[56:59], v[44:47], a[68:71]
  v_add_u32 v244, s31, v18
  v_add_u32 v245, s31, v19
  v_mfma_f32_16x16x32_bf16 a[12:15], v[60:63], v[32:35], a[12:15]
  ds_read_b128 v[92:95], v236 offset:7168
  v_add_u32 v246, s31, v20
  v_mfma_f32_16x16x32_bf16 a[32:35], v[60:63], v[36:39], a[32:35]
  buffer_load_dwordx4 v11, s[12:15], s59 offen offset:3072 sc1 lds
  v_mfma_f32_16x16x32_bf16 a[52:55], v[60:63], v[40:43], a[52:55]
  ds_read_b128 v[96:99], v236 offset:8192
  v_add_u32 v247, s34, v16
  v_mfma_f32_16x16x32_bf16 a[72:75], v[60:63], v[44:47], a[72:75]
  v_add_u32 v248, s34, v17
  v_add_u32 v249, s34, v18
  v_mfma_f32_16x16x32_bf16 a[16:19], v[64:67], v[32:35], a[16:19]
  ds_read_b128 v[100:103], v236 offset:9216
  v_add_u32 v250, s34, v19
  v_mfma_f32_16x16x32_bf16 a[36:39], v[64:67], v[36:39], a[36:39]
  s_waitcnt lgkmcnt(3)
  v_add_u32 v251, s34, v20
  v_mfma_f32_16x16x32_bf16 a[56:59], v[64:67], v[40:43], a[56:59]
  s_add_u32 s16, s6, 54525952
  s_addc_u32 s17, s7, 0
  s_and_b32 s17, s17, 0xffff
  v_mfma_f32_16x16x32_bf16 a[76:79], v[64:67], v[44:47], a[76:79]
  s_mov_b32 s18, 6062080
  s_mov_b32 s19, 0x20000
  s_mul_i32 s47, s29, 757760
  s_mul_i32 s31, s30, 25600
  s_add_u32 s47, s47, s31
  s_add_u32 s47, s47, 655360
  v_mfma_f32_16x16x32_bf16 a[0:3], v[84:87], v[68:71], a[0:3]
  v_mfma_f32_16x16x32_bf16 a[20:23], v[84:87], v[72:75], a[20:23]
  s_waitcnt vmcnt(18) lgkmcnt(0)
  s_barrier
  s_cmp_lg_u32 s30, 0
  s_cbranch_scc1 L_p4ob
  s_cmp_eq_u32 s45, 0
  s_cbranch_scc1 L_p4ob
  s_mov_b32 s45, 0
  s_lshl_b32 s31, s28, 7
  s_lshl_b32 s33, s29, 2
  s_add_u32 s31, s31, s33
  s_add_u32 s31, s31, 8192
  v_mov_b32 v6, s100
  v_mov_b32 v7, 0
  s_mov_b64 exec, 1
  buffer_store_dword v6, v7, s[24:27], s31 offen offset:0 sc1
  s_mov_b64 exec, -1
L_p4ob:
  v_mfma_f32_16x16x32_bf16 a[40:43], v[84:87], v[76:79], a[40:43]
  ds_read_b128 v[48:51], v241 offset:0
  v_mfma_f32_16x16x32_bf16 a[60:63], v[84:87], v[80:83], a[60:63]
  buffer_load_dwordx4 v[104:107], v3, s[16:19], s47 offen offset:0 sc1
  v_mfma_f32_16x16x32_bf16 a[4:7], v[88:91], v[68:71], a[4:7]
  ds_read_b128 v[32:35], v237 offset:0
  v_mfma_f32_16x16x32_bf16 a[24:27], v[88:91], v[72:75], a[24:27]
  v_mfma_f32_16x16x32_bf16 a[44:47], v[88:91], v[76:79], a[44:47]
  ds_read_b128 v[36:39], v238 offset:0
  v_mfma_f32_16x16x32_bf16 a[64:67], v[88:91], v[80:83], a[64:67]
  buffer_load_dwordx4 v[108:111], v3, s[16:19], s47 offen offset:1024 sc1
  v_mfma_f32_16x16x32_bf16 a[8:11], v[92:95], v[68:71], a[8:11]
  ds_read_b128 v[40:43], v239 offset:0
  v_mfma_f32_16x16x32_bf16 a[28:31], v[92:95], v[72:75], a[28:31]
  v_mfma_f32_16x16x32_bf16 a[48:51], v[92:95], v[76:79], a[48:51]
  ds_read_b128 v[44:47], v240 offset:0
  v_mfma_f32_16x16x32_bf16 a[68:71], v[92:95], v[80:83], a[68:71]
  buffer_load_dwordx4 v[112:115], v3, s[16:19], s47 offen offset:2048 sc1
  v_mfma_f32_16x16x32_bf16 a[12:15], v[96:99], v[68:71], a[12:15]
  ds_read_b128 v[52:55], v241 offset:1024
  v_mfma_f32_16x16x32_bf16 a[32:35], v[96:99], v[72:75], a[32:35]
  v_mfma_f32_16x16x32_bf16 a[52:55], v[96:99], v[76:79], a[52:55]
  ds_read_b128 v[56:59], v241 offset:2048
  v_mfma_f32_16x16x32_bf16 a[72:75], v[96:99], v[80:83], a[72:75]
  buffer_load_dwordx4 v[116:119], v3, s[16:19], s47 offen offset:3072 sc1
  v_mfma_f32_16x16x32_bf16 a[16:19], v[100:103], v[68:71], a[16:19]
  ds_read_b128 v[60:63], v241 offset:3072
  v_mfma_f32_16x16x32_bf16 a[36:39], v[100:103], v[72:75], a[36:39]
  v_mfma_f32_16x16x32_bf16 a[56:59], v[100:103], v[76:79], a[56:59]
  ds_read_b128 v[64:67], v241 offset:4096
  v_mfma_f32_16x16x32_bf16 a[76:79], v[100:103], v[80:83], a[76:79]
  s_waitcnt lgkmcnt(6)
  v_mfma_f32_16x16x32_bf16 a[0:3], v[48:51], v[32:35], a[0:3]
  ds_read_b128 v[84:87], v241 offset:5120
  v_mfma_f32_16x16x32_bf16 a[20:23], v[48:51], v[36:39], a[20:23]
  s_waitcnt lgkmcnt(6)
  buffer_load_dwordx4 v[120:123], v12, s[16:19], s47 offen sc1
  v_mfma_f32_16x16x32_bf16 a[40:43], v[48:51], v[40:43], a[40:43]
  s_waitcnt lgkmcnt(5)
  ds_read_b128 v[68:71], v237 offset:1024
  v_mfma_f32_16x16x32_bf16 a[60:63], v[48:51], v[44:47], a[60:63]
  s_waitcnt lgkmcnt(5)
  v_mfma_f32_16x16x32_bf16 a[4:7], v[52:55], v[32:35], a[4:7]
  ds_read_b128 v[72:75], v238 offset:1024
  v_mfma_f32_16x16x32_bf16 a[24:27], v[52:55], v[36:39], a[24:27]
  s_add_u32 s47, s47, 5120
  buffer_load_dwordx4 v[124:127], v3, s[16:19], s47 offen offset:0 sc1
  v_mfma_f32_16x16x32_bf16 a[44:47], v[52:55], v[40:43], a[44:47]
  ds_read_b128 v[76:79], v239 offset:1024
  v_mfma_f32_16x16x32_bf16 a[64:67], v[52:55], v[44:47], a[64:67]
  s_waitcnt lgkmcnt(6)
  v_mfma_f32_16x16x32_bf16 a[8:11], v[56:59], v[32:35], a[8:11]
  ds_read_b128 v[80:83], v240 offset:1024
  v_mfma_f32_16x16x32_bf16 a[28:31], v[56:59], v[36:39], a[28:31]
  buffer_load_dwordx4 v[128:131], v3, s[16:19], s47 offen offset:1024 sc1
  v_mfma_f32_16x16x32_bf16 a[48:51], v[56:59], v[40:43], a[48:51]
  ds_read_b128 v[88:91], v241 offset:6144
  v_mfma_f32_16x16x32_bf16 a[68:71], v[56:59], v[44:47], a[68:71]
  s_waitcnt lgkmcnt(6)
  v_mfma_f32_16x16x32_bf16 a[12:15], v[60:63], v[32:35], a[12:15]
  ds_read_b128 v[92:95], v241 offset:7168
  v_mfma_f32_16x16x32_bf16 a[32:35], v[60:63], v[36:39], a[32:35]
  buffer_load_dwordx4 v[132:135], v3, s[16:19], s47 offen offset:2048 sc1
  v_mfma_f32_16x16x32_bf16 a[52:55], v[60:63], v[40:43], a[52:55]
  ds_read_b128 v[96:99], v241 offset:8192
  v_mfma_f32_16x16x32_bf16 a[72:75], v[60:63], v[44:47], a[72:75]
  v_mfma_f32_16x16x32_bf16 a[16:19], v[64:67], v[32:35], a[16:19]
  ds_read_b128 v[100:103], v241 offset:9216
  v_mfma_f32_16x16x32_bf16 a[36:39], v[64:67], v[36:39], a[36:39]
  v_mfma_f32_16x16x32_bf16 a[56:59], v[64:67], v[40:43], a[56:59]
  v_mfma_f32_16x16x32_bf16 a[76:79], v[64:67], v[44:47], a[76:79]
  s_waitcnt lgkmcnt(6)
  v_mfma_f32_16x16x32_bf16 a[0:3], v[84:87], v[68:71], a[0:3]
  v_mfma_f32_16x16x32_bf16 a[20:23], v[84:87], v[72:75], a[20:23]
  s_waitcnt vmcnt(17) lgkmcnt(0)
  s_barrier
  v_mfma_f32_16x16x32_bf16 a[40:43], v[84:87], v[76:79], a[40:43]
  ds_read_b128 v[48:51], v246 offset:0
  v_mfma_f32_16x16x32_bf16 a[60:63], v[84:87], v[80:83], a[60:63]
  buffer_load_dwordx4 v[136:139], v3, s[16:19], s47 offen offset:3072 sc1
  v_mfma_f32_16x16x32_bf16 a[4:7], v[88:91], v[68:71], a[4:7]
  ds_read_b128 v[32:35], v242 offset:0
  v_mfma_f32_16x16x32_bf16 a[24:27], v[88:91], v[72:75], a[24:27]
  v_mfma_f32_16x16x32_bf16 a[44:47], v[88:91], v[76:79], a[44:47]
  ds_read_b128 v[36:39], v243 offset:0
  v_mfma_f32_16x16x32_bf16 a[64:67], v[88:91], v[80:83], a[64:67]
  buffer_load_dwordx4 v[140:143], v12, s[16:19], s47 offen sc1
  v_mfma_f32_16x16x32_bf16 a[8:11], v[92:95], v[68:71], a[8:11]
  ds_read_b128 v[40:43], v244 offset:0
  v_mfma_f32_16x16x32_bf16 a[28:31], v[92:95], v[72:75], a[28:31]
  v_mfma_f32_16x16x32_bf16 a[48:51], v[92:95], v[76:79], a[48:51]
  ds_read_b128 v[44:47], v245 offset:0
  v_mfma_f32_16x16x32_bf16 a[68:71], v[92:95], v[80:83], a[68:71]
  s_add_u32 s47, s47, 5120
  buffer_load_dwordx4 v[144:147], v3, s[16:19], s47 offen offset:0 sc1
  v_mfma_f32_16x16x32_bf16 a[12:15], v[96:99], v[68:71], a[12:15]
  ds_read_b128 v[52:55], v246 offset:1024
  v_mfma_f32_16x16x32_bf16 a[32:35], v[96:99], v[72:75], a[32:35]
  v_mfma_f32_16x16x32_bf16 a[52:55], v[96:99], v[76:79], a[52:55]
  ds_read_b128 v[56:59], v246 offset:2048
  v_mfma_f32_16x16x32_bf16 a[72:75], v[96:99], v[80:83], a[72:75]
  buffer_load_dwordx4 v[148:151], v3, s[16:19], s47 offen offset:1024 sc1
  v_mfma_f32_16x16x32_bf16 a[16:19], v[100:103], v[68:71], a[16:19]
  ds_read_b128 v[60:63], v246 offset:3072
  v_mfma_f32_16x16x32_bf16 a[36:39], v[100:103], v[72:75], a[36:39]
  v_mfma_f32_16x16x32_bf16 a[56:59], v[100:103], v[76:79], a[56:59]
  ds_read_b128 v[64:67], v246 offset:4096
  v_mfma_f32_16x16x32_bf16 a[76:79], v[100:103], v[80:83], a[76:79]
  s_waitcnt lgkmcnt(6)
  v_mfma_f32_16x16x32_bf16 a[0:3], v[48:51], v[32:35], a[0:3]
  ds_read_b128 v[84:87], v246 offset:5120
  v_mfma_f32_16x16x32_bf16 a[20:23], v[48:51], v[36:39], a[20:23]
  s_waitcnt lgkmcnt(6)
  buffer_load_dwordx4 v[152:155], v3, s[16:19], s47 offen offset:2048 sc1
  v_mfma_f32_16x16x32_bf16 a[40:43], v[48:51], v[40:43], a[40:43]
  s_waitcnt lgkmcnt(5)
  ds_read_b128 v[68:71], v242 offset:1024
  v_mfma_f32_16x16x32_bf16 a[60:63], v[48:51], v[44:47], a[60:63]
  s_waitcnt lgkmcnt(5)
  v_mfma_f32_16x16x32_bf16 a[4:7], v[52:55], v[32:35], a[4:7]
  ds_read_b128 v[72:75], v243 offset:1024
  v_mfma_f32_16x16x32_bf16 a[24:27], v[52:55], v[36:39], a[24:27]
  buffer_load_dwordx4 v[156:159], v3, s[16:19], s47 offen offset:3072 sc1
  v_mfma_f32_16x16x32_bf16 a[44:47], v[52:55], v[40:43], a[44:47]
  ds_read_b128 v[76:79], v244 offset:1024
  v_mfma_f32_16x16x32_bf16 a[64:67], v[52:55], v[44:47], a[64:67]
  s_waitcnt lgkmcnt(6)
  v_mfma_f32_16x16x32_bf16 a[8:11], v[56:59], v[32:35], a[8:11]
  ds_read_b128 v[80:83], v245 offset:1024
  v_mfma_f32_16x16x32_bf16 a[28:31], v[56:59], v[36:39], a[28:31]
  buffer_load_dwordx4 v[160:163], v12, s[16:19], s47 offen sc1
  v_mfma_f32_16x16x32_bf16 a[48:51], v[56:59], v[40:43], a[48:51]
  ds_read_b128 v[88:91], v246 offset:6144
  v_mfma_f32_16x16x32_bf16 a[68:71], v[56:59], v[44:47], a[68:71]
  s_waitcnt lgkmcnt(6)
  v_mfma_f32_16x16x32_bf16 a[12:15], v[60:63], v[32:35], a[12:15]
  ds_read_b128 v[92:95], v246 offset:7168
  v_mfma_f32_16x16x32_bf16 a[32:35], v[60:63], v[36:39], a[32:35]
  s_add_u32 s47, s47, 5120
  buffer_load_dwordx4 v[164:167], v3, s[16:19], s47 offen offset:0 sc1
  v_mfma_f32_16x16x32_bf16 a[52:55], v[60:63], v[40:43], a[52:55]
  ds_read_b128 v[96:99], v246 offset:8192
  v_mfma_f32_16x16x32_bf16 a[72:75], v[60:63], v[44:47], a[72:75]
  v_mfma_f32_16x16x32_bf16 a[16:19], v[64:67], v[32:35], a[16:19]
  ds_read_b128 v[100:103], v246 offset:9216
  v_mfma_f32_16x16x32_bf16 a[36:39], v[64:67], v[36:39], a[36:39]
  v_mfma_f32_16x16x32_bf16 a[56:59], v[64:67], v[40:43], a[56:59]
  v_mfma_f32_16x16x32_bf16 a[76:79], v[64:67], v[44:47], a[76:79]
  s_waitcnt lgkmcnt(5)
  v_mfma_f32_16x16x32_bf16 a[0:3], v[84:87], v[68:71], a[0:3]
  v_mfma_f32_16x16x32_bf16 a[20:23], v[84:87], v[72:75], a[20:23]
  s_waitcnt vmcnt(16) lgkmcnt(0)
  s_barrier
  s_cmp_lg_u32 s30, 0
  s_cbranch_scc1 L_p4lk
  buffer_load_dword v8, v9, s[24:27], s62 offen sc1
L_p4lk:
  v_mfma_f32_16x16x32_bf16 a[40:43], v[84:87], v[76:79], a[40:43]
  ds_read_b128 v[48:51], v251 offset:0
  v_mfma_f32_16x16x32_bf16 a[60:63], v[84:87], v[80:83], a[60:63]
  buffer_load_dwordx4 v[168:171], v3, s[16:19], s47 offen offset:1024 sc1
  v_mfma_f32_16x16x32_bf16 a[4:7], v[88:91], v[68:71], a[4:7]
  ds_read_b128 v[32:35], v247 offset:0
  v_mfma_f32_16x16x32_bf16 a[24:27], v[88:91], v[72:75], a[24:27]
  v_mfma_f32_16x16x32_bf16 a[44:47], v[88:91], v[76:79], a[44:47]
  ds_read_b128 v[36:39], v248 offset:0
  v_mfma_f32_16x16x32_bf16 a[64:67], v[88:91], v[80:83], a[64:67]
  buffer_load_dwordx4 v[172:175], v3, s[16:19], s47 offen offset:2048 sc1
  v_mfma_f32_16x16x32_bf16 a[8:11], v[92:95], v[68:71], a[8:11]
  ds_read_b128 v[40:43], v249 offset:0
  v_mfma_f32_16x16x32_bf16 a[28:31], v[92:95], v[72:75], a[28:31]
  v_mfma_f32_16x16x32_bf16 a[48:51], v[92:95], v[76:79], a[48:51]
  ds_read_b128 v[44:47], v250 offset:0
  v_mfma_f32_16x16x32_bf16 a[68:71], v[92:95], v[80:83], a[68:71]
  buffer_load_dwordx4 v[176:179], v3, s[16:19], s47 offen offset:3072 sc1
  v_mfma_f32_16x16x32_bf16 a[12:15], v[96:99], v[68:71], a[12:15]
  ds_read_b128 v[52:55], v251 offset:1024
  v_mfma_f32_16x16x32_bf16 a[32:35], v[96:99], v[72:75], a[32:35]
  v_mfma_f32_16x16x32_bf16 a[52:55], v[96:99], v[76:79], a[52:55]
  ds_read_b128 v[56:59], v251 offset:2048
  v_mfma_f32_16x16x32_bf16 a[72:75], v[96:99], v[80:83], a[72:75]
  buffer_load_dwordx4 v[180:183], v12, s[16:19], s47 offen sc1
  v_mfma_f32_16x16x32_bf16 a[16:19], v[100:103], v[68:71], a[16:19]
  ds_read_b128 v[60:63], v251 offset:3072
  v_mfma_f32_16x16x32_bf16 a[36:39], v[100:103], v[72:75], a[36:39]
  v_mfma_f32_16x16x32_bf16 a[56:59], v[100:103], v[76:79], a[56:59]
  s_waitcnt lgkmcnt(5)
  ds_read_b128 v[64:67], v251 offset:4096
  v_mfma_f32_16x16x32_bf16 a[76:79], v[100:103], v[80:83], a[76:79]
  s_add_u32 s47, s47, 5120
  v_mfma_f32_16x16x32_bf16 a[0:3], v[48:51], v[32:35], a[0:3]
  ds_read_b128 v[84:87], v251 offset:5120
  v_mfma_f32_16x16x32_bf16 a[20:23], v[48:51], v[36:39], a[20:23]
  s_waitcnt lgkmcnt(6)
  buffer_load_dwordx4 v[184:187], v3, s[16:19], s47 offen offset:0 sc1
  v_mfma_f32_16x16x32_bf16 a[40:43], v[48:51], v[40:43], a[40:43]
  s_waitcnt lgkmcnt(5)
  ds_read_b128 v[68:71], v247 offset:1024
  v_mfma_f32_16x16x32_bf16 a[60:63], v[48:51], v[44:47], a[60:63]
  s_waitcnt lgkmcnt(5)
  v_mfma_f32_16x16x32_bf16 a[4:7], v[52:55], v[32:35], a[4:7]
  ds_read_b128 v[72:75], v248 offset:1024
  v_mfma_f32_16x16x32_bf16 a[24:27], v[52:55], v[36:39], a[24:27]
  buffer_load_dwordx4 v[188:191], v3, s[16:19], s47 offen offset:1024 sc1
  v_mfma_f32_16x16x32_bf16 a[44:47], v[52:55], v[40:43], a[44:47]
  ds_read_b128 v[76:79], v249 offset:1024
  v_mfma_f32_16x16x32_bf16 a[64:67], v[52:55], v[44:47], a[64:67]
  s_waitcnt lgkmcnt(6)
  v_mfma_f32_16x16x32_bf16 a[8:11], v[56:59], v[32:35], a[8:11]
  ds_read_b128 v[80:83], v250 offset:1024
  v_mfma_f32_16x16x32_bf16 a[28:31], v[56:59], v[36:39], a[28:31]
  buffer_load_dwordx4 v[192:195], v3, s[16:19], s47 offen offset:2048 sc1
  v_mfma_f32_16x16x32_bf16 a[48:51], v[56:59], v[40:43], a[48:51]
  ds_read_b128 v[88:91], v251 offset:6144
  v_mfma_f32_16x16x32_bf16 a[68:71], v[56:59], v[44:47], a[68:71]
  s_waitcnt lgkmcnt(6)
  v_mfma_f32_16x16x32_bf16 a[12:15], v[60:63], v[32:35], a[12:15]
  ds_read_b128 v[92:95], v251 offset:7168
  v_mfma_f32_16x16x32_bf16 a[32:35], v[60:63], v[36:39], a[32:35]
  buffer_load_dwordx4 v[196:199], v3, s[16:19], s47 offen offset:3072 sc1
  v_mfma_f32_16x16x32_bf16 a[52:55], v[60:63], v[40:43], a[52:55]
  ds_read_b128 v[96:99], v251 offset:8192
  v_mfma_f32_16x16x32_bf16 a[72:75], v[60:63], v[44:47], a[72:75]
  v_mfma_f32_16x16x32_bf16 a[16:19], v[64:67], v[32:35], a[16:19]
  ds_read_b128 v[100:103], v251 offset:9216
  v_mfma_f32_16x16x32_bf16 a[36:39], v[64:67], v[36:39], a[36:39]
  v_mfma_f32_16x16x32_bf16 a[56:59], v[64:67], v[40:43], a[56:59]
  v_mfma_f32_16x16x32_bf16 a[76:79], v[64:67], v[44:47], a[76:79]
  s_waitcnt lgkmcnt(6)
  v_mfma_f32_16x16x32_bf16 a[0:3], v[84:87], v[68:71], a[0:3]
  v_mfma_f32_16x16x32_bf16 a[20:23], v[84:87], v[72:75], a[20:23]
  s_waitcnt lgkmcnt(5)
  buffer_load_dwordx4 v[200:203], v12, s[16:19], s47 offen sc1
  v_mfma_f32_16x16x32_bf16 a[40:43], v[84:87], v[76:79], a[40:43]
  s_waitcnt lgkmcnt(4)
  v_mfma_f32_16x16x32_bf16 a[60:63], v[84:87], v[80:83], a[60:63]
  s_waitcnt lgkmcnt(3)
  v_mfma_f32_16x16x32_bf16 a[4:7], v[88:91], v[68:71], a[4:7]
  v_mfma_f32_16x16x32_bf16 a[24:27], v[88:91], v[72:75], a[24:27]
  s_add_u32 s47, s47, 5120
  v_mfma_f32_16x16x32_bf16 a[44:47], v[88:91], v[76:79], a[44:47]
  v_mfma_f32_16x16x32_bf16 a[64:67], v[88:91], v[80:83], a[64:67]
  s_waitcnt lgkmcnt(2)
  v_mfma_f32_16x16x32_bf16 a[8:11], v[92:95], v[68:71], a[8:11]
  v_mfma_f32_16x16x32_bf16 a[28:31], v[92:95], v[72:75], a[28:31]
  v_mfma_f32_16x16x32_bf16 a[48:51], v[92:95], v[76:79], a[48:51]
  v_mfma_f32_16x16x32_bf16 a[68:71], v[92:95], v[80:83], a[68:71]
  s_waitcnt lgkmcnt(1)
  v_mfma_f32_16x16x32_bf16 a[12:15], v[96:99], v[68:71], a[12:15]
  v_mfma_f32_16x16x32_bf16 a[32:35], v[96:99], v[72:75], a[32:35]
  v_mfma_f32_16x16x32_bf16 a[52:55], v[96:99], v[76:79], a[52:55]
  v_mfma_f32_16x16x32_bf16 a[72:75], v[96:99], v[80:83], a[72:75]
  s_waitcnt lgkmcnt(0)
  v_mfma_f32_16x16x32_bf16 a[16:19], v[100:103], v[68:71], a[16:19]
  v_mfma_f32_16x16x32_bf16 a[36:39], v[100:103], v[72:75], a[36:39]
  v_mfma_f32_16x16x32_bf16 a[56:59], v[100:103], v[76:79], a[56:59]
  v_mfma_f32_16x16x32_bf16 a[76:79], v[100:103], v[80:83], a[76:79]
  s_add_u32 s31, s30, 0
  s_and_b32 s31, s31, 3
  s_mul_i32 s31, s31, 151552
  v_add_u32 v16, s31, v3
  s_add_u32 s31, s30, 1
  s_and_b32 s31, s31, 3
  s_mul_i32 s31, s31, 151552
  v_add_u32 v17, s31, v3
  s_add_u32 s31, s30, 2
  s_and_b32 s31, s31, 3
  s_mul_i32 s31, s31, 151552
  v_add_u32 v18, s31, v3
  s_add_u32 s31, s30, 3
  s_and_b32 s31, s31, 3
  s_mul_i32 s31, s31, 151552
  v_add_u32 v19, s31, v3
  s_mul_i32 s46, s28, 606208
  s_mul_i32 s31, s30, 5120
  s_add_u32 s46, s46, s31
  s_add_u32 s46, s46, 131072
  s_add_u32 s20, s6, 67108864
  s_addc_u32 s21, s7, 0
  s_and_b32 s21, s21, 0xffff
  s_mov_b32 s22, 8388608
  s_mov_b32 s23, 0x20000
  s_mul_i32 s35, s30, 2560
  s_mul_i32 s31, s51, 131072
  s_add_u32 s35, s35, s31
  v_lshlrev_b32 v15, 3, v2
  s_add_u32 s31, s48, 1
  s_and_b32 s31, s31, 3
  s_mul_i32 s31, s31, 30720
  s_add_u32 s31, s31, s35
  s_add_u32 s31, s31, 0
  v_accvgpr_read_b32 v232, a20
  v_accvgpr_read_b32 v233, a21
  v_accvgpr_read_b32 v234, a22
  v_accvgpr_read_b32 v235, a23
  v_accvgpr_read_b32 v236, a24
  v_accvgpr_read_b32 v237, a25
  v_accvgpr_read_b32 v238, a26
  v_accvgpr_read_b32 v239, a27
  v_accvgpr_read_b32 v240, a28
  v_accvgpr_read_b32 v241, a29
  v_accvgpr_read_b32 v242, a30
  v_accvgpr_read_b32 v243, a31
  v_accvgpr_read_b32 v244, a32
  v_accvgpr_read_b32 v245, a33
  v_accvgpr_read_b32 v246, a34
  v_accvgpr_read_b32 v247, a35
  v_accvgpr_read_b32 v248, a36
  v_accvgpr_read_b32 v249, a37
  v_accvgpr_read_b32 v250, a38
  v_accvgpr_read_b32 v251, a39
  v_cvt_pk_bf16_f32 v212, v232, v233
  v_cvt_pk_bf16_f32 v213, v234, v235
  v_cvt_pk_bf16_f32 v214, v236, v237
  v_cvt_pk_bf16_f32 v215, v238, v239
  v_cvt_pk_bf16_f32 v216, v240, v241
  v_cvt_pk_bf16_f32 v217, v242, v243
  v_cvt_pk_bf16_f32 v218, v244, v245
  v_cvt_pk_bf16_f32 v219, v246, v247
  v_cvt_pk_bf16_f32 v220, v248, v249
  v_cvt_pk_bf16_f32 v221, v250, v251
  buffer_store_dwordx4 v[212:215], v3, s[20:23], s31 offen sc1
  buffer_store_dwordx4 v[216:219], v3, s[20:23], s31 offen offset:1024 sc1
  buffer_store_dwordx2 v[220:221], v15, s[20:23], s31 offen offset:2048 sc1
  s_add_u32 s31, s48, 2
  s_and_b32 s31, s31, 3
  s_mul_i32 s31, s31, 30720
  s_add_u32 s31, s31, s35
  s_add_u32 s31, s31, 10240
  v_accvgpr_read_b32 v232, a40
  v_accvgpr_read_b32 v233, a41
  v_accvgpr_read_b32 v234, a42
  v_accvgpr_read_b32 v235, a43
  v_accvgpr_read_b32 v236, a44
  v_accvgpr_read_b32 v237, a45
  v_accvgpr_read_b32 v238, a46
  v_accvgpr_read_b32 v239, a47
  v_accvgpr_read_b32 v240, a48
  v_accvgpr_read_b32 v241, a49
  v_accvgpr_read_b32 v242, a50
  v_accvgpr_read_b32 v243, a51
  v_accvgpr_read_b32 v244, a52
  v_accvgpr_read_b32 v245, a53
  v_accvgpr_read_b32 v246, a54
  v_accvgpr_read_b32 v247, a55
  v_accvgpr_read_b32 v248, a56
  v_accvgpr_read_b32 v249, a57
  v_accvgpr_read_b32 v250, a58
  v_accvgpr_read_b32 v251, a59
  v_cvt_pk_bf16_f32 v222, v232, v233
  v_cvt_pk_bf16_f32 v223, v234, v235
  v_cvt_pk_bf16_f32 v224, v236, v237
  v_cvt_pk_bf16_f32 v225, v238, v239
  v_cvt_pk_bf16_f32 v226, v240, v241
  v_cvt_pk_bf16_f32 v227, v242, v243
  v_cvt_pk_bf16_f32 v228, v244, v245
  v_cvt_pk_bf16_f32 v229, v246, v247
  v_cvt_pk_bf16_f32 v230, v248, v249
  v_cvt_pk_bf16_f32 v231, v250, v251
  buffer_store_dwordx4 v[222:225], v3, s[20:23], s31 offen sc1
  buffer_store_dwordx4 v[226:229], v3, s[20:23], s31 offen offset:1024 sc1
  buffer_store_dwordx2 v[230:231], v15, s[20:23], s31 offen offset:2048 sc1
  s_add_u32 s31, s48, 3
  s_and_b32 s31, s31, 3
  s_mul_i32 s31, s31, 30720
  s_add_u32 s31, s31, s35
  s_add_u32 s31, s31, 20480
  v_accvgpr_read_b32 v232, a60
  v_accvgpr_read_b32 v233, a61
  v_accvgpr_read_b32 v234, a62
  v_accvgpr_read_b32 v235, a63
  v_accvgpr_read_b32 v236, a64
  v_accvgpr_read_b32 v237, a65
  v_accvgpr_read_b32 v238, a66
  v_accvgpr_read_b32 v239, a67
  v_accvgpr_read_b32 v240, a68
  v_accvgpr_read_b32 v241, a69
  v_accvgpr_read_b32 v242, a70
  v_accvgpr_read_b32 v243, a71
  v_accvgpr_read_b32 v244, a72
  v_accvgpr_read_b32 v245, a73
  v_accvgpr_read_b32 v246, a74
  v_accvgpr_read_b32 v247, a75
  v_accvgpr_read_b32 v248, a76
  v_accvgpr_read_b32 v249, a77
  v_accvgpr_read_b32 v250, a78
  v_accvgpr_read_b32 v251, a79
  v_cvt_pk_bf16_f32 v212, v232, v233
  v_cvt_pk_bf16_f32 v213, v234, v235
  v_cvt_pk_bf16_f32 v214, v236, v237
  v_cvt_pk_bf16_f32 v215, v238, v239
  v_cvt_pk_bf16_f32 v216, v240, v241
  v_cvt_pk_bf16_f32 v217, v242, v243
  v_cvt_pk_bf16_f32 v218, v244, v245
  v_cvt_pk_bf16_f32 v219, v246, v247
  v_cvt_pk_bf16_f32 v220, v248, v249
  v_cvt_pk_bf16_f32 v221, v250, v251
  buffer_store_dwordx4 v[212:215], v3, s[20:23], s31 offen sc1
  buffer_store_dwordx4 v[216:219], v3, s[20:23], s31 offen offset:1024 sc1
  buffer_store_dwordx2 v[220:221], v15, s[20:23], s31 offen offset:2048 sc1
  s_cmp_lg_u32 s30, 0
  s_cbranch_scc1 L_p4w2
  s_waitcnt vmcnt(9)
  v_cmp_eq_u32 vcc, s100, v8
  s_mov_b32 s33, 47
  s_nop 0
  s_andn2_b32 s31, s33, vcc_lo
  s_cbranch_scc0 L_p4w2
  s_mov_b32 s34, 262144
  s_mov_b32 s33, 47
L_p4s2:
  buffer_load_dword v8, v9, s[24:27], s62 offen sc1
  s_waitcnt vmcnt(0)
  v_cmp_eq_u32 vcc, s100, v8
  s_sub_u32 s34, s34, 1
  s_cselect_b32 s33, 0, s33
  s_andn2_b32 s31, s33, vcc_lo
  s_cbranch_scc1 L_p4s2
L_p4w2:
  s_barrier
  buffer_load_dwordx4 v[32:35], v16, s[12:15], s46 offen offset:0 sc1
  buffer_load_dwordx4 v[36:39], v17, s[12:15], s46 offen offset:0 sc1
  buffer_load_dwordx4 v[40:43], v18, s[12:15], s46 offen offset:0 sc1
  buffer_load_dwordx4 v[44:47], v19, s[12:15], s46 offen offset:0 sc1
  buffer_load_dwordx4 v[48:51], v16, s[12:15], s46 offen offset:1024 sc1
  buffer_load_dwordx4 v[52:55], v17, s[12:15], s46 offen offset:1024 sc1
  buffer_load_dwordx4 v[56:59], v18, s[12:15], s46 offen offset:1024 sc1
  buffer_load_dwordx4 v[60:63], v19, s[12:15], s46 offen offset:1024 sc1
  buffer_load_dwordx4 v[64:67], v16, s[12:15], s46 offen offset:2048 sc1
  buffer_load_dwordx4 v[68:71], v17, s[12:15], s46 offen offset:2048 sc1
  buffer_load_dwordx4 v[72:75], v18, s[12:15], s46 offen offset:2048 sc1
  buffer_load_dwordx4 v[76:79], v19, s[12:15], s46 offen offset:2048 sc1
  s_mov_b32 s64, s98
  s_and_b32 s65, s99, 0xffff
  s_mov_b32 s66, 5242880
  s_mov_b32 s67, 0x20000
  s_add_u32 s31, s30, 1
  s_and_b32 s31, s31, 3
  s_mul_i32 s31, s31, 15360
  s_add_u32 s31, s31, 0
  v_add_u32 v21, s31, v3
  s_add_u32 s31, s30, 2
  s_and_b32 s31, s31, 3
  s_mul_i32 s31, s31, 15360
  s_add_u32 s31, s31, 5120
  v_add_u32 v22, s31, v3
  s_add_u32 s31, s30, 3
  s_and_b32 s31, s31, 3
  s_mul_i32 s31, s31, 15360
  s_add_u32 s31, s31, 10240
  v_add_u32 v23, s31, v3
  s_mul_i32 s31, s30, 15360
  v_add_u32 v24, s31, v3
  v_mul_u32_u24 v13, 2560, v4
  v_mul_u32_u24 v14, 40, v5
  v_add_u32 v13, v13, v14
  s_lshl_b32 s31, s49, 3
  s_lshl_b32 s33, s52, 2
  s_add_u32 s31, s31, s33
  s_add_u32 s31, s31, s48
  s_mul_i32 s31, s31, 40960
  s_lshl_b32 s33, s50, 1
  s_add_u32 s33, s33, s53
  s_mul_i32 s33, s33, 160
  s_add_u32 s31, s31, s33
  v_add_u32 v14, s31, v13
  s_lshl_b32 s31, s28, 2
  s_add_u32 s31, s31, s30
  s_mul_i32 s31, s31, 40960
  s_mul_i32 s33, s29, 160
  s_add_u32 s31, s31, s33
  s_add_u32 s31, s31, 1280
  v_add_u32 v13, s31, v13
  s_lshl_b32 s62, s51, 7
  s_add_u32 s62, s62, 16384
  s_lshl_b32 s63, s48, 2
  s_add_u32 s63, s63, s62
  s_waitcnt vmcnt(8)
  s_barrier
  s_cmp_lg_u32 s30, 0
  s_cbranch_scc1 L_p4w3
  v_mov_b32 v6, s100
  v_mov_b32 v7, 0
  s_mov_b64 exec, 1
  buffer_store_dword v6, v7, s[24:27], s63 offen offset:0 sc1
  s_mov_b64 exec, -1
L_p4w3:
  v_mfma_f32_16x16x32_bf16 a[80:83], v[104:107], v[32:35], a[80:83]
  v_mfma_f32_16x16x32_bf16 a[100:103], v[104:107], v[36:39], a[100:103]
  buffer_load_dwordx4 v[80:83], v16, s[12:15], s46 offen offset:3072 sc1
  v_mfma_f32_16x16x32_bf16 a[120:123], v[104:107], v[40:43], a[120:123]
  v_mfma_f32_16x16x32_bf16 a[140:143], v[104:107], v[44:47], a[140:143]
  v_mfma_f32_16x16x32_bf16 a[84:87], v[108:111], v[32:35], a[84:87]
  v_mfma_f32_16x16x32_bf16 a[104:107], v[108:111], v[36:39], a[104:107]
  buffer_load_dwordx4 v[84:87], v17, s[12:15], s46 offen offset:3072 sc1
  v_mfma_f32_16x16x32_bf16 a[124:127], v[108:111], v[40:43], a[124:127]
  v_mfma_f32_16x16x32_bf16 a[144:147], v[108:111], v[44:47], a[144:147]
  v_mfma_f32_16x16x32_bf16 a[88:91], v[112:115], v[32:35], a[88:91]
  v_mfma_f32_16x16x32_bf16 a[108:111], v[112:115], v[36:39], a[108:111]
  buffer_load_dwordx4 v[88:91], v18, s[12:15], s46 offen offset:3072 sc1
  v_mfma_f32_16x16x32_bf16 a[128:131], v[112:115], v[40:43], a[128:131]
  v_mfma_f32_16x16x32_bf16 a[148:151], v[112:115], v[44:47], a[148:151]
  v_mfma_f32_16x16x32_bf16 a[92:95], v[116:119], v[32:35], a[92:95]
  v_mfma_f32_16x16x32_bf16 a[112:115], v[116:119], v[36:39], a[112:115]
  buffer_load_dwordx4 v[92:95], v19, s[12:15], s46 offen offset:3072 sc1
  v_mfma_f32_16x16x32_bf16 a[132:135], v[116:119], v[40:43], a[132:135]
  v_mfma_f32_16x16x32_bf16 a[152:155], v[116:119], v[44:47], a[152:155]
  v_mfma_f32_16x16x32_bf16 a[96:99], v[120:123], v[32:35], a[96:99]
  v_mfma_f32_16x16x32_bf16 a[116:119], v[120:123], v[36:39], a[116:119]
  v_mfma_f32_16x16x32_bf16 a[136:139], v[120:123], v[40:43], a[136:139]
  v_mfma_f32_16x16x32_bf16 a[156:159], v[120:123], v[44:47], a[156:159]
  s_waitcnt vmcnt(8)
  v_mfma_f32_16x16x32_bf16 a[80:83], v[124:127], v[48:51], a[80:83]
  v_mfma_f32_16x16x32_bf16 a[100:103], v[124:127], v[52:55], a[100:103]
  s_add_u32 s46, s46, 4096
  buffer_load_dwordx4 v[96:99], v16, s[12:15], s46 offen offset:0 sc1
  v_mfma_f32_16x16x32_bf16 a[120:123], v[124:127], v[56:59], a[120:123]
  v_mfma_f32_16x16x32_bf16 a[140:143], v[124:127], v[60:63], a[140:143]
  v_mfma_f32_16x16x32_bf16 a[84:87], v[128:131], v[48:51], a[84:87]
  v_mfma_f32_16x16x32_bf16 a[104:107], v[128:131], v[52:55], a[104:107]
  buffer_load_dwordx4 v[100:103], v17, s[12:15], s46 offen offset:0 sc1
  v_mfma_f32_16x16x32_bf16 a[124:127], v[128:131], v[56:59], a[124:127]
  v_mfma_f32_16x16x32_bf16 a[144:147], v[128:131], v[60:63], a[144:147]
  v_mfma_f32_16x16x32_bf16 a[88:91], v[132:135], v[48:51], a[88:91]
  v_mfma_f32_16x16x32_bf16 a[108:111], v[132:135], v[52:55], a[108:111]
  buffer_load_dwordx4 v[204:207], v18, s[12:15], s46 offen offset:0 sc1
  v_mfma_f32_16x16x32_bf16 a[128:131], v[132:135], v[56:59], a[128:131]
  v_mfma_f32_16x16x32_bf16 a[148:151], v[132:135], v[60:63], a[148:151]
  v_mfma_f32_16x16x32_bf16 a[92:95], v[136:139], v[48:51], a[92:95]
  v_mfma_f32_16x16x32_bf16 a[112:115], v[136:139], v[52:55], a[112:115]
  buffer_load_dwordx4 v[208:211], v19, s[12:15], s46 offen offset:0 sc1
  v_mfma_f32_16x16x32_bf16 a[132:135], v[136:139], v[56:59], a[132:135]
  v_mfma_f32_16x16x32_bf16 a[152:155], v[136:139], v[60:63], a[152:155]
  v_mfma_f32_16x16x32_bf16 a[96:99], v[140:143], v[48:51], a[96:99]
  v_mfma_f32_16x16x32_bf16 a[116:119], v[140:143], v[52:55], a[116:119]
  v_mfma_f32_16x16x32_bf16 a[136:139], v[140:143], v[56:59], a[136:139]
  v_mfma_f32_16x16x32_bf16 a[156:159], v[140:143], v[60:63], a[156:159]
  s_waitcnt vmcnt(8)
  v_mfma_f32_16x16x32_bf16 a[80:83], v[144:147], v[64:67], a[80:83]
  v_accvgpr_read_b32 v212, a0
  v_accvgpr_read_b32 v213, a1
  v_mfma_f32_16x16x32_bf16 a[100:103], v[144:147], v[68:71], a[100:103]
  v_accvgpr_read_b32 v214, a2
  v_accvgpr_read_b32 v215, a3
  v_mfma_f32_16x16x32_bf16 a[120:123], v[144:147], v[72:75], a[120:123]
  v_accvgpr_read_b32 v216, a4
  v_accvgpr_read_b32 v217, a5
  v_mfma_f32_16x16x32_bf16 a[140:143], v[144:147], v[76:79], a[140:143]
  v_accvgpr_read_b32 v218, a6
  v_accvgpr_read_b32 v219, a7
  v_mfma_f32_16x16x32_bf16 a[84:87], v[148:151], v[64:67], a[84:87]
  v_accvgpr_read_b32 v220, a8
  v_accvgpr_read_b32 v221, a9
  v_mfma_f32_16x16x32_bf16 a[104:107], v[148:151], v[68:71], a[104:107]
  v_accvgpr_read_b32 v222, a10
  v_accvgpr_read_b32 v223, a11
  v_mfma_f32_16x16x32_bf16 a[124:127], v[148:151], v[72:75], a[124:127]
  v_accvgpr_read_b32 v224, a12
  v_accvgpr_read_b32 v225, a13
  v_mfma_f32_16x16x32_bf16 a[144:147], v[148:151], v[76:79], a[144:147]
  v_accvgpr_read_b32 v226, a14
  v_accvgpr_read_b32 v227, a15
  v_mfma_f32_16x16x32_bf16 a[88:91], v[152:155], v[64:67], a[88:91]
  v_accvgpr_read_b32 v228, a16
  v_accvgpr_read_b32 v229, a17
  v_mfma_f32_16x16x32_bf16 a[108:111], v[152:155], v[68:71], a[108:111]
  v_accvgpr_read_b32 v230, a18
  v_accvgpr_read_b32 v231, a19
  v_mfma_f32_16x16x32_bf16 a[128:131], v[152:155], v[72:75], a[128:131]
  v_mfma_f32_16x16x32_bf16 a[148:151], v[152:155], v[76:79], a[148:151]
  v_mfma_f32_16x16x32_bf16 a[92:95], v[156:159], v[64:67], a[92:95]
  v_mfma_f32_16x16x32_bf16 a[112:115], v[156:159], v[68:71], a[112:115]
  v_mfma_f32_16x16x32_bf16 a[132:135], v[156:159], v[72:75], a[132:135]
  v_mfma_f32_16x16x32_bf16 a[152:155], v[156:159], v[76:79], a[152:155]
  v_mfma_f32_16x16x32_bf16 a[96:99], v[160:163], v[64:67], a[96:99]
  v_mfma_f32_16x16x32_bf16 a[116:119], v[160:163], v[68:71], a[116:119]
  v_mfma_f32_16x16x32_bf16 a[136:139], v[160:163], v[72:75], a[136:139]
  v_mfma_f32_16x16x32_bf16 a[156:159], v[160:163], v[76:79], a[156:159]
  s_waitcnt vmcnt(4)
  v_mfma_f32_16x16x32_bf16 a[80:83], v[164:167], v[80:83], a[80:83]
  v_mfma_f32_16x16x32_bf16 a[100:103], v[164:167], v[84:87], a[100:103]
  v_mfma_f32_16x16x32_bf16 a[120:123], v[164:167], v[88:91], a[120:123]
  v_mfma_f32_16x16x32_bf16 a[140:143], v[164:167], v[92:95], a[140:143]
  v_mfma_f32_16x16x32_bf16 a[84:87], v[168:171], v[80:83], a[84:87]
  v_mfma_f32_16x16x32_bf16 a[104:107], v[168:171], v[84:87], a[104:107]
  v_mfma_f32_16x16x32_bf16 a[124:127], v[168:171], v[88:91], a[124:127]
  v_mfma_f32_16x16x32_bf16 a[144:147], v[168:171], v[92:95], a[144:147]
  v_mfma_f32_16x16x32_bf16 a[88:91], v[172:175], v[80:83], a[88:91]
  v_mfma_f32_16x16x32_bf16 a[108:111], v[172:175], v[84:87], a[108:111]
  v_mfma_f32_16x16x32_bf16 a[128:131], v[172:175], v[88:91], a[128:131]
  v_mfma_f32_16x16x32_bf16 a[148:151], v[172:175], v[92:95], a[148:151]
  v_mfma_f32_16x16x32_bf16 a[92:95], v[176:179], v[80:83], a[92:95]
  v_mfma_f32_16x16x32_bf16 a[112:115], v[176:179], v[84:87], a[112:115]
  v_mfma_f32_16x16x32_bf16 a[132:135], v[176:179], v[88:91], a[132:135]
  v_mfma_f32_16x16x32_bf16 a[152:155], v[176:179], v[92:95], a[152:155]
  v_mfma_f32_16x16x32_bf16 a[96:99], v[180:183], v[80:83], a[96:99]
  v_mfma_f32_16x16x32_bf16 a[116:119], v[180:183], v[84:87], a[116:119]
  v_mfma_f32_16x16x32_bf16 a[136:139], v[180:183], v[88:91], a[136:139]
  v_mfma_f32_16x16x32_bf16 a[156:159], v[180:183], v[92:95], a[156:159]
  s_waitcnt vmcnt(0)
  s_cmp_lg_u32 s30, 0
  s_cbranch_scc1 L_p4q2
  buffer_load_dword v8, v9, s[24:27], s62 offen sc1
L_p4q2:
  v_mfma_f32_16x16x32_bf16 a[100:103], v[184:187], v[100:103], a[100:103]
  v_mfma_f32_16x16x32_bf16 a[104:107], v[188:191], v[100:103], a[104:107]
  v_mfma_f32_16x16x32_bf16 a[108:111], v[192:195], v[100:103], a[108:111]
  v_mfma_f32_16x16x32_bf16 a[112:115], v[196:199], v[100:103], a[112:115]
  v_mfma_f32_16x16x32_bf16 a[116:119], v[200:203], v[100:103], a[116:119]
  v_mfma_f32_16x16x32_bf16 a[120:123], v[184:187], v[204:207], a[120:123]
  v_mfma_f32_16x16x32_bf16 a[124:127], v[188:191], v[204:207], a[124:127]
  v_mfma_f32_16x16x32_bf16 a[128:131], v[192:195], v[204:207], a[128:131]
  v_mfma_f32_16x16x32_bf16 a[132:135], v[196:199], v[204:207], a[132:135]
  v_mfma_f32_16x16x32_bf16 a[136:139], v[200:203], v[204:207], a[136:139]
  ds_write_b128 v21, a[100:103] offset:0
  v_mfma_f32_16x16x32_bf16 a[140:143], v[184:187], v[208:211], a[140:143]
  ds_write_b128 v21, a[104:107] offset:1024
  v_mfma_f32_16x16x32_bf16 a[144:147], v[188:191], v[208:211], a[144:147]
  ds_write_b128 v21, a[108:111] offset:2048
  v_mfma_f32_16x16x32_bf16 a[148:151], v[192:195], v[208:211], a[148:151]
  ds_write_b128 v21, a[112:115] offset:3072
  v_mfma_f32_16x16x32_bf16 a[152:155], v[196:199], v[208:211], a[152:155]
  ds_write_b128 v21, a[116:119] offset:4096
  v_mfma_f32_16x16x32_bf16 a[156:159], v[200:203], v[208:211], a[156:159]
  ds_write_b128 v22, a[120:123] offset:0
  v_mfma_f32_16x16x32_bf16 a[80:83], v[184:187], v[96:99], a[80:83]
  ds_write_b128 v22, a[124:127] offset:1024
  v_mfma_f32_16x16x32_bf16 a[84:87], v[188:191], v[96:99], a[84:87]
  ds_write_b128 v22, a[128:131] offset:2048
  v_mfma_f32_16x16x32_bf16 a[88:91], v[192:195], v[96:99], a[88:91]
  ds_write_b128 v22, a[132:135] offset:3072
  v_mfma_f32_16x16x32_bf16 a[92:95], v[196:199], v[96:99], a[92:95]
  ds_write_b128 v22, a[136:139] offset:4096
  v_mfma_f32_16x16x32_bf16 a[96:99], v[200:203], v[96:99], a[96:99]
  ds_write_b128 v23, a[140:143] offset:0
  ds_write_b128 v23, a[144:147] offset:1024
  ds_write_b128 v23, a[148:151] offset:2048
  ds_write_b128 v23, a[152:155] offset:3072
  ds_write_b128 v23, a[156:159] offset:4096
  v_accvgpr_read_b32 v32, a80
  v_accvgpr_read_b32 v33, a81
  v_accvgpr_read_b32 v34, a82
  v_accvgpr_read_b32 v35, a83
  v_accvgpr_read_b32 v36, a84
  v_accvgpr_read_b32 v37, a85
  v_accvgpr_read_b32 v38, a86
  v_accvgpr_read_b32 v39, a87
  v_accvgpr_read_b32 v40, a88
  v_accvgpr_read_b32 v41, a89
  v_accvgpr_read_b32 v42, a90
  v_accvgpr_read_b32 v43, a91
  v_accvgpr_read_b32 v44, a92
  v_accvgpr_read_b32 v45, a93
  v_accvgpr_read_b32 v46, a94
  v_accvgpr_read_b32 v47, a95
  v_accvgpr_read_b32 v48, a96
  v_accvgpr_read_b32 v49, a97
  v_accvgpr_read_b32 v50, a98
  v_accvgpr_read_b32 v51, a99
  s_mul_i32 s31, s48, 30720
  s_add_u32 s35, s35, s31
  s_cmp_lg_u32 s30, 0
  s_cbranch_scc1 L_p4w4
  s_waitcnt vmcnt(0)
  v_cmp_eq_u32 vcc, s100, v8
  s_mov_b32 s33, 15
  s_nop 0
  s_andn2_b32 s31, s33, vcc_lo
  s_cbranch_scc0 L_p4w4
  s_mov_b32 s34, 262144
  s_mov_b32 s33, 15
L_p4s4:
  buffer_load_dword v8, v9, s[24:27], s62 offen sc1
  s_waitcnt vmcnt(0)
  v_cmp_eq_u32 vcc, s100, v8
  s_sub_u32 s34, s34, 1
  s_cselect_b32 s33, 0, s33
  s_andn2_b32 s31, s33, vcc_lo
  s_cbranch_scc1 L_p4s4
L_p4w4:
  s_waitcnt lgkmcnt(0)
  s_barrier
  buffer_load_dwordx4 v[140:143], v3, s[20:23], s35 offen sc1
  buffer_load_dwordx4 v[144:147], v3, s[20:23], s35 offen offset:1024 sc1
  buffer_load_dwordx2 v[148:149], v15, s[20:23], s35 offen offset:2048 sc1
  s_add_u32 s35, s35, 10240
  buffer_load_dwordx4 v[150:153], v3, s[20:23], s35 offen sc1
  buffer_load_dwordx4 v[154:157], v3, s[20:23], s35 offen offset:1024 sc1
  buffer_load_dwordx2 v[158:159], v15, s[20:23], s35 offen offset:2048 sc1
  s_add_u32 s35, s35, 10240
  buffer_load_dwordx4 v[160:163], v3, s[20:23], s35 offen sc1
  buffer_load_dwordx4 v[164:167], v3, s[20:23], s35 offen offset:1024 sc1
  buffer_load_dwordx2 v[168:169], v15, s[20:23], s35 offen offset:2048 sc1
  ds_read_b128 v[72:75], v24 offset:0
  ds_read_b128 v[76:79], v24 offset:1024
  ds_read_b128 v[80:83], v24 offset:2048
  ds_read_b128 v[84:87], v24 offset:3072
  ds_read_b128 v[88:91], v24 offset:4096
  ds_read_b128 v[92:95], v24 offset:5120
  ds_read_b128 v[96:99], v24 offset:6144
  ds_read_b128 v[100:103], v24 offset:7168
  ds_read_b128 v[104:107], v24 offset:8192
  ds_read_b128 v[108:111], v24 offset:9216
  ds_read_b128 v[112:115], v24 offset:10240
  ds_read_b128 v[116:119], v24 offset:11264
  ds_read_b128 v[120:123], v24 offset:12288
  ds_read_b128 v[124:127], v24 offset:13312
  ds_read_b128 v[128:131], v24 offset:14336
  s_waitcnt lgkmcnt(0)
  v_add_f32 v32, v32, v72
  v_add_f32 v33, v33, v73
  v_add_f32 v34, v34, v74
  v_add_f32 v35, v35, v75
  v_add_f32 v36, v36, v76
  v_add_f32 v37, v37, v77
  v_add_f32 v38, v38, v78
  v_add_f32 v39, v39, v79
  v_add_f32 v40, v40, v80
  v_add_f32 v41, v41, v81
  v_add_f32 v42, v42, v82
  v_add_f32 v43, v43, v83
  v_add_f32 v44, v44, v84
  v_add_f32 v45, v45, v85
  v_add_f32 v46, v46, v86
  v_add_f32 v47, v47, v87
  v_add_f32 v48, v48, v88
  v_add_f32 v49, v49, v89
  v_add_f32 v50, v50, v90
  v_add_f32 v51, v51, v91
  v_add_f32 v32, v32, v92
  v_add_f32 v33, v33, v93
  v_add_f32 v34, v34, v94
  v_add_f32 v35, v35, v95
  v_add_f32 v36, v36, v96
  v_add_f32 v37, v37, v97
  v_add_f32 v38, v38, v98
  v_add_f32 v39, v39, v99
  v_add_f32 v40, v40, v100
  v_add_f32 v41, v41, v101
  v_add_f32 v42, v42, v102
  v_add_f32 v43, v43, v103
  v_add_f32 v44, v44, v104
  v_add_f32 v45, v45, v105
  v_add_f32 v46, v46, v106
  v_add_f32 v47, v47, v107
  v_add_f32 v48, v48, v108
  v_add_f32 v49, v49, v109
  v_add_f32 v50, v50, v110
  v_add_f32 v51, v51, v111
  v_add_f32 v32, v32, v112
  v_add_f32 v33, v33, v113
  v_add_f32 v34, v34, v114
  v_add_f32 v35, v35, v115
  v_add_f32 v36, v36, v116
  v_add_f32 v37, v37, v117
  v_add_f32 v38, v38, v118
  v_add_f32 v39, v39, v119
  v_add_f32 v40, v40, v120
  v_add_f32 v41, v41, v121
  v_add_f32 v42, v42, v122
  v_add_f32 v43, v43, v123
  v_add_f32 v44, v44, v124
  v_add_f32 v45, v45, v125
  v_add_f32 v46, v46, v126
  v_add_f32 v47, v47, v127
  v_add_f32 v48, v48, v128
  v_add_f32 v49, v49, v129
  v_add_f32 v50, v50, v130
  v_add_f32 v51, v51, v131
  v_cvt_pk_bf16_f32 v72, v32, v33
  v_cvt_pk_bf16_f32 v73, v34, v35
  v_cvt_pk_bf16_f32 v74, v36, v37
  v_cvt_pk_bf16_f32 v75, v38, v39
  v_cvt_pk_bf16_f32 v76, v40, v41
  v_cvt_pk_bf16_f32 v77, v42, v43
  v_cvt_pk_bf16_f32 v78, v44, v45
  v_cvt_pk_bf16_f32 v79, v46, v47
  v_cvt_pk_bf16_f32 v80, v48, v49
  v_cvt_pk_bf16_f32 v81, v50, v51
  buffer_store_dwordx4 v[72:75], v13, s[64:67], 0 offen
  buffer_store_dwordx4 v[76:79], v13, s[64:67], 0 offen offset:16
  buffer_store_dwordx2 v[80:81], v13, s[64:67], 0 offen offset:32
  s_waitcnt vmcnt(9)
  v_lshlrev_b32 v180, 16, v140
  v_and_b32 v181, 0xffff0000, v140
  v_add_f32 v212, v212, v180
  v_add_f32 v213, v213, v181
  v_lshlrev_b32 v180, 16, v141
  v_and_b32 v181, 0xffff0000, v141
  v_add_f32 v214, v214, v180
  v_add_f32 v215, v215, v181
  v_lshlrev_b32 v180, 16, v142
  v_and_b32 v181, 0xffff0000, v142
  v_add_f32 v216, v216, v180
  v_add_f32 v217, v217, v181
  v_lshlrev_b32 v180, 16, v143
  v_and_b32 v181, 0xffff0000, v143
  v_add_f32 v218, v218, v180
  v_add_f32 v219, v219, v181
  v_lshlrev_b32 v180, 16, v144
  v_and_b32 v181, 0xffff0000, v144
  v_add_f32 v220, v220, v180
  v_add_f32 v221, v221, v181
  v_lshlrev_b32 v180, 16, v145
  v_and_b32 v181, 0xffff0000, v145
  v_add_f32 v222, v222, v180
  v_add_f32 v223, v223, v181
  v_lshlrev_b32 v180, 16, v146
  v_and_b32 v181, 0xffff0000, v146
  v_add_f32 v224, v224, v180
  v_add_f32 v225, v225, v181
  v_lshlrev_b32 v180, 16, v147
  v_and_b32 v181, 0xffff0000, v147
  v_add_f32 v226, v226, v180
  v_add_f32 v227, v227, v181
  v_lshlrev_b32 v180, 16, v148
  v_and_b32 v181, 0xffff0000, v148
  v_add_f32 v228, v228, v180
  v_add_f32 v229, v229, v181
  v_lshlrev_b32 v180, 16, v149
  v_and_b32 v181, 0xffff0000, v149
  v_add_f32 v230, v230, v180
  v_add_f32 v231, v231, v181
  s_waitcnt vmcnt(6)
  v_lshlrev_b32 v180, 16, v150
  v_and_b32 v181, 0xffff0000, v150
  v_add_f32 v212, v212, v180
  v_add_f32 v213, v213, v181
  v_lshlrev_b32 v180, 16, v151
  v_and_b32 v181, 0xffff0000, v151
  v_add_f32 v214, v214, v180
  v_add_f32 v215, v215, v181
  v_lshlrev_b32 v180, 16, v152
  v_and_b32 v181, 0xffff0000, v152
  v_add_f32 v216, v216, v180
  v_add_f32 v217, v217, v181
  v_lshlrev_b32 v180, 16, v153
  v_and_b32 v181, 0xffff0000, v153
  v_add_f32 v218, v218, v180
  v_add_f32 v219, v219, v181
  v_lshlrev_b32 v180, 16, v154
  v_and_b32 v181, 0xffff0000, v154
  v_add_f32 v220, v220, v180
  v_add_f32 v221, v221, v181
  v_lshlrev_b32 v180, 16, v155
  v_and_b32 v181, 0xffff0000, v155
  v_add_f32 v222, v222, v180
  v_add_f32 v223, v223, v181
  v_lshlrev_b32 v180, 16, v156
  v_and_b32 v181, 0xffff0000, v156
  v_add_f32 v224, v224, v180
  v_add_f32 v225, v225, v181
  v_lshlrev_b32 v180, 16, v157
  v_and_b32 v181, 0xffff0000, v157
  v_add_f32 v226, v226, v180
  v_add_f32 v227, v227, v181
  v_lshlrev_b32 v180, 16, v158
  v_and_b32 v181, 0xffff0000, v158
  v_add_f32 v228, v228, v180
  v_add_f32 v229, v229, v181
  v_lshlrev_b32 v180, 16, v159
  v_and_b32 v181, 0xffff0000, v159
  v_add_f32 v230, v230, v180
  v_add_f32 v231, v231, v181
  s_waitcnt vmcnt(3)
  v_lshlrev_b32 v180, 16, v160
  v_and_b32 v181, 0xffff0000, v160
  v_add_f32 v212, v212, v180
  v_add_f32 v213, v213, v181
  v_lshlrev_b32 v180, 16, v161
  v_and_b32 v181, 0xffff0000, v161
  v_add_f32 v214, v214, v180
  v_add_f32 v215, v215, v181
  v_lshlrev_b32 v180, 16, v162
  v_and_b32 v181, 0xffff0000, v162
  v_add_f32 v216, v216, v180
  v_add_f32 v217, v217, v181
  v_lshlrev_b32 v180, 16, v163
  v_and_b32 v181, 0xffff0000, v163
  v_add_f32 v218, v218, v180
  v_add_f32 v219, v219, v181
  v_lshlrev_b32 v180, 16, v164
  v_and_b32 v181, 0xffff0000, v164
  v_add_f32 v220, v220, v180
  v_add_f32 v221, v221, v181
  v_lshlrev_b32 v180, 16, v165
  v_and_b32 v181, 0xffff0000, v165
  v_add_f32 v222, v222, v180
  v_add_f32 v223, v223, v181
  v_lshlrev_b32 v180, 16, v166
  v_and_b32 v181, 0xffff0000, v166
  v_add_f32 v224, v224, v180
  v_add_f32 v225, v225, v181
  v_lshlrev_b32 v180, 16, v167
  v_and_b32 v181, 0xffff0000, v167
  v_add_f32 v226, v226, v180
  v_add_f32 v227, v227, v181
  v_lshlrev_b32 v180, 16, v168
  v_and_b32 v181, 0xffff0000, v168
  v_add_f32 v228, v228, v180
  v_add_f32 v229, v229, v181
  v_lshlrev_b32 v180, 16, v169
  v_and_b32 v181, 0xffff0000, v169
  v_add_f32 v230, v230, v180
  v_add_f32 v231, v231, v181
  v_cvt_pk_bf16_f32 v184, v212, v213
  v_cvt_pk_bf16_f32 v185, v214, v215
  v_cvt_pk_bf16_f32 v186, v216, v217
  v_cvt_pk_bf16_f32 v187, v218, v219
  v_cvt_pk_bf16_f32 v188, v220, v221
  v_cvt_pk_bf16_f32 v189, v222, v223
  v_cvt_pk_bf16_f32 v190, v224, v225
  v_cvt_pk_bf16_f32 v191, v226, v227
  v_cvt_pk_bf16_f32 v192, v228, v229
  v_cvt_pk_bf16_f32 v193, v230, v231
  buffer_store_dwordx4 v[184:187], v14, s[64:67], 0 offen
  buffer_store_dwordx4 v[188:191], v14, s[64:67], 0 offen offset:16
  buffer_store_dwordx2 v[192:193], v14, s[64:67], 0 offen offset:32
  s_endpgm
L_fin0:
  s_add_u32 s31, s2, s100
  s_and_b32 s48, s31, 3
  s_lshr_b32 s32, s31, 2
  s_xor_b32 s31, s31, s32
  s_and_b32 s31, s31, 1
  s_lshl_b32 s49, s31, 3
  s_mov_b32 s56, 0
  s_mov_b32 s57, 0
  s_cmp_eq_u32 s48, 1
  s_cselect_b32 s56, 470618644, s56
  s_cselect_b32 s57, 134746129, s57
  s_cmp_eq_u32 s48, 2
  s_cselect_b32 s56, 606020380, s56
  s_cselect_b32 s57, 605822241, s57
  s_cmp_eq_u32 s48, 3
  s_cselect_b32 s56, 942682936, s56
  s_cselect_b32 s57, 740568878, s57
  s_lshl_b32 s31, s29, 3
  s_lshr_b64 s[56:57], s[56:57], s31
  s_and_b32 s54, s56, 255
  s_mov_b32 s56, 135269640
  s_mov_b32 s57, 337383698
  s_lshr_b64 s[56:57], s[56:57], s31
  s_and_b32 s55, s56, 255
  s_cmp_eq_u32 s49, 0
  s_cselect_b32 s32, 3, 2
  s_bitcmp1_b32 s48, 0
  s_cselect_b32 s33, s32, 0
  s_add_u32 s54, s54, s33
  s_lshl_b32 s33, s33, 1
  s_sub_u32 s32, s32, s33
  s_add_u32 s55, s55, s32
  s_lshl_b32 s31, s29, 2
  s_lshr_b32 s31, 544478803, s31
  s_sub_u32 s32, s31, s48
  s_and_b32 s32, s32, 3
  s_and_b32 s31, s31, 4
  s_or_b32 s31, s31, s32
  s_and_b32 s50, s31, 2
  s_bfe_u32 s32, s28, 0x10001
  s_or_b32 s50, s50, s32
  s_and_b32 s32, s31, 1
  s_lshl_b32 s32, s32, 1
  s_and_b32 s31, s31, 4
  s_or_b32 s31, s31, s32
  s_and_b32 s32, s28, 1
  s_or_b32 s31, s31, s32
  s_lshl_b32 s31, s31, 2
  s_lshr_b32 s31, 1980781618, s31
  s_and_b32 s31, s31, 7
  s_add_u32 s49, s49, s31
  s_lshl_b32 s51, s49, 2
  s_add_u32 s51, s51, s50
  s_and_b32 s52, s30, 1
  s_lshr_b32 s53, s30, 1
  v_and_b32 v9, 31, v2
  v_lshlrev_b32 v9, 2, v9
  s_lshr_b32 s62, s49, 1
  s_lshl_b32 s62, s62, 7
  s_add_u32 s62, s62, 4096
  s_lshr_b32 s31, s54, 1
  s_add_u32 s32, s54, s55
  s_add_u32 s32, s32, 1
  s_lshr_b32 s32, s32, 1
  s_sub_u32 s32, s32, s31
  s_bfm_b32 s63, s32, s31
  s_lshl_b32 s31, s50, 1
  s_add_u32 s31, s31, s53
  s_mul_i32 s31, s31, 148
  s_lshl_b32 s32, s54, 1
  s_add_u32 s31, s31, s32
  s_add_u32 s31, s31, s52
  s_mul_i32 s58, s31, 5120
  s_lshl_b32 s31, s49, 3
  s_lshl_b32 s33, s30, 1
  s_add_u32 s31, s31, s33
  s_mul_i32 s31, s31, 148
  s_add_u32 s31, s31, s32
  s_lshl_b32 s59, s31, 10
  s_cmp_lg_u32 s30, 0
  s_cbranch_scc1 L_f0a
  s_mov_b32 s32, 29696
  buffer_load_dwordx4 v[20:23], v236, s[24:27], s32 offen sc1
  buffer_load_dword v24, v9, s[24:27], s62 offen sc1
L_f0a:
  s_waitcnt vmcnt(0) lgkmcnt(0)
  s_barrier
  s_cmp_lg_u32 s30, 0
  s_cbranch_scc1 L_f0b
  s_waitcnt vmcnt(0)
  v_xor_b32 v20, s100, v20
  v_xor_b32 v21, s100, v21
  v_xor_b32 v22, s100, v22
  v_xor_b32 v23, s100, v23
  v_or3_b32 v20, v20, v21, v22
  v_or_b32 v20, v20, v23
  v_cmp_ne_u32 vcc, 0, v20
  v_cmp_eq_u32 s[56:57], s100, v24
  s_nop 0
  s_andn2_b32 s31, s63, s56
  s_or_b32 s31, s31, vcc_lo
  s_mov_b32 s34, s31
  s_lshl_b32 s31, s29, 7
  s_lshl_b32 s33, s28, 2
  s_add_u32 s31, s31, s33
  s_add_u32 s31, s31, 4096
  v_mov_b32 v6, s100
  v_mov_b32 v7, 0
  s_mov_b64 exec, 1
  buffer_store_dword v6, v7, s[24:27], s31 offen offset:0 sc1
  s_mov_b64 exec, -1
  s_cmp_lg_u32 s34, 0
  s_cbranch_scc0 L_f0b
  s_mov_b32 s34, 262144
L_f0bl:
  s_mov_b32 s32, 29696
  buffer_load_dwordx4 v[20:23], v236, s[24:27], s32 offen sc1
  buffer_load_dword v24, v9, s[24:27], s62 offen sc1
  s_sub_u32 s34, s34, 1
  s_cbranch_scc1 L_f0b
  s_waitcnt vmcnt(0)
  v_xor_b32 v20, s100, v20
  v_xor_b32 v21, s100, v21
  v_xor_b32 v22, s100, v22
  v_xor_b32 v23, s100, v23
  v_or3_b32 v20, v20, v21, v22
  v_or_b32 v20, v20, v23
  v_cmp_ne_u32 vcc, 0, v20
  v_cmp_eq_u32 s[56:57], s100, v24
  s_nop 0
  s_andn2_b32 s31, s63, s56
  s_or_b32 s31, s31, vcc_lo
  s_cbranch_scc1 L_f0bl
  s_branch L_f0b
L_f0b:
  s_barrier
  s_add_u32 s64, s6, 54525952
  s_addc_u32 s65, s7, 0
  s_and_b32 s65, s65, 0xffff
  s_mov_b32 s66, 6062080
  s_mov_b32 s67, 0x20000
  v_mov_b32 v10, v236
  v_add_u32 v11, 149504, v236
  v_add_u32 v27, 4096, v236
  s_mul_i32 s38, s30, 5120
  s_add_u32 s38, s38, 16384
  s_lshl_b32 s46, s30, 12
  s_add_u32 m0, s38, 0
  s_nop 0
  buffer_load_dwordx4 v10, s[64:67], s58 offen offset:0 sc1 lds
  buffer_load_dwordx4 v10, s[64:67], s58 offen offset:1024 sc1 lds
  buffer_load_dwordx4 v10, s[64:67], s58 offen offset:2048 sc1 lds
  buffer_load_dwordx4 v10, s[64:67], s58 offen offset:3072 sc1 lds
  s_add_u32 m0, s38, 4096
  s_nop 0
  buffer_load_dwordx4 v27, s[64:67], s58 offen sc1 lds
  s_add_u32 s58, s58, 10240
  s_add_u32 m0, s46, 0
  s_nop 0
  buffer_load_dwordx4 v10, s[12:15], s59 offen offset:0 sc1 lds
  buffer_load_dwordx4 v10, s[12:15], s59 offen offset:1024 sc1 lds
  buffer_load_dwordx4 v11, s[12:15], s59 offen offset:2048 sc1 lds
  buffer_load_dwordx4 v11, s[12:15], s59 offen offset:3072 sc1 lds
  s_add_u32 s59, s59, 2048
  s_add_u32 m0, s38, 36864
  s_nop 0
  buffer_load_dwordx4 v10, s[64:67], s58 offen offset:0 sc1 lds
  buffer_load_dwordx4 v10, s[64:67], s58 offen offset:1024 sc1 lds
  buffer_load_dwordx4 v10, s[64:67], s58 offen offset:2048 sc1 lds
  buffer_load_dwordx4 v10, s[64:67], s58 offen offset:3072 sc1 lds
  s_add_u32 m0, s38, 40960
  s_nop 0
  buffer_load_dwordx4 v27, s[64:67], s58 offen sc1 lds
  s_add_u32 s58, s58, 10240
  s_add_u32 m0, s46, 36864
  s_nop 0
  buffer_load_dwordx4 v10, s[12:15], s59 offen offset:0 sc1 lds
  buffer_load_dwordx4 v10, s[12:15], s59 offen offset:1024 sc1 lds
  buffer_load_dwordx4 v11, s[12:15], s59 offen offset:2048 sc1 lds
  buffer_load_dwordx4 v11, s[12:15], s59 offen offset:3072 sc1 lds
  s_add_u32 s59, s59, 2048
  s_branch L_p4
L_epi0:
  v_mov_b32 v248, v232
  v_mov_b32 v249, v233
  v_mov_b32 v250, v234
  v_mov_b32 v251, v235
  s_nop 0
  v_permlane32_swap_b32 v232, v248
  v_permlane32_swap_b32 v233, v249
  v_permlane32_swap_b32 v234, v250
  v_permlane32_swap_b32 v235, v251
  s_nop 0
  v_add_f32 v232, v232, v248
  v_add_f32 v233, v233, v249
  v_add_f32 v234, v234, v250
  v_add_f32 v235, v235, v251
  v_mov_b32 v248, v232
  v_mov_b32 v249, v233
  v_mov_b32 v250, v234
  v_mov_b32 v251, v235
  s_nop 0
  v_permlane16_swap_b32 v232, v248
  v_permlane16_swap_b32 v233, v249
  v_permlane16_swap_b32 v234, v250
  v_permlane16_swap_b32 v235, v251
  s_nop 0
  v_add_f32 v232, v232, v248
  v_add_f32 v233, v233, v249
  v_add_f32 v234, v234, v250
  v_add_f32 v235, v235, v251
  v_accvgpr_write_b32 a128, v232
  v_accvgpr_write_b32 a132, v233
  v_accvgpr_write_b32 a136, v234
  v_accvgpr_write_b32 a140, v235
  s_mov_b32 s31, 1904214016
  s_mov_b64 s[56:57], 0
  v_accvgpr_read_b32 v240, a128
  v_cmp_ngt_f32 vcc, s31, v240
  s_nop 1
  s_or_b64 s[56:57], s[56:57], vcc
  v_cmp_nlt_f32 vcc, 0.5, v240
  s_nop 1
  s_or_b64 s[56:57], s[56:57], vcc
  v_accvgpr_read_b32 v241, a132
  v_cmp_ngt_f32 vcc, s31, v241
  s_nop 1
  s_or_b64 s[56:57], s[56:57], vcc
  v_cmp_nlt_f32 vcc, 0.5, v241
  s_nop 1
  s_or_b64 s[56:57], s[56:57], vcc
  v_accvgpr_read_b32 v242, a136
  v_cmp_ngt_f32 vcc, s31, v242
  s_nop 1
  s_or_b64 s[56:57], s[56:57], vcc
  v_cmp_nlt_f32 vcc, 0.5, v242
  s_nop 1
  s_or_b64 s[56:57], s[56:57], vcc
  v_accvgpr_read_b32 v243, a140
  v_cmp_ngt_f32 vcc, s31, v243
  s_nop 1
  s_or_b64 s[56:57], s[56:57], vcc
  v_cmp_nlt_f32 vcc, 0.5, v243
  s_nop 1
  s_or_b64 s[56:57], s[56:57], vcc
  s_cmp_lg_u64 s[56:57], 0
  s_cselect_b32 s31, 1, 0
  v_mov_b32 v7, s31
  s_lshl_b32 s31, s30, 2
  s_add_u32 s31, s31, 163824
  v_mov_b32 v6, s31
  ds_write_b32 v6, v7
  v_rcp_f32 v244, v240
  v_rcp_f32 v245, v241
  v_rcp_f32 v246, v242
  v_rcp_f32 v247, v243
  s_lshl_b32 s31, s29, 4
  s_add_u32 s32, s31, s30
  s_sub_u32 s33, s31, s30
  s_add_u32 s33, s33, 7
  s_mul_i32 s32, s32, 151552
  s_mul_i32 s33, s33, 151552
  s_lshl_b32 s31, s28, 12
  s_add_u32 s32, s32, s31
  s_add_u32 s33, s33, s31
  v_accvgpr_read_b32 v128, a0
  v_accvgpr_read_b32 v129, a1
  v_accvgpr_read_b32 v130, a2
  v_accvgpr_read_b32 v131, a3
  v_accvgpr_read_b32 v132, a16
  v_accvgpr_read_b32 v133, a17
  v_accvgpr_read_b32 v134, a18
  v_accvgpr_read_b32 v135, a19
  v_mul_f32 v128, v128, v244
  v_mul_f32 v129, v129, v244
  v_mul_f32 v130, v130, v244
  v_mul_f32 v131, v131, v244
  v_mul_f32 v132, v132, v244
  v_mul_f32 v133, v133, v244
  v_mul_f32 v134, v134, v244
  v_mul_f32 v135, v135, v244
  v_cvt_pk_bf16_f32 v136, v128, v129
  v_cvt_pk_bf16_f32 v137, v130, v131
  v_cvt_pk_bf16_f32 v138, v132, v133
  v_cvt_pk_bf16_f32 v139, v134, v135
  buffer_store_dwordx4 v[136:139], v236, s[12:15], s32 offen offset:0 sc1
  v_accvgpr_read_b32 v144, a32
  v_accvgpr_read_b32 v145, a33
  v_accvgpr_read_b32 v146, a34
  v_accvgpr_read_b32 v147, a35
  v_accvgpr_read_b32 v148, a48
  v_accvgpr_read_b32 v149, a49
  v_accvgpr_read_b32 v150, a50
  v_accvgpr_read_b32 v151, a51
  v_mul_f32 v144, v144, v244
  v_mul_f32 v145, v145, v244
  v_mul_f32 v146, v146, v244
  v_mul_f32 v147, v147, v244
  v_mul_f32 v148, v148, v244
  v_mul_f32 v149, v149, v244
  v_mul_f32 v150, v150, v244
  v_mul_f32 v151, v151, v244
  v_cvt_pk_bf16_f32 v152, v144, v145
  v_cvt_pk_bf16_f32 v153, v146, v147
  v_cvt_pk_bf16_f32 v154, v148, v149
  v_cvt_pk_bf16_f32 v155, v150, v151
  buffer_store_dwordx4 v[152:155], v236, s[12:15], s32 offen offset:1024 sc1
  v_accvgpr_read_b32 v160, a64
  v_accvgpr_read_b32 v161, a65
  v_accvgpr_read_b32 v162, a66
  v_accvgpr_read_b32 v163, a67
  v_accvgpr_read_b32 v164, a80
  v_accvgpr_read_b32 v165, a81
  v_accvgpr_read_b32 v166, a82
  v_accvgpr_read_b32 v167, a83
  v_mul_f32 v160, v160, v244
  v_mul_f32 v161, v161, v244
  v_mul_f32 v162, v162, v244
  v_mul_f32 v163, v163, v244
  v_mul_f32 v164, v164, v244
  v_mul_f32 v165, v165, v244
  v_mul_f32 v166, v166, v244
  v_mul_f32 v167, v167, v244
  v_cvt_pk_bf16_f32 v168, v160, v161
  v_cvt_pk_bf16_f32 v169, v162, v163
  v_cvt_pk_bf16_f32 v170, v164, v165
  v_cvt_pk_bf16_f32 v171, v166, v167
  buffer_store_dwordx4 v[168:171], v236, s[12:15], s32 offen offset:2048 sc1
  v_accvgpr_read_b32 v176, a96
  v_accvgpr_read_b32 v177, a97
  v_accvgpr_read_b32 v178, a98
  v_accvgpr_read_b32 v179, a99
  v_accvgpr_read_b32 v180, a112
  v_accvgpr_read_b32 v181, a113
  v_accvgpr_read_b32 v182, a114
  v_accvgpr_read_b32 v183, a115
  v_mul_f32 v176, v176, v244
  v_mul_f32 v177, v177, v244
  v_mul_f32 v178, v178, v244
  v_mul_f32 v179, v179, v244
  v_mul_f32 v180, v180, v244
  v_mul_f32 v181, v181, v244
  v_mul_f32 v182, v182, v244
  v_mul_f32 v183, v183, v244
  v_cvt_pk_bf16_f32 v184, v176, v177
  v_cvt_pk_bf16_f32 v185, v178, v179
  v_cvt_pk_bf16_f32 v186, v180, v181
  v_cvt_pk_bf16_f32 v187, v182, v183
  buffer_store_dwordx4 v[184:187], v236, s[12:15], s32 offen offset:3072 sc1
  v_accvgpr_read_b32 v128, a4
  v_accvgpr_read_b32 v129, a5
  v_accvgpr_read_b32 v130, a6
  v_accvgpr_read_b32 v131, a7
  v_accvgpr_read_b32 v132, a20
  v_accvgpr_read_b32 v133, a21
  v_accvgpr_read_b32 v134, a22
  v_accvgpr_read_b32 v135, a23
  v_mul_f32 v128, v128, v245
  v_mul_f32 v129, v129, v245
  v_mul_f32 v130, v130, v245
  v_mul_f32 v131, v131, v245
  v_mul_f32 v132, v132, v245
  v_mul_f32 v133, v133, v245
  v_mul_f32 v134, v134, v245
  v_mul_f32 v135, v135, v245
  v_cvt_pk_bf16_f32 v136, v128, v129
  v_cvt_pk_bf16_f32 v137, v130, v131
  v_cvt_pk_bf16_f32 v138, v132, v133
  v_cvt_pk_bf16_f32 v139, v134, v135
  buffer_store_dwordx4 v[136:139], v236, s[12:15], s33 offen offset:0 sc1
  v_accvgpr_read_b32 v144, a36
  v_accvgpr_read_b32 v145, a37
  v_accvgpr_read_b32 v146, a38
  v_accvgpr_read_b32 v147, a39
  v_accvgpr_read_b32 v148, a52
  v_accvgpr_read_b32 v149, a53
  v_accvgpr_read_b32 v150, a54
  v_accvgpr_read_b32 v151, a55
  v_mul_f32 v144, v144, v245
  v_mul_f32 v145, v145, v245
  v_mul_f32 v146, v146, v245
  v_mul_f32 v147, v147, v245
  v_mul_f32 v148, v148, v245
  v_mul_f32 v149, v149, v245
  v_mul_f32 v150, v150, v245
  v_mul_f32 v151, v151, v245
  v_cvt_pk_bf16_f32 v152, v144, v145
  v_cvt_pk_bf16_f32 v153, v146, v147
  v_cvt_pk_bf16_f32 v154, v148, v149
  v_cvt_pk_bf16_f32 v155, v150, v151
  buffer_store_dwordx4 v[152:155], v236, s[12:15], s33 offen offset:1024 sc1
  v_accvgpr_read_b32 v160, a68
  v_accvgpr_read_b32 v161, a69
  v_accvgpr_read_b32 v162, a70
  v_accvgpr_read_b32 v163, a71
  v_accvgpr_read_b32 v164, a84
  v_accvgpr_read_b32 v165, a85
  v_accvgpr_read_b32 v166, a86
  v_accvgpr_read_b32 v167, a87
  v_mul_f32 v160, v160, v245
  v_mul_f32 v161, v161, v245
  v_mul_f32 v162, v162, v245
  v_mul_f32 v163, v163, v245
  v_mul_f32 v164, v164, v245
  v_mul_f32 v165, v165, v245
  v_mul_f32 v166, v166, v245
  v_mul_f32 v167, v167, v245
  v_cvt_pk_bf16_f32 v168, v160, v161
  v_cvt_pk_bf16_f32 v169, v162, v163
  v_cvt_pk_bf16_f32 v170, v164, v165
  v_cvt_pk_bf16_f32 v171, v166, v167
  buffer_store_dwordx4 v[168:171], v236, s[12:15], s33 offen offset:2048 sc1
  v_accvgpr_read_b32 v176, a100
  v_accvgpr_read_b32 v177, a101
  v_accvgpr_read_b32 v178, a102
  v_accvgpr_read_b32 v179, a103
  v_accvgpr_read_b32 v180, a116
  v_accvgpr_read_b32 v181, a117
  v_accvgpr_read_b32 v182, a118
  v_accvgpr_read_b32 v183, a119
  v_mul_f32 v176, v176, v245
  v_mul_f32 v177, v177, v245
  v_mul_f32 v178, v178, v245
  v_mul_f32 v179, v179, v245
  v_mul_f32 v180, v180, v245
  v_mul_f32 v181, v181, v245
  v_mul_f32 v182, v182, v245
  v_mul_f32 v183, v183, v245
  v_cvt_pk_bf16_f32 v184, v176, v177
  v_cvt_pk_bf16_f32 v185, v178, v179
  v_cvt_pk_bf16_f32 v186, v180, v181
  v_cvt_pk_bf16_f32 v187, v182, v183
  buffer_store_dwordx4 v[184:187], v236, s[12:15], s33 offen offset:3072 sc1
  s_add_u32 s32, s32, 1212416
  s_add_u32 s33, s33, 1212416
  v_accvgpr_read_b32 v128, a8
  v_accvgpr_read_b32 v129, a9
  v_accvgpr_read_b32 v130, a10
  v_accvgpr_read_b32 v131, a11
  v_accvgpr_read_b32 v132, a24
  v_accvgpr_read_b32 v133, a25
  v_accvgpr_read_b32 v134, a26
  v_accvgpr_read_b32 v135, a27
  v_mul_f32 v128, v128, v246
  v_mul_f32 v129, v129, v246
  v_mul_f32 v130, v130, v246
  v_mul_f32 v131, v131, v246
  v_mul_f32 v132, v132, v246
  v_mul_f32 v133, v133, v246
  v_mul_f32 v134, v134, v246
  v_mul_f32 v135, v135, v246
  v_cvt_pk_bf16_f32 v136, v128, v129
  v_cvt_pk_bf16_f32 v137, v130, v131
  v_cvt_pk_bf16_f32 v138, v132, v133
  v_cvt_pk_bf16_f32 v139, v134, v135
  buffer_store_dwordx4 v[136:139], v236, s[12:15], s32 offen offset:0 sc1
  v_accvgpr_read_b32 v144, a40
  v_accvgpr_read_b32 v145, a41
  v_accvgpr_read_b32 v146, a42
  v_accvgpr_read_b32 v147, a43
  v_accvgpr_read_b32 v148, a56
  v_accvgpr_read_b32 v149, a57
  v_accvgpr_read_b32 v150, a58
  v_accvgpr_read_b32 v151, a59
  v_mul_f32 v144, v144, v246
  v_mul_f32 v145, v145, v246
  v_mul_f32 v146, v146, v246
  v_mul_f32 v147, v147, v246
  v_mul_f32 v148, v148, v246
  v_mul_f32 v149, v149, v246
  v_mul_f32 v150, v150, v246
  v_mul_f32 v151, v151, v246
  v_cvt_pk_bf16_f32 v152, v144, v145
  v_cvt_pk_bf16_f32 v153, v146, v147
  v_cvt_pk_bf16_f32 v154, v148, v149
  v_cvt_pk_bf16_f32 v155, v150, v151
  buffer_store_dwordx4 v[152:155], v236, s[12:15], s32 offen offset:1024 sc1
  v_accvgpr_read_b32 v160, a72
  v_accvgpr_read_b32 v161, a73
  v_accvgpr_read_b32 v162, a74
  v_accvgpr_read_b32 v163, a75
  v_accvgpr_read_b32 v164, a88
  v_accvgpr_read_b32 v165, a89
  v_accvgpr_read_b32 v166, a90
  v_accvgpr_read_b32 v167, a91
  v_mul_f32 v160, v160, v246
  v_mul_f32 v161, v161, v246
  v_mul_f32 v162, v162, v246
  v_mul_f32 v163, v163, v246
  v_mul_f32 v164, v164, v246
  v_mul_f32 v165, v165, v246
  v_mul_f32 v166, v166, v246
  v_mul_f32 v167, v167, v246
  v_cvt_pk_bf16_f32 v168, v160, v161
  v_cvt_pk_bf16_f32 v169, v162, v163
  v_cvt_pk_bf16_f32 v170, v164, v165
  v_cvt_pk_bf16_f32 v171, v166, v167
  buffer_store_dwordx4 v[168:171], v236, s[12:15], s32 offen offset:2048 sc1
  v_accvgpr_read_b32 v176, a104
  v_accvgpr_read_b32 v177, a105
  v_accvgpr_read_b32 v178, a106
  v_accvgpr_read_b32 v179, a107
  v_accvgpr_read_b32 v180, a120
  v_accvgpr_read_b32 v181, a121
  v_accvgpr_read_b32 v182, a122
  v_accvgpr_read_b32 v183, a123
  v_mul_f32 v176, v176, v246
  v_mul_f32 v177, v177, v246
  v_mul_f32 v178, v178, v246
  v_mul_f32 v179, v179, v246
  v_mul_f32 v180, v180, v246
  v_mul_f32 v181, v181, v246
  v_mul_f32 v182, v182, v246
  v_mul_f32 v183, v183, v246
  v_cvt_pk_bf16_f32 v184, v176, v177
  v_cvt_pk_bf16_f32 v185, v178, v179
  v_cvt_pk_bf16_f32 v186, v180, v181
  v_cvt_pk_bf16_f32 v187, v182, v183
  buffer_store_dwordx4 v[184:187], v236, s[12:15], s32 offen offset:3072 sc1
  v_accvgpr_read_b32 v128, a12
  v_accvgpr_read_b32 v129, a13
  v_accvgpr_read_b32 v130, a14
  v_accvgpr_read_b32 v131, a15
  v_accvgpr_read_b32 v132, a28
  v_accvgpr_read_b32 v133, a29
  v_accvgpr_read_b32 v134, a30
  v_accvgpr_read_b32 v135, a31
  v_mul_f32 v128, v128, v247
  v_mul_f32 v129, v129, v247
  v_mul_f32 v130, v130, v247
  v_mul_f32 v131, v131, v247
  v_mul_f32 v132, v132, v247
  v_mul_f32 v133, v133, v247
  v_mul_f32 v134, v134, v247
  v_mul_f32 v135, v135, v247
  v_cvt_pk_bf16_f32 v136, v128, v129
  v_cvt_pk_bf16_f32 v137, v130, v131
  v_cvt_pk_bf16_f32 v138, v132, v133
  v_cvt_pk_bf16_f32 v139, v134, v135
  buffer_store_dwordx4 v[136:139], v236, s[12:15], s33 offen offset:0 sc1
  v_accvgpr_read_b32 v144, a44
  v_accvgpr_read_b32 v145, a45
  v_accvgpr_read_b32 v146, a46
  v_accvgpr_read_b32 v147, a47
  v_accvgpr_read_b32 v148, a60
  v_accvgpr_read_b32 v149, a61
  v_accvgpr_read_b32 v150, a62
  v_accvgpr_read_b32 v151, a63
  v_mul_f32 v144, v144, v247
  v_mul_f32 v145, v145, v247
  v_mul_f32 v146, v146, v247
  v_mul_f32 v147, v147, v247
  v_mul_f32 v148, v148, v247
  v_mul_f32 v149, v149, v247
  v_mul_f32 v150, v150, v247
  v_mul_f32 v151, v151, v247
  v_cvt_pk_bf16_f32 v152, v144, v145
  v_cvt_pk_bf16_f32 v153, v146, v147
  v_cvt_pk_bf16_f32 v154, v148, v149
  v_cvt_pk_bf16_f32 v155, v150, v151
  buffer_store_dwordx4 v[152:155], v236, s[12:15], s33 offen offset:1024 sc1
  v_accvgpr_read_b32 v160, a76
  v_accvgpr_read_b32 v161, a77
  v_accvgpr_read_b32 v162, a78
  v_accvgpr_read_b32 v163, a79
  v_accvgpr_read_b32 v164, a92
  v_accvgpr_read_b32 v165, a93
  v_accvgpr_read_b32 v166, a94
  v_accvgpr_read_b32 v167, a95
  v_mul_f32 v160, v160, v247
  v_mul_f32 v161, v161, v247
  v_mul_f32 v162, v162, v247
  v_mul_f32 v163, v163, v247
  v_mul_f32 v164, v164, v247
  v_mul_f32 v165, v165, v247
  v_mul_f32 v166, v166, v247
  v_mul_f32 v167, v167, v247
  v_cvt_pk_bf16_f32 v168, v160, v161
  v_cvt_pk_bf16_f32 v169, v162, v163
  v_cvt_pk_bf16_f32 v170, v164, v165
  v_cvt_pk_bf16_f32 v171, v166, v167
  buffer_store_dwordx4 v[168:171], v236, s[12:15], s33 offen offset:2048 sc1
  v_accvgpr_read_b32 v176, a108
  v_accvgpr_read_b32 v177, a109
  v_accvgpr_read_b32 v178, a110
  v_accvgpr_read_b32 v179, a111
  v_accvgpr_read_b32 v180, a124
  v_accvgpr_read_b32 v181, a125
  v_accvgpr_read_b32 v182, a126
  v_accvgpr_read_b32 v183, a127
  v_mul_f32 v176, v176, v247
  v_mul_f32 v177, v177, v247
  v_mul_f32 v178, v178, v247
  v_mul_f32 v179, v179, v247
  v_mul_f32 v180, v180, v247
  v_mul_f32 v181, v181, v247
  v_mul_f32 v182, v182, v247
  v_mul_f32 v183, v183, v247
  v_cvt_pk_bf16_f32 v184, v176, v177
  v_cvt_pk_bf16_f32 v185, v178, v179
  v_cvt_pk_bf16_f32 v186, v180, v181
  v_cvt_pk_bf16_f32 v187, v182, v183
  buffer_store_dwordx4 v[184:187], v236, s[12:15], s33 offen offset:3072 sc1
  s_waitcnt lgkmcnt(0)
  s_branch L_nopref2
L_cu1:
  s_add_u32 m0, s46, 36864
  s_nop 0
  buffer_load_dwordx4 v10, s[12:15], s59 offen offset:0 sc1 lds
  buffer_load_dwordx4 v10, s[12:15], s59 offen offset:1024 sc1 lds
  buffer_load_dwordx4 v11, s[12:15], s59 offen offset:2048 sc1 lds
  buffer_load_dwordx4 v11, s[12:15], s59 offen offset:3072 sc1 lds
  s_add_u32 s59, s59, 2048
  s_branch L_join
L_slow0:
  s_mov_b32 s34, 262144
L_slow0l:
  buffer_load_dword v27, v26, s[24:27], 0 offen offset:32 sc1
  s_waitcnt vmcnt(0)
  v_cmp_eq_u32 vcc, s100, v27
  s_sub_u32 s34, s34, 1
  s_cselect_b32 s47, -1, s47
  s_or_b32 s47, s47, vcc_lo
  s_bitcmp1_b32 s47, 0
  s_cbranch_scc0 L_slow0l
  s_branch L_rdy0
L_slow1:
  s_mov_b32 s34, 262144
L_slow1l:
  buffer_load_dword v27, v26, s[24:27], 0 offen offset:32 sc1
  s_waitcnt vmcnt(0)
  v_cmp_eq_u32 vcc, s100, v27
  s_sub_u32 s34, s34, 1
  s_cselect_b32 s47, -1, s47
  s_or_b32 s47, s47, vcc_lo
  s_bitcmp1_b32 s47, s31
  s_cbranch_scc0 L_slow1l
  s_branch L_loop
L_tagspin:
  s_mov_b32 s34, 262144
  v_mov_b32 v7, 0
L_tagspinl:
  global_load_dword v6, v7, s[4:5] sc1
  s_waitcnt vmcnt(0)
  v_readfirstlane_b32 s100, v6
  s_sub_u32 s34, s34, 1
  s_cselect_b32 s100, 8, s100
  s_cmp_eq_u32 s100, 0
  s_cbranch_scc1 L_tagspinl
  s_branch L_tagok
L_fbA:
  s_mov_b32 s39, 1
  s_lshl_b32 s10, s29, 17
  s_add_u32 s10, s10, 131072
  v_mov_b32 v216, 4048155338
  v_mov_b32 v220, 4048155338
  v_mov_b32 v224, 4048155338
  v_mov_b32 v228, 4048155338
  s_lshl_b32 s31, s29, 8
  v_lshlrev_b32 v3, 2, v5
  v_sub_u32 v3, v4, v3
  v_add_u32 v3, s31, v3
  s_lshl_b32 s31, s30, 4
  v_add_u32 v8, s31, v3
  v_add_u32 v10, 128, v8
  s_sub_u32 s31, 112, s31
  v_add_u32 v9, s31, v3
  v_add_u32 v11, 128, v9
  s_lshl_b32 s37, s29, 3
  s_add_u32 s37, s37, 8
  s_mov_b32 s33, 0
  v_mov_b32 v6, 4048155338
  s_waitcnt vmcnt(0)
L_fbA_loop:
  s_lshr_b32 s34, s33, 1
  s_lshl_b32 s34, s34, 15
  s_and_b32 s31, s33, 1
  s_lshl_b32 s31, s31, 13
  s_add_u32 s34, s34, s31
  buffer_load_dwordx4 v[128:131], v236, s[8:11], s34 offen offset:0 sc1
  buffer_load_dwordx4 v[132:135], v236, s[8:11], s34 offen offset:1024 sc1
  buffer_load_dwordx4 v[136:139], v236, s[8:11], s34 offen offset:2048 sc1
  buffer_load_dwordx4 v[140:143], v236, s[8:11], s34 offen offset:3072 sc1
  s_add_u32 s34, s34, 4096
  buffer_load_dwordx4 v[144:147], v236, s[8:11], s34 offen offset:0 sc1
  buffer_load_dwordx4 v[148:151], v236, s[8:11], s34 offen offset:1024 sc1
  buffer_load_dwordx4 v[152:155], v236, s[8:11], s34 offen offset:2048 sc1
  buffer_load_dwordx4 v[156:159], v236, s[8:11], s34 offen offset:3072 sc1
  s_waitcnt vmcnt(0)
  v_mfma_f32_16x16x32_bf16 v[32:35], v[128:131], v[64:67], 0
  v_mfma_f32_16x16x32_bf16 v[36:39], v[144:147], v[64:67], 0
  v_mfma_f32_16x16x32_bf16 v[32:35], v[132:135], v[68:71], v[32:35]
  v_mfma_f32_16x16x32_bf16 v[36:39], v[148:151], v[68:71], v[36:39]
  v_mfma_f32_16x16x32_bf16 v[32:35], v[136:139], v[72:75], v[32:35]
  v_mfma_f32_16x16x32_bf16 v[36:39], v[152:155], v[72:75], v[36:39]
  v_mfma_f32_16x16x32_bf16 v[32:35], v[140:143], v[76:79], v[32:35]
  v_mfma_f32_16x16x32_bf16 v[36:39], v[156:159], v[76:79], v[36:39]
  v_mfma_f32_16x16x32_bf16 v[40:43], v[128:131], v[80:83], 0
  v_mfma_f32_16x16x32_bf16 v[44:47], v[144:147], v[80:83], 0
  v_mfma_f32_16x16x32_bf16 v[40:43], v[132:135], v[84:87], v[40:43]
  v_mfma_f32_16x16x32_bf16 v[44:47], v[148:151], v[84:87], v[44:47]
  v_mfma_f32_16x16x32_bf16 v[40:43], v[136:139], v[88:91], v[40:43]
  v_mfma_f32_16x16x32_bf16 v[44:47], v[152:155], v[88:91], v[44:47]
  v_mfma_f32_16x16x32_bf16 v[40:43], v[140:143], v[92:95], v[40:43]
  v_mfma_f32_16x16x32_bf16 v[44:47], v[156:159], v[92:95], v[44:47]
  v_mfma_f32_16x16x32_bf16 v[48:51], v[128:131], v[96:99], 0
  v_mfma_f32_16x16x32_bf16 v[52:55], v[144:147], v[96:99], 0
  v_mfma_f32_16x16x32_bf16 v[48:51], v[132:135], v[100:103], v[48:51]
  v_mfma_f32_16x16x32_bf16 v[52:55], v[148:151], v[100:103], v[52:55]
  v_mfma_f32_16x16x32_bf16 v[48:51], v[136:139], v[104:107], v[48:51]
  v_mfma_f32_16x16x32_bf16 v[52:55], v[152:155], v[104:107], v[52:55]
  v_mfma_f32_16x16x32_bf16 v[48:51], v[140:143], v[108:111], v[48:51]
  v_mfma_f32_16x16x32_bf16 v[52:55], v[156:159], v[108:111], v[52:55]
  v_mfma_f32_16x16x32_bf16 v[56:59], v[128:131], v[112:115], 0
  v_mfma_f32_16x16x32_bf16 v[60:63], v[144:147], v[112:115], 0
  v_mfma_f32_16x16x32_bf16 v[56:59], v[132:135], v[116:119], v[56:59]
  v_mfma_f32_16x16x32_bf16 v[60:63], v[148:151], v[116:119], v[60:63]
  v_mfma_f32_16x16x32_bf16 v[56:59], v[136:139], v[120:123], v[56:59]
  v_mfma_f32_16x16x32_bf16 v[60:63], v[152:155], v[120:123], v[60:63]
  v_mfma_f32_16x16x32_bf16 v[56:59], v[140:143], v[124:127], v[56:59]
  v_mfma_f32_16x16x32_bf16 v[60:63], v[156:159], v[124:127], v[60:63]
  s_nop 7
  s_lshl_b32 s31, s33, 5
  s_add_u32 s34, s31, 0
  v_cmp_gt_i32 vcc, s34, v8
  s_nop 1
  v_cndmask_b32 v7, v32, v6, vcc
  v_max_f32 v216, v216, v7
  s_add_u32 s34, s31, 1
  v_cmp_gt_i32 vcc, s34, v8
  s_nop 1
  v_cndmask_b32 v7, v33, v6, vcc
  v_max_f32 v216, v216, v7
  s_add_u32 s34, s31, 2
  v_cmp_gt_i32 vcc, s34, v8
  s_nop 1
  v_cndmask_b32 v7, v34, v6, vcc
  v_max_f32 v216, v216, v7
  s_add_u32 s34, s31, 3
  v_cmp_gt_i32 vcc, s34, v8
  s_nop 1
  v_cndmask_b32 v7, v35, v6, vcc
  v_max_f32 v216, v216, v7
  s_add_u32 s34, s31, 16
  v_cmp_gt_i32 vcc, s34, v8
  s_nop 1
  v_cndmask_b32 v7, v36, v6, vcc
  v_max_f32 v216, v216, v7
  s_add_u32 s34, s31, 17
  v_cmp_gt_i32 vcc, s34, v8
  s_nop 1
  v_cndmask_b32 v7, v37, v6, vcc
  v_max_f32 v216, v216, v7
  s_add_u32 s34, s31, 18
  v_cmp_gt_i32 vcc, s34, v8
  s_nop 1
  v_cndmask_b32 v7, v38, v6, vcc
  v_max_f32 v216, v216, v7
  s_add_u32 s34, s31, 19
  v_cmp_gt_i32 vcc, s34, v8
  s_nop 1
  v_cndmask_b32 v7, v39, v6, vcc
  v_max_f32 v216, v216, v7
  s_add_u32 s34, s31, 0
  v_cmp_gt_i32 vcc, s34, v9
  s_nop 1
  v_cndmask_b32 v7, v40, v6, vcc
  v_max_f32 v220, v220, v7
  s_add_u32 s34, s31, 1
  v_cmp_gt_i32 vcc, s34, v9
  s_nop 1
  v_cndmask_b32 v7, v41, v6, vcc
  v_max_f32 v220, v220, v7
  s_add_u32 s34, s31, 2
  v_cmp_gt_i32 vcc, s34, v9
  s_nop 1
  v_cndmask_b32 v7, v42, v6, vcc
  v_max_f32 v220, v220, v7
  s_add_u32 s34, s31, 3
  v_cmp_gt_i32 vcc, s34, v9
  s_nop 1
  v_cndmask_b32 v7, v43, v6, vcc
  v_max_f32 v220, v220, v7
  s_add_u32 s34, s31, 16
  v_cmp_gt_i32 vcc, s34, v9
  s_nop 1
  v_cndmask_b32 v7, v44, v6, vcc
  v_max_f32 v220, v220, v7
  s_add_u32 s34, s31, 17
  v_cmp_gt_i32 vcc, s34, v9
  s_nop 1
  v_cndmask_b32 v7, v45, v6, vcc
  v_max_f32 v220, v220, v7
  s_add_u32 s34, s31, 18
  v_cmp_gt_i32 vcc, s34, v9
  s_nop 1
  v_cndmask_b32 v7, v46, v6, vcc
  v_max_f32 v220, v220, v7
  s_add_u32 s34, s31, 19
  v_cmp_gt_i32 vcc, s34, v9
  s_nop 1
  v_cndmask_b32 v7, v47, v6, vcc
  v_max_f32 v220, v220, v7
  s_add_u32 s34, s31, 0
  v_cmp_gt_i32 vcc, s34, v10
  s_nop 1
  v_cndmask_b32 v7, v48, v6, vcc
  v_max_f32 v224, v224, v7
  s_add_u32 s34, s31, 1
  v_cmp_gt_i32 vcc, s34, v10
  s_nop 1
  v_cndmask_b32 v7, v49, v6, vcc
  v_max_f32 v224, v224, v7
  s_add_u32 s34, s31, 2
  v_cmp_gt_i32 vcc, s34, v10
  s_nop 1
  v_cndmask_b32 v7, v50, v6, vcc
  v_max_f32 v224, v224, v7
  s_add_u32 s34, s31, 3
  v_cmp_gt_i32 vcc, s34, v10
  s_nop 1
  v_cndmask_b32 v7, v51, v6, vcc
  v_max_f32 v224, v224, v7
  s_add_u32 s34, s31, 16
  v_cmp_gt_i32 vcc, s34, v10
  s_nop 1
  v_cndmask_b32 v7, v52, v6, vcc
  v_max_f32 v224, v224, v7
  s_add_u32 s34, s31, 17
  v_cmp_gt_i32 vcc, s34, v10
  s_nop 1
  v_cndmask_b32 v7, v53, v6, vcc
  v_max_f32 v224, v224, v7
  s_add_u32 s34, s31, 18
  v_cmp_gt_i32 vcc, s34, v10
  s_nop 1
  v_cndmask_b32 v7, v54, v6, vcc
  v_max_f32 v224, v224, v7
  s_add_u32 s34, s31, 19
  v_cmp_gt_i32 vcc, s34, v10
  s_nop 1
  v_cndmask_b32 v7, v55, v6, vcc
  v_max_f32 v224, v224, v7
  s_add_u32 s34, s31, 0
  v_cmp_gt_i32 vcc, s34, v11
  s_nop 1
  v_cndmask_b32 v7, v56, v6, vcc
  v_max_f32 v228, v228, v7
  s_add_u32 s34, s31, 1
  v_cmp_gt_i32 vcc, s34, v11
  s_nop 1
  v_cndmask_b32 v7, v57, v6, vcc
  v_max_f32 v228, v228, v7
  s_add_u32 s34, s31, 2
  v_cmp_gt_i32 vcc, s34, v11
  s_nop 1
  v_cndmask_b32 v7, v58, v6, vcc
  v_max_f32 v228, v228, v7
  s_add_u32 s34, s31, 3
  v_cmp_gt_i32 vcc, s34, v11
  s_nop 1
  v_cndmask_b32 v7, v59, v6, vcc
  v_max_f32 v228, v228, v7
  s_add_u32 s34, s31, 16
  v_cmp_gt_i32 vcc, s34, v11
  s_nop 1
  v_cndmask_b32 v7, v60, v6, vcc
  v_max_f32 v228, v228, v7
  s_add_u32 s34, s31, 17
  v_cmp_gt_i32 vcc, s34, v11
  s_nop 1
  v_cndmask_b32 v7, v61, v6, vcc
  v_max_f32 v228, v228, v7
  s_add_u32 s34, s31, 18
  v_cmp_gt_i32 vcc, s34, v11
  s_nop 1
  v_cndmask_b32 v7, v62, v6, vcc
  v_max_f32 v228, v228, v7
  s_add_u32 s34, s31, 19
  v_cmp_gt_i32 vcc, s34, v11
  s_nop 1
  v_cndmask_b32 v7, v63, v6, vcc
  v_max_f32 v228, v228, v7
  s_add_u32 s33, s33, 1
  s_cmp_lt_u32 s33, s37
  s_cbranch_scc1 L_fbA_loop
  v_mov_b32 v217, v216
  v_mov_b32 v221, v220
  v_mov_b32 v225, v224
  v_mov_b32 v229, v228
  v_permlane32_swap_b32 v216, v217
  v_permlane32_swap_b32 v220, v221
  v_permlane32_swap_b32 v224, v225
  v_permlane32_swap_b32 v228, v229
  v_max_f32 v216, v216, v217
  v_max_f32 v220, v220, v221
  v_max_f32 v224, v224, v225
  v_max_f32 v228, v228, v229
  v_mov_b32 v217, v216
  v_mov_b32 v221, v220
  v_mov_b32 v225, v224
  v_mov_b32 v229, v228
  v_permlane16_swap_b32 v216, v217
  v_permlane16_swap_b32 v220, v221
  v_permlane16_swap_b32 v224, v225
  v_permlane16_swap_b32 v228, v229
  v_max_f32 v216, v216, v217
  v_max_f32 v220, v220, v221
  v_max_f32 v224, v224, v225
  v_max_f32 v228, v228, v229
  v_sub_f32 v217, 0, v216
  v_sub_f32 v218, 0, v216
  v_sub_f32 v219, 0, v216
  v_sub_f32 v216, 0, v216
  v_sub_f32 v221, 0, v220
  v_sub_f32 v222, 0, v220
  v_sub_f32 v223, 0, v220
  v_sub_f32 v220, 0, v220
  v_sub_f32 v225, 0, v224
  v_sub_f32 v226, 0, v224
  v_sub_f32 v227, 0, v224
  v_sub_f32 v224, 0, v224
  v_sub_f32 v229, 0, v228
  v_sub_f32 v230, 0, v228
  v_sub_f32 v231, 0, v228
  v_sub_f32 v228, 0, v228
  v_add_u32 v238, s36, v236
  s_barrier
  s_lshl_b32 s35, s29, 17
  s_add_u32 m0, s36, 32768
  s_nop 0
  buffer_load_dwordx4 v238, s[8:11], s35 offen offset:0 sc1 lds
  buffer_load_dwordx4 v238, s[8:11], s35 offen offset:1024 sc1 lds
  buffer_load_dwordx4 v238, s[8:11], s35 offen offset:2048 sc1 lds
  buffer_load_dwordx4 v238, s[8:11], s35 offen offset:3072 sc1 lds
  s_add_u32 s35, s35, 4096
  s_add_u32 m0, s36, 36864
  s_nop 0
  buffer_load_dwordx4 v238, s[8:11], s35 offen offset:0 sc1 lds
  buffer_load_dwordx4 v238, s[8:11], s35 offen offset:1024 sc1 lds
  buffer_load_dwordx4 v238, s[8:11], s35 offen offset:2048 sc1 lds
  buffer_load_dwordx4 v238, s[8:11], s35 offen offset:3072 sc1 lds
  s_add_u32 s35, s35, 28672
  s_add_u32 m0, s36, 65536
  s_nop 0
  buffer_load_dwordx4 v238, s[8:11], s35 offen offset:0 sc1 lds
  buffer_load_dwordx4 v238, s[8:11], s35 offen offset:1024 sc1 lds
  buffer_load_dwordx4 v238, s[8:11], s35 offen offset:2048 sc1 lds
  buffer_load_dwordx4 v238, s[8:11], s35 offen offset:3072 sc1 lds
  s_add_u32 s35, s35, 4096
  s_add_u32 m0, s36, 69632
  s_nop 0
  buffer_load_dwordx4 v238, s[8:11], s35 offen offset:0 sc1 lds
  buffer_load_dwordx4 v238, s[8:11], s35 offen offset:1024 sc1 lds
  buffer_load_dwordx4 v238, s[8:11], s35 offen offset:2048 sc1 lds
  buffer_load_dwordx4 v238, s[8:11], s35 offen offset:3072 sc1 lds
  s_add_u32 s35, s35, 28672
  s_add_u32 m0, s36, 98304
  s_nop 0
  buffer_load_dwordx4 v238, s[8:11], s35 offen offset:0 sc1 lds
  buffer_load_dwordx4 v238, s[8:11], s35 offen offset:1024 sc1 lds
  buffer_load_dwordx4 v238, s[8:11], s35 offen offset:2048 sc1 lds
  buffer_load_dwordx4 v238, s[8:11], s35 offen offset:3072 sc1 lds
  s_add_u32 s35, s35, 4096
  s_add_u32 m0, s36, 102400
  s_nop 0
  buffer_load_dwordx4 v238, s[8:11], s35 offen offset:0 sc1 lds
  buffer_load_dwordx4 v238, s[8:11], s35 offen offset:1024 sc1 lds
  buffer_load_dwordx4 v238, s[8:11], s35 offen offset:2048 sc1 lds
  buffer_load_dwordx4 v238, s[8:11], s35 offen offset:3072 sc1 lds
  s_add_u32 s35, s35, 28672
  s_add_u32 m0, s36, 131072
  s_nop 0
  buffer_load_dwordx4 v238, s[8:11], s35 offen offset:0 sc1 lds
  buffer_load_dwordx4 v238, s[8:11], s35 offen offset:1024 sc1 lds
  buffer_load_dwordx4 v238, s[8:11], s35 offen offset:2048 sc1 lds
  buffer_load_dwordx4 v238, s[8:11], s35 offen offset:3072 sc1 lds
  s_add_u32 s35, s35, 4096
  s_add_u32 m0, s36, 135168
  s_nop 0
  buffer_load_dwordx4 v238, s[8:11], s35 offen offset:0 sc1 lds
  buffer_load_dwordx4 v238, s[8:11], s35 offen offset:1024 sc1 lds
  buffer_load_dwordx4 v238, s[8:11], s35 offen offset:2048 sc1 lds
  buffer_load_dwordx4 v238, s[8:11], s35 offen offset:3072 sc1 lds
  s_add_u32 s35, s35, 28672
  s_waitcnt vmcnt(0)
  s_branch L_att_start
L_fbB:
  s_mov_b32 s39, 1
  s_mov_b32 vcc_lo, -1
  s_mov_b32 vcc_hi, 0
  v_mov_b32 v240, 4048155338
  v_cndmask_b32 v196, 0, v196, vcc
  v_cndmask_b32 v197, 0, v197, vcc
  v_mov_b32 v241, 4048155338
  v_cndmask_b32 v204, 0, v204, vcc
  v_cndmask_b32 v205, 0, v205, vcc
  v_mov_b32 v242, 4048155338
  v_cndmask_b32 v212, 0, v212, vcc
  v_cndmask_b32 v213, 0, v213, vcc
  v_mov_b32 v243, 4048155338
  v_cndmask_b32 v220, 0, v220, vcc
  v_cndmask_b32 v221, 0, v221, vcc
  v_mov_b32 v244, 4048155338
  v_cndmask_b32 v228, 0, v228, vcc
  v_cndmask_b32 v229, 0, v229, vcc
  s_mov_b32 s37, 0
L_fbB_loop:
  s_lshr_b32 s34, s37, 3
  s_mul_i32 s34, s34, 28672
  s_and_b32 s31, s37, 7
  s_mul_i32 s33, s31, 3072
  s_add_u32 s33, s33, s34
  s_lshr_b32 s32, s31, 1
  s_lshl_b32 s32, s32, 10
  s_add_u32 s34, s34, s32
  s_and_b32 s31, s31, 1
  s_lshl_b32 s31, s31, 3
  s_add_u32 s34, s34, s31
  s_add_u32 s34, s34, 24576
  buffer_load_dwordx4 v[144:147], v236, s[16:19], s33 offen sc1
  buffer_load_dwordx2 v[152:153], v236, s[16:19], s34 offen sc1
  s_waitcnt vmcnt(0)
  v_mfma_f32_32x32x16_bf16 v[64:79], v[144:147], v[192:195], 0
  s_nop 9
  v_mfma_f32_32x32x8_bf16 v[64:79], v[152:153], v[196:197], v[64:79]
  v_mfma_f32_32x32x16_bf16 v[80:95], v[144:147], v[200:203], 0
  s_nop 9
  v_mfma_f32_32x32x8_bf16 v[80:95], v[152:153], v[204:205], v[80:95]
  v_mfma_f32_32x32x16_bf16 v[96:111], v[144:147], v[208:211], 0
  s_nop 9
  v_mfma_f32_32x32x8_bf16 v[96:111], v[152:153], v[212:213], v[96:111]
  v_mfma_f32_32x32x16_bf16 v[112:127], v[144:147], v[216:219], 0
  s_nop 9
  v_mfma_f32_32x32x8_bf16 v[112:127], v[152:153], v[220:221], v[112:127]
  v_mfma_f32_32x32x16_bf16 v[128:143], v[144:147], v[224:227], 0
  s_nop 9
  v_mfma_f32_32x32x8_bf16 v[128:143], v[152:153], v[228:229], v[128:143]
  s_nop 11
  v_max3_f32 v240, v240, v64, v65
  v_max3_f32 v240, v240, v66, v67
  v_max3_f32 v240, v240, v68, v69
  v_max3_f32 v240, v240, v70, v71
  v_max3_f32 v240, v240, v72, v73
  v_max3_f32 v240, v240, v74, v75
  v_max3_f32 v240, v240, v76, v77
  v_max3_f32 v240, v240, v78, v79
  v_max3_f32 v241, v241, v80, v81
  v_max3_f32 v241, v241, v82, v83
  v_max3_f32 v241, v241, v84, v85
  v_max3_f32 v241, v241, v86, v87
  v_max3_f32 v241, v241, v88, v89
  v_max3_f32 v241, v241, v90, v91
  v_max3_f32 v241, v241, v92, v93
  v_max3_f32 v241, v241, v94, v95
  v_max3_f32 v242, v242, v96, v97
  v_max3_f32 v242, v242, v98, v99
  v_max3_f32 v242, v242, v100, v101
  v_max3_f32 v242, v242, v102, v103
  v_max3_f32 v242, v242, v104, v105
  v_max3_f32 v242, v242, v106, v107
  v_max3_f32 v242, v242, v108, v109
  v_max3_f32 v242, v242, v110, v111
  v_max3_f32 v243, v243, v112, v113
  v_max3_f32 v243, v243, v114, v115
  v_max3_f32 v243, v243, v116, v117
  v_max3_f32 v243, v243, v118, v119
  v_max3_f32 v243, v243, v120, v121
  v_max3_f32 v243, v243, v122, v123
  v_max3_f32 v243, v243, v124, v125
  v_max3_f32 v243, v243, v126, v127
  v_max3_f32 v244, v244, v128, v129
  v_max3_f32 v244, v244, v130, v131
  v_max3_f32 v244, v244, v132, v133
  v_max3_f32 v244, v244, v134, v135
  v_max3_f32 v244, v244, v136, v137
  v_max3_f32 v244, v244, v138, v139
  v_max3_f32 v244, v244, v140, v141
  v_max3_f32 v244, v244, v142, v143
  s_add_u32 s37, s37, 1
  s_cmp_lt_u32 s37, 64
  s_cbranch_scc1 L_fbB_loop
  s_mov_b32 vcc_lo, -1
  s_mov_b32 vcc_hi, 0
  v_mov_b32 v248, v240
  v_mov_b32 v249, v241
  v_mov_b32 v250, v242
  v_mov_b32 v251, v243
  v_mov_b32 v252, v244
  v_permlane32_swap_b32 v240, v248
  v_permlane32_swap_b32 v241, v249
  v_permlane32_swap_b32 v242, v250
  v_permlane32_swap_b32 v243, v251
  v_permlane32_swap_b32 v244, v252
  v_max_f32 v240, v240, v248
  v_sub_f32 v240, 0, v240
  v_and_b32 v248, 0xffff0000, v240
  v_sub_f32 v240, v240, v248
  v_lshrrev_b32 v248, 16, v248
  v_and_b32 v6, 0xffff0000, v240
  v_or_b32 v248, v248, v6
  v_sub_f32 v240, v240, v6
  v_lshrrev_b32 v240, 16, v240
  v_cndmask_b32 v196, v248, v196, vcc
  v_cndmask_b32 v197, v240, v197, vcc
  v_max_f32 v241, v241, v249
  v_sub_f32 v241, 0, v241
  v_and_b32 v249, 0xffff0000, v241
  v_sub_f32 v241, v241, v249
  v_lshrrev_b32 v249, 16, v249
  v_and_b32 v6, 0xffff0000, v241
  v_or_b32 v249, v249, v6
  v_sub_f32 v241, v241, v6
  v_lshrrev_b32 v241, 16, v241
  v_cndmask_b32 v204, v249, v204, vcc
  v_cndmask_b32 v205, v241, v205, vcc
  v_max_f32 v242, v242, v250
  v_sub_f32 v242, 0, v242
  v_and_b32 v250, 0xffff0000, v242
  v_sub_f32 v242, v242, v250
  v_lshrrev_b32 v250, 16, v250
  v_and_b32 v6, 0xffff0000, v242
  v_or_b32 v250, v250, v6
  v_sub_f32 v242, v242, v6
  v_lshrrev_b32 v242, 16, v242
  v_cndmask_b32 v212, v250, v212, vcc
  v_cndmask_b32 v213, v242, v213, vcc
  v_max_f32 v243, v243, v251
  v_sub_f32 v243, 0, v243
  v_and_b32 v251, 0xffff0000, v243
  v_sub_f32 v243, v243, v251
  v_lshrrev_b32 v251, 16, v251
  v_and_b32 v6, 0xffff0000, v243
  v_or_b32 v251, v251, v6
  v_sub_f32 v243, v243, v6
  v_lshrrev_b32 v243, 16, v243
  v_cndmask_b32 v220, v251, v220, vcc
  v_cndmask_b32 v221, v243, v221, vcc
  v_max_f32 v244, v244, v252
  v_sub_f32 v244, 0, v244
  v_and_b32 v252, 0xffff0000, v244
  v_sub_f32 v244, v244, v252
  v_lshrrev_b32 v252, 16, v252
  v_and_b32 v6, 0xffff0000, v244
  v_or_b32 v252, v252, v6
  v_sub_f32 v244, v244, v6
  v_lshrrev_b32 v244, 16, v244
  v_cndmask_b32 v228, v252, v228, vcc
  v_cndmask_b32 v229, v244, v229, vcc
  s_waitcnt vmcnt(0)
  s_barrier
  s_add_u32 m0, s61, 0
  s_mov_b32 s34, 0
  buffer_load_dwordx4 v238, s[16:19], s34 offen offset:0 sc1 lds
  buffer_load_dwordx4 v238, s[16:19], s34 offen offset:1024 sc1 lds
  buffer_load_dwordx4 v238, s[16:19], s34 offen offset:2048 sc1 lds
  buffer_load_dwordx4 v238, s[16:19], s34 offen offset:3072 sc1 lds
  s_add_u32 m0, s61, 4096
  s_mov_b32 s34, 4096
  buffer_load_dwordx4 v238, s[16:19], s34 offen offset:0 sc1 lds
  buffer_load_dwordx4 v238, s[16:19], s34 offen offset:1024 sc1 lds
  buffer_load_dwordx4 v238, s[16:19], s34 offen offset:2048 sc1 lds
  s_add_u32 m0, s61, 32768
  s_mov_b32 s34, 28672
  buffer_load_dwordx4 v238, s[16:19], s34 offen offset:0 sc1 lds
  buffer_load_dwordx4 v238, s[16:19], s34 offen offset:1024 sc1 lds
  buffer_load_dwordx4 v238, s[16:19], s34 offen offset:2048 sc1 lds
  buffer_load_dwordx4 v238, s[16:19], s34 offen offset:3072 sc1 lds
  s_add_u32 m0, s61, 36864
  s_mov_b32 s34, 32768
  buffer_load_dwordx4 v238, s[16:19], s34 offen offset:0 sc1 lds
  buffer_load_dwordx4 v238, s[16:19], s34 offen offset:1024 sc1 lds
  buffer_load_dwordx4 v238, s[16:19], s34 offen offset:2048 sc1 lds
  s_add_u32 m0, s61, 65536
  s_mov_b32 s34, 57344
  buffer_load_dwordx4 v238, s[16:19], s34 offen offset:0 sc1 lds
  buffer_load_dwordx4 v238, s[16:19], s34 offen offset:1024 sc1 lds
  buffer_load_dwordx4 v238, s[16:19], s34 offen offset:2048 sc1 lds
  buffer_load_dwordx4 v238, s[16:19], s34 offen offset:3072 sc1 lds
  s_add_u32 m0, s61, 69632
  s_mov_b32 s34, 61440
  buffer_load_dwordx4 v238, s[16:19], s34 offen offset:0 sc1 lds
  buffer_load_dwordx4 v238, s[16:19], s34 offen offset:1024 sc1 lds
  buffer_load_dwordx4 v238, s[16:19], s34 offen offset:2048 sc1 lds
  v_accvgpr_write_b32 a0, 0
  v_accvgpr_write_b32 a1, 0
  v_accvgpr_write_b32 a2, 0
  v_accvgpr_write_b32 a3, 0
  v_accvgpr_write_b32 a4, 0
  v_accvgpr_write_b32 a5, 0
  v_accvgpr_write_b32 a6, 0
  v_accvgpr_write_b32 a7, 0
  v_accvgpr_write_b32 a8, 0
  v_accvgpr_write_b32 a9, 0
  v_accvgpr_write_b32 a10, 0
  v_accvgpr_write_b32 a11, 0
  v_accvgpr_write_b32 a12, 0
  v_accvgpr_write_b32 a13, 0
  v_accvgpr_write_b32 a14, 0
  v_accvgpr_write_b32 a15, 0
  v_accvgpr_write_b32 a16, 0
  v_accvgpr_write_b32 a17, 0
  v_accvgpr_write_b32 a18, 0
  v_accvgpr_write_b32 a19, 0
  v_accvgpr_write_b32 a20, 0
  v_accvgpr_write_b32 a21, 0
  v_accvgpr_write_b32 a22, 0
  v_accvgpr_write_b32 a23, 0
  v_accvgpr_write_b32 a24, 0
  v_accvgpr_write_b32 a25, 0
  v_accvgpr_write_b32 a26, 0
  v_accvgpr_write_b32 a27, 0
  v_accvgpr_write_b32 a28, 0
  v_accvgpr_write_b32 a29, 0
  v_accvgpr_write_b32 a30, 0
  v_accvgpr_write_b32 a31, 0
  v_accvgpr_write_b32 a32, 0
  v_accvgpr_write_b32 a33, 0
  v_accvgpr_write_b32 a34, 0
  v_accvgpr_write_b32 a35, 0
  v_accvgpr_write_b32 a36, 0
  v_accvgpr_write_b32 a37, 0
  v_accvgpr_write_b32 a38, 0
  v_accvgpr_write_b32 a39, 0
  v_accvgpr_write_b32 a40, 0
  v_accvgpr_write_b32 a41, 0
  v_accvgpr_write_b32 a42, 0
  v_accvgpr_write_b32 a43, 0
  v_accvgpr_write_b32 a44, 0
  v_accvgpr_write_b32 a45, 0
  v_accvgpr_write_b32 a46, 0
  v_accvgpr_write_b32 a47, 0
  v_accvgpr_write_b32 a48, 0
  v_accvgpr_write_b32 a49, 0
  v_accvgpr_write_b32 a50, 0
  v_accvgpr_write_b32 a51, 0
  v_accvgpr_write_b32 a52, 0
  v_accvgpr_write_b32 a53, 0
  v_accvgpr_write_b32 a54, 0
  v_accvgpr_write_b32 a55, 0
  v_accvgpr_write_b32 a56, 0
  v_accvgpr_write_b32 a57, 0
  v_accvgpr_write_b32 a58, 0
  v_accvgpr_write_b32 a59, 0
  v_accvgpr_write_b32 a60, 0
  v_accvgpr_write_b32 a61, 0
  v_accvgpr_write_b32 a62, 0
  v_accvgpr_write_b32 a63, 0
  v_accvgpr_write_b32 a64, 0
  v_accvgpr_write_b32 a65, 0
  v_accvgpr_write_b32 a66, 0
  v_accvgpr_write_b32 a67, 0
  v_accvgpr_write_b32 a68, 0
  v_accvgpr_write_b32 a69, 0
  v_accvgpr_write_b32 a70, 0
  v_accvgpr_write_b32 a71, 0
  v_accvgpr_write_b32 a72, 0
  v_accvgpr_write_b32 a73, 0
  v_accvgpr_write_b32 a74, 0
  v_accvgpr_write_b32 a75, 0
  v_accvgpr_write_b32 a76, 0
  v_accvgpr_write_b32 a77, 0
  v_accvgpr_write_b32 a78, 0
  v_accvgpr_write_b32 a79, 0
  s_add_u32 s31, s2, s100
  s_and_b32 s48, s31, 3
  s_lshr_b32 s32, s31, 2
  s_xor_b32 s31, s31, s32
  s_and_b32 s31, s31, 1
  s_lshl_b32 s49, s31, 3
  s_mov_b32 s56, 0
  s_mov_b32 s57, 0
  s_cmp_eq_u32 s48, 1
  s_cselect_b32 s56, 470618644, s56
  s_cselect_b32 s57, 134746129, s57
  s_cmp_eq_u32 s48, 2
  s_cselect_b32 s56, 606020380, s56
  s_cselect_b32 s57, 605822241, s57
  s_cmp_eq_u32 s48, 3
  s_cselect_b32 s56, 942682936, s56
  s_cselect_b32 s57, 740568878, s57
  s_lshl_b32 s31, s29, 3
  s_lshr_b64 s[56:57], s[56:57], s31
  s_and_b32 s54, s56, 255
  s_mov_b32 s56, 135269640
  s_mov_b32 s57, 337383698
  s_lshr_b64 s[56:57], s[56:57], s31
  s_and_b32 s55, s56, 255
  s_cmp_eq_u32 s49, 0
  s_cselect_b32 s32, 3, 2
  s_bitcmp1_b32 s48, 0
  s_cselect_b32 s33, s32, 0
  s_add_u32 s54, s54, s33
  s_lshl_b32 s33, s33, 1
  s_sub_u32 s32, s32, s33
  s_add_u32 s55, s55, s32
  s_lshl_b32 s31, s29, 2
  s_lshr_b32 s31, 544478803, s31
  s_sub_u32 s32, s31, s48
  s_and_b32 s32, s32, 3
  s_and_b32 s31, s31, 4
  s_or_b32 s31, s31, s32
  s_and_b32 s50, s31, 2
  s_bfe_u32 s32, s28, 0x10001
  s_or_b32 s50, s50, s32
  s_and_b32 s32, s31, 1
  s_lshl_b32 s32, s32, 1
  s_and_b32 s31, s31, 4
  s_or_b32 s31, s31, s32
  s_and_b32 s32, s28, 1
  s_or_b32 s31, s31, s32
  s_lshl_b32 s31, s31, 2
  s_lshr_b32 s31, 1980781618, s31
  s_and_b32 s31, s31, 7
  s_add_u32 s49, s49, s31
  s_lshl_b32 s51, s49, 2
  s_add_u32 s51, s51, s50
  s_and_b32 s52, s30, 1
  s_lshr_b32 s53, s30, 1
  v_and_b32 v9, 31, v2
  v_lshlrev_b32 v9, 2, v9
  s_lshr_b32 s62, s49, 1
  s_lshl_b32 s62, s62, 7
  s_add_u32 s62, s62, 4096
  s_lshr_b32 s31, s54, 1
  s_add_u32 s32, s54, s55
  s_add_u32 s32, s32, 1
  s_lshr_b32 s32, s32, 1
  s_sub_u32 s32, s32, s31
  s_bfm_b32 s63, s32, s31
  s_lshl_b32 s31, s50, 1
  s_add_u32 s31, s31, s53
  s_mul_i32 s31, s31, 148
  s_lshl_b32 s32, s54, 1
  s_add_u32 s31, s31, s32
  s_add_u32 s31, s31, s52
  s_mul_i32 s58, s31, 5120
  s_lshl_b32 s31, s49, 3
  s_lshl_b32 s33, s30, 1
  s_add_u32 s31, s31, s33
  s_mul_i32 s31, s31, 148
  s_add_u32 s31, s31, s32
  s_lshl_b32 s59, s31, 10
  s_cmp_eq_u32 s30, 0
  s_cselect_b32 s47, 0x43, 1
  s_waitcnt vmcnt(0) lgkmcnt(0)
  s_barrier
  s_branch L_B_start
L_jobG:
  s_load_dwordx4 s[12:15], s[0:1], 48
  s_load_dwordx4 s[48:51], s[0:1], 64
  v_lshrrev_b32 v3, 3, v2
  v_and_b32 v6, 7, v2
  v_lshrrev_b32 v5, 4, v2
  v_and_b32 v4, 15, v2
  s_mul_i32 s31, s30, 81920
  v_mul_u32_u24 v3, 1280, v3
  v_add_u32 v3, s31, v3
  v_xor_b32 v6, v6, v5
  v_lshlrev_b32 v6, 4, v6
  v_add_u32 v8, v3, v6
  v_xor_b32 v6, 64, v6
  v_add_u32 v9, v3, v6
  v_add_u32 v9, 9216, v9
  s_and_b32 s40, s28, 3
  s_lshr_b32 s41, s28, 2
  s_lshr_b32 s31, s30, 1
  s_mul_i32 s31, s31, 160
  s_mul_i32 s32, s40, 320
  s_add_u32 s31, s31, s32
  s_and_b32 s32, s30, 1
  s_mul_i32 s32, s32, 40960
  s_add_u32 s31, s31, s32
  v_add_u32 v6, 0, v2
  v_mul_u32_u24 v7, 6554, v6
  v_lshrrev_b32 v7, 16, v7
  v_mul_u32_u24 v3, 10, v7
  v_sub_u32 v6, v6, v3
  v_lshlrev_b32 v6, 4, v6
  v_bfe_u32 v3, v7, 2, 2
  v_lshlrev_b32 v3, 3, v3
  v_lshrrev_b32 v1, 4, v7
  v_lshlrev_b32 v1, 2, v1
  v_and_b32 v7, 3, v7
  v_add3_u32 v7, v7, v3, v1
  v_mul_u32_u24 v7, 1280, v7
  v_add3_u32 v10, v7, v6, s31
  v_add_u32 v6, 64, v2
  v_mul_u32_u24 v7, 6554, v6
  v_lshrrev_b32 v7, 16, v7
  v_mul_u32_u24 v3, 10, v7
  v_sub_u32 v6, v6, v3
  v_lshlrev_b32 v6, 4, v6
  v_bfe_u32 v3, v7, 2, 2
  v_lshlrev_b32 v3, 3, v3
  v_lshrrev_b32 v1, 4, v7
  v_lshlrev_b32 v1, 2, v1
  v_and_b32 v7, 3, v7
  v_add3_u32 v7, v7, v3, v1
  v_mul_u32_u24 v7, 1280, v7
  v_add3_u32 v11, v7, v6, s31
  v_add_u32 v6, 128, v2
  v_mul_u32_u24 v7, 6554, v6
  v_lshrrev_b32 v7, 16, v7
  v_mul_u32_u24 v3, 10, v7
  v_sub_u32 v6, v6, v3
  v_lshlrev_b32 v6, 4, v6
  v_bfe_u32 v3, v7, 2, 2
  v_lshlrev_b32 v3, 3, v3
  v_lshrrev_b32 v1, 4, v7
  v_lshlrev_b32 v1, 2, v1
  v_and_b32 v7, 3, v7
  v_add3_u32 v7, v7, v3, v1
  v_mul_u32_u24 v7, 1280, v7
  v_add3_u32 v12, v7, v6, s31
  v_add_u32 v6, 192, v2
  v_mul_u32_u24 v7, 6554, v6
  v_lshrrev_b32 v7, 16, v7
  v_mul_u32_u24 v3, 10, v7
  v_sub_u32 v6, v6, v3
  v_lshlrev_b32 v6, 4, v6
  v_bfe_u32 v3, v7, 2, 2
  v_lshlrev_b32 v3, 3, v3
  v_lshrrev_b32 v1, 4, v7
  v_lshlrev_b32 v1, 2, v1
  v_and_b32 v7, 3, v7
  v_add3_u32 v7, v7, v3, v1
  v_mul_u32_u24 v7, 1280, v7
  v_add3_u32 v13, v7, v6, s31
  v_add_u32 v6, 256, v2
  v_mul_u32_u24 v7, 6554, v6
  v_lshrrev_b32 v7, 16, v7
  v_mul_u32_u24 v3, 10, v7
  v_sub_u32 v6, v6, v3
  v_lshlrev_b32 v6, 4, v6
  v_bfe_u32 v3, v7, 2, 2
  v_lshlrev_b32 v3, 3, v3
  v_lshrrev_b32 v1, 4, v7
  v_lshlrev_b32 v1, 2, v1
  v_and_b32 v7, 3, v7
  v_add3_u32 v7, v7, v3, v1
  v_mul_u32_u24 v7, 1280, v7
  v_add3_u32 v14, v7, v6, s31
  s_lshl_b32 s36, s30, 13
  s_mul_i32 s39, s30, 5120
  s_waitcnt lgkmcnt(0)
  s_mul_i32 s31, s41, 327680
  s_add_u32 s16, s12, s31
  s_addc_u32 s17, s13, 0
  s_and_b32 s17, s17, 0xffff
  s_sub_u32 s18, 2621440, s31
  s_mov_b32 s19, 0x20000
  s_mov_b32 s20, s14
  s_and_b32 s21, s15, 0xffff
  s_mov_b32 s22, 819200
  s_mov_b32 s23, 0x20000
  s_add_u32 m0, s36, 0
  s_mov_b32 s32, 0
  buffer_load_dwordx4 v8, s[16:19], s32 offen offset:0 lds
  buffer_load_dwordx4 v9, s[16:19], s32 offen offset:1024 lds
  s_mov_b32 s32, 18432
  buffer_load_dwordx4 v8, s[16:19], s32 offen offset:2048 lds
  buffer_load_dwordx4 v9, s[16:19], s32 offen offset:3072 lds
  s_add_u32 m0, s36, 4096
  s_mov_b32 s32, 40960
  buffer_load_dwordx4 v8, s[16:19], s32 offen offset:0 lds
  buffer_load_dwordx4 v9, s[16:19], s32 offen offset:1024 lds
  s_mov_b32 s32, 59392
  buffer_load_dwordx4 v8, s[16:19], s32 offen offset:2048 lds
  buffer_load_dwordx4 v9, s[16:19], s32 offen offset:3072 lds
  s_mov_b32 s34, 0
  s_add_u32 m0, s39, 98304
  s_nop 0
  buffer_load_dwordx4 v10, s[20:23], s34 offen lds
  s_add_u32 m0, s39, 99328
  s_nop 0
  buffer_load_dwordx4 v11, s[20:23], s34 offen lds
  s_add_u32 m0, s39, 100352
  s_nop 0
  buffer_load_dwordx4 v12, s[20:23], s34 offen lds
  s_add_u32 m0, s39, 101376
  s_nop 0
  buffer_load_dwordx4 v13, s[20:23], s34 offen lds
  s_add_u32 m0, s39, 102400
  s_nop 0
  buffer_load_dwordx4 v14, s[20:23], s34 offen lds
  s_cmp_lt_u32 s40, 2
  s_cselect_b32 s48, s48, s50
  s_cselect_b32 s49, s49, s51
  s_mov_b32 s52, s48
  s_and_b32 s53, s49, 0xffff
  s_mov_b32 s54, 25600
  s_mov_b32 s55, 0x20000
  v_lshrrev_b32 v23, 1, v2
  v_mul_u32_u24 v23, 40, v23
  v_and_b32 v3, 1, v2
  v_lshl_add_u32 v23, v3, 4, v23
  s_mul_i32 s31, s30, 6400
  s_and_b32 s32, s40, 1
  s_lshl_b32 s32, s32, 5
  s_add_u32 s31, s31, s32
  s_add_u32 m0, s39, 139264
  s_add_u32 s32, s31, 0
  buffer_load_dwordx4 v23, s[52:55], s32 offen lds
  s_add_u32 m0, s39, 140288
  s_add_u32 s32, s31, 1280
  buffer_load_dwordx4 v23, s[52:55], s32 offen lds
  s_add_u32 m0, s39, 141312
  s_add_u32 s32, s31, 2560
  buffer_load_dwordx4 v23, s[52:55], s32 offen lds
  s_add_u32 m0, s39, 142336
  s_add_u32 s32, s31, 3840
  buffer_load_dwordx4 v23, s[52:55], s32 offen lds
  s_add_u32 m0, s39, 143360
  s_add_u32 s32, s31, 5120
  buffer_load_dwordx4 v23, s[52:55], s32 offen lds
  s_add_u32 m0, s36, 32768
  s_mov_b32 s32, 128
  buffer_load_dwordx4 v8, s[16:19], s32 offen offset:0 lds
  buffer_load_dwordx4 v9, s[16:19], s32 offen offset:1024 lds
  s_mov_b32 s32, 18560
  buffer_load_dwordx4 v8, s[16:19], s32 offen offset:2048 lds
  buffer_load_dwordx4 v9, s[16:19], s32 offen offset:3072 lds
  s_add_u32 m0, s36, 36864
  s_mov_b32 s32, 41088
  buffer_load_dwordx4 v8, s[16:19], s32 offen offset:0 lds
  buffer_load_dwordx4 v9, s[16:19], s32 offen offset:1024 lds
  s_mov_b32 s32, 59520
  buffer_load_dwordx4 v8, s[16:19], s32 offen offset:2048 lds
  buffer_load_dwordx4 v9, s[16:19], s32 offen offset:3072 lds
  s_mov_b32 s34, 81920
  s_add_u32 m0, s39, 118784
  s_nop 0
  buffer_load_dwordx4 v10, s[20:23], s34 offen lds
  s_add_u32 m0, s39, 119808
  s_nop 0
  buffer_load_dwordx4 v11, s[20:23], s34 offen lds
  s_add_u32 m0, s39, 120832
  s_nop 0
  buffer_load_dwordx4 v12, s[20:23], s34 offen lds
  s_add_u32 m0, s39, 121856
  s_nop 0
  buffer_load_dwordx4 v13, s[20:23], s34 offen lds
  s_add_u32 m0, s39, 122880
  s_nop 0
  buffer_load_dwordx4 v14, s[20:23], s34 offen lds
  v_min_u32 v21, 19, v2
  v_lshlrev_b32 v21, 7, v21
  s_lshl_b32 s33, s2, 2
  s_add_u32 s33, s33, s30
  s_mul_i32 s33, s33, 2560
  s_mov_b32 s52, s12
  s_and_b32 s53, s13, 0xffff
  s_mov_b32 s54, 2621440
  s_mov_b32 s55, 0x20000
  buffer_load_dword v27, v21, s[52:55], s33 offen
  v_lshrrev_b32 v6, 1, v4
  v_xor_b32 v6, v5, v6
  v_lshlrev_b32 v6, 4, v6
  v_lshlrev_b32 v3, 7, v4
  v_add_u32 v3, v3, v6
  v_add_u32 v16, s36, v3
  v_xor_b32 v17, 64, v16
  v_add_u32 v18, 0x10000, v16
  v_add_u32 v19, 0x10000, v17
  v_bfe_u32 v6, v2, 2, 2
  v_and_b32 v7, 3, v2
  v_lshlrev_b32 v3, 2, v5
  v_add_u32 v3, v3, v6
  v_mul_u32_u24 v3, 160, v3
  v_mul_u32_u24 v7, 40, v7
  v_add_u32 v20, v3, v7
  v_add_u32 v20, 98304, v20
  v_bfe_u32 v6, v2, 2, 2
  v_lshlrev_b32 v3, 3, v5
  v_add_u32 v3, v3, v6
  v_lshlrev_b32 v3, 5, v3
  v_and_b32 v7, 3, v2
  v_lshlrev_b32 v7, 3, v7
  v_add_u32 v3, v3, v7
  v_add_u32 v3, 139264, v3
  s_waitcnt vmcnt(14)
  s_barrier
  ds_read_b64_tr_b16 v[80:81], v20 offset:0
  ds_read_b64_tr_b16 v[82:83], v20 offset:2560
  ds_read_b128 v[64:67], v16 offset:0
  ds_read_b128 v[68:71], v16 offset:2048
  ds_read_b128 v[72:75], v16 offset:4096
  ds_read_b128 v[76:79], v16 offset:6144
  ds_read_b64_tr_b16 v[84:85], v20 offset:8
  ds_read_b64_tr_b16 v[86:87], v20 offset:2568
  ds_read_b64_tr_b16 v[88:89], v20 offset:16
  ds_read_b64_tr_b16 v[90:91], v20 offset:2576
  ds_read_b64_tr_b16 v[92:93], v20 offset:24
  ds_read_b64_tr_b16 v[94:95], v20 offset:2584
  ds_read_b64_tr_b16 v[96:97], v20 offset:32
  ds_read_b64_tr_b16 v[98:99], v20 offset:2592
  ds_read_b64_tr_b16 v[100:101], v20 offset:10240
  ds_read_b64_tr_b16 v[102:103], v20 offset:12800
  ds_read_b64_tr_b16 v[104:105], v20 offset:10248
  ds_read_b64_tr_b16 v[106:107], v20 offset:12808
  ds_read_b64_tr_b16 v[108:109], v20 offset:10256
  ds_read_b64_tr_b16 v[110:111], v20 offset:12816
  ds_read_b64_tr_b16 v[112:113], v20 offset:10264
  ds_read_b64_tr_b16 v[114:115], v20 offset:12824
  ds_read_b64_tr_b16 v[116:117], v20 offset:10272
  ds_read_b64_tr_b16 v[118:119], v20 offset:12832
  ds_read_b64_tr_b16 v[176:177], v3 offset:0
  ds_read_b64_tr_b16 v[178:179], v3 offset:128
  ds_read_b64_tr_b16 v[180:181], v3 offset:1024
  ds_read_b64_tr_b16 v[182:183], v3 offset:1152
  ds_read_b64_tr_b16 v[184:185], v3 offset:2048
  ds_read_b64_tr_b16 v[186:187], v3 offset:2176
  ds_read_b64_tr_b16 v[188:189], v3 offset:3072
  ds_read_b64_tr_b16 v[190:191], v3 offset:3200
  ds_read_b64_tr_b16 v[192:193], v3 offset:4096
  ds_read_b64_tr_b16 v[194:195], v3 offset:4224
  ds_read_b64_tr_b16 v[196:197], v3 offset:5120
  ds_read_b64_tr_b16 v[198:199], v3 offset:5248
  ds_read_b64_tr_b16 v[200:201], v3 offset:6144
  ds_read_b64_tr_b16 v[202:203], v3 offset:6272
  ds_read_b64_tr_b16 v[204:205], v3 offset:7168
  ds_read_b64_tr_b16 v[206:207], v3 offset:7296
  ds_read_b64_tr_b16 v[208:209], v3 offset:8192
  ds_read_b64_tr_b16 v[210:211], v3 offset:8320
  ds_read_b64_tr_b16 v[212:213], v3 offset:9216
  ds_read_b64_tr_b16 v[214:215], v3 offset:9344
  ds_read_b64_tr_b16 v[216:217], v3 offset:10240
  ds_read_b64_tr_b16 v[218:219], v3 offset:10368
  ds_read_b64_tr_b16 v[220:221], v3 offset:11264
  ds_read_b64_tr_b16 v[222:223], v3 offset:11392
  ds_read_b64_tr_b16 v[224:225], v3 offset:12288
  ds_read_b64_tr_b16 v[226:227], v3 offset:12416
  ds_read_b64_tr_b16 v[228:229], v3 offset:13312
  ds_read_b64_tr_b16 v[230:231], v3 offset:13440
  ds_read_b64_tr_b16 v[232:233], v3 offset:14336
  ds_read_b64_tr_b16 v[234:235], v3 offset:14464
  ds_read_b64_tr_b16 v[236:237], v3 offset:15360
  ds_read_b64_tr_b16 v[238:239], v3 offset:15488
  ds_read_b64_tr_b16 v[240:241], v3 offset:16384
  ds_read_b64_tr_b16 v[242:243], v3 offset:16512
  ds_read_b64_tr_b16 v[244:245], v3 offset:17408
  ds_read_b64_tr_b16 v[246:247], v3 offset:17536
  ds_read_b64_tr_b16 v[248:249], v3 offset:18432
  ds_read_b64_tr_b16 v[250:251], v3 offset:18560
  ds_read_b64_tr_b16 v[252:253], v3 offset:19456
  ds_read_b64_tr_b16 v[254:255], v3 offset:19584
  s_waitcnt lgkmcnt(15)
  v_mfma_f32_16x16x32_bf16 a[0:3], v[80:83], v[64:67], 0
  ds_read_b64_tr_b16 v[136:137], v20 offset:5120
  v_mfma_f32_16x16x32_bf16 a[40:43], v[80:83], v[68:71], 0
  s_add_u32 m0, s36, 65536
  s_mov_b32 s32, 256
  v_mfma_f32_16x16x32_bf16 a[80:83], v[80:83], v[72:75], 0
  ds_read_b64_tr_b16 v[138:139], v20 offset:7680
  v_mfma_f32_16x16x32_bf16 a[120:123], v[80:83], v[76:79], 0
  buffer_load_dwordx4 v8, s[16:19], s32 offen offset:0 lds
  v_mfma_f32_16x16x32_bf16 a[4:7], v[84:87], v[64:67], 0
  ds_read_b128 v[120:123], v17 offset:0
  v_mfma_f32_16x16x32_bf16 a[44:47], v[84:87], v[68:71], 0
  ds_read_b128 v[124:127], v17 offset:2048
  v_mfma_f32_16x16x32_bf16 a[84:87], v[84:87], v[72:75], 0
  buffer_load_dwordx4 v9, s[16:19], s32 offen offset:1024 lds
  v_mfma_f32_16x16x32_bf16 a[124:127], v[84:87], v[76:79], 0
  ds_read_b128 v[128:131], v17 offset:4096
  v_mfma_f32_16x16x32_bf16 a[8:11], v[88:91], v[64:67], 0
  ds_read_b128 v[132:135], v17 offset:6144
  v_mfma_f32_16x16x32_bf16 a[48:51], v[88:91], v[68:71], 0
  v_mfma_f32_16x16x32_bf16 a[88:91], v[88:91], v[72:75], 0
  ds_read_b64_tr_b16 v[140:141], v20 offset:5128
  v_mfma_f32_16x16x32_bf16 a[128:131], v[88:91], v[76:79], 0
  s_mov_b32 s32, 18688
  buffer_load_dwordx4 v8, s[16:19], s32 offen offset:2048 lds
  v_mfma_f32_16x16x32_bf16 a[12:15], v[92:95], v[64:67], 0
  ds_read_b64_tr_b16 v[142:143], v20 offset:7688
  v_mfma_f32_16x16x32_bf16 a[52:55], v[92:95], v[68:71], 0
  ds_read_b64_tr_b16 v[144:145], v20 offset:5136
  v_mfma_f32_16x16x32_bf16 a[92:95], v[92:95], v[72:75], 0
  v_mfma_f32_16x16x32_bf16 a[132:135], v[92:95], v[76:79], 0
  ds_read_b64_tr_b16 v[146:147], v20 offset:7696
  v_mfma_f32_16x16x32_bf16 a[16:19], v[96:99], v[64:67], 0
  ds_read_b64_tr_b16 v[148:149], v20 offset:5144
  v_mfma_f32_16x16x32_bf16 a[56:59], v[96:99], v[68:71], 0
  buffer_load_dwordx4 v9, s[16:19], s32 offen offset:3072 lds
  v_mfma_f32_16x16x32_bf16 a[96:99], v[96:99], v[72:75], 0
  ds_read_b64_tr_b16 v[150:151], v20 offset:7704
  v_mfma_f32_16x16x32_bf16 a[136:139], v[96:99], v[76:79], 0
  v_mfma_f32_16x16x32_bf16 a[20:23], v[100:103], v[64:67], 0
  ds_read_b64_tr_b16 v[152:153], v20 offset:5152
  v_mfma_f32_16x16x32_bf16 a[60:63], v[100:103], v[68:71], 0
  s_add_u32 m0, s36, 69632
  s_mov_b32 s32, 41216
  ds_read_b64_tr_b16 v[154:155], v20 offset:7712
  v_mfma_f32_16x16x32_bf16 a[100:103], v[100:103], v[72:75], 0
  buffer_load_dwordx4 v8, s[16:19], s32 offen offset:0 lds
  v_mfma_f32_16x16x32_bf16 a[140:143], v[100:103], v[76:79], 0
  ds_read_b64_tr_b16 v[156:157], v20 offset:15360
  v_mfma_f32_16x16x32_bf16 a[24:27], v[104:107], v[64:67], 0
  ds_read_b64_tr_b16 v[158:159], v20 offset:17920
  v_mfma_f32_16x16x32_bf16 a[64:67], v[104:107], v[68:71], 0
  v_mfma_f32_16x16x32_bf16 a[104:107], v[104:107], v[72:75], 0
  ds_read_b64_tr_b16 v[160:161], v20 offset:15368
  v_mfma_f32_16x16x32_bf16 a[144:147], v[104:107], v[76:79], 0
  buffer_load_dwordx4 v9, s[16:19], s32 offen offset:1024 lds
  v_mfma_f32_16x16x32_bf16 a[28:31], v[108:111], v[64:67], 0
  ds_read_b64_tr_b16 v[162:163], v20 offset:17928
  v_mfma_f32_16x16x32_bf16 a[68:71], v[108:111], v[68:71], 0
  ds_read_b64_tr_b16 v[164:165], v20 offset:15376
  v_mfma_f32_16x16x32_bf16 a[108:111], v[108:111], v[72:75], 0
  v_mfma_f32_16x16x32_bf16 a[148:151], v[108:111], v[76:79], 0
  s_mov_b32 s32, 59648
  ds_read_b64_tr_b16 v[166:167], v20 offset:17936
  v_mfma_f32_16x16x32_bf16 a[32:35], v[112:115], v[64:67], 0
  ds_read_b64_tr_b16 v[168:169], v20 offset:15384
  v_mfma_f32_16x16x32_bf16 a[72:75], v[112:115], v[68:71], 0
  buffer_load_dwordx4 v8, s[16:19], s32 offen offset:2048 lds
  v_mfma_f32_16x16x32_bf16 a[112:115], v[112:115], v[72:75], 0
  ds_read_b64_tr_b16 v[170:171], v20 offset:17944
  v_mfma_f32_16x16x32_bf16 a[152:155], v[112:115], v[76:79], 0
  v_mfma_f32_16x16x32_bf16 a[36:39], v[116:119], v[64:67], 0
  ds_read_b64_tr_b16 v[172:173], v20 offset:15392
  v_mfma_f32_16x16x32_bf16 a[76:79], v[116:119], v[68:71], 0
  ds_read_b64_tr_b16 v[174:175], v20 offset:17952
  v_mfma_f32_16x16x32_bf16 a[116:119], v[116:119], v[72:75], 0
  buffer_load_dwordx4 v9, s[16:19], s32 offen offset:3072 lds
  v_mfma_f32_16x16x32_bf16 a[156:159], v[116:119], v[76:79], 0
  v_mfma_f32_16x16x32_bf16 a[160:163], v[176:179], v[64:67], 0
  v_mfma_f32_16x16x32_bf16 a[176:179], v[64:67], v[176:179], 0
  v_mfma_f32_16x16x32_bf16 a[164:167], v[176:179], v[68:71], 0
  v_mfma_f32_16x16x32_bf16 a[180:183], v[68:71], v[176:179], 0
  v_mfma_f32_16x16x32_bf16 a[168:171], v[176:179], v[72:75], 0
  v_mfma_f32_16x16x32_bf16 a[184:187], v[72:75], v[176:179], 0
  v_mfma_f32_16x16x32_bf16 a[172:175], v[176:179], v[76:79], 0
  v_mfma_f32_16x16x32_bf16 a[188:191], v[76:79], v[176:179], 0
  s_waitcnt lgkmcnt(3)
  v_mfma_f32_16x16x32_bf16 a[0:3], v[136:139], v[120:123], a[0:3]
  v_mfma_f32_16x16x32_bf16 a[40:43], v[136:139], v[124:127], a[40:43]
  v_mfma_f32_16x16x32_bf16 a[80:83], v[136:139], v[128:131], a[80:83]
  v_mfma_f32_16x16x32_bf16 a[120:123], v[136:139], v[132:135], a[120:123]
  s_waitcnt vmcnt(9) lgkmcnt(0)
  s_barrier
  s_mov_b32 s34, 163840
  s_add_u32 m0, s39, 139264
  s_nop 0
  buffer_load_dwordx4 v10, s[20:23], s34 offen lds
  s_add_u32 m0, s39, 140288
  s_nop 0
  buffer_load_dwordx4 v11, s[20:23], s34 offen lds
  s_add_u32 m0, s39, 141312
  s_nop 0
  buffer_load_dwordx4 v12, s[20:23], s34 offen lds
  s_add_u32 m0, s39, 142336
  s_nop 0
  buffer_load_dwordx4 v13, s[20:23], s34 offen lds
  s_add_u32 m0, s39, 143360
  s_nop 0
  buffer_load_dwordx4 v14, s[20:23], s34 offen lds
  v_mfma_f32_16x16x32_bf16 a[4:7], v[140:143], v[120:123], a[4:7]
  ds_read_b64_tr_b16 v[80:81], v20 offset:20480
  v_mfma_f32_16x16x32_bf16 a[44:47], v[140:143], v[124:127], a[44:47]
  s_add_u32 m0, s36, 0
  s_mov_b32 s32, 384
  v_mfma_f32_16x16x32_bf16 a[84:87], v[140:143], v[128:131], a[84:87]
  ds_read_b64_tr_b16 v[82:83], v20 offset:23040
  v_mfma_f32_16x16x32_bf16 a[124:127], v[140:143], v[132:135], a[124:127]
  buffer_load_dwordx4 v8, s[16:19], s32 offen offset:0 lds
  v_mfma_f32_16x16x32_bf16 a[8:11], v[144:147], v[120:123], a[8:11]
  ds_read_b128 v[64:67], v16 offset:32768
  v_mfma_f32_16x16x32_bf16 a[48:51], v[144:147], v[124:127], a[48:51]
  ds_read_b128 v[68:71], v16 offset:34816
  v_mfma_f32_16x16x32_bf16 a[88:91], v[144:147], v[128:131], a[88:91]
  buffer_load_dwordx4 v9, s[16:19], s32 offen offset:1024 lds
  v_mfma_f32_16x16x32_bf16 a[128:131], v[144:147], v[132:135], a[128:131]
  ds_read_b128 v[72:75], v16 offset:36864
  v_mfma_f32_16x16x32_bf16 a[12:15], v[148:151], v[120:123], a[12:15]
  ds_read_b128 v[76:79], v16 offset:38912
  v_mfma_f32_16x16x32_bf16 a[52:55], v[148:151], v[124:127], a[52:55]
  v_mfma_f32_16x16x32_bf16 a[92:95], v[148:151], v[128:131], a[92:95]
  ds_read_b64_tr_b16 v[84:85], v20 offset:20488
  v_mfma_f32_16x16x32_bf16 a[132:135], v[148:151], v[132:135], a[132:135]
  s_mov_b32 s32, 18816
  buffer_load_dwordx4 v8, s[16:19], s32 offen offset:2048 lds
  v_mfma_f32_16x16x32_bf16 a[16:19], v[152:155], v[120:123], a[16:19]
  ds_read_b64_tr_b16 v[86:87], v20 offset:23048
  v_mfma_f32_16x16x32_bf16 a[56:59], v[152:155], v[124:127], a[56:59]
  ds_read_b64_tr_b16 v[88:89], v20 offset:20496
  v_mfma_f32_16x16x32_bf16 a[96:99], v[152:155], v[128:131], a[96:99]
  v_mfma_f32_16x16x32_bf16 a[136:139], v[152:155], v[132:135], a[136:139]
  ds_read_b64_tr_b16 v[90:91], v20 offset:23056
  v_mfma_f32_16x16x32_bf16 a[20:23], v[156:159], v[120:123], a[20:23]
  ds_read_b64_tr_b16 v[92:93], v20 offset:20504
  v_mfma_f32_16x16x32_bf16 a[60:63], v[156:159], v[124:127], a[60:63]
  buffer_load_dwordx4 v9, s[16:19], s32 offen offset:3072 lds
  v_mfma_f32_16x16x32_bf16 a[100:103], v[156:159], v[128:131], a[100:103]
  ds_read_b64_tr_b16 v[94:95], v20 offset:23064
  v_mfma_f32_16x16x32_bf16 a[140:143], v[156:159], v[132:135], a[140:143]
  v_mfma_f32_16x16x32_bf16 a[24:27], v[160:163], v[120:123], a[24:27]
  ds_read_b64_tr_b16 v[96:97], v20 offset:20512
  v_mfma_f32_16x16x32_bf16 a[64:67], v[160:163], v[124:127], a[64:67]
  s_add_u32 m0, s36, 4096
  s_mov_b32 s32, 41344
  ds_read_b64_tr_b16 v[98:99], v20 offset:23072
  v_mfma_f32_16x16x32_bf16 a[104:107], v[160:163], v[128:131], a[104:107]
  buffer_load_dwordx4 v8, s[16:19], s32 offen offset:0 lds
  v_mfma_f32_16x16x32_bf16 a[144:147], v[160:163], v[132:135], a[144:147]
  ds_read_b64_tr_b16 v[100:101], v20 offset:30720
  v_mfma_f32_16x16x32_bf16 a[28:31], v[164:167], v[120:123], a[28:31]
  ds_read_b64_tr_b16 v[102:103], v20 offset:33280
  v_mfma_f32_16x16x32_bf16 a[68:71], v[164:167], v[124:127], a[68:71]
  v_mfma_f32_16x16x32_bf16 a[108:111], v[164:167], v[128:131], a[108:111]
  ds_read_b64_tr_b16 v[104:105], v20 offset:30728
  v_mfma_f32_16x16x32_bf16 a[148:151], v[164:167], v[132:135], a[148:151]
  buffer_load_dwordx4 v9, s[16:19], s32 offen offset:1024 lds
  v_mfma_f32_16x16x32_bf16 a[32:35], v[168:171], v[120:123], a[32:35]
  ds_read_b64_tr_b16 v[106:107], v20 offset:33288
  v_mfma_f32_16x16x32_bf16 a[72:75], v[168:171], v[124:127], a[72:75]
  ds_read_b64_tr_b16 v[108:109], v20 offset:30736
  v_mfma_f32_16x16x32_bf16 a[112:115], v[168:171], v[128:131], a[112:115]
  v_mfma_f32_16x16x32_bf16 a[152:155], v[168:171], v[132:135], a[152:155]
  s_mov_b32 s32, 59776
  ds_read_b64_tr_b16 v[110:111], v20 offset:33296
  v_mfma_f32_16x16x32_bf16 a[36:39], v[172:175], v[120:123], a[36:39]
  ds_read_b64_tr_b16 v[112:113], v20 offset:30744
  v_mfma_f32_16x16x32_bf16 a[76:79], v[172:175], v[124:127], a[76:79]
  buffer_load_dwordx4 v8, s[16:19], s32 offen offset:2048 lds
  v_mfma_f32_16x16x32_bf16 a[116:119], v[172:175], v[128:131], a[116:119]
  ds_read_b64_tr_b16 v[114:115], v20 offset:33304
  v_mfma_f32_16x16x32_bf16 a[156:159], v[172:175], v[132:135], a[156:159]
  v_mfma_f32_16x16x32_bf16 a[160:163], v[180:183], v[120:123], a[160:163]
  ds_read_b64_tr_b16 v[116:117], v20 offset:30752
  v_mfma_f32_16x16x32_bf16 a[176:179], v[120:123], v[180:183], a[176:179]
  ds_read_b64_tr_b16 v[118:119], v20 offset:33312
  v_mfma_f32_16x16x32_bf16 a[164:167], v[180:183], v[124:127], a[164:167]
  v_mfma_f32_16x16x32_bf16 a[180:183], v[124:127], v[180:183], a[180:183]
  v_mfma_f32_16x16x32_bf16 a[168:171], v[180:183], v[128:131], a[168:171]
  v_mfma_f32_16x16x32_bf16 a[184:187], v[128:131], v[180:183], a[184:187]
  v_mfma_f32_16x16x32_bf16 a[172:175], v[180:183], v[132:135], a[172:175]
  v_mfma_f32_16x16x32_bf16 a[188:191], v[132:135], v[180:183], a[188:191]
  s_waitcnt lgkmcnt(5)
  v_mfma_f32_16x16x32_bf16 a[0:3], v[80:83], v[64:67], a[0:3]
  ds_read_b64_tr_b16 v[136:137], v20 offset:25600
  v_mfma_f32_16x16x32_bf16 a[40:43], v[80:83], v[68:71], a[40:43]
  buffer_load_dwordx4 v9, s[16:19], s32 offen offset:3072 lds
  v_mfma_f32_16x16x32_bf16 a[80:83], v[80:83], v[72:75], a[80:83]
  ds_read_b64_tr_b16 v[138:139], v20 offset:28160
  v_mfma_f32_16x16x32_bf16 a[120:123], v[80:83], v[76:79], a[120:123]
  v_mfma_f32_16x16x32_bf16 a[4:7], v[84:87], v[64:67], a[4:7]
  ds_read_b128 v[120:123], v17 offset:32768
  v_mfma_f32_16x16x32_bf16 a[44:47], v[84:87], v[68:71], a[44:47]
  ds_read_b128 v[124:127], v17 offset:34816
  v_mfma_f32_16x16x32_bf16 a[84:87], v[84:87], v[72:75], a[84:87]
  s_mov_b32 s34, 245760
  s_add_u32 m0, s39, 98304
  v_mfma_f32_16x16x32_bf16 a[124:127], v[84:87], v[76:79], a[124:127]
  ds_read_b128 v[128:131], v17 offset:36864
  v_mfma_f32_16x16x32_bf16 a[8:11], v[88:91], v[64:67], a[8:11]
  ds_read_b128 v[132:135], v17 offset:38912
  v_mfma_f32_16x16x32_bf16 a[48:51], v[88:91], v[68:71], a[48:51]
  buffer_load_dwordx4 v10, s[20:23], s34 offen lds
  v_mfma_f32_16x16x32_bf16 a[88:91], v[88:91], v[72:75], a[88:91]
  ds_read_b64_tr_b16 v[140:141], v20 offset:25608
  v_mfma_f32_16x16x32_bf16 a[128:131], v[88:91], v[76:79], a[128:131]
  s_add_u32 m0, s39, 99328
  v_mfma_f32_16x16x32_bf16 a[12:15], v[92:95], v[64:67], a[12:15]
  ds_read_b64_tr_b16 v[142:143], v20 offset:28168
  v_mfma_f32_16x16x32_bf16 a[52:55], v[92:95], v[68:71], a[52:55]
  ds_read_b64_tr_b16 v[144:145], v20 offset:25616
  v_mfma_f32_16x16x32_bf16 a[92:95], v[92:95], v[72:75], a[92:95]
  buffer_load_dwordx4 v11, s[20:23], s34 offen lds
  v_mfma_f32_16x16x32_bf16 a[132:135], v[92:95], v[76:79], a[132:135]
  ds_read_b64_tr_b16 v[146:147], v20 offset:28176
  v_mfma_f32_16x16x32_bf16 a[16:19], v[96:99], v[64:67], a[16:19]
  s_add_u32 m0, s39, 100352
  ds_read_b64_tr_b16 v[148:149], v20 offset:25624
  v_mfma_f32_16x16x32_bf16 a[56:59], v[96:99], v[68:71], a[56:59]
  buffer_load_dwordx4 v12, s[20:23], s34 offen lds
  v_mfma_f32_16x16x32_bf16 a[96:99], v[96:99], v[72:75], a[96:99]
  ds_read_b64_tr_b16 v[150:151], v20 offset:28184
  v_mfma_f32_16x16x32_bf16 a[136:139], v[96:99], v[76:79], a[136:139]
  v_mfma_f32_16x16x32_bf16 a[20:23], v[100:103], v[64:67], a[20:23]
  ds_read_b64_tr_b16 v[152:153], v20 offset:25632
  v_mfma_f32_16x16x32_bf16 a[60:63], v[100:103], v[68:71], a[60:63]
  s_add_u32 m0, s39, 101376
  ds_read_b64_tr_b16 v[154:155], v20 offset:28192
  v_mfma_f32_16x16x32_bf16 a[100:103], v[100:103], v[72:75], a[100:103]
  buffer_load_dwordx4 v13, s[20:23], s34 offen lds
  v_mfma_f32_16x16x32_bf16 a[140:143], v[100:103], v[76:79], a[140:143]
  ds_read_b64_tr_b16 v[156:157], v20 offset:35840
  v_mfma_f32_16x16x32_bf16 a[24:27], v[104:107], v[64:67], a[24:27]
  ds_read_b64_tr_b16 v[158:159], v20 offset:38400
  v_mfma_f32_16x16x32_bf16 a[64:67], v[104:107], v[68:71], a[64:67]
  v_mfma_f32_16x16x32_bf16 a[104:107], v[104:107], v[72:75], a[104:107]
  s_add_u32 m0, s39, 102400
  ds_read_b64_tr_b16 v[160:161], v20 offset:35848
  v_mfma_f32_16x16x32_bf16 a[144:147], v[104:107], v[76:79], a[144:147]
  s_waitcnt lgkmcnt(7)
  buffer_load_dwordx4 v14, s[20:23], s34 offen lds
  v_mfma_f32_16x16x32_bf16 a[28:31], v[108:111], v[64:67], a[28:31]
  ds_read_b64_tr_b16 v[162:163], v20 offset:38408
  v_mfma_f32_16x16x32_bf16 a[68:71], v[108:111], v[68:71], a[68:71]
  ds_read_b64_tr_b16 v[164:165], v20 offset:35856
  v_mfma_f32_16x16x32_bf16 a[108:111], v[108:111], v[72:75], a[108:111]
  v_mfma_f32_16x16x32_bf16 a[148:151], v[108:111], v[76:79], a[148:151]
  ds_read_b64_tr_b16 v[166:167], v20 offset:38416
  v_mfma_f32_16x16x32_bf16 a[32:35], v[112:115], v[64:67], a[32:35]
  ds_read_b64_tr_b16 v[168:169], v20 offset:35864
  v_mfma_f32_16x16x32_bf16 a[72:75], v[112:115], v[68:71], a[72:75]
  v_mfma_f32_16x16x32_bf16 a[112:115], v[112:115], v[72:75], a[112:115]
  ds_read_b64_tr_b16 v[170:171], v20 offset:38424
  v_mfma_f32_16x16x32_bf16 a[152:155], v[112:115], v[76:79], a[152:155]
  v_mfma_f32_16x16x32_bf16 a[36:39], v[116:119], v[64:67], a[36:39]
  ds_read_b64_tr_b16 v[172:173], v20 offset:35872
  v_mfma_f32_16x16x32_bf16 a[76:79], v[116:119], v[68:71], a[76:79]
  ds_read_b64_tr_b16 v[174:175], v20 offset:38432
  v_mfma_f32_16x16x32_bf16 a[116:119], v[116:119], v[72:75], a[116:119]
  v_mfma_f32_16x16x32_bf16 a[156:159], v[116:119], v[76:79], a[156:159]
  v_mfma_f32_16x16x32_bf16 a[160:163], v[184:187], v[64:67], a[160:163]
  v_mfma_f32_16x16x32_bf16 a[176:179], v[64:67], v[184:187], a[176:179]
  v_mfma_f32_16x16x32_bf16 a[164:167], v[184:187], v[68:71], a[164:167]
  v_mfma_f32_16x16x32_bf16 a[180:183], v[68:71], v[184:187], a[180:183]
  v_mfma_f32_16x16x32_bf16 a[168:171], v[184:187], v[72:75], a[168:171]
  v_mfma_f32_16x16x32_bf16 a[184:187], v[72:75], v[184:187], a[184:187]
  v_mfma_f32_16x16x32_bf16 a[172:175], v[184:187], v[76:79], a[172:175]
  v_mfma_f32_16x16x32_bf16 a[188:191], v[76:79], v[184:187], a[188:191]
  v_mfma_f32_16x16x32_bf16 a[0:3], v[136:139], v[120:123], a[0:3]
  v_mfma_f32_16x16x32_bf16 a[40:43], v[136:139], v[124:127], a[40:43]
  v_mfma_f32_16x16x32_bf16 a[80:83], v[136:139], v[128:131], a[80:83]
  v_mfma_f32_16x16x32_bf16 a[120:123], v[136:139], v[132:135], a[120:123]
  s_waitcnt vmcnt(13) lgkmcnt(0)
  s_barrier
  s_mov_b32 s24, s4
  s_and_b32 s25, s5, 0xffff
  s_mov_b32 s26, 256
  s_mov_b32 s27, 0x20000
  v_mov_b32 v61, 0
  buffer_load_dword v60, v61, s[24:27], 0 offen sc1
  v_mfma_f32_16x16x32_bf16 a[4:7], v[140:143], v[120:123], a[4:7]
  ds_read_b64_tr_b16 v[80:81], v20 offset:40960
  v_mfma_f32_16x16x32_bf16 a[44:47], v[140:143], v[124:127], a[44:47]
  s_add_u32 m0, s36, 32768
  s_mov_b32 s32, 512
  v_mfma_f32_16x16x32_bf16 a[84:87], v[140:143], v[128:131], a[84:87]
  ds_read_b64_tr_b16 v[82:83], v20 offset:43520
  v_mfma_f32_16x16x32_bf16 a[124:127], v[140:143], v[132:135], a[124:127]
  buffer_load_dwordx4 v8, s[16:19], s32 offen offset:0 lds
  v_mfma_f32_16x16x32_bf16 a[8:11], v[144:147], v[120:123], a[8:11]
  ds_read_b128 v[64:67], v18 offset:0
  v_mfma_f32_16x16x32_bf16 a[48:51], v[144:147], v[124:127], a[48:51]
  ds_read_b128 v[68:71], v18 offset:2048
  v_mfma_f32_16x16x32_bf16 a[88:91], v[144:147], v[128:131], a[88:91]
  buffer_load_dwordx4 v9, s[16:19], s32 offen offset:1024 lds
  v_mfma_f32_16x16x32_bf16 a[128:131], v[144:147], v[132:135], a[128:131]
  ds_read_b128 v[72:75], v18 offset:4096
  v_mfma_f32_16x16x32_bf16 a[12:15], v[148:151], v[120:123], a[12:15]
  ds_read_b128 v[76:79], v18 offset:6144
  v_mfma_f32_16x16x32_bf16 a[52:55], v[148:151], v[124:127], a[52:55]
  v_mfma_f32_16x16x32_bf16 a[92:95], v[148:151], v[128:131], a[92:95]
  ds_read_b64_tr_b16 v[84:85], v20 offset:40968
  v_mfma_f32_16x16x32_bf16 a[132:135], v[148:151], v[132:135], a[132:135]
  s_mov_b32 s32, 18944
  buffer_load_dwordx4 v8, s[16:19], s32 offen offset:2048 lds
  v_mfma_f32_16x16x32_bf16 a[16:19], v[152:155], v[120:123], a[16:19]
  ds_read_b64_tr_b16 v[86:87], v20 offset:43528
  v_mfma_f32_16x16x32_bf16 a[56:59], v[152:155], v[124:127], a[56:59]
  ds_read_b64_tr_b16 v[88:89], v20 offset:40976
  v_mfma_f32_16x16x32_bf16 a[96:99], v[152:155], v[128:131], a[96:99]
  v_mfma_f32_16x16x32_bf16 a[136:139], v[152:155], v[132:135], a[136:139]
  ds_read_b64_tr_b16 v[90:91], v20 offset:43536
  v_mfma_f32_16x16x32_bf16 a[20:23], v[156:159], v[120:123], a[20:23]
  ds_read_b64_tr_b16 v[92:93], v20 offset:40984
  v_mfma_f32_16x16x32_bf16 a[60:63], v[156:159], v[124:127], a[60:63]
  buffer_load_dwordx4 v9, s[16:19], s32 offen offset:3072 lds
  v_mfma_f32_16x16x32_bf16 a[100:103], v[156:159], v[128:131], a[100:103]
  ds_read_b64_tr_b16 v[94:95], v20 offset:43544
  v_mfma_f32_16x16x32_bf16 a[140:143], v[156:159], v[132:135], a[140:143]
  v_mfma_f32_16x16x32_bf16 a[24:27], v[160:163], v[120:123], a[24:27]
  ds_read_b64_tr_b16 v[96:97], v20 offset:40992
  v_mfma_f32_16x16x32_bf16 a[64:67], v[160:163], v[124:127], a[64:67]
  s_add_u32 m0, s36, 36864
  s_mov_b32 s32, 41472
  ds_read_b64_tr_b16 v[98:99], v20 offset:43552
  v_mfma_f32_16x16x32_bf16 a[104:107], v[160:163], v[128:131], a[104:107]
  buffer_load_dwordx4 v8, s[16:19], s32 offen offset:0 lds
  v_mfma_f32_16x16x32_bf16 a[144:147], v[160:163], v[132:135], a[144:147]
  ds_read_b64_tr_b16 v[100:101], v20 offset:51200
  v_mfma_f32_16x16x32_bf16 a[28:31], v[164:167], v[120:123], a[28:31]
  ds_read_b64_tr_b16 v[102:103], v20 offset:53760
  v_mfma_f32_16x16x32_bf16 a[68:71], v[164:167], v[124:127], a[68:71]
  v_mfma_f32_16x16x32_bf16 a[108:111], v[164:167], v[128:131], a[108:111]
  ds_read_b64_tr_b16 v[104:105], v20 offset:51208
  v_mfma_f32_16x16x32_bf16 a[148:151], v[164:167], v[132:135], a[148:151]
  buffer_load_dwordx4 v9, s[16:19], s32 offen offset:1024 lds
  v_mfma_f32_16x16x32_bf16 a[32:35], v[168:171], v[120:123], a[32:35]
  ds_read_b64_tr_b16 v[106:107], v20 offset:53768
  v_mfma_f32_16x16x32_bf16 a[72:75], v[168:171], v[124:127], a[72:75]
  ds_read_b64_tr_b16 v[108:109], v20 offset:51216
  v_mfma_f32_16x16x32_bf16 a[112:115], v[168:171], v[128:131], a[112:115]
  v_mfma_f32_16x16x32_bf16 a[152:155], v[168:171], v[132:135], a[152:155]
  s_mov_b32 s32, 59904
  ds_read_b64_tr_b16 v[110:111], v20 offset:53776
  v_mfma_f32_16x16x32_bf16 a[36:39], v[172:175], v[120:123], a[36:39]
  ds_read_b64_tr_b16 v[112:113], v20 offset:51224
  v_mfma_f32_16x16x32_bf16 a[76:79], v[172:175], v[124:127], a[76:79]
  buffer_load_dwordx4 v8, s[16:19], s32 offen offset:2048 lds
  v_mfma_f32_16x16x32_bf16 a[116:119], v[172:175], v[128:131], a[116:119]
  ds_read_b64_tr_b16 v[114:115], v20 offset:53784
  v_mfma_f32_16x16x32_bf16 a[156:159], v[172:175], v[132:135], a[156:159]
  v_mfma_f32_16x16x32_bf16 a[160:163], v[188:191], v[120:123], a[160:163]
  ds_read_b64_tr_b16 v[116:117], v20 offset:51232
  v_mfma_f32_16x16x32_bf16 a[176:179], v[120:123], v[188:191], a[176:179]
  ds_read_b64_tr_b16 v[118:119], v20 offset:53792
  v_mfma_f32_16x16x32_bf16 a[164:167], v[188:191], v[124:127], a[164:167]
  v_mfma_f32_16x16x32_bf16 a[180:183], v[124:127], v[188:191], a[180:183]
  v_mfma_f32_16x16x32_bf16 a[168:171], v[188:191], v[128:131], a[168:171]
  v_mfma_f32_16x16x32_bf16 a[184:187], v[128:131], v[188:191], a[184:187]
  v_mfma_f32_16x16x32_bf16 a[172:175], v[188:191], v[132:135], a[172:175]
  v_mfma_f32_16x16x32_bf16 a[188:191], v[132:135], v[188:191], a[188:191]
  s_waitcnt lgkmcnt(5)
  v_mfma_f32_16x16x32_bf16 a[0:3], v[80:83], v[64:67], a[0:3]
  ds_read_b64_tr_b16 v[136:137], v20 offset:46080
  v_mfma_f32_16x16x32_bf16 a[40:43], v[80:83], v[68:71], a[40:43]
  buffer_load_dwordx4 v9, s[16:19], s32 offen offset:3072 lds
  v_mfma_f32_16x16x32_bf16 a[80:83], v[80:83], v[72:75], a[80:83]
  ds_read_b64_tr_b16 v[138:139], v20 offset:48640
  v_mfma_f32_16x16x32_bf16 a[120:123], v[80:83], v[76:79], a[120:123]
  v_mfma_f32_16x16x32_bf16 a[4:7], v[84:87], v[64:67], a[4:7]
  ds_read_b128 v[120:123], v19 offset:0
  v_mfma_f32_16x16x32_bf16 a[44:47], v[84:87], v[68:71], a[44:47]
  ds_read_b128 v[124:127], v19 offset:2048
  v_mfma_f32_16x16x32_bf16 a[84:87], v[84:87], v[72:75], a[84:87]
  s_mov_b32 s34, 327680
  s_add_u32 m0, s39, 118784
  v_mfma_f32_16x16x32_bf16 a[124:127], v[84:87], v[76:79], a[124:127]
  ds_read_b128 v[128:131], v19 offset:4096
  v_mfma_f32_16x16x32_bf16 a[8:11], v[88:91], v[64:67], a[8:11]
  ds_read_b128 v[132:135], v19 offset:6144
  v_mfma_f32_16x16x32_bf16 a[48:51], v[88:91], v[68:71], a[48:51]
  buffer_load_dwordx4 v10, s[20:23], s34 offen lds
  v_mfma_f32_16x16x32_bf16 a[88:91], v[88:91], v[72:75], a[88:91]
  ds_read_b64_tr_b16 v[140:141], v20 offset:46088
  v_mfma_f32_16x16x32_bf16 a[128:131], v[88:91], v[76:79], a[128:131]
  s_add_u32 m0, s39, 119808
  v_mfma_f32_16x16x32_bf16 a[12:15], v[92:95], v[64:67], a[12:15]
  ds_read_b64_tr_b16 v[142:143], v20 offset:48648
  v_mfma_f32_16x16x32_bf16 a[52:55], v[92:95], v[68:71], a[52:55]
  ds_read_b64_tr_b16 v[144:145], v20 offset:46096
  v_mfma_f32_16x16x32_bf16 a[92:95], v[92:95], v[72:75], a[92:95]
  buffer_load_dwordx4 v11, s[20:23], s34 offen lds
  v_mfma_f32_16x16x32_bf16 a[132:135], v[92:95], v[76:79], a[132:135]
  ds_read_b64_tr_b16 v[146:147], v20 offset:48656
  v_mfma_f32_16x16x32_bf16 a[16:19], v[96:99], v[64:67], a[16:19]
  s_add_u32 m0, s39, 120832
  ds_read_b64_tr_b16 v[148:149], v20 offset:46104
  v_mfma_f32_16x16x32_bf16 a[56:59], v[96:99], v[68:71], a[56:59]
  buffer_load_dwordx4 v12, s[20:23], s34 offen lds
  v_mfma_f32_16x16x32_bf16 a[96:99], v[96:99], v[72:75], a[96:99]
  ds_read_b64_tr_b16 v[150:151], v20 offset:48664
  v_mfma_f32_16x16x32_bf16 a[136:139], v[96:99], v[76:79], a[136:139]
  v_mfma_f32_16x16x32_bf16 a[20:23], v[100:103], v[64:67], a[20:23]
  ds_read_b64_tr_b16 v[152:153], v20 offset:46112
  v_mfma_f32_16x16x32_bf16 a[60:63], v[100:103], v[68:71], a[60:63]
  s_add_u32 m0, s39, 121856
  ds_read_b64_tr_b16 v[154:155], v20 offset:48672
  v_mfma_f32_16x16x32_bf16 a[100:103], v[100:103], v[72:75], a[100:103]
  buffer_load_dwordx4 v13, s[20:23], s34 offen lds
  v_mfma_f32_16x16x32_bf16 a[140:143], v[100:103], v[76:79], a[140:143]
  ds_read_b64_tr_b16 v[156:157], v20 offset:56320
  v_mfma_f32_16x16x32_bf16 a[24:27], v[104:107], v[64:67], a[24:27]
  ds_read_b64_tr_b16 v[158:159], v20 offset:58880
  v_mfma_f32_16x16x32_bf16 a[64:67], v[104:107], v[68:71], a[64:67]
  v_mfma_f32_16x16x32_bf16 a[104:107], v[104:107], v[72:75], a[104:107]
  s_add_u32 m0, s39, 122880
  ds_read_b64_tr_b16 v[160:161], v20 offset:56328
  v_mfma_f32_16x16x32_bf16 a[144:147], v[104:107], v[76:79], a[144:147]
  s_waitcnt lgkmcnt(7)
  buffer_load_dwordx4 v14, s[20:23], s34 offen lds
  v_mfma_f32_16x16x32_bf16 a[28:31], v[108:111], v[64:67], a[28:31]
  ds_read_b64_tr_b16 v[162:163], v20 offset:58888
  v_mfma_f32_16x16x32_bf16 a[68:71], v[108:111], v[68:71], a[68:71]
  ds_read_b64_tr_b16 v[164:165], v20 offset:56336
  v_mfma_f32_16x16x32_bf16 a[108:111], v[108:111], v[72:75], a[108:111]
  v_mfma_f32_16x16x32_bf16 a[148:151], v[108:111], v[76:79], a[148:151]
  ds_read_b64_tr_b16 v[166:167], v20 offset:58896
  v_mfma_f32_16x16x32_bf16 a[32:35], v[112:115], v[64:67], a[32:35]
  ds_read_b64_tr_b16 v[168:169], v20 offset:56344
  v_mfma_f32_16x16x32_bf16 a[72:75], v[112:115], v[68:71], a[72:75]
  v_mfma_f32_16x16x32_bf16 a[112:115], v[112:115], v[72:75], a[112:115]
  ds_read_b64_tr_b16 v[170:171], v20 offset:58904
  v_mfma_f32_16x16x32_bf16 a[152:155], v[112:115], v[76:79], a[152:155]
  v_mfma_f32_16x16x32_bf16 a[36:39], v[116:119], v[64:67], a[36:39]
  ds_read_b64_tr_b16 v[172:173], v20 offset:56352
  v_mfma_f32_16x16x32_bf16 a[76:79], v[116:119], v[68:71], a[76:79]
  ds_read_b64_tr_b16 v[174:175], v20 offset:58912
  v_mfma_f32_16x16x32_bf16 a[116:119], v[116:119], v[72:75], a[116:119]
  v_mfma_f32_16x16x32_bf16 a[156:159], v[116:119], v[76:79], a[156:159]
  v_mfma_f32_16x16x32_bf16 a[160:163], v[192:195], v[64:67], a[160:163]
  v_mfma_f32_16x16x32_bf16 a[176:179], v[64:67], v[192:195], a[176:179]
  v_mfma_f32_16x16x32_bf16 a[164:167], v[192:195], v[68:71], a[164:167]
  v_mfma_f32_16x16x32_bf16 a[180:183], v[68:71], v[192:195], a[180:183]
  v_mfma_f32_16x16x32_bf16 a[168:171], v[192:195], v[72:75], a[168:171]
  v_mfma_f32_16x16x32_bf16 a[184:187], v[72:75], v[192:195], a[184:187]
  v_mfma_f32_16x16x32_bf16 a[172:175], v[192:195], v[76:79], a[172:175]
  v_mfma_f32_16x16x32_bf16 a[188:191], v[76:79], v[192:195], a[188:191]
  v_mfma_f32_16x16x32_bf16 a[0:3], v[136:139], v[120:123], a[0:3]
  v_mfma_f32_16x16x32_bf16 a[40:43], v[136:139], v[124:127], a[40:43]
  v_mfma_f32_16x16x32_bf16 a[80:83], v[136:139], v[128:131], a[80:83]
  v_mfma_f32_16x16x32_bf16 a[120:123], v[136:139], v[132:135], a[120:123]
  s_waitcnt vmcnt(13) lgkmcnt(0)
  s_barrier
  v_mfma_f32_16x16x32_bf16 a[4:7], v[140:143], v[120:123], a[4:7]
  ds_read_b64_tr_b16 v[80:81], v20 offset:0
  v_mfma_f32_16x16x32_bf16 a[44:47], v[140:143], v[124:127], a[44:47]
  s_add_u32 m0, s36, 65536
  s_mov_b32 s32, 640
  v_mfma_f32_16x16x32_bf16 a[84:87], v[140:143], v[128:131], a[84:87]
  ds_read_b64_tr_b16 v[82:83], v20 offset:2560
  v_mfma_f32_16x16x32_bf16 a[124:127], v[140:143], v[132:135], a[124:127]
  buffer_load_dwordx4 v8, s[16:19], s32 offen offset:0 lds
  v_mfma_f32_16x16x32_bf16 a[8:11], v[144:147], v[120:123], a[8:11]
  ds_read_b128 v[64:67], v16 offset:0
  v_mfma_f32_16x16x32_bf16 a[48:51], v[144:147], v[124:127], a[48:51]
  ds_read_b128 v[68:71], v16 offset:2048
  v_mfma_f32_16x16x32_bf16 a[88:91], v[144:147], v[128:131], a[88:91]
  buffer_load_dwordx4 v9, s[16:19], s32 offen offset:1024 lds
  v_mfma_f32_16x16x32_bf16 a[128:131], v[144:147], v[132:135], a[128:131]
  ds_read_b128 v[72:75], v16 offset:4096
  v_mfma_f32_16x16x32_bf16 a[12:15], v[148:151], v[120:123], a[12:15]
  ds_read_b128 v[76:79], v16 offset:6144
  v_mfma_f32_16x16x32_bf16 a[52:55], v[148:151], v[124:127], a[52:55]
  v_mfma_f32_16x16x32_bf16 a[92:95], v[148:151], v[128:131], a[92:95]
  ds_read_b64_tr_b16 v[84:85], v20 offset:8
  v_mfma_f32_16x16x32_bf16 a[132:135], v[148:151], v[132:135], a[132:135]
  s_mov_b32 s32, 19072
  buffer_load_dwordx4 v8, s[16:19], s32 offen offset:2048 lds
  v_mfma_f32_16x16x32_bf16 a[16:19], v[152:155], v[120:123], a[16:19]
  ds_read_b64_tr_b16 v[86:87], v20 offset:2568
  v_mfma_f32_16x16x32_bf16 a[56:59], v[152:155], v[124:127], a[56:59]
  ds_read_b64_tr_b16 v[88:89], v20 offset:16
  v_mfma_f32_16x16x32_bf16 a[96:99], v[152:155], v[128:131], a[96:99]
  v_mfma_f32_16x16x32_bf16 a[136:139], v[152:155], v[132:135], a[136:139]
  ds_read_b64_tr_b16 v[90:91], v20 offset:2576
  v_mfma_f32_16x16x32_bf16 a[20:23], v[156:159], v[120:123], a[20:23]
  ds_read_b64_tr_b16 v[92:93], v20 offset:24
  v_mfma_f32_16x16x32_bf16 a[60:63], v[156:159], v[124:127], a[60:63]
  buffer_load_dwordx4 v9, s[16:19], s32 offen offset:3072 lds
  v_mfma_f32_16x16x32_bf16 a[100:103], v[156:159], v[128:131], a[100:103]
  ds_read_b64_tr_b16 v[94:95], v20 offset:2584
  v_mfma_f32_16x16x32_bf16 a[140:143], v[156:159], v[132:135], a[140:143]
  v_mfma_f32_16x16x32_bf16 a[24:27], v[160:163], v[120:123], a[24:27]
  ds_read_b64_tr_b16 v[96:97], v20 offset:32
  v_mfma_f32_16x16x32_bf16 a[64:67], v[160:163], v[124:127], a[64:67]
  s_add_u32 m0, s36, 69632
  s_mov_b32 s32, 41600
  ds_read_b64_tr_b16 v[98:99], v20 offset:2592
  v_mfma_f32_16x16x32_bf16 a[104:107], v[160:163], v[128:131], a[104:107]
  buffer_load_dwordx4 v8, s[16:19], s32 offen offset:0 lds
  v_mfma_f32_16x16x32_bf16 a[144:147], v[160:163], v[132:135], a[144:147]
  ds_read_b64_tr_b16 v[100:101], v20 offset:10240
  v_mfma_f32_16x16x32_bf16 a[28:31], v[164:167], v[120:123], a[28:31]
  ds_read_b64_tr_b16 v[102:103], v20 offset:12800
  v_mfma_f32_16x16x32_bf16 a[68:71], v[164:167], v[124:127], a[68:71]
  v_mfma_f32_16x16x32_bf16 a[108:111], v[164:167], v[128:131], a[108:111]
  ds_read_b64_tr_b16 v[104:105], v20 offset:10248
  v_mfma_f32_16x16x32_bf16 a[148:151], v[164:167], v[132:135], a[148:151]
  buffer_load_dwordx4 v9, s[16:19], s32 offen offset:1024 lds
  v_mfma_f32_16x16x32_bf16 a[32:35], v[168:171], v[120:123], a[32:35]
  ds_read_b64_tr_b16 v[106:107], v20 offset:12808
  v_mfma_f32_16x16x32_bf16 a[72:75], v[168:171], v[124:127], a[72:75]
  ds_read_b64_tr_b16 v[108:109], v20 offset:10256
  v_mfma_f32_16x16x32_bf16 a[112:115], v[168:171], v[128:131], a[112:115]
  v_mfma_f32_16x16x32_bf16 a[152:155], v[168:171], v[132:135], a[152:155]
  s_mov_b32 s32, 60032
  ds_read_b64_tr_b16 v[110:111], v20 offset:12816
  v_mfma_f32_16x16x32_bf16 a[36:39], v[172:175], v[120:123], a[36:39]
  ds_read_b64_tr_b16 v[112:113], v20 offset:10264
  v_mfma_f32_16x16x32_bf16 a[76:79], v[172:175], v[124:127], a[76:79]
  buffer_load_dwordx4 v8, s[16:19], s32 offen offset:2048 lds
  v_mfma_f32_16x16x32_bf16 a[116:119], v[172:175], v[128:131], a[116:119]
  ds_read_b64_tr_b16 v[114:115], v20 offset:12824
  v_mfma_f32_16x16x32_bf16 a[156:159], v[172:175], v[132:135], a[156:159]
  v_mfma_f32_16x16x32_bf16 a[160:163], v[196:199], v[120:123], a[160:163]
  ds_read_b64_tr_b16 v[116:117], v20 offset:10272
  v_mfma_f32_16x16x32_bf16 a[176:179], v[120:123], v[196:199], a[176:179]
  ds_read_b64_tr_b16 v[118:119], v20 offset:12832
  v_mfma_f32_16x16x32_bf16 a[164:167], v[196:199], v[124:127], a[164:167]
  v_mfma_f32_16x16x32_bf16 a[180:183], v[124:127], v[196:199], a[180:183]
  v_mfma_f32_16x16x32_bf16 a[168:171], v[196:199], v[128:131], a[168:171]
  v_mfma_f32_16x16x32_bf16 a[184:187], v[128:131], v[196:199], a[184:187]
  v_mfma_f32_16x16x32_bf16 a[172:175], v[196:199], v[132:135], a[172:175]
  v_mfma_f32_16x16x32_bf16 a[188:191], v[132:135], v[196:199], a[188:191]
  s_waitcnt lgkmcnt(5)
  v_mfma_f32_16x16x32_bf16 a[0:3], v[80:83], v[64:67], a[0:3]
  ds_read_b64_tr_b16 v[136:137], v20 offset:5120
  v_mfma_f32_16x16x32_bf16 a[40:43], v[80:83], v[68:71], a[40:43]
  buffer_load_dwordx4 v9, s[16:19], s32 offen offset:3072 lds
  v_mfma_f32_16x16x32_bf16 a[80:83], v[80:83], v[72:75], a[80:83]
  ds_read_b64_tr_b16 v[138:139], v20 offset:7680
  v_mfma_f32_16x16x32_bf16 a[120:123], v[80:83], v[76:79], a[120:123]
  v_mfma_f32_16x16x32_bf16 a[4:7], v[84:87], v[64:67], a[4:7]
  ds_read_b128 v[120:123], v17 offset:0
  v_mfma_f32_16x16x32_bf16 a[44:47], v[84:87], v[68:71], a[44:47]
  ds_read_b128 v[124:127], v17 offset:2048
  v_mfma_f32_16x16x32_bf16 a[84:87], v[84:87], v[72:75], a[84:87]
  s_mov_b32 s34, 409600
  s_add_u32 m0, s39, 139264
  v_mfma_f32_16x16x32_bf16 a[124:127], v[84:87], v[76:79], a[124:127]
  ds_read_b128 v[128:131], v17 offset:4096
  v_mfma_f32_16x16x32_bf16 a[8:11], v[88:91], v[64:67], a[8:11]
  ds_read_b128 v[132:135], v17 offset:6144
  v_mfma_f32_16x16x32_bf16 a[48:51], v[88:91], v[68:71], a[48:51]
  buffer_load_dwordx4 v10, s[20:23], s34 offen lds
  v_mfma_f32_16x16x32_bf16 a[88:91], v[88:91], v[72:75], a[88:91]
  ds_read_b64_tr_b16 v[140:141], v20 offset:5128
  v_mfma_f32_16x16x32_bf16 a[128:131], v[88:91], v[76:79], a[128:131]
  s_add_u32 m0, s39, 140288
  v_mfma_f32_16x16x32_bf16 a[12:15], v[92:95], v[64:67], a[12:15]
  ds_read_b64_tr_b16 v[142:143], v20 offset:7688
  v_mfma_f32_16x16x32_bf16 a[52:55], v[92:95], v[68:71], a[52:55]
  ds_read_b64_tr_b16 v[144:145], v20 offset:5136
  v_mfma_f32_16x16x32_bf16 a[92:95], v[92:95], v[72:75], a[92:95]
  buffer_load_dwordx4 v11, s[20:23], s34 offen lds
  v_mfma_f32_16x16x32_bf16 a[132:135], v[92:95], v[76:79], a[132:135]
  ds_read_b64_tr_b16 v[146:147], v20 offset:7696
  v_mfma_f32_16x16x32_bf16 a[16:19], v[96:99], v[64:67], a[16:19]
  s_add_u32 m0, s39, 141312
  ds_read_b64_tr_b16 v[148:149], v20 offset:5144
  v_mfma_f32_16x16x32_bf16 a[56:59], v[96:99], v[68:71], a[56:59]
  buffer_load_dwordx4 v12, s[20:23], s34 offen lds
  v_mfma_f32_16x16x32_bf16 a[96:99], v[96:99], v[72:75], a[96:99]
  ds_read_b64_tr_b16 v[150:151], v20 offset:7704
  v_mfma_f32_16x16x32_bf16 a[136:139], v[96:99], v[76:79], a[136:139]
  v_mfma_f32_16x16x32_bf16 a[20:23], v[100:103], v[64:67], a[20:23]
  ds_read_b64_tr_b16 v[152:153], v20 offset:5152
  v_mfma_f32_16x16x32_bf16 a[60:63], v[100:103], v[68:71], a[60:63]
  s_add_u32 m0, s39, 142336
  ds_read_b64_tr_b16 v[154:155], v20 offset:7712
  v_mfma_f32_16x16x32_bf16 a[100:103], v[100:103], v[72:75], a[100:103]
  buffer_load_dwordx4 v13, s[20:23], s34 offen lds
  v_mfma_f32_16x16x32_bf16 a[140:143], v[100:103], v[76:79], a[140:143]
  ds_read_b64_tr_b16 v[156:157], v20 offset:15360
  v_mfma_f32_16x16x32_bf16 a[24:27], v[104:107], v[64:67], a[24:27]
  ds_read_b64_tr_b16 v[158:159], v20 offset:17920
  v_mfma_f32_16x16x32_bf16 a[64:67], v[104:107], v[68:71], a[64:67]
  v_mfma_f32_16x16x32_bf16 a[104:107], v[104:107], v[72:75], a[104:107]
  s_add_u32 m0, s39, 143360
  ds_read_b64_tr_b16 v[160:161], v20 offset:15368
  v_mfma_f32_16x16x32_bf16 a[144:147], v[104:107], v[76:79], a[144:147]
  s_waitcnt lgkmcnt(7)
  buffer_load_dwordx4 v14, s[20:23], s34 offen lds
  v_mfma_f32_16x16x32_bf16 a[28:31], v[108:111], v[64:67], a[28:31]
  ds_read_b64_tr_b16 v[162:163], v20 offset:17928
  v_mfma_f32_16x16x32_bf16 a[68:71], v[108:111], v[68:71], a[68:71]
  ds_read_b64_tr_b16 v[164:165], v20 offset:15376
  v_mfma_f32_16x16x32_bf16 a[108:111], v[108:111], v[72:75], a[108:111]
  v_mfma_f32_16x16x32_bf16 a[148:151], v[108:111], v[76:79], a[148:151]
  ds_read_b64_tr_b16 v[166:167], v20 offset:17936
  v_mfma_f32_16x16x32_bf16 a[32:35], v[112:115], v[64:67], a[32:35]
  ds_read_b64_tr_b16 v[168:169], v20 offset:15384
  v_mfma_f32_16x16x32_bf16 a[72:75], v[112:115], v[68:71], a[72:75]
  v_mfma_f32_16x16x32_bf16 a[112:115], v[112:115], v[72:75], a[112:115]
  ds_read_b64_tr_b16 v[170:171], v20 offset:17944
  v_mfma_f32_16x16x32_bf16 a[152:155], v[112:115], v[76:79], a[152:155]
  v_mfma_f32_16x16x32_bf16 a[36:39], v[116:119], v[64:67], a[36:39]
  ds_read_b64_tr_b16 v[172:173], v20 offset:15392
  v_mfma_f32_16x16x32_bf16 a[76:79], v[116:119], v[68:71], a[76:79]
  ds_read_b64_tr_b16 v[174:175], v20 offset:17952
  v_mfma_f32_16x16x32_bf16 a[116:119], v[116:119], v[72:75], a[116:119]
  v_mfma_f32_16x16x32_bf16 a[156:159], v[116:119], v[76:79], a[156:159]
  v_mfma_f32_16x16x32_bf16 a[160:163], v[200:203], v[64:67], a[160:163]
  v_mfma_f32_16x16x32_bf16 a[176:179], v[64:67], v[200:203], a[176:179]
  v_mfma_f32_16x16x32_bf16 a[164:167], v[200:203], v[68:71], a[164:167]
  v_mfma_f32_16x16x32_bf16 a[180:183], v[68:71], v[200:203], a[180:183]
  v_mfma_f32_16x16x32_bf16 a[168:171], v[200:203], v[72:75], a[168:171]
  v_mfma_f32_16x16x32_bf16 a[184:187], v[72:75], v[200:203], a[184:187]
  v_mfma_f32_16x16x32_bf16 a[172:175], v[200:203], v[76:79], a[172:175]
  v_mfma_f32_16x16x32_bf16 a[188:191], v[76:79], v[200:203], a[188:191]
  v_mfma_f32_16x16x32_bf16 a[0:3], v[136:139], v[120:123], a[0:3]
  v_mfma_f32_16x16x32_bf16 a[40:43], v[136:139], v[124:127], a[40:43]
  v_mfma_f32_16x16x32_bf16 a[80:83], v[136:139], v[128:131], a[80:83]
  v_mfma_f32_16x16x32_bf16 a[120:123], v[136:139], v[132:135], a[120:123]
  s_waitcnt vmcnt(13) lgkmcnt(0)
  s_barrier
  v_readfirstlane_b32 s100, v60
  s_nop 0
  s_cmp_eq_u32 s100, 0
  s_cbranch_scc1 L_gspin
L_gok:
  v_mfma_f32_16x16x32_bf16 a[4:7], v[140:143], v[120:123], a[4:7]
  ds_read_b64_tr_b16 v[80:81], v20 offset:20480
  v_mfma_f32_16x16x32_bf16 a[44:47], v[140:143], v[124:127], a[44:47]
  s_add_u32 m0, s36, 0
  s_mov_b32 s32, 768
  v_mfma_f32_16x16x32_bf16 a[84:87], v[140:143], v[128:131], a[84:87]
  ds_read_b64_tr_b16 v[82:83], v20 offset:23040
  v_mfma_f32_16x16x32_bf16 a[124:127], v[140:143], v[132:135], a[124:127]
  buffer_load_dwordx4 v8, s[16:19], s32 offen offset:0 lds
  v_mfma_f32_16x16x32_bf16 a[8:11], v[144:147], v[120:123], a[8:11]
  ds_read_b128 v[64:67], v16 offset:32768
  v_mfma_f32_16x16x32_bf16 a[48:51], v[144:147], v[124:127], a[48:51]
  ds_read_b128 v[68:71], v16 offset:34816
  v_mfma_f32_16x16x32_bf16 a[88:91], v[144:147], v[128:131], a[88:91]
  buffer_load_dwordx4 v9, s[16:19], s32 offen offset:1024 lds
  v_mfma_f32_16x16x32_bf16 a[128:131], v[144:147], v[132:135], a[128:131]
  ds_read_b128 v[72:75], v16 offset:36864
  v_mfma_f32_16x16x32_bf16 a[12:15], v[148:151], v[120:123], a[12:15]
  ds_read_b128 v[76:79], v16 offset:38912
  v_mfma_f32_16x16x32_bf16 a[52:55], v[148:151], v[124:127], a[52:55]
  v_mfma_f32_16x16x32_bf16 a[92:95], v[148:151], v[128:131], a[92:95]
  ds_read_b64_tr_b16 v[84:85], v20 offset:20488
  v_mfma_f32_16x16x32_bf16 a[132:135], v[148:151], v[132:135], a[132:135]
  s_mov_b32 s32, 19200
  buffer_load_dwordx4 v8, s[16:19], s32 offen offset:2048 lds
  v_mfma_f32_16x16x32_bf16 a[16:19], v[152:155], v[120:123], a[16:19]
  ds_read_b64_tr_b16 v[86:87], v20 offset:23048
  v_mfma_f32_16x16x32_bf16 a[56:59], v[152:155], v[124:127], a[56:59]
  ds_read_b64_tr_b16 v[88:89], v20 offset:20496
  v_mfma_f32_16x16x32_bf16 a[96:99], v[152:155], v[128:131], a[96:99]
  v_mfma_f32_16x16x32_bf16 a[136:139], v[152:155], v[132:135], a[136:139]
  ds_read_b64_tr_b16 v[90:91], v20 offset:23056
  v_mfma_f32_16x16x32_bf16 a[20:23], v[156:159], v[120:123], a[20:23]
  ds_read_b64_tr_b16 v[92:93], v20 offset:20504
  v_mfma_f32_16x16x32_bf16 a[60:63], v[156:159], v[124:127], a[60:63]
  buffer_load_dwordx4 v9, s[16:19], s32 offen offset:3072 lds
  v_mfma_f32_16x16x32_bf16 a[100:103], v[156:159], v[128:131], a[100:103]
  ds_read_b64_tr_b16 v[94:95], v20 offset:23064
  v_mfma_f32_16x16x32_bf16 a[140:143], v[156:159], v[132:135], a[140:143]
  v_mfma_f32_16x16x32_bf16 a[24:27], v[160:163], v[120:123], a[24:27]
  ds_read_b64_tr_b16 v[96:97], v20 offset:20512
  v_mfma_f32_16x16x32_bf16 a[64:67], v[160:163], v[124:127], a[64:67]
  s_add_u32 m0, s36, 4096
  s_mov_b32 s32, 41728
  ds_read_b64_tr_b16 v[98:99], v20 offset:23072
  v_mfma_f32_16x16x32_bf16 a[104:107], v[160:163], v[128:131], a[104:107]
  buffer_load_dwordx4 v8, s[16:19], s32 offen offset:0 lds
  v_mfma_f32_16x16x32_bf16 a[144:147], v[160:163], v[132:135], a[144:147]
  ds_read_b64_tr_b16 v[100:101], v20 offset:30720
  v_mfma_f32_16x16x32_bf16 a[28:31], v[164:167], v[120:123], a[28:31]
  ds_read_b64_tr_b16 v[102:103], v20 offset:33280
  v_mfma_f32_16x16x32_bf16 a[68:71], v[164:167], v[124:127], a[68:71]
  v_mfma_f32_16x16x32_bf16 a[108:111], v[164:167], v[128:131], a[108:111]
  ds_read_b64_tr_b16 v[104:105], v20 offset:30728
  v_mfma_f32_16x16x32_bf16 a[148:151], v[164:167], v[132:135], a[148:151]
  buffer_load_dwordx4 v9, s[16:19], s32 offen offset:1024 lds
  v_mfma_f32_16x16x32_bf16 a[32:35], v[168:171], v[120:123], a[32:35]
  ds_read_b64_tr_b16 v[106:107], v20 offset:33288
  v_mfma_f32_16x16x32_bf16 a[72:75], v[168:171], v[124:127], a[72:75]
  ds_read_b64_tr_b16 v[108:109], v20 offset:30736
  v_mfma_f32_16x16x32_bf16 a[112:115], v[168:171], v[128:131], a[112:115]
  v_mfma_f32_16x16x32_bf16 a[152:155], v[168:171], v[132:135], a[152:155]
  s_mov_b32 s32, 60160
  ds_read_b64_tr_b16 v[110:111], v20 offset:33296
  v_mfma_f32_16x16x32_bf16 a[36:39], v[172:175], v[120:123], a[36:39]
  ds_read_b64_tr_b16 v[112:113], v20 offset:30744
  v_mfma_f32_16x16x32_bf16 a[76:79], v[172:175], v[124:127], a[76:79]
  buffer_load_dwordx4 v8, s[16:19], s32 offen offset:2048 lds
  v_mfma_f32_16x16x32_bf16 a[116:119], v[172:175], v[128:131], a[116:119]
  ds_read_b64_tr_b16 v[114:115], v20 offset:33304
  v_mfma_f32_16x16x32_bf16 a[156:159], v[172:175], v[132:135], a[156:159]
  v_mfma_f32_16x16x32_bf16 a[160:163], v[204:207], v[120:123], a[160:163]
  ds_read_b64_tr_b16 v[116:117], v20 offset:30752
  v_mfma_f32_16x16x32_bf16 a[176:179], v[120:123], v[204:207], a[176:179]
  ds_read_b64_tr_b16 v[118:119], v20 offset:33312
  v_mfma_f32_16x16x32_bf16 a[164:167], v[204:207], v[124:127], a[164:167]
  v_mfma_f32_16x16x32_bf16 a[180:183], v[124:127], v[204:207], a[180:183]
  v_mfma_f32_16x16x32_bf16 a[168:171], v[204:207], v[128:131], a[168:171]
  v_mfma_f32_16x16x32_bf16 a[184:187], v[128:131], v[204:207], a[184:187]
  v_mfma_f32_16x16x32_bf16 a[172:175], v[204:207], v[132:135], a[172:175]
  v_mfma_f32_16x16x32_bf16 a[188:191], v[132:135], v[204:207], a[188:191]
  s_waitcnt lgkmcnt(5)
  v_mfma_f32_16x16x32_bf16 a[0:3], v[80:83], v[64:67], a[0:3]
  ds_read_b64_tr_b16 v[136:137], v20 offset:25600
  v_mfma_f32_16x16x32_bf16 a[40:43], v[80:83], v[68:71], a[40:43]
  buffer_load_dwordx4 v9, s[16:19], s32 offen offset:3072 lds
  v_mfma_f32_16x16x32_bf16 a[80:83], v[80:83], v[72:75], a[80:83]
  ds_read_b64_tr_b16 v[138:139], v20 offset:28160
  v_mfma_f32_16x16x32_bf16 a[120:123], v[80:83], v[76:79], a[120:123]
  v_mfma_f32_16x16x32_bf16 a[4:7], v[84:87], v[64:67], a[4:7]
  ds_read_b128 v[120:123], v17 offset:32768
  v_mfma_f32_16x16x32_bf16 a[44:47], v[84:87], v[68:71], a[44:47]
  ds_read_b128 v[124:127], v17 offset:34816
  v_mfma_f32_16x16x32_bf16 a[84:87], v[84:87], v[72:75], a[84:87]
  s_mov_b32 s34, 491520
  s_add_u32 m0, s39, 98304
  v_mfma_f32_16x16x32_bf16 a[124:127], v[84:87], v[76:79], a[124:127]
  ds_read_b128 v[128:131], v17 offset:36864
  v_mfma_f32_16x16x32_bf16 a[8:11], v[88:91], v[64:67], a[8:11]
  ds_read_b128 v[132:135], v17 offset:38912
  v_mfma_f32_16x16x32_bf16 a[48:51], v[88:91], v[68:71], a[48:51]
  buffer_load_dwordx4 v10, s[20:23], s34 offen lds
  v_mfma_f32_16x16x32_bf16 a[88:91], v[88:91], v[72:75], a[88:91]
  ds_read_b64_tr_b16 v[140:141], v20 offset:25608
  v_mfma_f32_16x16x32_bf16 a[128:131], v[88:91], v[76:79], a[128:131]
  s_add_u32 m0, s39, 99328
  v_mfma_f32_16x16x32_bf16 a[12:15], v[92:95], v[64:67], a[12:15]
  ds_read_b64_tr_b16 v[142:143], v20 offset:28168
  v_mfma_f32_16x16x32_bf16 a[52:55], v[92:95], v[68:71], a[52:55]
  ds_read_b64_tr_b16 v[144:145], v20 offset:25616
  v_mfma_f32_16x16x32_bf16 a[92:95], v[92:95], v[72:75], a[92:95]
  buffer_load_dwordx4 v11, s[20:23], s34 offen lds
  v_mfma_f32_16x16x32_bf16 a[132:135], v[92:95], v[76:79], a[132:135]
  ds_read_b64_tr_b16 v[146:147], v20 offset:28176
  v_mfma_f32_16x16x32_bf16 a[16:19], v[96:99], v[64:67], a[16:19]
  s_add_u32 m0, s39, 100352
  ds_read_b64_tr_b16 v[148:149], v20 offset:25624
  v_mfma_f32_16x16x32_bf16 a[56:59], v[96:99], v[68:71], a[56:59]
  buffer_load_dwordx4 v12, s[20:23], s34 offen lds
  v_mfma_f32_16x16x32_bf16 a[96:99], v[96:99], v[72:75], a[96:99]
  ds_read_b64_tr_b16 v[150:151], v20 offset:28184
  v_mfma_f32_16x16x32_bf16 a[136:139], v[96:99], v[76:79], a[136:139]
  v_mfma_f32_16x16x32_bf16 a[20:23], v[100:103], v[64:67], a[20:23]
  ds_read_b64_tr_b16 v[152:153], v20 offset:25632
  v_mfma_f32_16x16x32_bf16 a[60:63], v[100:103], v[68:71], a[60:63]
  s_add_u32 m0, s39, 101376
  ds_read_b64_tr_b16 v[154:155], v20 offset:28192
  v_mfma_f32_16x16x32_bf16 a[100:103], v[100:103], v[72:75], a[100:103]
  buffer_load_dwordx4 v13, s[20:23], s34 offen lds
  v_mfma_f32_16x16x32_bf16 a[140:143], v[100:103], v[76:79], a[140:143]
  ds_read_b64_tr_b16 v[156:157], v20 offset:35840
  v_mfma_f32_16x16x32_bf16 a[24:27], v[104:107], v[64:67], a[24:27]
  ds_read_b64_tr_b16 v[158:159], v20 offset:38400
  v_mfma_f32_16x16x32_bf16 a[64:67], v[104:107], v[68:71], a[64:67]
  v_mfma_f32_16x16x32_bf16 a[104:107], v[104:107], v[72:75], a[104:107]
  s_add_u32 m0, s39, 102400
  ds_read_b64_tr_b16 v[160:161], v20 offset:35848
  v_mfma_f32_16x16x32_bf16 a[144:147], v[104:107], v[76:79], a[144:147]
  s_waitcnt lgkmcnt(7)
  buffer_load_dwordx4 v14, s[20:23], s34 offen lds
  v_mfma_f32_16x16x32_bf16 a[28:31], v[108:111], v[64:67], a[28:31]
  ds_read_b64_tr_b16 v[162:163], v20 offset:38408
  v_mfma_f32_16x16x32_bf16 a[68:71], v[108:111], v[68:71], a[68:71]
  ds_read_b64_tr_b16 v[164:165], v20 offset:35856
  v_mfma_f32_16x16x32_bf16 a[108:111], v[108:111], v[72:75], a[108:111]
  v_mfma_f32_16x16x32_bf16 a[148:151], v[108:111], v[76:79], a[148:151]
  ds_read_b64_tr_b16 v[166:167], v20 offset:38416
  v_mfma_f32_16x16x32_bf16 a[32:35], v[112:115], v[64:67], a[32:35]
  ds_read_b64_tr_b16 v[168:169], v20 offset:35864
  v_mfma_f32_16x16x32_bf16 a[72:75], v[112:115], v[68:71], a[72:75]
  v_mfma_f32_16x16x32_bf16 a[112:115], v[112:115], v[72:75], a[112:115]
  ds_read_b64_tr_b16 v[170:171], v20 offset:38424
  v_mfma_f32_16x16x32_bf16 a[152:155], v[112:115], v[76:79], a[152:155]
  v_mfma_f32_16x16x32_bf16 a[36:39], v[116:119], v[64:67], a[36:39]
  ds_read_b64_tr_b16 v[172:173], v20 offset:35872
  v_mfma_f32_16x16x32_bf16 a[76:79], v[116:119], v[68:71], a[76:79]
  ds_read_b64_tr_b16 v[174:175], v20 offset:38432
  v_mfma_f32_16x16x32_bf16 a[116:119], v[116:119], v[72:75], a[116:119]
  v_mfma_f32_16x16x32_bf16 a[156:159], v[116:119], v[76:79], a[156:159]
  v_mfma_f32_16x16x32_bf16 a[160:163], v[208:211], v[64:67], a[160:163]
  v_mfma_f32_16x16x32_bf16 a[176:179], v[64:67], v[208:211], a[176:179]
  v_mfma_f32_16x16x32_bf16 a[164:167], v[208:211], v[68:71], a[164:167]
  v_mfma_f32_16x16x32_bf16 a[180:183], v[68:71], v[208:211], a[180:183]
  v_mfma_f32_16x16x32_bf16 a[168:171], v[208:211], v[72:75], a[168:171]
  v_mfma_f32_16x16x32_bf16 a[184:187], v[72:75], v[208:211], a[184:187]
  v_mfma_f32_16x16x32_bf16 a[172:175], v[208:211], v[76:79], a[172:175]
  v_mfma_f32_16x16x32_bf16 a[188:191], v[76:79], v[208:211], a[188:191]
  v_mfma_f32_16x16x32_bf16 a[0:3], v[136:139], v[120:123], a[0:3]
  v_mfma_f32_16x16x32_bf16 a[40:43], v[136:139], v[124:127], a[40:43]
  v_mfma_f32_16x16x32_bf16 a[80:83], v[136:139], v[128:131], a[80:83]
  v_mfma_f32_16x16x32_bf16 a[120:123], v[136:139], v[132:135], a[120:123]
  s_waitcnt vmcnt(13) lgkmcnt(0)
  s_barrier
  s_lshl_b32 s33, s29, 18
  s_lshl_b32 s31, s40, 16
  s_add_u32 s33, s33, s31
  s_lshl_b32 s31, s30, 14
  s_add_u32 s33, s33, s31
  v_lshrrev_b32 v25, 2, v2
  v_lshlrev_b32 v25, 10, v25
  v_and_b32 v24, 3, v2
  v_lshl_add_u32 v25, v24, 7, v25
  s_mov_b32 s52, s58
  s_and_b32 s53, s59, 0xffff
  s_mov_b32 s54, 2097152
  s_mov_b32 s55, 0x20000
  v_mfma_f32_16x16x32_bf16 a[4:7], v[140:143], v[120:123], a[4:7]
  ds_read_b64_tr_b16 v[80:81], v20 offset:40960
  v_mfma_f32_16x16x32_bf16 a[44:47], v[140:143], v[124:127], a[44:47]
  s_add_u32 m0, s36, 32768
  s_mov_b32 s32, 896
  v_mfma_f32_16x16x32_bf16 a[84:87], v[140:143], v[128:131], a[84:87]
  ds_read_b64_tr_b16 v[82:83], v20 offset:43520
  v_mfma_f32_16x16x32_bf16 a[124:127], v[140:143], v[132:135], a[124:127]
  buffer_load_dwordx4 v8, s[16:19], s32 offen offset:0 lds
  v_mfma_f32_16x16x32_bf16 a[8:11], v[144:147], v[120:123], a[8:11]
  ds_read_b128 v[64:67], v18 offset:0
  v_mfma_f32_16x16x32_bf16 a[48:51], v[144:147], v[124:127], a[48:51]
  ds_read_b128 v[68:71], v18 offset:2048
  v_mfma_f32_16x16x32_bf16 a[88:91], v[144:147], v[128:131], a[88:91]
  buffer_load_dwordx4 v9, s[16:19], s32 offen offset:1024 lds
  v_mfma_f32_16x16x32_bf16 a[128:131], v[144:147], v[132:135], a[128:131]
  ds_read_b128 v[72:75], v18 offset:4096
  v_mfma_f32_16x16x32_bf16 a[12:15], v[148:151], v[120:123], a[12:15]
  ds_read_b128 v[76:79], v18 offset:6144
  v_mfma_f32_16x16x32_bf16 a[52:55], v[148:151], v[124:127], a[52:55]
  v_mfma_f32_16x16x32_bf16 a[92:95], v[148:151], v[128:131], a[92:95]
  ds_read_b64_tr_b16 v[84:85], v20 offset:40968
  v_mfma_f32_16x16x32_bf16 a[132:135], v[148:151], v[132:135], a[132:135]
  s_mov_b32 s32, 19328
  buffer_load_dwordx4 v8, s[16:19], s32 offen offset:2048 lds
  v_mfma_f32_16x16x32_bf16 a[16:19], v[152:155], v[120:123], a[16:19]
  ds_read_b64_tr_b16 v[86:87], v20 offset:43528
  v_mfma_f32_16x16x32_bf16 a[56:59], v[152:155], v[124:127], a[56:59]
  ds_read_b64_tr_b16 v[88:89], v20 offset:40976
  v_mfma_f32_16x16x32_bf16 a[96:99], v[152:155], v[128:131], a[96:99]
  v_mfma_f32_16x16x32_bf16 a[136:139], v[152:155], v[132:135], a[136:139]
  ds_read_b64_tr_b16 v[90:91], v20 offset:43536
  v_mfma_f32_16x16x32_bf16 a[20:23], v[156:159], v[120:123], a[20:23]
  ds_read_b64_tr_b16 v[92:93], v20 offset:40984
  v_mfma_f32_16x16x32_bf16 a[60:63], v[156:159], v[124:127], a[60:63]
  buffer_load_dwordx4 v9, s[16:19], s32 offen offset:3072 lds
  v_mfma_f32_16x16x32_bf16 a[100:103], v[156:159], v[128:131], a[100:103]
  ds_read_b64_tr_b16 v[94:95], v20 offset:43544
  v_mfma_f32_16x16x32_bf16 a[140:143], v[156:159], v[132:135], a[140:143]
  v_mfma_f32_16x16x32_bf16 a[24:27], v[160:163], v[120:123], a[24:27]
  ds_read_b64_tr_b16 v[96:97], v20 offset:40992
  v_mfma_f32_16x16x32_bf16 a[64:67], v[160:163], v[124:127], a[64:67]
  s_add_u32 m0, s36, 36864
  s_mov_b32 s32, 41856
  ds_read_b64_tr_b16 v[98:99], v20 offset:43552
  v_mfma_f32_16x16x32_bf16 a[104:107], v[160:163], v[128:131], a[104:107]
  buffer_load_dwordx4 v8, s[16:19], s32 offen offset:0 lds
  v_mfma_f32_16x16x32_bf16 a[144:147], v[160:163], v[132:135], a[144:147]
  ds_read_b64_tr_b16 v[100:101], v20 offset:51200
  v_mfma_f32_16x16x32_bf16 a[28:31], v[164:167], v[120:123], a[28:31]
  ds_read_b64_tr_b16 v[102:103], v20 offset:53760
  v_mfma_f32_16x16x32_bf16 a[68:71], v[164:167], v[124:127], a[68:71]
  v_mfma_f32_16x16x32_bf16 a[108:111], v[164:167], v[128:131], a[108:111]
  ds_read_b64_tr_b16 v[104:105], v20 offset:51208
  v_mfma_f32_16x16x32_bf16 a[148:151], v[164:167], v[132:135], a[148:151]
  buffer_load_dwordx4 v9, s[16:19], s32 offen offset:1024 lds
  v_mfma_f32_16x16x32_bf16 a[32:35], v[168:171], v[120:123], a[32:35]
  ds_read_b64_tr_b16 v[106:107], v20 offset:53768
  v_mfma_f32_16x16x32_bf16 a[72:75], v[168:171], v[124:127], a[72:75]
  ds_read_b64_tr_b16 v[108:109], v20 offset:51216
  v_mfma_f32_16x16x32_bf16 a[112:115], v[168:171], v[128:131], a[112:115]
  v_mfma_f32_16x16x32_bf16 a[152:155], v[168:171], v[132:135], a[152:155]
  s_mov_b32 s32, 60288
  ds_read_b64_tr_b16 v[110:111], v20 offset:53776
  v_mfma_f32_16x16x32_bf16 a[36:39], v[172:175], v[120:123], a[36:39]
  ds_read_b64_tr_b16 v[112:113], v20 offset:51224
  v_mfma_f32_16x16x32_bf16 a[76:79], v[172:175], v[124:127], a[76:79]
  buffer_load_dwordx4 v8, s[16:19], s32 offen offset:2048 lds
  v_mfma_f32_16x16x32_bf16 a[116:119], v[172:175], v[128:131], a[116:119]
  ds_read_b64_tr_b16 v[114:115], v20 offset:53784
  v_mfma_f32_16x16x32_bf16 a[156:159], v[172:175], v[132:135], a[156:159]
  v_mfma_f32_16x16x32_bf16 a[160:163], v[212:215], v[120:123], a[160:163]
  ds_read_b64_tr_b16 v[116:117], v20 offset:51232
  v_mfma_f32_16x16x32_bf16 a[176:179], v[120:123], v[212:215], a[176:179]
  ds_read_b64_tr_b16 v[118:119], v20 offset:53792
  v_mfma_f32_16x16x32_bf16 a[164:167], v[212:215], v[124:127], a[164:167]
  v_mfma_f32_16x16x32_bf16 a[180:183], v[124:127], v[212:215], a[180:183]
  v_mfma_f32_16x16x32_bf16 a[168:171], v[212:215], v[128:131], a[168:171]
  v_mfma_f32_16x16x32_bf16 a[184:187], v[128:131], v[212:215], a[184:187]
  v_mfma_f32_16x16x32_bf16 a[172:175], v[212:215], v[132:135], a[172:175]
  v_mfma_f32_16x16x32_bf16 a[188:191], v[132:135], v[212:215], a[188:191]
  s_waitcnt lgkmcnt(5)
  v_mfma_f32_16x16x32_bf16 a[0:3], v[80:83], v[64:67], a[0:3]
  ds_read_b64_tr_b16 v[136:137], v20 offset:46080
  v_mfma_f32_16x16x32_bf16 a[40:43], v[80:83], v[68:71], a[40:43]
  buffer_load_dwordx4 v9, s[16:19], s32 offen offset:3072 lds
  v_mfma_f32_16x16x32_bf16 a[80:83], v[80:83], v[72:75], a[80:83]
  ds_read_b64_tr_b16 v[138:139], v20 offset:48640
  v_mfma_f32_16x16x32_bf16 a[120:123], v[80:83], v[76:79], a[120:123]
  v_mfma_f32_16x16x32_bf16 a[4:7], v[84:87], v[64:67], a[4:7]
  ds_read_b128 v[120:123], v19 offset:0
  v_mfma_f32_16x16x32_bf16 a[44:47], v[84:87], v[68:71], a[44:47]
  ds_read_b128 v[124:127], v19 offset:2048
  v_mfma_f32_16x16x32_bf16 a[84:87], v[84:87], v[72:75], a[84:87]
  s_mov_b32 s34, 573440
  s_add_u32 m0, s39, 118784
  v_mfma_f32_16x16x32_bf16 a[124:127], v[84:87], v[76:79], a[124:127]
  ds_read_b128 v[128:131], v19 offset:4096
  v_mfma_f32_16x16x32_bf16 a[8:11], v[88:91], v[64:67], a[8:11]
  ds_read_b128 v[132:135], v19 offset:6144
  v_mfma_f32_16x16x32_bf16 a[48:51], v[88:91], v[68:71], a[48:51]
  buffer_load_dwordx4 v10, s[20:23], s34 offen lds
  v_mfma_f32_16x16x32_bf16 a[88:91], v[88:91], v[72:75], a[88:91]
  ds_read_b64_tr_b16 v[140:141], v20 offset:46088
  v_mfma_f32_16x16x32_bf16 a[128:131], v[88:91], v[76:79], a[128:131]
  s_add_u32 m0, s39, 119808
  v_mfma_f32_16x16x32_bf16 a[12:15], v[92:95], v[64:67], a[12:15]
  ds_read_b64_tr_b16 v[142:143], v20 offset:48648
  v_mfma_f32_16x16x32_bf16 a[52:55], v[92:95], v[68:71], a[52:55]
  ds_read_b64_tr_b16 v[144:145], v20 offset:46096
  v_mfma_f32_16x16x32_bf16 a[92:95], v[92:95], v[72:75], a[92:95]
  buffer_load_dwordx4 v11, s[20:23], s34 offen lds
  v_mfma_f32_16x16x32_bf16 a[132:135], v[92:95], v[76:79], a[132:135]
  ds_read_b64_tr_b16 v[146:147], v20 offset:48656
  v_mfma_f32_16x16x32_bf16 a[16:19], v[96:99], v[64:67], a[16:19]
  s_add_u32 m0, s39, 120832
  ds_read_b64_tr_b16 v[148:149], v20 offset:46104
  v_mfma_f32_16x16x32_bf16 a[56:59], v[96:99], v[68:71], a[56:59]
  buffer_load_dwordx4 v12, s[20:23], s34 offen lds
  v_mfma_f32_16x16x32_bf16 a[96:99], v[96:99], v[72:75], a[96:99]
  ds_read_b64_tr_b16 v[150:151], v20 offset:48664
  v_mfma_f32_16x16x32_bf16 a[136:139], v[96:99], v[76:79], a[136:139]
  v_mfma_f32_16x16x32_bf16 a[20:23], v[100:103], v[64:67], a[20:23]
  ds_read_b64_tr_b16 v[152:153], v20 offset:46112
  v_mfma_f32_16x16x32_bf16 a[60:63], v[100:103], v[68:71], a[60:63]
  s_add_u32 m0, s39, 121856
  ds_read_b64_tr_b16 v[154:155], v20 offset:48672
  v_mfma_f32_16x16x32_bf16 a[100:103], v[100:103], v[72:75], a[100:103]
  buffer_load_dwordx4 v13, s[20:23], s34 offen lds
  v_mfma_f32_16x16x32_bf16 a[140:143], v[100:103], v[76:79], a[140:143]
  ds_read_b64_tr_b16 v[156:157], v20 offset:56320
  v_mfma_f32_16x16x32_bf16 a[24:27], v[104:107], v[64:67], a[24:27]
  ds_read_b64_tr_b16 v[158:159], v20 offset:58880
  v_mfma_f32_16x16x32_bf16 a[64:67], v[104:107], v[68:71], a[64:67]
  v_mfma_f32_16x16x32_bf16 a[104:107], v[104:107], v[72:75], a[104:107]
  s_add_u32 m0, s39, 122880
  ds_read_b64_tr_b16 v[160:161], v20 offset:56328
  v_mfma_f32_16x16x32_bf16 a[144:147], v[104:107], v[76:79], a[144:147]
  s_waitcnt lgkmcnt(7)
  buffer_load_dwordx4 v14, s[20:23], s34 offen lds
  v_mfma_f32_16x16x32_bf16 a[28:31], v[108:111], v[64:67], a[28:31]
  ds_read_b64_tr_b16 v[162:163], v20 offset:58888
  v_mfma_f32_16x16x32_bf16 a[68:71], v[108:111], v[68:71], a[68:71]
  ds_read_b64_tr_b16 v[164:165], v20 offset:56336
  v_mfma_f32_16x16x32_bf16 a[108:111], v[108:111], v[72:75], a[108:111]
  v_mfma_f32_16x16x32_bf16 a[148:151], v[108:111], v[76:79], a[148:151]
  ds_read_b64_tr_b16 v[166:167], v20 offset:58896
  v_mfma_f32_16x16x32_bf16 a[32:35], v[112:115], v[64:67], a[32:35]
  ds_read_b64_tr_b16 v[168:169], v20 offset:56344
  v_mfma_f32_16x16x32_bf16 a[72:75], v[112:115], v[68:71], a[72:75]
  v_mfma_f32_16x16x32_bf16 a[112:115], v[112:115], v[72:75], a[112:115]
  ds_read_b64_tr_b16 v[170:171], v20 offset:58904
  v_mfma_f32_16x16x32_bf16 a[152:155], v[112:115], v[76:79], a[152:155]
  v_mfma_f32_16x16x32_bf16 a[36:39], v[116:119], v[64:67], a[36:39]
  ds_read_b64_tr_b16 v[172:173], v20 offset:56352
  v_mfma_f32_16x16x32_bf16 a[76:79], v[116:119], v[68:71], a[76:79]
  ds_read_b64_tr_b16 v[174:175], v20 offset:58912
  v_mfma_f32_16x16x32_bf16 a[116:119], v[116:119], v[72:75], a[116:119]
  v_mfma_f32_16x16x32_bf16 a[156:159], v[116:119], v[76:79], a[156:159]
  v_mfma_f32_16x16x32_bf16 a[160:163], v[216:219], v[64:67], a[160:163]
  v_mfma_f32_16x16x32_bf16 a[176:179], v[64:67], v[216:219], a[176:179]
  v_mfma_f32_16x16x32_bf16 a[164:167], v[216:219], v[68:71], a[164:167]
  v_mfma_f32_16x16x32_bf16 a[180:183], v[68:71], v[216:219], a[180:183]
  v_mfma_f32_16x16x32_bf16 a[168:171], v[216:219], v[72:75], a[168:171]
  v_mfma_f32_16x16x32_bf16 a[184:187], v[72:75], v[216:219], a[184:187]
  v_mfma_f32_16x16x32_bf16 a[172:175], v[216:219], v[76:79], a[172:175]
  v_mfma_f32_16x16x32_bf16 a[188:191], v[76:79], v[216:219], a[188:191]
  v_mfma_f32_16x16x32_bf16 a[0:3], v[136:139], v[120:123], a[0:3]
  v_mfma_f32_16x16x32_bf16 a[40:43], v[136:139], v[124:127], a[40:43]
  v_mfma_f32_16x16x32_bf16 a[80:83], v[136:139], v[128:131], a[80:83]
  v_mfma_f32_16x16x32_bf16 a[120:123], v[136:139], v[132:135], a[120:123]
  s_waitcnt vmcnt(13) lgkmcnt(0)
  s_barrier
  v_mfma_f32_16x16x32_bf16 a[4:7], v[140:143], v[120:123], a[4:7]
  ds_read_b64_tr_b16 v[80:81], v20 offset:0
  v_mfma_f32_16x16x32_bf16 a[44:47], v[140:143], v[124:127], a[44:47]
  s_add_u32 m0, s36, 65536
  s_mov_b32 s32, 1024
  v_mfma_f32_16x16x32_bf16 a[84:87], v[140:143], v[128:131], a[84:87]
  ds_read_b64_tr_b16 v[82:83], v20 offset:2560
  v_mfma_f32_16x16x32_bf16 a[124:127], v[140:143], v[132:135], a[124:127]
  buffer_load_dwordx4 v8, s[16:19], s32 offen offset:0 lds
  v_mfma_f32_16x16x32_bf16 a[8:11], v[144:147], v[120:123], a[8:11]
  ds_read_b128 v[64:67], v16 offset:0
  v_mfma_f32_16x16x32_bf16 a[48:51], v[144:147], v[124:127], a[48:51]
  ds_read_b128 v[68:71], v16 offset:2048
  v_mfma_f32_16x16x32_bf16 a[88:91], v[144:147], v[128:131], a[88:91]
  buffer_load_dwordx4 v9, s[16:19], s32 offen offset:1024 lds
  v_mfma_f32_16x16x32_bf16 a[128:131], v[144:147], v[132:135], a[128:131]
  ds_read_b128 v[72:75], v16 offset:4096
  v_mfma_f32_16x16x32_bf16 a[12:15], v[148:151], v[120:123], a[12:15]
  ds_read_b128 v[76:79], v16 offset:6144
  v_mfma_f32_16x16x32_bf16 a[52:55], v[148:151], v[124:127], a[52:55]
  v_mfma_f32_16x16x32_bf16 a[92:95], v[148:151], v[128:131], a[92:95]
  ds_read_b64_tr_b16 v[84:85], v20 offset:8
  v_mfma_f32_16x16x32_bf16 a[132:135], v[148:151], v[132:135], a[132:135]
  s_mov_b32 s32, 19456
  buffer_load_dwordx4 v8, s[16:19], s32 offen offset:2048 lds
  v_mfma_f32_16x16x32_bf16 a[16:19], v[152:155], v[120:123], a[16:19]
  ds_read_b64_tr_b16 v[86:87], v20 offset:2568
  v_mfma_f32_16x16x32_bf16 a[56:59], v[152:155], v[124:127], a[56:59]
  ds_read_b64_tr_b16 v[88:89], v20 offset:16
  v_mfma_f32_16x16x32_bf16 a[96:99], v[152:155], v[128:131], a[96:99]
  v_mfma_f32_16x16x32_bf16 a[136:139], v[152:155], v[132:135], a[136:139]
  ds_read_b64_tr_b16 v[90:91], v20 offset:2576
  v_mfma_f32_16x16x32_bf16 a[20:23], v[156:159], v[120:123], a[20:23]
  ds_read_b64_tr_b16 v[92:93], v20 offset:24
  v_mfma_f32_16x16x32_bf16 a[60:63], v[156:159], v[124:127], a[60:63]
  buffer_load_dwordx4 v9, s[16:19], s32 offen offset:3072 lds
  v_mfma_f32_16x16x32_bf16 a[100:103], v[156:159], v[128:131], a[100:103]
  ds_read_b64_tr_b16 v[94:95], v20 offset:2584
  v_mfma_f32_16x16x32_bf16 a[140:143], v[156:159], v[132:135], a[140:143]
  v_mfma_f32_16x16x32_bf16 a[24:27], v[160:163], v[120:123], a[24:27]
  ds_read_b64_tr_b16 v[96:97], v20 offset:32
  v_mfma_f32_16x16x32_bf16 a[64:67], v[160:163], v[124:127], a[64:67]
  s_add_u32 m0, s36, 69632
  s_mov_b32 s32, 41984
  ds_read_b64_tr_b16 v[98:99], v20 offset:2592
  v_mfma_f32_16x16x32_bf16 a[104:107], v[160:163], v[128:131], a[104:107]
  buffer_load_dwordx4 v8, s[16:19], s32 offen offset:0 lds
  v_mfma_f32_16x16x32_bf16 a[144:147], v[160:163], v[132:135], a[144:147]
  ds_read_b64_tr_b16 v[100:101], v20 offset:10240
  v_mfma_f32_16x16x32_bf16 a[28:31], v[164:167], v[120:123], a[28:31]
  ds_read_b64_tr_b16 v[102:103], v20 offset:12800
  v_mfma_f32_16x16x32_bf16 a[68:71], v[164:167], v[124:127], a[68:71]
  v_mfma_f32_16x16x32_bf16 a[108:111], v[164:167], v[128:131], a[108:111]
  ds_read_b64_tr_b16 v[104:105], v20 offset:10248
  v_mfma_f32_16x16x32_bf16 a[148:151], v[164:167], v[132:135], a[148:151]
  buffer_load_dwordx4 v9, s[16:19], s32 offen offset:1024 lds
  v_mfma_f32_16x16x32_bf16 a[32:35], v[168:171], v[120:123], a[32:35]
  ds_read_b64_tr_b16 v[106:107], v20 offset:12808
  v_mfma_f32_16x16x32_bf16 a[72:75], v[168:171], v[124:127], a[72:75]
  ds_read_b64_tr_b16 v[108:109], v20 offset:10256
  v_mfma_f32_16x16x32_bf16 a[112:115], v[168:171], v[128:131], a[112:115]
  v_mfma_f32_16x16x32_bf16 a[152:155], v[168:171], v[132:135], a[152:155]
  s_mov_b32 s32, 60416
  ds_read_b64_tr_b16 v[110:111], v20 offset:12816
  v_mfma_f32_16x16x32_bf16 a[36:39], v[172:175], v[120:123], a[36:39]
  ds_read_b64_tr_b16 v[112:113], v20 offset:10264
  v_mfma_f32_16x16x32_bf16 a[76:79], v[172:175], v[124:127], a[76:79]
  buffer_load_dwordx4 v8, s[16:19], s32 offen offset:2048 lds
  v_mfma_f32_16x16x32_bf16 a[116:119], v[172:175], v[128:131], a[116:119]
  ds_read_b64_tr_b16 v[114:115], v20 offset:12824
  v_mfma_f32_16x16x32_bf16 a[156:159], v[172:175], v[132:135], a[156:159]
  v_mfma_f32_16x16x32_bf16 a[160:163], v[220:223], v[120:123], a[160:163]
  ds_read_b64_tr_b16 v[116:117], v20 offset:10272
  v_mfma_f32_16x16x32_bf16 a[176:179], v[120:123], v[220:223], a[176:179]
  ds_read_b64_tr_b16 v[118:119], v20 offset:12832
  v_mfma_f32_16x16x32_bf16 a[164:167], v[220:223], v[124:127], a[164:167]
  v_mfma_f32_16x16x32_bf16 a[180:183], v[124:127], v[220:223], a[180:183]
  v_mfma_f32_16x16x32_bf16 a[168:171], v[220:223], v[128:131], a[168:171]
  v_mfma_f32_16x16x32_bf16 a[184:187], v[128:131], v[220:223], a[184:187]
  v_mfma_f32_16x16x32_bf16 a[172:175], v[220:223], v[132:135], a[172:175]
  v_mfma_f32_16x16x32_bf16 a[188:191], v[132:135], v[220:223], a[188:191]
  s_waitcnt lgkmcnt(5)
  v_mfma_f32_16x16x32_bf16 a[0:3], v[80:83], v[64:67], a[0:3]
  ds_read_b64_tr_b16 v[136:137], v20 offset:5120
  v_mfma_f32_16x16x32_bf16 a[40:43], v[80:83], v[68:71], a[40:43]
  buffer_load_dwordx4 v9, s[16:19], s32 offen offset:3072 lds
  v_mfma_f32_16x16x32_bf16 a[80:83], v[80:83], v[72:75], a[80:83]
  ds_read_b64_tr_b16 v[138:139], v20 offset:7680
  v_mfma_f32_16x16x32_bf16 a[120:123], v[80:83], v[76:79], a[120:123]
  v_mfma_f32_16x16x32_bf16 a[4:7], v[84:87], v[64:67], a[4:7]
  ds_read_b128 v[120:123], v17 offset:0
  v_mfma_f32_16x16x32_bf16 a[44:47], v[84:87], v[68:71], a[44:47]
  ds_read_b128 v[124:127], v17 offset:2048
  v_mfma_f32_16x16x32_bf16 a[84:87], v[84:87], v[72:75], a[84:87]
  s_mov_b32 s34, 655360
  s_add_u32 m0, s39, 139264
  v_mfma_f32_16x16x32_bf16 a[124:127], v[84:87], v[76:79], a[124:127]
  ds_read_b128 v[128:131], v17 offset:4096
  v_mfma_f32_16x16x32_bf16 a[8:11], v[88:91], v[64:67], a[8:11]
  ds_read_b128 v[132:135], v17 offset:6144
  v_mfma_f32_16x16x32_bf16 a[48:51], v[88:91], v[68:71], a[48:51]
  buffer_load_dwordx4 v10, s[20:23], s34 offen lds
  v_mfma_f32_16x16x32_bf16 a[88:91], v[88:91], v[72:75], a[88:91]
  ds_read_b64_tr_b16 v[140:141], v20 offset:5128
  v_mfma_f32_16x16x32_bf16 a[128:131], v[88:91], v[76:79], a[128:131]
  s_add_u32 m0, s39, 140288
  v_mfma_f32_16x16x32_bf16 a[12:15], v[92:95], v[64:67], a[12:15]
  ds_read_b64_tr_b16 v[142:143], v20 offset:7688
  v_mfma_f32_16x16x32_bf16 a[52:55], v[92:95], v[68:71], a[52:55]
  ds_read_b64_tr_b16 v[144:145], v20 offset:5136
  v_mfma_f32_16x16x32_bf16 a[92:95], v[92:95], v[72:75], a[92:95]
  buffer_load_dwordx4 v11, s[20:23], s34 offen lds
  v_mfma_f32_16x16x32_bf16 a[132:135], v[92:95], v[76:79], a[132:135]
  ds_read_b64_tr_b16 v[146:147], v20 offset:7696
  v_mfma_f32_16x16x32_bf16 a[16:19], v[96:99], v[64:67], a[16:19]
  s_add_u32 m0, s39, 141312
  ds_read_b64_tr_b16 v[148:149], v20 offset:5144
  v_mfma_f32_16x16x32_bf16 a[56:59], v[96:99], v[68:71], a[56:59]
  buffer_load_dwordx4 v12, s[20:23], s34 offen lds
  v_mfma_f32_16x16x32_bf16 a[96:99], v[96:99], v[72:75], a[96:99]
  ds_read_b64_tr_b16 v[150:151], v20 offset:7704
  v_mfma_f32_16x16x32_bf16 a[136:139], v[96:99], v[76:79], a[136:139]
  v_mfma_f32_16x16x32_bf16 a[20:23], v[100:103], v[64:67], a[20:23]
  ds_read_b64_tr_b16 v[152:153], v20 offset:5152
  v_mfma_f32_16x16x32_bf16 a[60:63], v[100:103], v[68:71], a[60:63]
  s_add_u32 m0, s39, 142336
  ds_read_b64_tr_b16 v[154:155], v20 offset:7712
  v_mfma_f32_16x16x32_bf16 a[100:103], v[100:103], v[72:75], a[100:103]
  buffer_load_dwordx4 v13, s[20:23], s34 offen lds
  v_mfma_f32_16x16x32_bf16 a[140:143], v[100:103], v[76:79], a[140:143]
  ds_read_b64_tr_b16 v[156:157], v20 offset:15360
  v_mfma_f32_16x16x32_bf16 a[24:27], v[104:107], v[64:67], a[24:27]
  ds_read_b64_tr_b16 v[158:159], v20 offset:17920
  v_mfma_f32_16x16x32_bf16 a[64:67], v[104:107], v[68:71], a[64:67]
  v_mfma_f32_16x16x32_bf16 a[104:107], v[104:107], v[72:75], a[104:107]
  s_add_u32 m0, s39, 143360
  ds_read_b64_tr_b16 v[160:161], v20 offset:15368
  v_mfma_f32_16x16x32_bf16 a[144:147], v[104:107], v[76:79], a[144:147]
  s_waitcnt lgkmcnt(7)
  buffer_load_dwordx4 v14, s[20:23], s34 offen lds
  v_mfma_f32_16x16x32_bf16 a[28:31], v[108:111], v[64:67], a[28:31]
  ds_read_b64_tr_b16 v[162:163], v20 offset:17928
  v_mfma_f32_16x16x32_bf16 a[68:71], v[108:111], v[68:71], a[68:71]
  ds_read_b64_tr_b16 v[164:165], v20 offset:15376
  v_mfma_f32_16x16x32_bf16 a[108:111], v[108:111], v[72:75], a[108:111]
  v_mfma_f32_16x16x32_bf16 a[148:151], v[108:111], v[76:79], a[148:151]
  ds_read_b64_tr_b16 v[166:167], v20 offset:17936
  v_mfma_f32_16x16x32_bf16 a[32:35], v[112:115], v[64:67], a[32:35]
  ds_read_b64_tr_b16 v[168:169], v20 offset:15384
  v_mfma_f32_16x16x32_bf16 a[72:75], v[112:115], v[68:71], a[72:75]
  v_mfma_f32_16x16x32_bf16 a[112:115], v[112:115], v[72:75], a[112:115]
  ds_read_b64_tr_b16 v[170:171], v20 offset:17944
  v_mfma_f32_16x16x32_bf16 a[152:155], v[112:115], v[76:79], a[152:155]
  v_mfma_f32_16x16x32_bf16 a[36:39], v[116:119], v[64:67], a[36:39]
  ds_read_b64_tr_b16 v[172:173], v20 offset:15392
  v_mfma_f32_16x16x32_bf16 a[76:79], v[116:119], v[68:71], a[76:79]
  ds_read_b64_tr_b16 v[174:175], v20 offset:17952
  v_mfma_f32_16x16x32_bf16 a[116:119], v[116:119], v[72:75], a[116:119]
  v_mfma_f32_16x16x32_bf16 a[156:159], v[116:119], v[76:79], a[156:159]
  v_mfma_f32_16x16x32_bf16 a[160:163], v[224:227], v[64:67], a[160:163]
  v_mfma_f32_16x16x32_bf16 a[176:179], v[64:67], v[224:227], a[176:179]
  v_mfma_f32_16x16x32_bf16 a[164:167], v[224:227], v[68:71], a[164:167]
  v_mfma_f32_16x16x32_bf16 a[180:183], v[68:71], v[224:227], a[180:183]
  v_mfma_f32_16x16x32_bf16 a[168:171], v[224:227], v[72:75], a[168:171]
  v_mfma_f32_16x16x32_bf16 a[184:187], v[72:75], v[224:227], a[184:187]
  v_mfma_f32_16x16x32_bf16 a[172:175], v[224:227], v[76:79], a[172:175]
  v_mfma_f32_16x16x32_bf16 a[188:191], v[76:79], v[224:227], a[188:191]
  v_mfma_f32_16x16x32_bf16 a[0:3], v[136:139], v[120:123], a[0:3]
  v_mfma_f32_16x16x32_bf16 a[40:43], v[136:139], v[124:127], a[40:43]
  v_mfma_f32_16x16x32_bf16 a[80:83], v[136:139], v[128:131], a[80:83]
  v_mfma_f32_16x16x32_bf16 a[120:123], v[136:139], v[132:135], a[120:123]
  s_waitcnt vmcnt(13) lgkmcnt(0)
  s_barrier
  v_mfma_f32_16x16x32_bf16 a[4:7], v[140:143], v[120:123], a[4:7]
  ds_read_b64_tr_b16 v[80:81], v20 offset:20480
  v_mfma_f32_16x16x32_bf16 a[44:47], v[140:143], v[124:127], a[44:47]
  s_add_u32 m0, s36, 0
  s_mov_b32 s32, 1152
  v_mfma_f32_16x16x32_bf16 a[84:87], v[140:143], v[128:131], a[84:87]
  ds_read_b64_tr_b16 v[82:83], v20 offset:23040
  v_mfma_f32_16x16x32_bf16 a[124:127], v[140:143], v[132:135], a[124:127]
  buffer_load_dwordx4 v8, s[16:19], s32 offen offset:0 lds
  v_mfma_f32_16x16x32_bf16 a[8:11], v[144:147], v[120:123], a[8:11]
  ds_read_b128 v[64:67], v16 offset:32768
  v_mfma_f32_16x16x32_bf16 a[48:51], v[144:147], v[124:127], a[48:51]
  ds_read_b128 v[68:71], v16 offset:34816
  v_mfma_f32_16x16x32_bf16 a[88:91], v[144:147], v[128:131], a[88:91]
  buffer_load_dwordx4 v9, s[16:19], s32 offen offset:1024 lds
  v_mfma_f32_16x16x32_bf16 a[128:131], v[144:147], v[132:135], a[128:131]
  ds_read_b128 v[72:75], v16 offset:36864
  v_mfma_f32_16x16x32_bf16 a[12:15], v[148:151], v[120:123], a[12:15]
  ds_read_b128 v[76:79], v16 offset:38912
  v_mfma_f32_16x16x32_bf16 a[52:55], v[148:151], v[124:127], a[52:55]
  v_mfma_f32_16x16x32_bf16 a[92:95], v[148:151], v[128:131], a[92:95]
  ds_read_b64_tr_b16 v[84:85], v20 offset:20488
  v_mfma_f32_16x16x32_bf16 a[132:135], v[148:151], v[132:135], a[132:135]
  s_mov_b32 s32, 19584
  buffer_load_dwordx4 v8, s[16:19], s32 offen offset:2048 lds
  v_mfma_f32_16x16x32_bf16 a[16:19], v[152:155], v[120:123], a[16:19]
  ds_read_b64_tr_b16 v[86:87], v20 offset:23048
  v_mfma_f32_16x16x32_bf16 a[56:59], v[152:155], v[124:127], a[56:59]
  ds_read_b64_tr_b16 v[88:89], v20 offset:20496
  v_mfma_f32_16x16x32_bf16 a[96:99], v[152:155], v[128:131], a[96:99]
  v_mfma_f32_16x16x32_bf16 a[136:139], v[152:155], v[132:135], a[136:139]
  ds_read_b64_tr_b16 v[90:91], v20 offset:23056
  v_mfma_f32_16x16x32_bf16 a[20:23], v[156:159], v[120:123], a[20:23]
  ds_read_b64_tr_b16 v[92:93], v20 offset:20504
  v_mfma_f32_16x16x32_bf16 a[60:63], v[156:159], v[124:127], a[60:63]
  buffer_load_dwordx4 v9, s[16:19], s32 offen offset:3072 lds
  v_mfma_f32_16x16x32_bf16 a[100:103], v[156:159], v[128:131], a[100:103]
  ds_read_b64_tr_b16 v[94:95], v20 offset:23064
  v_mfma_f32_16x16x32_bf16 a[140:143], v[156:159], v[132:135], a[140:143]
  v_mfma_f32_16x16x32_bf16 a[24:27], v[160:163], v[120:123], a[24:27]
  ds_read_b64_tr_b16 v[96:97], v20 offset:20512
  v_mfma_f32_16x16x32_bf16 a[64:67], v[160:163], v[124:127], a[64:67]
  s_add_u32 m0, s36, 4096
  s_mov_b32 s32, 42112
  ds_read_b64_tr_b16 v[98:99], v20 offset:23072
  v_mfma_f32_16x16x32_bf16 a[104:107], v[160:163], v[128:131], a[104:107]
  buffer_load_dwordx4 v8, s[16:19], s32 offen offset:0 lds
  v_mfma_f32_16x16x32_bf16 a[144:147], v[160:163], v[132:135], a[144:147]
  ds_read_b64_tr_b16 v[100:101], v20 offset:30720
  v_mfma_f32_16x16x32_bf16 a[28:31], v[164:167], v[120:123], a[28:31]
  ds_read_b64_tr_b16 v[102:103], v20 offset:33280
  v_mfma_f32_16x16x32_bf16 a[68:71], v[164:167], v[124:127], a[68:71]
  v_mfma_f32_16x16x32_bf16 a[108:111], v[164:167], v[128:131], a[108:111]
  ds_read_b64_tr_b16 v[104:105], v20 offset:30728
  v_mfma_f32_16x16x32_bf16 a[148:151], v[164:167], v[132:135], a[148:151]
  buffer_load_dwordx4 v9, s[16:19], s32 offen offset:1024 lds
  v_mfma_f32_16x16x32_bf16 a[32:35], v[168:171], v[120:123], a[32:35]
  ds_read_b64_tr_b16 v[106:107], v20 offset:33288
  v_mfma_f32_16x16x32_bf16 a[72:75], v[168:171], v[124:127], a[72:75]
  ds_read_b64_tr_b16 v[108:109], v20 offset:30736
  v_mfma_f32_16x16x32_bf16 a[112:115], v[168:171], v[128:131], a[112:115]
  v_mfma_f32_16x16x32_bf16 a[152:155], v[168:171], v[132:135], a[152:155]
  s_mov_b32 s32, 60544
  ds_read_b64_tr_b16 v[110:111], v20 offset:33296
  v_mfma_f32_16x16x32_bf16 a[36:39], v[172:175], v[120:123], a[36:39]
  ds_read_b64_tr_b16 v[112:113], v20 offset:30744
  v_mfma_f32_16x16x32_bf16 a[76:79], v[172:175], v[124:127], a[76:79]
  buffer_load_dwordx4 v8, s[16:19], s32 offen offset:2048 lds
  v_mfma_f32_16x16x32_bf16 a[116:119], v[172:175], v[128:131], a[116:119]
  ds_read_b64_tr_b16 v[114:115], v20 offset:33304
  v_mfma_f32_16x16x32_bf16 a[156:159], v[172:175], v[132:135], a[156:159]
  v_mfma_f32_16x16x32_bf16 a[160:163], v[228:231], v[120:123], a[160:163]
  ds_read_b64_tr_b16 v[116:117], v20 offset:30752
  v_mfma_f32_16x16x32_bf16 a[176:179], v[120:123], v[228:231], a[176:179]
  ds_read_b64_tr_b16 v[118:119], v20 offset:33312
  v_mfma_f32_16x16x32_bf16 a[164:167], v[228:231], v[124:127], a[164:167]
  v_mfma_f32_16x16x32_bf16 a[180:183], v[124:127], v[228:231], a[180:183]
  v_mfma_f32_16x16x32_bf16 a[168:171], v[228:231], v[128:131], a[168:171]
  v_mfma_f32_16x16x32_bf16 a[184:187], v[128:131], v[228:231], a[184:187]
  v_mfma_f32_16x16x32_bf16 a[172:175], v[228:231], v[132:135], a[172:175]
  v_mfma_f32_16x16x32_bf16 a[188:191], v[132:135], v[228:231], a[188:191]
  s_waitcnt lgkmcnt(5)
  v_mfma_f32_16x16x32_bf16 a[0:3], v[80:83], v[64:67], a[0:3]
  ds_read_b64_tr_b16 v[136:137], v20 offset:25600
  v_mfma_f32_16x16x32_bf16 a[40:43], v[80:83], v[68:71], a[40:43]
  buffer_load_dwordx4 v9, s[16:19], s32 offen offset:3072 lds
  v_mfma_f32_16x16x32_bf16 a[80:83], v[80:83], v[72:75], a[80:83]
  ds_read_b64_tr_b16 v[138:139], v20 offset:28160
  v_mfma_f32_16x16x32_bf16 a[120:123], v[80:83], v[76:79], a[120:123]
  v_mfma_f32_16x16x32_bf16 a[4:7], v[84:87], v[64:67], a[4:7]
  ds_read_b128 v[120:123], v17 offset:32768
  v_mfma_f32_16x16x32_bf16 a[44:47], v[84:87], v[68:71], a[44:47]
  ds_read_b128 v[124:127], v17 offset:34816
  v_mfma_f32_16x16x32_bf16 a[84:87], v[84:87], v[72:75], a[84:87]
  s_mov_b32 s34, 737280
  s_add_u32 m0, s39, 98304
  v_mfma_f32_16x16x32_bf16 a[124:127], v[84:87], v[76:79], a[124:127]
  ds_read_b128 v[128:131], v17 offset:36864
  v_mfma_f32_16x16x32_bf16 a[8:11], v[88:91], v[64:67], a[8:11]
  ds_read_b128 v[132:135], v17 offset:38912
  v_mfma_f32_16x16x32_bf16 a[48:51], v[88:91], v[68:71], a[48:51]
  buffer_load_dwordx4 v10, s[20:23], s34 offen lds
  v_mfma_f32_16x16x32_bf16 a[88:91], v[88:91], v[72:75], a[88:91]
  ds_read_b64_tr_b16 v[140:141], v20 offset:25608
  v_mfma_f32_16x16x32_bf16 a[128:131], v[88:91], v[76:79], a[128:131]
  s_add_u32 m0, s39, 99328
  v_mfma_f32_16x16x32_bf16 a[12:15], v[92:95], v[64:67], a[12:15]
  ds_read_b64_tr_b16 v[142:143], v20 offset:28168
  v_mfma_f32_16x16x32_bf16 a[52:55], v[92:95], v[68:71], a[52:55]
  ds_read_b64_tr_b16 v[144:145], v20 offset:25616
  v_mfma_f32_16x16x32_bf16 a[92:95], v[92:95], v[72:75], a[92:95]
  buffer_load_dwordx4 v11, s[20:23], s34 offen lds
  v_mfma_f32_16x16x32_bf16 a[132:135], v[92:95], v[76:79], a[132:135]
  ds_read_b64_tr_b16 v[146:147], v20 offset:28176
  v_mfma_f32_16x16x32_bf16 a[16:19], v[96:99], v[64:67], a[16:19]
  s_add_u32 m0, s39, 100352
  ds_read_b64_tr_b16 v[148:149], v20 offset:25624
  v_mfma_f32_16x16x32_bf16 a[56:59], v[96:99], v[68:71], a[56:59]
  buffer_load_dwordx4 v12, s[20:23], s34 offen lds
  v_mfma_f32_16x16x32_bf16 a[96:99], v[96:99], v[72:75], a[96:99]
  ds_read_b64_tr_b16 v[150:151], v20 offset:28184
  v_mfma_f32_16x16x32_bf16 a[136:139], v[96:99], v[76:79], a[136:139]
  v_mfma_f32_16x16x32_bf16 a[20:23], v[100:103], v[64:67], a[20:23]
  ds_read_b64_tr_b16 v[152:153], v20 offset:25632
  v_mfma_f32_16x16x32_bf16 a[60:63], v[100:103], v[68:71], a[60:63]
  s_add_u32 m0, s39, 101376
  ds_read_b64_tr_b16 v[154:155], v20 offset:28192
  v_mfma_f32_16x16x32_bf16 a[100:103], v[100:103], v[72:75], a[100:103]
  buffer_load_dwordx4 v13, s[20:23], s34 offen lds
  v_mfma_f32_16x16x32_bf16 a[140:143], v[100:103], v[76:79], a[140:143]
  ds_read_b64_tr_b16 v[156:157], v20 offset:35840
  v_mfma_f32_16x16x32_bf16 a[24:27], v[104:107], v[64:67], a[24:27]
  ds_read_b64_tr_b16 v[158:159], v20 offset:38400
  v_mfma_f32_16x16x32_bf16 a[64:67], v[104:107], v[68:71], a[64:67]
  v_mfma_f32_16x16x32_bf16 a[104:107], v[104:107], v[72:75], a[104:107]
  s_add_u32 m0, s39, 102400
  ds_read_b64_tr_b16 v[160:161], v20 offset:35848
  v_mfma_f32_16x16x32_bf16 a[144:147], v[104:107], v[76:79], a[144:147]
  s_waitcnt lgkmcnt(7)
  buffer_load_dwordx4 v14, s[20:23], s34 offen lds
  v_mfma_f32_16x16x32_bf16 a[28:31], v[108:111], v[64:67], a[28:31]
  ds_read_b64_tr_b16 v[162:163], v20 offset:38408
  v_mfma_f32_16x16x32_bf16 a[68:71], v[108:111], v[68:71], a[68:71]
  ds_read_b64_tr_b16 v[164:165], v20 offset:35856
  v_mfma_f32_16x16x32_bf16 a[108:111], v[108:111], v[72:75], a[108:111]
  v_mfma_f32_16x16x32_bf16 a[148:151], v[108:111], v[76:79], a[148:151]
  ds_read_b64_tr_b16 v[166:167], v20 offset:38416
  v_mfma_f32_16x16x32_bf16 a[32:35], v[112:115], v[64:67], a[32:35]
  ds_read_b64_tr_b16 v[168:169], v20 offset:35864
  v_mfma_f32_16x16x32_bf16 a[72:75], v[112:115], v[68:71], a[72:75]
  buffer_load_dword v24, v25, s[52:55], s33 offen
  v_mfma_f32_16x16x32_bf16 a[112:115], v[112:115], v[72:75], a[112:115]
  ds_read_b64_tr_b16 v[170:171], v20 offset:38424
  v_mfma_f32_16x16x32_bf16 a[152:155], v[112:115], v[76:79], a[152:155]
  v_mfma_f32_16x16x32_bf16 a[36:39], v[116:119], v[64:67], a[36:39]
  ds_read_b64_tr_b16 v[172:173], v20 offset:35872
  v_mfma_f32_16x16x32_bf16 a[76:79], v[116:119], v[68:71], a[76:79]
  ds_read_b64_tr_b16 v[174:175], v20 offset:38432
  v_mfma_f32_16x16x32_bf16 a[116:119], v[116:119], v[72:75], a[116:119]
  buffer_load_dword v26, v25, s[52:55], s33 offen offset:512
  v_mfma_f32_16x16x32_bf16 a[156:159], v[116:119], v[76:79], a[156:159]
  v_mfma_f32_16x16x32_bf16 a[160:163], v[232:235], v[64:67], a[160:163]
  v_mfma_f32_16x16x32_bf16 a[176:179], v[64:67], v[232:235], a[176:179]
  v_mfma_f32_16x16x32_bf16 a[164:167], v[232:235], v[68:71], a[164:167]
  v_mfma_f32_16x16x32_bf16 a[180:183], v[68:71], v[232:235], a[180:183]
  v_mfma_f32_16x16x32_bf16 a[168:171], v[232:235], v[72:75], a[168:171]
  v_mfma_f32_16x16x32_bf16 a[184:187], v[72:75], v[232:235], a[184:187]
  v_mfma_f32_16x16x32_bf16 a[172:175], v[232:235], v[76:79], a[172:175]
  v_mfma_f32_16x16x32_bf16 a[188:191], v[76:79], v[232:235], a[188:191]
  v_mfma_f32_16x16x32_bf16 a[0:3], v[136:139], v[120:123], a[0:3]
  v_mfma_f32_16x16x32_bf16 a[40:43], v[136:139], v[124:127], a[40:43]
  v_mfma_f32_16x16x32_bf16 a[80:83], v[136:139], v[128:131], a[80:83]
  v_mfma_f32_16x16x32_bf16 a[120:123], v[136:139], v[132:135], a[120:123]
  s_waitcnt vmcnt(15) lgkmcnt(0)
  s_barrier
  v_mfma_f32_16x16x32_bf16 a[4:7], v[140:143], v[120:123], a[4:7]
  ds_read_b64_tr_b16 v[80:81], v20 offset:40960
  v_mfma_f32_16x16x32_bf16 a[44:47], v[140:143], v[124:127], a[44:47]
  v_mfma_f32_16x16x32_bf16 a[84:87], v[140:143], v[128:131], a[84:87]
  ds_read_b64_tr_b16 v[82:83], v20 offset:43520
  v_mfma_f32_16x16x32_bf16 a[124:127], v[140:143], v[132:135], a[124:127]
  v_mfma_f32_16x16x32_bf16 a[8:11], v[144:147], v[120:123], a[8:11]
  ds_read_b128 v[64:67], v18 offset:0
  v_mfma_f32_16x16x32_bf16 a[48:51], v[144:147], v[124:127], a[48:51]
  ds_read_b128 v[68:71], v18 offset:2048
  v_mfma_f32_16x16x32_bf16 a[88:91], v[144:147], v[128:131], a[88:91]
  v_mfma_f32_16x16x32_bf16 a[128:131], v[144:147], v[132:135], a[128:131]
  ds_read_b128 v[72:75], v18 offset:4096
  v_mfma_f32_16x16x32_bf16 a[12:15], v[148:151], v[120:123], a[12:15]
  ds_read_b128 v[76:79], v18 offset:6144
  v_mfma_f32_16x16x32_bf16 a[52:55], v[148:151], v[124:127], a[52:55]
  v_mfma_f32_16x16x32_bf16 a[92:95], v[148:151], v[128:131], a[92:95]
  ds_read_b64_tr_b16 v[84:85], v20 offset:40968
  v_mfma_f32_16x16x32_bf16 a[132:135], v[148:151], v[132:135], a[132:135]
  v_mfma_f32_16x16x32_bf16 a[16:19], v[152:155], v[120:123], a[16:19]
  ds_read_b64_tr_b16 v[86:87], v20 offset:43528
  v_mfma_f32_16x16x32_bf16 a[56:59], v[152:155], v[124:127], a[56:59]
  ds_read_b64_tr_b16 v[88:89], v20 offset:40976
  v_mfma_f32_16x16x32_bf16 a[96:99], v[152:155], v[128:131], a[96:99]
  v_mfma_f32_16x16x32_bf16 a[136:139], v[152:155], v[132:135], a[136:139]
  ds_read_b64_tr_b16 v[90:91], v20 offset:43536
  v_mfma_f32_16x16x32_bf16 a[20:23], v[156:159], v[120:123], a[20:23]
  ds_read_b64_tr_b16 v[92:93], v20 offset:40984
  v_mfma_f32_16x16x32_bf16 a[60:63], v[156:159], v[124:127], a[60:63]
  v_mfma_f32_16x16x32_bf16 a[100:103], v[156:159], v[128:131], a[100:103]
  ds_read_b64_tr_b16 v[94:95], v20 offset:43544
  v_mfma_f32_16x16x32_bf16 a[140:143], v[156:159], v[132:135], a[140:143]
  v_mfma_f32_16x16x32_bf16 a[24:27], v[160:163], v[120:123], a[24:27]
  ds_read_b64_tr_b16 v[96:97], v20 offset:40992
  v_mfma_f32_16x16x32_bf16 a[64:67], v[160:163], v[124:127], a[64:67]
  ds_read_b64_tr_b16 v[98:99], v20 offset:43552
  v_mfma_f32_16x16x32_bf16 a[104:107], v[160:163], v[128:131], a[104:107]
  v_mfma_f32_16x16x32_bf16 a[144:147], v[160:163], v[132:135], a[144:147]
  ds_read_b64_tr_b16 v[100:101], v20 offset:51200
  v_mfma_f32_16x16x32_bf16 a[28:31], v[164:167], v[120:123], a[28:31]
  ds_read_b64_tr_b16 v[102:103], v20 offset:53760
  v_mfma_f32_16x16x32_bf16 a[68:71], v[164:167], v[124:127], a[68:71]
  v_mfma_f32_16x16x32_bf16 a[108:111], v[164:167], v[128:131], a[108:111]
  ds_read_b64_tr_b16 v[104:105], v20 offset:51208
  v_mfma_f32_16x16x32_bf16 a[148:151], v[164:167], v[132:135], a[148:151]
  v_mfma_f32_16x16x32_bf16 a[32:35], v[168:171], v[120:123], a[32:35]
  ds_read_b64_tr_b16 v[106:107], v20 offset:53768
  v_mfma_f32_16x16x32_bf16 a[72:75], v[168:171], v[124:127], a[72:75]
  ds_read_b64_tr_b16 v[108:109], v20 offset:51216
  v_mfma_f32_16x16x32_bf16 a[112:115], v[168:171], v[128:131], a[112:115]
  v_mfma_f32_16x16x32_bf16 a[152:155], v[168:171], v[132:135], a[152:155]
  ds_read_b64_tr_b16 v[110:111], v20 offset:53776
  v_mfma_f32_16x16x32_bf16 a[36:39], v[172:175], v[120:123], a[36:39]
  ds_read_b64_tr_b16 v[112:113], v20 offset:51224
  v_mfma_f32_16x16x32_bf16 a[76:79], v[172:175], v[124:127], a[76:79]
  v_mfma_f32_16x16x32_bf16 a[116:119], v[172:175], v[128:131], a[116:119]
  ds_read_b64_tr_b16 v[114:115], v20 offset:53784
  v_mfma_f32_16x16x32_bf16 a[156:159], v[172:175], v[132:135], a[156:159]
  v_mfma_f32_16x16x32_bf16 a[160:163], v[236:239], v[120:123], a[160:163]
  ds_read_b64_tr_b16 v[116:117], v20 offset:51232
  v_mfma_f32_16x16x32_bf16 a[176:179], v[120:123], v[236:239], a[176:179]
  ds_read_b64_tr_b16 v[118:119], v20 offset:53792
  v_mfma_f32_16x16x32_bf16 a[164:167], v[236:239], v[124:127], a[164:167]
  v_mfma_f32_16x16x32_bf16 a[180:183], v[124:127], v[236:239], a[180:183]
  v_mfma_f32_16x16x32_bf16 a[168:171], v[236:239], v[128:131], a[168:171]
  v_mfma_f32_16x16x32_bf16 a[184:187], v[128:131], v[236:239], a[184:187]
  v_mfma_f32_16x16x32_bf16 a[172:175], v[236:239], v[132:135], a[172:175]
  v_mfma_f32_16x16x32_bf16 a[188:191], v[132:135], v[236:239], a[188:191]
  s_waitcnt lgkmcnt(6)
  v_mfma_f32_16x16x32_bf16 a[0:3], v[80:83], v[64:67], a[0:3]
  ds_read_b64_tr_b16 v[136:137], v20 offset:46080
  v_mfma_f32_16x16x32_bf16 a[40:43], v[80:83], v[68:71], a[40:43]
  v_mfma_f32_16x16x32_bf16 a[80:83], v[80:83], v[72:75], a[80:83]
  ds_read_b64_tr_b16 v[138:139], v20 offset:48640
  v_mfma_f32_16x16x32_bf16 a[120:123], v[80:83], v[76:79], a[120:123]
  v_mfma_f32_16x16x32_bf16 a[4:7], v[84:87], v[64:67], a[4:7]
  ds_read_b128 v[120:123], v19 offset:0
  v_mfma_f32_16x16x32_bf16 a[44:47], v[84:87], v[68:71], a[44:47]
  ds_read_b128 v[124:127], v19 offset:2048
  v_mfma_f32_16x16x32_bf16 a[84:87], v[84:87], v[72:75], a[84:87]
  v_mfma_f32_16x16x32_bf16 a[124:127], v[84:87], v[76:79], a[124:127]
  ds_read_b128 v[128:131], v19 offset:4096
  v_mfma_f32_16x16x32_bf16 a[8:11], v[88:91], v[64:67], a[8:11]
  ds_read_b128 v[132:135], v19 offset:6144
  v_mfma_f32_16x16x32_bf16 a[48:51], v[88:91], v[68:71], a[48:51]
  v_mfma_f32_16x16x32_bf16 a[88:91], v[88:91], v[72:75], a[88:91]
  ds_read_b64_tr_b16 v[140:141], v20 offset:46088
  v_mfma_f32_16x16x32_bf16 a[128:131], v[88:91], v[76:79], a[128:131]
  v_mfma_f32_16x16x32_bf16 a[12:15], v[92:95], v[64:67], a[12:15]
  ds_read_b64_tr_b16 v[142:143], v20 offset:48648
  v_mfma_f32_16x16x32_bf16 a[52:55], v[92:95], v[68:71], a[52:55]
  ds_read_b64_tr_b16 v[144:145], v20 offset:46096
  v_mfma_f32_16x16x32_bf16 a[92:95], v[92:95], v[72:75], a[92:95]
  v_mfma_f32_16x16x32_bf16 a[132:135], v[92:95], v[76:79], a[132:135]
  ds_read_b64_tr_b16 v[146:147], v20 offset:48656
  v_mfma_f32_16x16x32_bf16 a[16:19], v[96:99], v[64:67], a[16:19]
  ds_read_b64_tr_b16 v[148:149], v20 offset:46104
  v_mfma_f32_16x16x32_bf16 a[56:59], v[96:99], v[68:71], a[56:59]
  v_mfma_f32_16x16x32_bf16 a[96:99], v[96:99], v[72:75], a[96:99]
  ds_read_b64_tr_b16 v[150:151], v20 offset:48664
  v_mfma_f32_16x16x32_bf16 a[136:139], v[96:99], v[76:79], a[136:139]
  v_mfma_f32_16x16x32_bf16 a[20:23], v[100:103], v[64:67], a[20:23]
  ds_read_b64_tr_b16 v[152:153], v20 offset:46112
  v_mfma_f32_16x16x32_bf16 a[60:63], v[100:103], v[68:71], a[60:63]
  ds_read_b64_tr_b16 v[154:155], v20 offset:48672
  v_mfma_f32_16x16x32_bf16 a[100:103], v[100:103], v[72:75], a[100:103]
  v_mfma_f32_16x16x32_bf16 a[140:143], v[100:103], v[76:79], a[140:143]
  ds_read_b64_tr_b16 v[156:157], v20 offset:56320
  v_mfma_f32_16x16x32_bf16 a[24:27], v[104:107], v[64:67], a[24:27]
  ds_read_b64_tr_b16 v[158:159], v20 offset:58880
  v_mfma_f32_16x16x32_bf16 a[64:67], v[104:107], v[68:71], a[64:67]
  v_mfma_f32_16x16x32_bf16 a[104:107], v[104:107], v[72:75], a[104:107]
  ds_read_b64_tr_b16 v[160:161], v20 offset:56328
  v_mfma_f32_16x16x32_bf16 a[144:147], v[104:107], v[76:79], a[144:147]
  s_waitcnt lgkmcnt(8)
  v_mfma_f32_16x16x32_bf16 a[28:31], v[108:111], v[64:67], a[28:31]
  ds_read_b64_tr_b16 v[162:163], v20 offset:58888
  v_mfma_f32_16x16x32_bf16 a[68:71], v[108:111], v[68:71], a[68:71]
  ds_read_b64_tr_b16 v[164:165], v20 offset:56336
  v_mfma_f32_16x16x32_bf16 a[108:111], v[108:111], v[72:75], a[108:111]
  v_mfma_f32_16x16x32_bf16 a[148:151], v[108:111], v[76:79], a[148:151]
  ds_read_b64_tr_b16 v[166:167], v20 offset:58896
  v_mfma_f32_16x16x32_bf16 a[32:35], v[112:115], v[64:67], a[32:35]
  ds_read_b64_tr_b16 v[168:169], v20 offset:56344
  v_mfma_f32_16x16x32_bf16 a[72:75], v[112:115], v[68:71], a[72:75]
  v_mfma_f32_16x16x32_bf16 a[112:115], v[112:115], v[72:75], a[112:115]
  ds_read_b64_tr_b16 v[170:171], v20 offset:58904
  v_mfma_f32_16x16x32_bf16 a[152:155], v[112:115], v[76:79], a[152:155]
  v_mfma_f32_16x16x32_bf16 a[36:39], v[116:119], v[64:67], a[36:39]
  ds_read_b64_tr_b16 v[172:173], v20 offset:56352
  v_mfma_f32_16x16x32_bf16 a[76:79], v[116:119], v[68:71], a[76:79]
  ds_read_b64_tr_b16 v[174:175], v20 offset:58912
  v_mfma_f32_16x16x32_bf16 a[116:119], v[116:119], v[72:75], a[116:119]
  v_mfma_f32_16x16x32_bf16 a[156:159], v[116:119], v[76:79], a[156:159]
  v_mfma_f32_16x16x32_bf16 a[160:163], v[240:243], v[64:67], a[160:163]
  v_mfma_f32_16x16x32_bf16 a[176:179], v[64:67], v[240:243], a[176:179]
  v_mfma_f32_16x16x32_bf16 a[164:167], v[240:243], v[68:71], a[164:167]
  v_mfma_f32_16x16x32_bf16 a[180:183], v[68:71], v[240:243], a[180:183]
  v_mfma_f32_16x16x32_bf16 a[168:171], v[240:243], v[72:75], a[168:171]
  v_mfma_f32_16x16x32_bf16 a[184:187], v[72:75], v[240:243], a[184:187]
  v_mfma_f32_16x16x32_bf16 a[172:175], v[240:243], v[76:79], a[172:175]
  v_mfma_f32_16x16x32_bf16 a[188:191], v[76:79], v[240:243], a[188:191]
  v_mfma_f32_16x16x32_bf16 a[0:3], v[136:139], v[120:123], a[0:3]
  v_mfma_f32_16x16x32_bf16 a[40:43], v[136:139], v[124:127], a[40:43]
  v_mfma_f32_16x16x32_bf16 a[80:83], v[136:139], v[128:131], a[80:83]
  v_mfma_f32_16x16x32_bf16 a[120:123], v[136:139], v[132:135], a[120:123]
  s_waitcnt vmcnt(2) lgkmcnt(0)
  s_barrier
  v_mfma_f32_16x16x32_bf16 a[4:7], v[140:143], v[120:123], a[4:7]
  ds_read_b64_tr_b16 v[80:81], v20 offset:0
  v_mfma_f32_16x16x32_bf16 a[44:47], v[140:143], v[124:127], a[44:47]
  v_mfma_f32_16x16x32_bf16 a[84:87], v[140:143], v[128:131], a[84:87]
  ds_read_b64_tr_b16 v[82:83], v20 offset:2560
  v_mfma_f32_16x16x32_bf16 a[124:127], v[140:143], v[132:135], a[124:127]
  v_mfma_f32_16x16x32_bf16 a[8:11], v[144:147], v[120:123], a[8:11]
  ds_read_b128 v[64:67], v16 offset:0
  v_mfma_f32_16x16x32_bf16 a[48:51], v[144:147], v[124:127], a[48:51]
  ds_read_b128 v[68:71], v16 offset:2048
  v_mfma_f32_16x16x32_bf16 a[88:91], v[144:147], v[128:131], a[88:91]
  v_mfma_f32_16x16x32_bf16 a[128:131], v[144:147], v[132:135], a[128:131]
  ds_read_b128 v[72:75], v16 offset:4096
  v_mfma_f32_16x16x32_bf16 a[12:15], v[148:151], v[120:123], a[12:15]
  ds_read_b128 v[76:79], v16 offset:6144
  v_mfma_f32_16x16x32_bf16 a[52:55], v[148:151], v[124:127], a[52:55]
  v_mfma_f32_16x16x32_bf16 a[92:95], v[148:151], v[128:131], a[92:95]
  ds_read_b64_tr_b16 v[84:85], v20 offset:8
  v_mfma_f32_16x16x32_bf16 a[132:135], v[148:151], v[132:135], a[132:135]
  v_mfma_f32_16x16x32_bf16 a[16:19], v[152:155], v[120:123], a[16:19]
  ds_read_b64_tr_b16 v[86:87], v20 offset:2568
  v_mfma_f32_16x16x32_bf16 a[56:59], v[152:155], v[124:127], a[56:59]
  ds_read_b64_tr_b16 v[88:89], v20 offset:16
  v_mfma_f32_16x16x32_bf16 a[96:99], v[152:155], v[128:131], a[96:99]
  v_mfma_f32_16x16x32_bf16 a[136:139], v[152:155], v[132:135], a[136:139]
  ds_read_b64_tr_b16 v[90:91], v20 offset:2576
  v_mfma_f32_16x16x32_bf16 a[20:23], v[156:159], v[120:123], a[20:23]
  ds_read_b64_tr_b16 v[92:93], v20 offset:24
  v_mfma_f32_16x16x32_bf16 a[60:63], v[156:159], v[124:127], a[60:63]
  v_mfma_f32_16x16x32_bf16 a[100:103], v[156:159], v[128:131], a[100:103]
  ds_read_b64_tr_b16 v[94:95], v20 offset:2584
  v_mfma_f32_16x16x32_bf16 a[140:143], v[156:159], v[132:135], a[140:143]
  v_mfma_f32_16x16x32_bf16 a[24:27], v[160:163], v[120:123], a[24:27]
  ds_read_b64_tr_b16 v[96:97], v20 offset:32
  v_mfma_f32_16x16x32_bf16 a[64:67], v[160:163], v[124:127], a[64:67]
  ds_read_b64_tr_b16 v[98:99], v20 offset:2592
  v_mfma_f32_16x16x32_bf16 a[104:107], v[160:163], v[128:131], a[104:107]
  v_mfma_f32_16x16x32_bf16 a[144:147], v[160:163], v[132:135], a[144:147]
  ds_read_b64_tr_b16 v[100:101], v20 offset:10240
  v_mfma_f32_16x16x32_bf16 a[28:31], v[164:167], v[120:123], a[28:31]
  ds_read_b64_tr_b16 v[102:103], v20 offset:12800
  v_mfma_f32_16x16x32_bf16 a[68:71], v[164:167], v[124:127], a[68:71]
  v_mfma_f32_16x16x32_bf16 a[108:111], v[164:167], v[128:131], a[108:111]
  ds_read_b64_tr_b16 v[104:105], v20 offset:10248
  v_mfma_f32_16x16x32_bf16 a[148:151], v[164:167], v[132:135], a[148:151]
  v_mfma_f32_16x16x32_bf16 a[32:35], v[168:171], v[120:123], a[32:35]
  ds_read_b64_tr_b16 v[106:107], v20 offset:12808
  v_mfma_f32_16x16x32_bf16 a[72:75], v[168:171], v[124:127], a[72:75]
  ds_read_b64_tr_b16 v[108:109], v20 offset:10256
  v_mfma_f32_16x16x32_bf16 a[112:115], v[168:171], v[128:131], a[112:115]
  v_mfma_f32_16x16x32_bf16 a[152:155], v[168:171], v[132:135], a[152:155]
  ds_read_b64_tr_b16 v[110:111], v20 offset:12816
  v_mfma_f32_16x16x32_bf16 a[36:39], v[172:175], v[120:123], a[36:39]
  ds_read_b64_tr_b16 v[112:113], v20 offset:10264
  v_mfma_f32_16x16x32_bf16 a[76:79], v[172:175], v[124:127], a[76:79]
  v_mfma_f32_16x16x32_bf16 a[116:119], v[172:175], v[128:131], a[116:119]
  ds_read_b64_tr_b16 v[114:115], v20 offset:12824
  v_mfma_f32_16x16x32_bf16 a[156:159], v[172:175], v[132:135], a[156:159]
  v_mfma_f32_16x16x32_bf16 a[160:163], v[244:247], v[120:123], a[160:163]
  ds_read_b64_tr_b16 v[116:117], v20 offset:10272
  v_mfma_f32_16x16x32_bf16 a[176:179], v[120:123], v[244:247], a[176:179]
  ds_read_b64_tr_b16 v[118:119], v20 offset:12832
  v_mfma_f32_16x16x32_bf16 a[164:167], v[244:247], v[124:127], a[164:167]
  v_mfma_f32_16x16x32_bf16 a[180:183], v[124:127], v[244:247], a[180:183]
  v_mfma_f32_16x16x32_bf16 a[168:171], v[244:247], v[128:131], a[168:171]
  v_mfma_f32_16x16x32_bf16 a[184:187], v[128:131], v[244:247], a[184:187]
  v_mfma_f32_16x16x32_bf16 a[172:175], v[244:247], v[132:135], a[172:175]
  v_mfma_f32_16x16x32_bf16 a[188:191], v[132:135], v[244:247], a[188:191]
  s_waitcnt lgkmcnt(6)
  v_mfma_f32_16x16x32_bf16 a[0:3], v[80:83], v[64:67], a[0:3]
  ds_read_b64_tr_b16 v[136:137], v20 offset:5120
  v_mfma_f32_16x16x32_bf16 a[40:43], v[80:83], v[68:71], a[40:43]
  v_mfma_f32_16x16x32_bf16 a[80:83], v[80:83], v[72:75], a[80:83]
  ds_read_b64_tr_b16 v[138:139], v20 offset:7680
  v_mfma_f32_16x16x32_bf16 a[120:123], v[80:83], v[76:79], a[120:123]
  v_mfma_f32_16x16x32_bf16 a[4:7], v[84:87], v[64:67], a[4:7]
  ds_read_b128 v[120:123], v17 offset:0
  v_mfma_f32_16x16x32_bf16 a[44:47], v[84:87], v[68:71], a[44:47]
  ds_read_b128 v[124:127], v17 offset:2048
  v_mfma_f32_16x16x32_bf16 a[84:87], v[84:87], v[72:75], a[84:87]
  v_mfma_f32_16x16x32_bf16 a[124:127], v[84:87], v[76:79], a[124:127]
  ds_read_b128 v[128:131], v17 offset:4096
  v_mfma_f32_16x16x32_bf16 a[8:11], v[88:91], v[64:67], a[8:11]
  ds_read_b128 v[132:135], v17 offset:6144
  v_mfma_f32_16x16x32_bf16 a[48:51], v[88:91], v[68:71], a[48:51]
  v_mfma_f32_16x16x32_bf16 a[88:91], v[88:91], v[72:75], a[88:91]
  ds_read_b64_tr_b16 v[140:141], v20 offset:5128
  v_mfma_f32_16x16x32_bf16 a[128:131], v[88:91], v[76:79], a[128:131]
  v_mfma_f32_16x16x32_bf16 a[12:15], v[92:95], v[64:67], a[12:15]
  ds_read_b64_tr_b16 v[142:143], v20 offset:7688
  v_mfma_f32_16x16x32_bf16 a[52:55], v[92:95], v[68:71], a[52:55]
  ds_read_b64_tr_b16 v[144:145], v20 offset:5136
  v_mfma_f32_16x16x32_bf16 a[92:95], v[92:95], v[72:75], a[92:95]
  v_mfma_f32_16x16x32_bf16 a[132:135], v[92:95], v[76:79], a[132:135]
  ds_read_b64_tr_b16 v[146:147], v20 offset:7696
  v_mfma_f32_16x16x32_bf16 a[16:19], v[96:99], v[64:67], a[16:19]
  ds_read_b64_tr_b16 v[148:149], v20 offset:5144
  v_mfma_f32_16x16x32_bf16 a[56:59], v[96:99], v[68:71], a[56:59]
  v_mfma_f32_16x16x32_bf16 a[96:99], v[96:99], v[72:75], a[96:99]
  ds_read_b64_tr_b16 v[150:151], v20 offset:7704
  v_mfma_f32_16x16x32_bf16 a[136:139], v[96:99], v[76:79], a[136:139]
  v_mfma_f32_16x16x32_bf16 a[20:23], v[100:103], v[64:67], a[20:23]
  ds_read_b64_tr_b16 v[152:153], v20 offset:5152
  v_mfma_f32_16x16x32_bf16 a[60:63], v[100:103], v[68:71], a[60:63]
  ds_read_b64_tr_b16 v[154:155], v20 offset:7712
  v_mfma_f32_16x16x32_bf16 a[100:103], v[100:103], v[72:75], a[100:103]
  v_mfma_f32_16x16x32_bf16 a[140:143], v[100:103], v[76:79], a[140:143]
  ds_read_b64_tr_b16 v[156:157], v20 offset:15360
  v_mfma_f32_16x16x32_bf16 a[24:27], v[104:107], v[64:67], a[24:27]
  ds_read_b64_tr_b16 v[158:159], v20 offset:17920
  v_mfma_f32_16x16x32_bf16 a[64:67], v[104:107], v[68:71], a[64:67]
  v_mfma_f32_16x16x32_bf16 a[104:107], v[104:107], v[72:75], a[104:107]
  ds_read_b64_tr_b16 v[160:161], v20 offset:15368
  v_mfma_f32_16x16x32_bf16 a[144:147], v[104:107], v[76:79], a[144:147]
  s_waitcnt lgkmcnt(8)
  v_mfma_f32_16x16x32_bf16 a[28:31], v[108:111], v[64:67], a[28:31]
  ds_read_b64_tr_b16 v[162:163], v20 offset:17928
  v_mfma_f32_16x16x32_bf16 a[68:71], v[108:111], v[68:71], a[68:71]
  ds_read_b64_tr_b16 v[164:165], v20 offset:15376
  v_mfma_f32_16x16x32_bf16 a[108:111], v[108:111], v[72:75], a[108:111]
  v_mfma_f32_16x16x32_bf16 a[148:151], v[108:111], v[76:79], a[148:151]
  ds_read_b64_tr_b16 v[166:167], v20 offset:17936
  v_mfma_f32_16x16x32_bf16 a[32:35], v[112:115], v[64:67], a[32:35]
  ds_read_b64_tr_b16 v[168:169], v20 offset:15384
  v_mfma_f32_16x16x32_bf16 a[72:75], v[112:115], v[68:71], a[72:75]
  v_mfma_f32_16x16x32_bf16 a[112:115], v[112:115], v[72:75], a[112:115]
  ds_read_b64_tr_b16 v[170:171], v20 offset:17944
  v_mfma_f32_16x16x32_bf16 a[152:155], v[112:115], v[76:79], a[152:155]
  v_mfma_f32_16x16x32_bf16 a[36:39], v[116:119], v[64:67], a[36:39]
  ds_read_b64_tr_b16 v[172:173], v20 offset:15392
  v_mfma_f32_16x16x32_bf16 a[76:79], v[116:119], v[68:71], a[76:79]
  ds_read_b64_tr_b16 v[174:175], v20 offset:17952
  v_mfma_f32_16x16x32_bf16 a[116:119], v[116:119], v[72:75], a[116:119]
  v_mfma_f32_16x16x32_bf16 a[156:159], v[116:119], v[76:79], a[156:159]
  v_mfma_f32_16x16x32_bf16 a[160:163], v[248:251], v[64:67], a[160:163]
  v_mfma_f32_16x16x32_bf16 a[176:179], v[64:67], v[248:251], a[176:179]
  v_mfma_f32_16x16x32_bf16 a[164:167], v[248:251], v[68:71], a[164:167]
  v_mfma_f32_16x16x32_bf16 a[180:183], v[68:71], v[248:251], a[180:183]
  v_mfma_f32_16x16x32_bf16 a[168:171], v[248:251], v[72:75], a[168:171]
  v_mfma_f32_16x16x32_bf16 a[184:187], v[72:75], v[248:251], a[184:187]
  v_mfma_f32_16x16x32_bf16 a[172:175], v[248:251], v[76:79], a[172:175]
  v_mfma_f32_16x16x32_bf16 a[188:191], v[76:79], v[248:251], a[188:191]
  v_mfma_f32_16x16x32_bf16 a[0:3], v[136:139], v[120:123], a[0:3]
  v_mfma_f32_16x16x32_bf16 a[40:43], v[136:139], v[124:127], a[40:43]
  v_mfma_f32_16x16x32_bf16 a[80:83], v[136:139], v[128:131], a[80:83]
  v_mfma_f32_16x16x32_bf16 a[120:123], v[136:139], v[132:135], a[120:123]
  s_waitcnt vmcnt(0) lgkmcnt(0)
  s_barrier
  v_mfma_f32_16x16x32_bf16 a[4:7], v[140:143], v[120:123], a[4:7]
  v_mfma_f32_16x16x32_bf16 a[44:47], v[140:143], v[124:127], a[44:47]
  v_mfma_f32_16x16x32_bf16 a[84:87], v[140:143], v[128:131], a[84:87]
  v_mfma_f32_16x16x32_bf16 a[124:127], v[140:143], v[132:135], a[124:127]
  v_mfma_f32_16x16x32_bf16 a[8:11], v[144:147], v[120:123], a[8:11]
  v_mfma_f32_16x16x32_bf16 a[48:51], v[144:147], v[124:127], a[48:51]
  v_mfma_f32_16x16x32_bf16 a[88:91], v[144:147], v[128:131], a[88:91]
  v_mfma_f32_16x16x32_bf16 a[128:131], v[144:147], v[132:135], a[128:131]
  v_mfma_f32_16x16x32_bf16 a[12:15], v[148:151], v[120:123], a[12:15]
  v_mfma_f32_16x16x32_bf16 a[52:55], v[148:151], v[124:127], a[52:55]
  v_mfma_f32_16x16x32_bf16 a[92:95], v[148:151], v[128:131], a[92:95]
  v_mfma_f32_16x16x32_bf16 a[132:135], v[148:151], v[132:135], a[132:135]
  v_mfma_f32_16x16x32_bf16 a[16:19], v[152:155], v[120:123], a[16:19]
  v_mfma_f32_16x16x32_bf16 a[56:59], v[152:155], v[124:127], a[56:59]
  v_mfma_f32_16x16x32_bf16 a[96:99], v[152:155], v[128:131], a[96:99]
  v_mfma_f32_16x16x32_bf16 a[136:139], v[152:155], v[132:135], a[136:139]
  v_mfma_f32_16x16x32_bf16 a[20:23], v[156:159], v[120:123], a[20:23]
  v_mfma_f32_16x16x32_bf16 a[60:63], v[156:159], v[124:127], a[60:63]
  v_mfma_f32_16x16x32_bf16 a[100:103], v[156:159], v[128:131], a[100:103]
  v_mfma_f32_16x16x32_bf16 a[140:143], v[156:159], v[132:135], a[140:143]
  v_mfma_f32_16x16x32_bf16 a[24:27], v[160:163], v[120:123], a[24:27]
  v_mfma_f32_16x16x32_bf16 a[64:67], v[160:163], v[124:127], a[64:67]
  v_mfma_f32_16x16x32_bf16 a[104:107], v[160:163], v[128:131], a[104:107]
  v_mfma_f32_16x16x32_bf16 a[144:147], v[160:163], v[132:135], a[144:147]
  v_mfma_f32_16x16x32_bf16 a[28:31], v[164:167], v[120:123], a[28:31]
  v_mfma_f32_16x16x32_bf16 a[68:71], v[164:167], v[124:127], a[68:71]
  v_mfma_f32_16x16x32_bf16 a[108:111], v[164:167], v[128:131], a[108:111]
  v_mfma_f32_16x16x32_bf16 a[148:151], v[164:167], v[132:135], a[148:151]
  v_mfma_f32_16x16x32_bf16 a[32:35], v[168:171], v[120:123], a[32:35]
  v_mfma_f32_16x16x32_bf16 a[72:75], v[168:171], v[124:127], a[72:75]
  v_mfma_f32_16x16x32_bf16 a[112:115], v[168:171], v[128:131], a[112:115]
  v_mfma_f32_16x16x32_bf16 a[152:155], v[168:171], v[132:135], a[152:155]
  v_mfma_f32_16x16x32_bf16 a[36:39], v[172:175], v[120:123], a[36:39]
  v_mfma_f32_16x16x32_bf16 a[76:79], v[172:175], v[124:127], a[76:79]
  v_mfma_f32_16x16x32_bf16 a[116:119], v[172:175], v[128:131], a[116:119]
  v_mfma_f32_16x16x32_bf16 a[156:159], v[172:175], v[132:135], a[156:159]
  v_mfma_f32_16x16x32_bf16 a[160:163], v[252:255], v[120:123], a[160:163]
  v_mfma_f32_16x16x32_bf16 a[176:179], v[120:123], v[252:255], a[176:179]
  v_mfma_f32_16x16x32_bf16 a[164:167], v[252:255], v[124:127], a[164:167]
  v_mfma_f32_16x16x32_bf16 a[180:183], v[124:127], v[252:255], a[180:183]
  v_mfma_f32_16x16x32_bf16 a[168:171], v[252:255], v[128:131], a[168:171]
  v_mfma_f32_16x16x32_bf16 a[184:187], v[128:131], v[252:255], a[184:187]
  v_mfma_f32_16x16x32_bf16 a[172:175], v[252:255], v[132:135], a[172:175]
  v_mfma_f32_16x16x32_bf16 a[188:191], v[132:135], v[252:255], a[188:191]
  s_barrier
  s_branch L_main
L_jobG_out:
  s_and_b32 s60, s28, 3
  s_lshr_b32 s61, s28, 2
  v_mul_u32_u24 v236, 1280, v5
  v_lshlrev_b32 v237, 4, v4
  v_add_u32 v238, v236, v237
  v_lshlrev_b32 v237, 3, v4
  v_add_u32 v239, v236, v237
  s_add_u32 s64, s6, 61865984
  s_addc_u32 s65, s7, 0
  s_and_b32 s65, s65, 0xffff
  s_mov_b32 s66, 2621440
  s_mov_b32 s67, 0x20000
  s_mov_b32 s62, 1051011932
  s_lshl_b32 s31, s61, 3
  s_lshl_b32 s63, s30, 1
  s_add_u32 s31, s31, s63
  s_lshl_b32 s31, s31, 5
  s_lshl_b32 s63, s60, 3
  s_add_u32 s31, s31, s63
  s_mul_i32 s31, s31, 1280
  v_accvgpr_read_b32 v64, a0
  v_accvgpr_read_b32 v65, a1
  v_accvgpr_read_b32 v66, a2
  v_accvgpr_read_b32 v67, a3
  v_accvgpr_read_b32 v68, a4
  v_accvgpr_read_b32 v69, a5
  v_accvgpr_read_b32 v70, a6
  v_accvgpr_read_b32 v71, a7
  v_accvgpr_read_b32 v72, a8
  v_accvgpr_read_b32 v73, a9
  v_accvgpr_read_b32 v74, a10
  v_accvgpr_read_b32 v75, a11
  v_accvgpr_read_b32 v76, a12
  v_accvgpr_read_b32 v77, a13
  v_accvgpr_read_b32 v78, a14
  v_accvgpr_read_b32 v79, a15
  v_accvgpr_read_b32 v80, a16
  v_accvgpr_read_b32 v81, a17
  v_accvgpr_read_b32 v82, a18
  v_accvgpr_read_b32 v83, a19
  v_mul_f32 v64, s62, v64
  v_mul_f32 v65, s62, v65
  v_mul_f32 v66, s62, v66
  v_mul_f32 v67, s62, v67
  v_mul_f32 v68, s62, v68
  v_mul_f32 v69, s62, v69
  v_mul_f32 v70, s62, v70
  v_mul_f32 v71, s62, v71
  v_mul_f32 v72, s62, v72
  v_mul_f32 v73, s62, v73
  v_mul_f32 v74, s62, v74
  v_mul_f32 v75, s62, v75
  v_mul_f32 v76, s62, v76
  v_mul_f32 v77, s62, v77
  v_mul_f32 v78, s62, v78
  v_mul_f32 v79, s62, v79
  v_mul_f32 v80, s62, v80
  v_mul_f32 v81, s62, v81
  v_mul_f32 v82, s62, v82
  v_mul_f32 v83, s62, v83
  v_cvt_pk_bf16_f32 v84, v64, v65
  v_cvt_pk_bf16_f32 v85, v66, v67
  v_cvt_pk_bf16_f32 v86, v68, v69
  v_cvt_pk_bf16_f32 v87, v70, v71
  v_cvt_pk_bf16_f32 v88, v72, v73
  v_cvt_pk_bf16_f32 v89, v74, v75
  v_cvt_pk_bf16_f32 v90, v76, v77
  v_cvt_pk_bf16_f32 v91, v78, v79
  v_cvt_pk_bf16_f32 v92, v80, v81
  v_cvt_pk_bf16_f32 v93, v82, v83
  s_add_u32 s63, s31, 0
  buffer_store_dwordx4 v[84:87], v238, s[64:67], s63 offen offset:0 sc1
  buffer_store_dwordx4 v[88:91], v238, s[64:67], s63 offen offset:512 sc1
  buffer_store_dwordx2 v[92:93], v239, s[64:67], s63 offen offset:1024 sc1
  v_accvgpr_read_b32 v96, a20
  v_accvgpr_read_b32 v97, a21
  v_accvgpr_read_b32 v98, a22
  v_accvgpr_read_b32 v99, a23
  v_accvgpr_read_b32 v100, a24
  v_accvgpr_read_b32 v101, a25
  v_accvgpr_read_b32 v102, a26
  v_accvgpr_read_b32 v103, a27
  v_accvgpr_read_b32 v104, a28
  v_accvgpr_read_b32 v105, a29
  v_accvgpr_read_b32 v106, a30
  v_accvgpr_read_b32 v107, a31
  v_accvgpr_read_b32 v108, a32
  v_accvgpr_read_b32 v109, a33
  v_accvgpr_read_b32 v110, a34
  v_accvgpr_read_b32 v111, a35
  v_accvgpr_read_b32 v112, a36
  v_accvgpr_read_b32 v113, a37
  v_accvgpr_read_b32 v114, a38
  v_accvgpr_read_b32 v115, a39
  v_mul_f32 v96, s62, v96
  v_mul_f32 v97, s62, v97
  v_mul_f32 v98, s62, v98
  v_mul_f32 v99, s62, v99
  v_mul_f32 v100, s62, v100
  v_mul_f32 v101, s62, v101
  v_mul_f32 v102, s62, v102
  v_mul_f32 v103, s62, v103
  v_mul_f32 v104, s62, v104
  v_mul_f32 v105, s62, v105
  v_mul_f32 v106, s62, v106
  v_mul_f32 v107, s62, v107
  v_mul_f32 v108, s62, v108
  v_mul_f32 v109, s62, v109
  v_mul_f32 v110, s62, v110
  v_mul_f32 v111, s62, v111
  v_mul_f32 v112, s62, v112
  v_mul_f32 v113, s62, v113
  v_mul_f32 v114, s62, v114
  v_mul_f32 v115, s62, v115
  v_cvt_pk_bf16_f32 v116, v96, v97
  v_cvt_pk_bf16_f32 v117, v98, v99
  v_cvt_pk_bf16_f32 v118, v100, v101
  v_cvt_pk_bf16_f32 v119, v102, v103
  v_cvt_pk_bf16_f32 v120, v104, v105
  v_cvt_pk_bf16_f32 v121, v106, v107
  v_cvt_pk_bf16_f32 v122, v108, v109
  v_cvt_pk_bf16_f32 v123, v110, v111
  v_cvt_pk_bf16_f32 v124, v112, v113
  v_cvt_pk_bf16_f32 v125, v114, v115
  s_add_u32 s63, s31, 5120
  buffer_store_dwordx4 v[116:119], v238, s[64:67], s63 offen offset:0 sc1
  buffer_store_dwordx4 v[120:123], v238, s[64:67], s63 offen offset:512 sc1
  buffer_store_dwordx2 v[124:125], v239, s[64:67], s63 offen offset:1024 sc1
  v_accvgpr_read_b32 v128, a40
  v_accvgpr_read_b32 v129, a41
  v_accvgpr_read_b32 v130, a42
  v_accvgpr_read_b32 v131, a43
  v_accvgpr_read_b32 v132, a44
  v_accvgpr_read_b32 v133, a45
  v_accvgpr_read_b32 v134, a46
  v_accvgpr_read_b32 v135, a47
  v_accvgpr_read_b32 v136, a48
  v_accvgpr_read_b32 v137, a49
  v_accvgpr_read_b32 v138, a50
  v_accvgpr_read_b32 v139, a51
  v_accvgpr_read_b32 v140, a52
  v_accvgpr_read_b32 v141, a53
  v_accvgpr_read_b32 v142, a54
  v_accvgpr_read_b32 v143, a55
  v_accvgpr_read_b32 v144, a56
  v_accvgpr_read_b32 v145, a57
  v_accvgpr_read_b32 v146, a58
  v_accvgpr_read_b32 v147, a59
  v_mul_f32 v128, s62, v128
  v_mul_f32 v129, s62, v129
  v_mul_f32 v130, s62, v130
  v_mul_f32 v131, s62, v131
  v_mul_f32 v132, s62, v132
  v_mul_f32 v133, s62, v133
  v_mul_f32 v134, s62, v134
  v_mul_f32 v135, s62, v135
  v_mul_f32 v136, s62, v136
  v_mul_f32 v137, s62, v137
  v_mul_f32 v138, s62, v138
  v_mul_f32 v139, s62, v139
  v_mul_f32 v140, s62, v140
  v_mul_f32 v141, s62, v141
  v_mul_f32 v142, s62, v142
  v_mul_f32 v143, s62, v143
  v_mul_f32 v144, s62, v144
  v_mul_f32 v145, s62, v145
  v_mul_f32 v146, s62, v146
  v_mul_f32 v147, s62, v147
  v_cvt_pk_bf16_f32 v148, v128, v129
  v_cvt_pk_bf16_f32 v149, v130, v131
  v_cvt_pk_bf16_f32 v150, v132, v133
  v_cvt_pk_bf16_f32 v151, v134, v135
  v_cvt_pk_bf16_f32 v152, v136, v137
  v_cvt_pk_bf16_f32 v153, v138, v139
  v_cvt_pk_bf16_f32 v154, v140, v141
  v_cvt_pk_bf16_f32 v155, v142, v143
  v_cvt_pk_bf16_f32 v156, v144, v145
  v_cvt_pk_bf16_f32 v157, v146, v147
  s_add_u32 s63, s31, 0
  buffer_store_dwordx4 v[148:151], v238, s[64:67], s63 offen offset:256 sc1
  buffer_store_dwordx4 v[152:155], v238, s[64:67], s63 offen offset:768 sc1
  buffer_store_dwordx2 v[156:157], v239, s[64:67], s63 offen offset:1152 sc1
  v_accvgpr_read_b32 v64, a60
  v_accvgpr_read_b32 v65, a61
  v_accvgpr_read_b32 v66, a62
  v_accvgpr_read_b32 v67, a63
  v_accvgpr_read_b32 v68, a64
  v_accvgpr_read_b32 v69, a65
  v_accvgpr_read_b32 v70, a66
  v_accvgpr_read_b32 v71, a67
  v_accvgpr_read_b32 v72, a68
  v_accvgpr_read_b32 v73, a69
  v_accvgpr_read_b32 v74, a70
  v_accvgpr_read_b32 v75, a71
  v_accvgpr_read_b32 v76, a72
  v_accvgpr_read_b32 v77, a73
  v_accvgpr_read_b32 v78, a74
  v_accvgpr_read_b32 v79, a75
  v_accvgpr_read_b32 v80, a76
  v_accvgpr_read_b32 v81, a77
  v_accvgpr_read_b32 v82, a78
  v_accvgpr_read_b32 v83, a79
  v_mul_f32 v64, s62, v64
  v_mul_f32 v65, s62, v65
  v_mul_f32 v66, s62, v66
  v_mul_f32 v67, s62, v67
  v_mul_f32 v68, s62, v68
  v_mul_f32 v69, s62, v69
  v_mul_f32 v70, s62, v70
  v_mul_f32 v71, s62, v71
  v_mul_f32 v72, s62, v72
  v_mul_f32 v73, s62, v73
  v_mul_f32 v74, s62, v74
  v_mul_f32 v75, s62, v75
  v_mul_f32 v76, s62, v76
  v_mul_f32 v77, s62, v77
  v_mul_f32 v78, s62, v78
  v_mul_f32 v79, s62, v79
  v_mul_f32 v80, s62, v80
  v_mul_f32 v81, s62, v81
  v_mul_f32 v82, s62, v82
  v_mul_f32 v83, s62, v83
  v_cvt_pk_bf16_f32 v84, v64, v65
  v_cvt_pk_bf16_f32 v85, v66, v67
  v_cvt_pk_bf16_f32 v86, v68, v69
  v_cvt_pk_bf16_f32 v87, v70, v71
  v_cvt_pk_bf16_f32 v88, v72, v73
  v_cvt_pk_bf16_f32 v89, v74, v75
  v_cvt_pk_bf16_f32 v90, v76, v77
  v_cvt_pk_bf16_f32 v91, v78, v79
  v_cvt_pk_bf16_f32 v92, v80, v81
  v_cvt_pk_bf16_f32 v93, v82, v83
  s_add_u32 s63, s31, 5120
  buffer_store_dwordx4 v[84:87], v238, s[64:67], s63 offen offset:256 sc1
  buffer_store_dwordx4 v[88:91], v238, s[64:67], s63 offen offset:768 sc1
  buffer_store_dwordx2 v[92:93], v239, s[64:67], s63 offen offset:1152 sc1
  v_accvgpr_read_b32 v96, a80
  v_accvgpr_read_b32 v97, a81
  v_accvgpr_read_b32 v98, a82
  v_accvgpr_read_b32 v99, a83
  v_accvgpr_read_b32 v100, a84
  v_accvgpr_read_b32 v101, a85
  v_accvgpr_read_b32 v102, a86
  v_accvgpr_read_b32 v103, a87
  v_accvgpr_read_b32 v104, a88
  v_accvgpr_read_b32 v105, a89
  v_accvgpr_read_b32 v106, a90
  v_accvgpr_read_b32 v107, a91
  v_accvgpr_read_b32 v108, a92
  v_accvgpr_read_b32 v109, a93
  v_accvgpr_read_b32 v110, a94
  v_accvgpr_read_b32 v111, a95
  v_accvgpr_read_b32 v112, a96
  v_accvgpr_read_b32 v113, a97
  v_accvgpr_read_b32 v114, a98
  v_accvgpr_read_b32 v115, a99
  v_mul_f32 v96, s62, v96
  v_mul_f32 v97, s62, v97
  v_mul_f32 v98, s62, v98
  v_mul_f32 v99, s62, v99
  v_mul_f32 v100, s62, v100
  v_mul_f32 v101, s62, v101
  v_mul_f32 v102, s62, v102
  v_mul_f32 v103, s62, v103
  v_mul_f32 v104, s62, v104
  v_mul_f32 v105, s62, v105
  v_mul_f32 v106, s62, v106
  v_mul_f32 v107, s62, v107
  v_mul_f32 v108, s62, v108
  v_mul_f32 v109, s62, v109
  v_mul_f32 v110, s62, v110
  v_mul_f32 v111, s62, v111
  v_mul_f32 v112, s62, v112
  v_mul_f32 v113, s62, v113
  v_mul_f32 v114, s62, v114
  v_mul_f32 v115, s62, v115
  v_cvt_pk_bf16_f32 v116, v96, v97
  v_cvt_pk_bf16_f32 v117, v98, v99
  v_cvt_pk_bf16_f32 v118, v100, v101
  v_cvt_pk_bf16_f32 v119, v102, v103
  v_cvt_pk_bf16_f32 v120, v104, v105
  v_cvt_pk_bf16_f32 v121, v106, v107
  v_cvt_pk_bf16_f32 v122, v108, v109
  v_cvt_pk_bf16_f32 v123, v110, v111
  v_cvt_pk_bf16_f32 v124, v112, v113
  v_cvt_pk_bf16_f32 v125, v114, v115
  s_add_u32 s63, s31, 40960
  buffer_store_dwordx4 v[116:119], v238, s[64:67], s63 offen offset:0 sc1
  buffer_store_dwordx4 v[120:123], v238, s[64:67], s63 offen offset:512 sc1
  buffer_store_dwordx2 v[124:125], v239, s[64:67], s63 offen offset:1024 sc1
  v_accvgpr_read_b32 v128, a100
  v_accvgpr_read_b32 v129, a101
  v_accvgpr_read_b32 v130, a102
  v_accvgpr_read_b32 v131, a103
  v_accvgpr_read_b32 v132, a104
  v_accvgpr_read_b32 v133, a105
  v_accvgpr_read_b32 v134, a106
  v_accvgpr_read_b32 v135, a107
  v_accvgpr_read_b32 v136, a108
  v_accvgpr_read_b32 v137, a109
  v_accvgpr_read_b32 v138, a110
  v_accvgpr_read_b32 v139, a111
  v_accvgpr_read_b32 v140, a112
  v_accvgpr_read_b32 v141, a113
  v_accvgpr_read_b32 v142, a114
  v_accvgpr_read_b32 v143, a115
  v_accvgpr_read_b32 v144, a116
  v_accvgpr_read_b32 v145, a117
  v_accvgpr_read_b32 v146, a118
  v_accvgpr_read_b32 v147, a119
  v_mul_f32 v128, s62, v128
  v_mul_f32 v129, s62, v129
  v_mul_f32 v130, s62, v130
  v_mul_f32 v131, s62, v131
  v_mul_f32 v132, s62, v132
  v_mul_f32 v133, s62, v133
  v_mul_f32 v134, s62, v134
  v_mul_f32 v135, s62, v135
  v_mul_f32 v136, s62, v136
  v_mul_f32 v137, s62, v137
  v_mul_f32 v138, s62, v138
  v_mul_f32 v139, s62, v139
  v_mul_f32 v140, s62, v140
  v_mul_f32 v141, s62, v141
  v_mul_f32 v142, s62, v142
  v_mul_f32 v143, s62, v143
  v_mul_f32 v144, s62, v144
  v_mul_f32 v145, s62, v145
  v_mul_f32 v146, s62, v146
  v_mul_f32 v147, s62, v147
  v_cvt_pk_bf16_f32 v148, v128, v129
  v_cvt_pk_bf16_f32 v149, v130, v131
  v_cvt_pk_bf16_f32 v150, v132, v133
  v_cvt_pk_bf16_f32 v151, v134, v135
  v_cvt_pk_bf16_f32 v152, v136, v137
  v_cvt_pk_bf16_f32 v153, v138, v139
  v_cvt_pk_bf16_f32 v154, v140, v141
  v_cvt_pk_bf16_f32 v155, v142, v143
  v_cvt_pk_bf16_f32 v156, v144, v145
  v_cvt_pk_bf16_f32 v157, v146, v147
  s_add_u32 s63, s31, 46080
  buffer_store_dwordx4 v[148:151], v238, s[64:67], s63 offen offset:0 sc1
  buffer_store_dwordx4 v[152:155], v238, s[64:67], s63 offen offset:512 sc1
  buffer_store_dwordx2 v[156:157], v239, s[64:67], s63 offen offset:1024 sc1
  v_accvgpr_read_b32 v64, a120
  v_accvgpr_read_b32 v65, a121
  v_accvgpr_read_b32 v66, a122
  v_accvgpr_read_b32 v67, a123
  v_accvgpr_read_b32 v68, a124
  v_accvgpr_read_b32 v69, a125
  v_accvgpr_read_b32 v70, a126
  v_accvgpr_read_b32 v71, a127
  v_accvgpr_read_b32 v72, a128
  v_accvgpr_read_b32 v73, a129
  v_accvgpr_read_b32 v74, a130
  v_accvgpr_read_b32 v75, a131
  v_accvgpr_read_b32 v76, a132
  v_accvgpr_read_b32 v77, a133
  v_accvgpr_read_b32 v78, a134
  v_accvgpr_read_b32 v79, a135
  v_accvgpr_read_b32 v80, a136
  v_accvgpr_read_b32 v81, a137
  v_accvgpr_read_b32 v82, a138
  v_accvgpr_read_b32 v83, a139
  v_mul_f32 v64, s62, v64
  v_mul_f32 v65, s62, v65
  v_mul_f32 v66, s62, v66
  v_mul_f32 v67, s62, v67
  v_mul_f32 v68, s62, v68
  v_mul_f32 v69, s62, v69
  v_mul_f32 v70, s62, v70
  v_mul_f32 v71, s62, v71
  v_mul_f32 v72, s62, v72
  v_mul_f32 v73, s62, v73
  v_mul_f32 v74, s62, v74
  v_mul_f32 v75, s62, v75
  v_mul_f32 v76, s62, v76
  v_mul_f32 v77, s62, v77
  v_mul_f32 v78, s62, v78
  v_mul_f32 v79, s62, v79
  v_mul_f32 v80, s62, v80
  v_mul_f32 v81, s62, v81
  v_mul_f32 v82, s62, v82
  v_mul_f32 v83, s62, v83
  v_cvt_pk_bf16_f32 v84, v64, v65
  v_cvt_pk_bf16_f32 v85, v66, v67
  v_cvt_pk_bf16_f32 v86, v68, v69
  v_cvt_pk_bf16_f32 v87, v70, v71
  v_cvt_pk_bf16_f32 v88, v72, v73
  v_cvt_pk_bf16_f32 v89, v74, v75
  v_cvt_pk_bf16_f32 v90, v76, v77
  v_cvt_pk_bf16_f32 v91, v78, v79
  v_cvt_pk_bf16_f32 v92, v80, v81
  v_cvt_pk_bf16_f32 v93, v82, v83
  s_add_u32 s63, s31, 40960
  buffer_store_dwordx4 v[84:87], v238, s[64:67], s63 offen offset:256 sc1
  buffer_store_dwordx4 v[88:91], v238, s[64:67], s63 offen offset:768 sc1
  buffer_store_dwordx2 v[92:93], v239, s[64:67], s63 offen offset:1152 sc1
  v_accvgpr_read_b32 v96, a140
  v_accvgpr_read_b32 v97, a141
  v_accvgpr_read_b32 v98, a142
  v_accvgpr_read_b32 v99, a143
  v_accvgpr_read_b32 v100, a144
  v_accvgpr_read_b32 v101, a145
  v_accvgpr_read_b32 v102, a146
  v_accvgpr_read_b32 v103, a147
  v_accvgpr_read_b32 v104, a148
  v_accvgpr_read_b32 v105, a149
  v_accvgpr_read_b32 v106, a150
  v_accvgpr_read_b32 v107, a151
  v_accvgpr_read_b32 v108, a152
  v_accvgpr_read_b32 v109, a153
  v_accvgpr_read_b32 v110, a154
  v_accvgpr_read_b32 v111, a155
  v_accvgpr_read_b32 v112, a156
  v_accvgpr_read_b32 v113, a157
  v_accvgpr_read_b32 v114, a158
  v_accvgpr_read_b32 v115, a159
  v_mul_f32 v96, s62, v96
  v_mul_f32 v97, s62, v97
  v_mul_f32 v98, s62, v98
  v_mul_f32 v99, s62, v99
  v_mul_f32 v100, s62, v100
  v_mul_f32 v101, s62, v101
  v_mul_f32 v102, s62, v102
  v_mul_f32 v103, s62, v103
  v_mul_f32 v104, s62, v104
  v_mul_f32 v105, s62, v105
  v_mul_f32 v106, s62, v106
  v_mul_f32 v107, s62, v107
  v_mul_f32 v108, s62, v108
  v_mul_f32 v109, s62, v109
  v_mul_f32 v110, s62, v110
  v_mul_f32 v111, s62, v111
  v_mul_f32 v112, s62, v112
  v_mul_f32 v113, s62, v113
  v_mul_f32 v114, s62, v114
  v_mul_f32 v115, s62, v115
  v_cvt_pk_bf16_f32 v116, v96, v97
  v_cvt_pk_bf16_f32 v117, v98, v99
  v_cvt_pk_bf16_f32 v118, v100, v101
  v_cvt_pk_bf16_f32 v119, v102, v103
  v_cvt_pk_bf16_f32 v120, v104, v105
  v_cvt_pk_bf16_f32 v121, v106, v107
  v_cvt_pk_bf16_f32 v122, v108, v109
  v_cvt_pk_bf16_f32 v123, v110, v111
  v_cvt_pk_bf16_f32 v124, v112, v113
  v_cvt_pk_bf16_f32 v125, v114, v115
  s_add_u32 s63, s31, 46080
  buffer_store_dwordx4 v[116:119], v238, s[64:67], s63 offen offset:256 sc1
  buffer_store_dwordx4 v[120:123], v238, s[64:67], s63 offen offset:768 sc1
  buffer_store_dwordx2 v[124:125], v239, s[64:67], s63 offen offset:1152 sc1
  s_add_u32 s64, s6, 65011712
  s_addc_u32 s65, s7, 0
  s_and_b32 s65, s65, 0xffff
  s_mov_b32 s66, 229376
  s_mov_b32 s67, 0x20000
  s_mul_i32 s61, s61, 28672
  s_mul_i32 s62, s30, 6144
  s_add_u32 s62, s62, s61
  s_add_u32 s63, s62, 3072
  v_mov_b32 v176, 0
  v_and_b32 v171, 1, v5
  v_lshrrev_b32 v172, 1, v5
  s_cmp_lt_u32 s60, 2
  s_cbranch_scc0 L_gV
  v_accvgpr_read_b32 v64, a160
  v_accvgpr_read_b32 v65, a161
  v_accvgpr_read_b32 v66, a162
  v_accvgpr_read_b32 v67, a163
  v_accvgpr_read_b32 v68, a164
  v_accvgpr_read_b32 v69, a165
  v_accvgpr_read_b32 v70, a166
  v_accvgpr_read_b32 v71, a167
  v_accvgpr_read_b32 v72, a168
  v_accvgpr_read_b32 v73, a169
  v_accvgpr_read_b32 v74, a170
  v_accvgpr_read_b32 v75, a171
  v_accvgpr_read_b32 v76, a172
  v_accvgpr_read_b32 v77, a173
  v_accvgpr_read_b32 v78, a174
  v_accvgpr_read_b32 v79, a175
  v_cvt_pk_bf16_f32 v240, v64, v65
  v_cvt_pk_bf16_f32 v241, v66, v67
  v_cvt_pk_bf16_f32 v242, v68, v69
  v_cvt_pk_bf16_f32 v243, v70, v71
  v_cvt_pk_bf16_f32 v244, v72, v73
  v_cvt_pk_bf16_f32 v245, v74, v75
  v_cvt_pk_bf16_f32 v246, v76, v77
  v_cvt_pk_bf16_f32 v247, v78, v79
  v_lshlrev_b32 v170, 9, v172
  v_lshlrev_b32 v173, 3, v171
  v_lshlrev_b32 v174, 4, v4
  v_add3_u32 v170, v170, v173, v174
  s_cmp_eq_u32 s60, 0
  s_cbranch_scc1 L_gK0
  v_cmp_eq_u32 vcc, 0, v5
  v_add_u32 v170, 512, v174
  s_lshl_b32 s62, s30, 10
  s_add_u32 s62, s62, s61
  v_cndmask_b32 v170, v170, v174, vcc
  s_add_u32 s62, s62, 24576
  s_add_u32 s63, s62, 8
  v_mov_b32 v174, 0x3f803f80
  v_mov_b32 v175, 0x00003f80
  v_cndmask_b32 v240, v174, v240, vcc
  v_cndmask_b32 v241, v175, v241, vcc
  v_cndmask_b32 v242, v174, v242, vcc
  v_cndmask_b32 v243, v175, v243, vcc
  v_cndmask_b32 v244, v174, v244, vcc
  v_cndmask_b32 v245, v175, v245, vcc
  v_cndmask_b32 v246, v174, v246, vcc
  v_cndmask_b32 v247, v175, v247, vcc
L_gK0:
  buffer_store_dwordx2 v[240:241], v170, s[64:67], s62 offen offset:0 sc1
  buffer_store_dwordx2 v[242:243], v170, s[64:67], s62 offen offset:256 sc1
  buffer_store_dwordx2 v[244:245], v170, s[64:67], s63 offen offset:0 sc1
  buffer_store_dwordx2 v[246:247], v170, s[64:67], s63 offen offset:256 sc1
  s_branch L_gdone
L_gV:
  v_accvgpr_read_b32 v64, a176
  v_accvgpr_read_b32 v65, a177
  v_accvgpr_read_b32 v66, a178
  v_accvgpr_read_b32 v67, a179
  v_accvgpr_read_b32 v68, a180
  v_accvgpr_read_b32 v69, a181
  v_accvgpr_read_b32 v70, a182
  v_accvgpr_read_b32 v71, a183
  v_accvgpr_read_b32 v72, a184
  v_accvgpr_read_b32 v73, a185
  v_accvgpr_read_b32 v74, a186
  v_accvgpr_read_b32 v75, a187
  v_accvgpr_read_b32 v76, a188
  v_accvgpr_read_b32 v77, a189
  v_accvgpr_read_b32 v78, a190
  v_accvgpr_read_b32 v79, a191
  v_cvt_pk_bf16_f32 v240, v64, v65
  v_cvt_pk_bf16_f32 v241, v66, v67
  v_cvt_pk_bf16_f32 v242, v68, v69
  v_cvt_pk_bf16_f32 v243, v70, v71
  v_cvt_pk_bf16_f32 v244, v72, v73
  v_cvt_pk_bf16_f32 v245, v74, v75
  v_cvt_pk_bf16_f32 v246, v76, v77
  v_cvt_pk_bf16_f32 v247, v78, v79
  v_lshlrev_b32 v171, 9, v171
  v_lshlrev_b32 v172, 3, v172
  v_add_u32 v171, v171, v172
  v_add_u32 v171, 1024, v171
  v_cmp_le_u32 vcc, 10, v4
  v_mov_b32 v188, 1
  s_nop 0
  v_cndmask_b32 v188, v176, v188, vcc
  v_mul_u32_u24 v189, 10, v188
  v_sub_u32 v189, v4, v189
  s_cmp_eq_u32 s60, 2
  s_cbranch_scc1 L_gV0
  v_subrev_u32 v168, 4, v4
  v_and_b32 v188, 1, v168
  v_lshrrev_b32 v189, 1, v168
  v_add_u32 v189, 10, v189
  v_cmp_eq_u32 vcc, 10, v189
  v_mov_b32 v174, 0x3f803f80
  s_nop 0
  v_cndmask_b32 v174, v176, v174, vcc
  v_cmp_gt_u32 vcc, 4, v4
  v_add_u32 v169, 6, v4
  v_mov_b32 v168, 1
  v_cndmask_b32 v188, v188, v168, vcc
  v_cndmask_b32 v189, v189, v169, vcc
  v_cndmask_b32 v240, v174, v240, vcc
  v_cndmask_b32 v241, v174, v241, vcc
  v_cndmask_b32 v242, v174, v242, vcc
  v_cndmask_b32 v243, v174, v243, vcc
  v_cndmask_b32 v244, v174, v244, vcc
  v_cndmask_b32 v245, v174, v245, vcc
  v_cndmask_b32 v246, v174, v246, vcc
  v_cndmask_b32 v247, v174, v247, vcc
L_gV0:
  v_lshrrev_b32 v177, 2, v189
  v_lshlrev_b32 v177, 3, v177
  v_and_b32 v178, 3, v189
  v_lshlrev_b32 v179, 2, v188
  v_add3_u32 v177, v177, v178, v179
  v_lshlrev_b32 v177, 4, v177
  v_add_u32 v170, v177, v171
  buffer_store_dwordx2 v[240:241], v170, s[64:67], s62 offen offset:0 sc1
  buffer_store_dwordx2 v[242:243], v170, s[64:67], s62 offen offset:1024 sc1
  buffer_store_dwordx2 v[244:245], v170, s[64:67], s63 offen offset:0 sc1
  buffer_store_dwordx2 v[246:247], v170, s[64:67], s63 offen offset:1024 sc1
L_gdone:
  s_branch L_jobG_ret
L_gspin:
  s_mov_b32 s34, 262144
  v_mov_b32 v7, 0
L_gspinl:
  global_load_dword v6, v7, s[4:5] sc1
  s_waitcnt vmcnt(0)
  v_readfirstlane_b32 s100, v6
  s_sub_u32 s34, s34, 1
  s_cselect_b32 s100, 8, s100
  s_cmp_eq_u32 s100, 0
  s_cbranch_scc1 L_gspinl
  s_branch L_gok
L_first6:
  s_waitcnt vmcnt(45)
  s_barrier
  s_cmp_eq_u32 s30, 0
  s_cselect_b32 s46, 1, 0
  s_branch L_first
L_p0pub:
  s_mov_b32 s46, 0
  s_lshl_b32 s31, s28, 2
  s_add_u32 s31, s31, 28672
  v_mov_b32 v6, s100
  v_mov_b32 v7, 0
  s_mov_b64 exec, 1
  buffer_store_dword v6, v7, s[24:27], s31 offen offset:0 sc1
  s_mov_b64 exec, -1
  s_branch L_p1loop
L_end:
  s_endpgm
.section .rodata,"a"
.p2align 6
.amdhsa_kernel concat_heads__compressed_kv_cla__grouped_kv_mqa__prompt_kernel
  .amdhsa_next_free_vgpr 512
  .amdhsa_next_free_sgpr 102
  .amdhsa_accum_offset 256
  .amdhsa_group_segment_fixed_size 0
  .amdhsa_kernarg_size 112
  .amdhsa_user_sgpr_count 2
  .amdhsa_user_sgpr_kernarg_segment_ptr 1
  .amdhsa_system_sgpr_workgroup_id_x 1
.end_amdhsa_kernel
```
